```python
import torch

def _softmax(x, axis=-1):
    return torch.softmax(x, dim=axis)
def _gelu(x):
    return torch.nn.functional.gelu(x, approximate="tanh")
def _silu(x):
    return torch.nn.functional.silu(x)
def _sigmoid(x):
    return torch.sigmoid(x)
def _layernorm(x, axis=-1, eps=1e-5):
    m = x.mean(dim=axis, keepdim=True)
    v = x.var(dim=axis, keepdim=True, unbiased=False)
    return (x - m) / torch.sqrt(v + eps)
def _scatter_add(tgt, idx, src, axis=0):
    return tgt.clone().index_add_(axis, idx, src)
def _segment_sum(src, seg, n):
    out = torch.zeros((n,) + src.shape[1:], dtype=src.dtype)
    return out.index_add_(0, seg, src)
def _pad(x, pw):
    flat = tuple(v for pair in reversed(pw) for v in pair)
    return torch.nn.functional.pad(x, flat)

kernel_name = 'interleave_layers__sliding_block_cached__gqa_block_cached__decode'

def setup_inputs():

    _w = (lambda a: (lambda t: t.to(torch.bfloat16) if t.is_floating_point() else t)(torch.as_tensor(a)))
    def _A_setup():
        B, Sq, D = 2, 1, 640
        Hq, Hkv, Sk, Dh = 32, 32, 4096, 192
        assert Hq % Hkv == 0, (Hq, Hkv)
        return {
            "x": _w((lambda *s: torch.randn(*s, dtype=torch.bfloat16) * 0.1)(B, Sq, D)),
            "k_cache": _w((lambda *s: torch.randn(*s, dtype=torch.bfloat16) * 0.8)(B, Hkv, Sk, Dh)),
            "v_cache": _w((lambda *s: torch.randn(*s, dtype=torch.bfloat16) * 3.2)(B, Hkv, Sk, Dh)),
            "wq": _w((lambda *s: torch.randn(*s, dtype=torch.bfloat16) * 0.8)(D, Hq * Dh) * (D ** -0.5)),
            "wo": _w((lambda *s: torch.randn(*s, dtype=torch.bfloat16) * 3.2)(Hq * Dh, D) * ((Hq * Dh) ** -0.5)),
        }
    _A_in = _A_setup()

    def _B_setup():
        B, Sq, D = 2, 1, 640
        Hq, Hkv, Sk, Dh = 32, 32, 4096, 192
        assert Hq % Hkv == 0, (Hq, Hkv)
        return {
            "x": _w((lambda *s: torch.randn(*s, dtype=torch.bfloat16) * 0.1)(B, Sq, D)),
            "k_cache": _w((lambda *s: torch.randn(*s, dtype=torch.bfloat16) * 1.6)(B, Hkv, Sk, Dh)),
            "v_cache": _w((lambda *s: torch.randn(*s, dtype=torch.bfloat16) * 1.6)(B, Hkv, Sk, Dh)),
            "wq": _w((lambda *s: torch.randn(*s, dtype=torch.bfloat16) * 1.6)(D, Hq * Dh) * (D ** -0.5)),
            "wo": _w((lambda *s: torch.randn(*s, dtype=torch.bfloat16) * 1.6)(Hq * Dh, D) * ((Hq * Dh) ** -0.5)),
        }
    _B_in = _B_setup()

    return {
        "A_x": _A_in["x"],
        "A_k_cache": _A_in["k_cache"],
        "A_v_cache": _A_in["v_cache"],
        "A_wq": _A_in["wq"],
        "A_wo": _A_in["wo"],
        "B_x": _B_in["x"],
        "B_k_cache": _B_in["k_cache"],
        "B_v_cache": _B_in["v_cache"],
        "B_wq": _B_in["wq"],
        "B_wo": _B_in["wo"],
    }

def reference(A_x, A_k_cache, A_v_cache, A_wq, A_wo, B_x, B_k_cache, B_v_cache, B_wq, B_wo):
    def _A_ref(x, k_cache, v_cache, wq, wo):
        B, Sq, D = x.shape
        Hq, Dh = 32, 192
        Hkv, Sk = k_cache.shape[1], k_cache.shape[2]
        W = min(4096, max(256, Sk // 4))
        rep = Hq // Hkv
        q = (lambda x, *d: x.permute(*d))((x @ wq).reshape(B, Sq, Hq, Dh), 0, 2, 1, 3)
        k = (lambda x, n, axis: torch.repeat_interleave(x, n, dim=axis))(k_cache[:, :, Sk - W:, :], rep, axis=1)
        v = (lambda x, n, axis: torch.repeat_interleave(x, n, dim=axis))(v_cache[:, :, Sk - W:, :], rep, axis=1)
        scores = torch.einsum("bhqd,bhkd->bhqk", q, k) * (Dh ** -0.5)
        p = _softmax(scores, axis=-1)
        o = torch.einsum("bhqk,bhkd->bhqd", p, v)
        return (lambda x, *d: x.permute(*d))(o, 0, 2, 1, 3).reshape(B, Sq, Hq * Dh) @ wo

    def _B_ref(x, k_cache, v_cache, wq, wo):
        B, Sq, D = x.shape
        Hq, Dh = 32, 192
        Hkv = k_cache.shape[1]
        rep = Hq // Hkv
        q = (lambda x, *d: x.permute(*d))((x @ wq).reshape(B, Sq, Hq, Dh), 0, 2, 1, 3)
        k = (lambda x, n, axis: torch.repeat_interleave(x, n, dim=axis))(k_cache, rep, axis=1)
        v = (lambda x, n, axis: torch.repeat_interleave(x, n, dim=axis))(v_cache, rep, axis=1)
        scores = torch.einsum("bhqd,bhkd->bhqk", q, k) * (Dh ** -0.5)
        p = _softmax(scores, axis=-1)
        o = torch.einsum("bhqk,bhkd->bhqd", p, v)
        return (lambda x, *d: x.permute(*d))(o, 0, 2, 1, 3).reshape(B, Sq, Hq * Dh) @ wo

    x = A_x
    x = x + _A_ref(_layernorm(x, axis=-1), A_k_cache, A_v_cache, A_wq, A_wo)
    x = x + _B_ref(_layernorm(x, axis=-1), B_k_cache, B_v_cache, B_wq, B_wo)
    x = x + _A_ref(_layernorm(x, axis=-1), A_k_cache, A_v_cache, A_wq, A_wo)
    x = x + _B_ref(_layernorm(x, axis=-1), B_k_cache, B_v_cache, B_wq, B_wo)
    return x
```

```asm
; @launch grid=(256,1,1) block=(256,1,1) lds=163840
.amdgcn_target "amdgcn-amd-amdhsa--gfx950"
.text
.globl interleave_layers__sliding_block_cached__gqa_block_cached__decode_kernel
.p2align 8
.type interleave_layers__sliding_block_cached__gqa_block_cached__decode_kernel,@function
interleave_layers__sliding_block_cached__gqa_block_cached__decode_kernel:
  s_cmp_ge_u32 s2, 256
  s_cbranch_scc1 L_end
  s_load_dwordx16 s[4:19], s[0:1], 0
  s_load_dwordx8 s[20:27], s[0:1], 64
  s_load_dwordx2 s[28:29], s[0:1], 96
  v_lshrrev_b32 v1, 6, v0
  v_lshlrev_b32 v6, 4, v0
  v_readfirstlane_b32 s3, v1
  v_and_b32 v0, 63, v0
  s_getpc_b64 s[98:99]
L_pw_1:
  s_sub_u32 s98, s98, L_pw_1-interleave_layers__sliding_block_cached__gqa_block_cached__decode_kernel
  s_subb_u32 s99, s99, 0
  s_lshr_b32 s91, s2, 3
  s_lshl_b32 s91, s91, 2
  s_add_u32 s91, s91, s3
  s_lshl_b32 s91, s91, 9
  v_lshl_add_u32 v73, v0, 7, s91
  v_min_u32 v73, L_cold-interleave_layers__sliding_block_cached__gqa_block_cached__decode_kernel-4, v73
  s_mov_b64 exec, 0xf
  global_load_dword v8, v73, s[98:99]
  s_mov_b64 exec, -1
  s_and_b32 s30, s2, 7
  s_lshl_b32 s30, s30, 2
  s_lshr_b32 s76, s2, 6
  s_add_u32 s30, s30, s76
  s_bfe_u32 s31, s2, 0x30003
  v_lshrrev_b32 v26, 3, v0
  v_and_b32 v27, 7, v0
  v_mul_u32_u24 v1, 384, v26
  v_lshl_add_u32 v1, v27, 4, v1
  s_mul_i32 s91, s30, 1572864
  s_lshl_b32 s92, s31, 2
  s_add_u32 s92, s92, s3
  s_mul_i32 s94, s92, 3072
  s_add_u32 s94, s94, s91
  s_add_u32 s93, s94, 1179648
  s_mov_b32 s35, 0x20000
  s_sub_u32 s34, 100663296, s93
  s_waitcnt lgkmcnt(0)
  s_load_dword s72, s[28:29], 0
  s_add_u32 s32, s6, s93
  s_addc_u32 s33, s7, 0
  s_mov_b32 s76, 0
  buffer_load_dwordx4 v[76:79], v1, s[32:35], s76 offen offset:0 nt
  buffer_load_dwordx4 v[80:83], v1, s[32:35], s76 offen offset:128 nt
  buffer_load_dwordx4 v[84:87], v1, s[32:35], s76 offen offset:256 nt
  s_lshl_b32 s27, s3, 10
  s_mul_i32 s95, s31, 983040
  s_mul_i32 s96, s30, 384
  s_add_u32 s95, s95, s96
  s_mul_i32 s96, s30, 245760
  s_mul_i32 s97, s31, 160
  s_add_u32 s96, s96, s97
  s_add_u32 s48, s10, s95
  s_addc_u32 s49, s11, 0
  s_sub_u32 s50, 7864320, s95
  s_mov_b32 s51, 0x20000
  v_lshrrev_b32 v71, 3, v0
  v_bfe_u32 v72, v0, 4, 2
  v_lshlrev_b32 v72, 1, v72
  v_and_b32 v73, 7, v0
  v_xor_b32 v72, v72, v73
  v_mul_u32_u24 v71, 12288, v71
  v_lshl_add_u32 v71, v72, 4, v71
  s_add_u32 s91, s3, 0
  s_mul_i32 s92, s91, 11
  s_lshr_b32 s92, s92, 5
  s_mul_i32 s78, s92, 97920
  s_lshl_b32 s92, s91, 7
  s_add_u32 s78, s78, s92
  s_add_u32 s91, s3, 4
  s_mul_i32 s92, s91, 11
  s_lshr_b32 s92, s92, 5
  s_mul_i32 s79, s92, 97920
  s_lshl_b32 s92, s91, 7
  s_add_u32 s79, s79, s92
  s_add_u32 s91, s3, 8
  s_mul_i32 s92, s91, 11
  s_lshr_b32 s92, s92, 5
  s_mul_i32 s80, s92, 97920
  s_lshl_b32 s92, s91, 7
  s_add_u32 s80, s80, s92
  s_add_u32 s81, s78, 393216
  s_add_u32 s82, s79, 393216
  s_add_u32 s83, s80, 393216
  s_add_u32 s84, s81, 393216
  s_add_u32 s85, s82, 393216
  s_add_u32 m0, s27, 32768
  s_nop 0
  buffer_load_dwordx4 v71, s[48:51], s78 offen nt lds
  s_add_u32 m0, s27, 36864
  s_nop 0
  buffer_load_dwordx4 v71, s[48:51], s79 offen nt lds
  s_add_u32 m0, s27, 40960
  s_nop 0
  buffer_load_dwordx4 v71, s[48:51], s80 offen nt lds
  s_add_u32 m0, s27, 45056
  s_nop 0
  buffer_load_dwordx4 v71, s[48:51], s81 offen nt lds
  s_add_u32 m0, s27, 49152
  s_nop 0
  buffer_load_dwordx4 v71, s[48:51], s82 offen nt lds
  s_add_u32 m0, s27, 53248
  s_nop 0
  buffer_load_dwordx4 v71, s[48:51], s83 offen nt lds
  s_add_u32 m0, s27, 57344
  s_nop 0
  buffer_load_dwordx4 v71, s[48:51], s84 offen nt lds
  s_cmp_ge_u32 s3, 2
  s_cbranch_scc1 L_wqskip_2
  s_add_u32 m0, s27, 61440
  s_nop 0
  buffer_load_dwordx4 v71, s[48:51], s85 offen nt lds
L_wqskip_2:
  s_add_u32 s60, s22, s96
  s_addc_u32 s61, s23, 0
  s_sub_u32 s62, 7864320, s96
  s_mov_b32 s63, 0x20000
  s_mov_b32 s22, 98304
  buffer_load_dwordx4 v[88:91], v1, s[32:35], s22 offen offset:0 nt
  buffer_load_dwordx4 v[92:95], v1, s[32:35], s22 offen offset:128 nt
  buffer_load_dwordx4 v[96:99], v1, s[32:35], s22 offen offset:256 nt
  s_getreg_b32 s90, hwreg(HW_REG_XCC_ID, 0, 4)
  s_mov_b32 s74, 0
  s_mov_b32 s75, 0x40000
  s_add_u32 s36, s8, s93
  s_addc_u32 s37, s9, 0
  s_sub_u32 s38, 100663296, s93
  s_mov_b32 s39, 0x20000
  s_add_u32 s56, s12, s96
  s_addc_u32 s57, s13, 0
  s_sub_u32 s58, 7864320, s96
  s_mov_b32 s59, 0x20000
  s_add_u32 s52, s20, s95
  s_addc_u32 s53, s21, 0
  s_sub_u32 s54, 7864320, s95
  s_mov_b32 s55, 0x20000
  s_add_u32 s40, s16, s94
  s_addc_u32 s41, s17, 0
  s_sub_u32 s42, 100663296, s94
  s_mov_b32 s43, 0x20000
  s_add_u32 s44, s18, s94
  s_addc_u32 s45, s19, 0
  s_sub_u32 s46, 100663296, s94
  s_mov_b32 s47, 0x20000
  s_mov_b32 s64, s28
  s_mov_b32 s65, s29
  s_mov_b32 s66, 16777216
  s_mov_b32 s67, 0x20000
  s_mov_b32 s68, s4
  s_mov_b32 s69, s5
  s_mov_b32 s70, 2560
  s_mov_b32 s71, 0x20000
  v_lshrrev_b32 v27, 5, v0
  v_bfe_u32 v28, v0, 3, 1
  v_lshl_add_u32 v27, v27, 1, v28
  v_and_b32 v26, 7, v0
  s_lshl_b32 s91, s3, 4
  s_lshl_b32 s92, s3, 2
  s_add_u32 s92, s92, 64
  v_cmp_gt_u32 vcc, 4, v26
  v_add_u32 v28, s92, v27
  v_lshl_add_u32 v27, v26, 2, v27
  v_add_u32 v27, s91, v27
  v_cndmask_b32 v26, v28, v27, vcc
  v_lshlrev_b32 v24, 1, v26
  s_mul_i32 s76, s31, 160
  s_add_u32 s101, s76, 1280
  s_mov_b32 exec_lo, 0x1f1f1f1f
  s_mov_b32 exec_hi, 0x1f1f1f1f
  buffer_load_ushort v7, v24, s[68:71], s76 offen
  buffer_load_ushort v25, v24, s[68:71], s101 offen
  s_mov_b64 exec, -1
  s_getpc_b64 s[0:1]
L_pc0:
  s_add_u32 s14, s0, L_consume-L_pc0
  s_addc_u32 s15, s1, 0
  s_add_u32 s0, s0, L_S6-L_pc0
  s_addc_u32 s1, s1, 0
  s_mov_b32 s16, 6
  s_mov_b32 s20, -1
  s_mov_b32 s18, 117
  s_mov_b32 s19, 126
  s_min_u32 s17, s18, s19
  s_mov_b32 s77, 0
  v_and_b32 v26, 1, v0
  v_cmp_eq_u32 vcc, 1, v26
  v_mov_b32 v27, 0xffff
  v_mov_b32 v28, 0xffff0000
  v_cndmask_b32 v27, v27, v28, vcc
  v_bfe_u32 v26, v0, 1, 2
  v_cmp_eq_u32 vcc, 0, v26
  s_nop 1
  v_cndmask_b32 v2, 0, v27, vcc
  v_cmp_eq_u32 vcc, 1, v26
  s_nop 1
  v_cndmask_b32 v3, 0, v27, vcc
  v_cmp_eq_u32 vcc, 2, v26
  s_nop 1
  v_cndmask_b32 v4, 0, v27, vcc
  v_cmp_eq_u32 vcc, 3, v26
  s_nop 1
  v_cndmask_b32 v5, 0, v27, vcc
  s_mov_b32 s84, 0x42424242
  s_mov_b32 s85, s84
  s_mov_b32 s86, 0x24242424
  s_mov_b32 s87, s86
  s_mov_b32 s88, 0x18181818
  s_mov_b32 s89, s88
  v_mov_b32 v27, 0x3f803f80
  v_lshlrev_b32 v26, 2, v0
  s_mov_b32 exec_hi, 0xff
  v_add_u32 v26, 161216, v26
  ds_write_b32 v26, v27
  s_mov_b64 exec, -1
  s_lshl_b32 s76, s30, 2
  s_add_u32 s76, s76, s3
  s_lshl_b32 s101, s31, 8
  s_lshl_b32 s79, s76, 12
  s_add_u32 s79, s79, 8192
  s_add_u32 s78, s79, s101
  s_sub_u32 s79, s79, s27
  s_lshl_b32 s81, s76, 13
  s_add_u32 s81, s81, 1056768
  s_add_u32 s80, s81, s101
  s_sub_u32 s81, s81, s27
  s_lshl_b32 s76, s31, 2
  s_add_u32 s76, s76, s3
  s_mul_i32 s76, s76, 4096
  s_add_u32 s83, s76, 5251072
  s_mul_i32 s101, s30, 128
  s_add_u32 s82, s83, s101
  s_lshl_b32 s21, s3, 2
  s_add_u32 s21, s21, 161376
  s_waitcnt lgkmcnt(0)
  s_add_u32 s72, s72, 16
  s_lshl_b32 s91, s30, 7
  s_add_u32 s97, s91, 1024
  s_lshl_b32 s91, s31, 4
  s_add_u32 s91, s91, s97
  v_mov_b32 v30, s90
  v_mov_b32 v31, s72
  s_cmp_lg_u32 s3, 0
  s_cbranch_scc1 L_idp_3
  s_mov_b64 exec, 0x1
  buffer_store_dwordx2 v[30:31], off, s[64:67], s91 sc1
  s_mov_b64 exec, -1
L_idp_3:
  s_cmp_lt_u32 s16, s17
  s_cbranch_scc0 L_tg_4
  s_waitcnt vmcnt(10)
  s_swappc_b64 s[28:29], s[0:1]
L_tb_5:
  s_cmp_lg_u32 s77, 0
  s_cbranch_scc1 L_wz_6
  s_waitcnt vmcnt(8)
L_wb_7:
  s_cmp_lg_u32 s77, 0
  s_cbranch_scc1 L_wz_8
  s_waitcnt vmcnt(3)
L_wb_9:
  v_add_u32 v26, 160128, v24
  s_mov_b32 exec_lo, 0x1f1f1f1f
  s_mov_b32 exec_hi, 0x1f1f1f1f
  ds_write_b16 v26, v7
  ds_write_b16 v26, v25 offset:160
  s_mov_b64 exec, -1
  v_lshlrev_b32 v7, 16, v7
  v_lshlrev_b32 v25, 16, v25
  s_mov_b32 s77, 0
  s_add_u32 s73, s72, 0
  v_and_b32 v32, 7, v0
  v_lshlrev_b32 v32, 4, v32
  buffer_load_dwordx2 v[30:31], v32, s[64:67], s97 offen sc1
  s_cmp_lt_u32 s16, s17
  s_cbranch_scc0 L_tg_10
  s_swappc_b64 s[28:29], s[0:1]
L_tb_11:
  s_cmp_lt_u32 s16, s17
  s_cbranch_scc0 L_tg_12
  s_swappc_b64 s[28:29], s[0:1]
L_tb_13:
  s_cmp_lg_u32 s77, 0
  s_cbranch_scc1 L_wz_14
  s_waitcnt vmcnt(6)
L_wb_15:
L_chk_16:
  v_bitop3_b32 v75, v31, v31, s73 bitop3:0x7e
  v_cmp_ne_u32 vcc, 0, v75
  s_nop 0
  s_cbranch_vccnz L_retry_17
  s_cmp_lt_u32 s16, s17
  s_cbranch_scc0 L_tg_24
  s_swappc_b64 s[28:29], s[0:1]
L_tb_25:
  v_cmp_ne_u32 vcc, s90, v30
  s_nop 0
  s_cmp_eq_u64 vcc, 0
  s_cselect_b32 s74, 1, 0
  s_waitcnt lgkmcnt(0)
  s_barrier
  s_cmp_eq_u32 s74, 0
  s_cbranch_scc1 L_apart
  v_bfe_u32 v72, v0, 2, 3
  v_lshrrev_b32 v71, 5, v0
  v_mul_u32_u24 v71, 3072, v71
  v_lshl_add_u32 v71, v72, 7, v71
  v_and_b32 v73, 3, v0
  v_lshl_add_u32 v71, v73, 3, v71
  v_lshrrev_b32 v72, 1, v72
  s_mul_i32 s91, s3, 3
  s_add_u32 s91, s91, 0
  s_and_b32 s92, s91, 3
  s_lshr_b32 s91, s91, 2
  v_xor_b32 v73, s92, v72
  s_lshl_b32 s91, s91, 10
  s_add_u32 s91, s91, 32768
  v_lshl_add_u32 v73, v73, 5, v71
  v_add_u32 v42, s91, v73
  ds_read_b64_tr_b16 v[44:45], v42 offset:0
  ds_read_b64_tr_b16 v[46:47], v42 offset:6144
  ds_read_b64_tr_b16 v[48:49], v42 offset:12288
  ds_read_b64_tr_b16 v[50:51], v42 offset:18432
  ds_read_b64_tr_b16 v[52:53], v42 offset:24576
  s_mul_i32 s91, s3, 3
  s_add_u32 s91, s91, 1
  s_and_b32 s92, s91, 3
  s_lshr_b32 s91, s91, 2
  v_xor_b32 v73, s92, v72
  s_lshl_b32 s91, s91, 10
  s_add_u32 s91, s91, 32768
  v_lshl_add_u32 v73, v73, 5, v71
  v_add_u32 v43, s91, v73
  ds_read_b64_tr_b16 v[54:55], v43 offset:0
  ds_read_b64_tr_b16 v[56:57], v43 offset:6144
  ds_read_b64_tr_b16 v[58:59], v43 offset:12288
  ds_read_b64_tr_b16 v[60:61], v43 offset:18432
  ds_read_b64_tr_b16 v[62:63], v43 offset:24576
  s_mul_i32 s91, s3, 3
  s_add_u32 s91, s91, 2
  s_and_b32 s92, s91, 3
  s_lshr_b32 s91, s91, 2
  v_xor_b32 v73, s92, v72
  s_lshl_b32 s91, s91, 10
  s_add_u32 s91, s91, 32768
  v_lshl_add_u32 v73, v73, 5, v71
  v_add_u32 v42, s91, v73
  ds_read_b64_tr_b16 v[64:65], v42 offset:0
  ds_read_b64_tr_b16 v[66:67], v42 offset:6144
  ds_read_b64_tr_b16 v[68:69], v42 offset:12288
  ds_read_b64_tr_b16 v[70:71], v42 offset:18432
  ds_read_b64_tr_b16 v[72:73], v42 offset:24576
  v_mov_b32 v75, 160128
  v_mov_b32 v32, 161216
  s_mov_b32 vcc_lo, 0x00f000f0
  s_mov_b32 vcc_hi, 0x00f000f0
  v_cndmask_b32 v75, v75, v32, vcc
  v_lshrrev_b32 v32, 4, v0
  v_lshl_add_u32 v75, v32, 3, v75
  ds_read2_b64 v[34:37], v75 offset0:0 offset1:4
  ds_read2_b64 v[38:41], v75 offset0:8 offset1:12
  ds_read_b64 v[42:43], v75 offset:128
  s_add_u32 s73, s72, 0
  s_add_u32 s76, s80, 0
  s_mul_i32 s91, s31, 240
  s_sub_u32 s91, 2048, s91
  v_lshlrev_b32 v74, 4, v0
  v_add_u32 v32, 3840, v74
  s_nop 1
  v_mov_b32_dpp v74, v32 quad_perm:[0,1,2,3] row_mask:0x2 bank_mask:0xf
  v_writelane_b32 v74, s91, 32
  s_waitcnt lgkmcnt(0)
  v_mfma_f32_16x16x32_bf16 v[26:29], v[34:37], v[44:47], 0
  v_mfma_f32_16x16x32_bf16 v[30:33], v[34:37], v[54:57], 0
  v_mfma_f32_16x16x32_bf16 v[26:29], v[38:41], v[48:51], v[26:29]
  v_mfma_f32_16x16x32_bf16 v[30:33], v[38:41], v[58:61], v[30:33]
  v_mfma_f32_16x16x16_bf16 v[26:29], v[42:43], v[52:53], v[26:29]
  v_mfma_f32_16x16x16_bf16 v[30:33], v[42:43], v[62:63], v[30:33]
  v_mfma_f32_16x16x32_bf16 v[48:51], v[34:37], v[34:37], 0
  v_mfma_f32_16x16x32_bf16 v[44:47], v[34:37], v[64:67], 0
  v_mfma_f32_16x16x32_bf16 v[48:51], v[38:41], v[38:41], v[48:51]
  v_mfma_f32_16x16x32_bf16 v[44:47], v[38:41], v[68:71], v[44:47]
  v_mfma_f32_16x16x16_bf16 v[48:51], v[42:43], v[42:43], v[48:51]
  v_mfma_f32_16x16x16_bf16 v[44:47], v[42:43], v[72:73], v[44:47]
  s_cmp_lt_u32 s16, s17
  s_cbranch_scc0 L_tg_26
  s_swappc_b64 s[28:29], s[0:1]
L_tb_27:
  v_mov_b32 v29, s73
  v_mov_b32 v27, v30
  s_nop 2
  v_mov_b32 v28, v44
  v_mov_b32_dpp v26, v48 quad_perm:[0,1,2,3] row_mask:0x4 bank_mask:0xf
  v_mov_b32_dpp v27, v48 row_ror:12 row_mask:0x4 bank_mask:0xf
  s_mov_b32 exec_lo, -1
  s_mov_b32 exec_hi, 1
  buffer_store_dwordx4 v[26:29], v74, s[64:67], s76 offen
  s_mov_b64 exec, -1
  v_mul_u32_u24 v71, 26, v0
  v_lshrrev_b32 v71, 8, v71
  v_mul_u32_u24 v71, 1120, v71
  v_lshl_add_u32 v71, v0, 4, v71
  s_mul_i32 s76, s3, 7680
  s_mul_i32 s91, s3, 960
  s_mov_b32 exec_hi, 0xfffffff
  s_waitcnt vmcnt(10)
  s_add_u32 m0, s91, 94208
  s_nop 0
  buffer_load_dwordx4 v71, s[56:59], s76 offen nt lds
  s_waitcnt vmcnt(10)
  s_add_u32 m0, s91, 98048
  s_add_u32 s76, s76, 30720
  buffer_load_dwordx4 v71, s[56:59], s76 offen nt lds
  s_waitcnt vmcnt(10)
  s_add_u32 m0, s91, 101888
  s_add_u32 s76, s76, 30720
  buffer_load_dwordx4 v71, s[56:59], s76 offen nt lds
  s_waitcnt vmcnt(10)
  s_add_u32 m0, s91, 105728
  s_add_u32 s76, s76, 30720
  buffer_load_dwordx4 v71, s[56:59], s76 offen nt lds
  s_waitcnt vmcnt(10)
  s_add_u32 m0, s91, 109568
  s_add_u32 s76, s76, 30720
  buffer_load_dwordx4 v71, s[56:59], s76 offen nt lds
  s_waitcnt vmcnt(10)
  s_add_u32 m0, s91, 113408
  s_add_u32 s76, s76, 30720
  buffer_load_dwordx4 v71, s[56:59], s76 offen nt lds
  s_waitcnt vmcnt(10)
  s_add_u32 m0, s91, 117248
  s_add_u32 s76, s76, 30720
  buffer_load_dwordx4 v71, s[56:59], s76 offen nt lds
  s_waitcnt vmcnt(10)
  s_add_u32 m0, s91, 121088
  s_add_u32 s76, s76, 30720
  buffer_load_dwordx4 v71, s[56:59], s76 offen nt lds
  s_mov_b64 exec, -1
  s_cmp_lt_u32 s16, s17
  s_cbranch_scc0 L_tg_28
  s_waitcnt vmcnt(10)
  s_swappc_b64 s[28:29], s[0:1]
L_tb_29:
  s_mov_b32 s77, 0
  s_add_u32 s73, s72, 0
  v_and_b32 v59, 7, v0
  s_add_u32 s91, s27, 2048
  v_lshl_add_u32 v59, v59, 4, s91
  s_add_u32 s97, s81, 0
  s_add_u32 s100, s97, 4096
  buffer_load_dwordx4 v[34:37], v59, s[64:67], s97 offen nt
  buffer_load_dwordx4 v[26:29], v6, s[64:67], s97 offen offset:0 nt
  buffer_load_dwordx4 v[30:33], v6, s[64:67], s97 offen offset:1024 nt
  buffer_load_dwordx4 v[38:41], v6, s[64:67], s100 offen offset:0 nt
  buffer_load_dwordx4 v[42:45], v6, s[64:67], s100 offen offset:1024 nt
  s_cmp_lt_u32 s16, s17
  s_cbranch_scc0 L_tg_30
  s_waitcnt vmcnt(14)
  s_swappc_b64 s[28:29], s[0:1]
L_tb_31:
  s_cmp_lt_u32 s16, s17
  s_cbranch_scc0 L_tg_32
  s_waitcnt vmcnt(14)
  s_swappc_b64 s[28:29], s[0:1]
L_tb_33:
  v_and_b32 v58, 15, v0
  v_bfe_u32 v60, v0, 4, 1
  v_lshl_add_u32 v58, v60, 5, v58
  v_lshrrev_b32 v60, 5, v0
  v_lshl_add_u32 v58, v60, 4, v58
  s_mul_i32 s91, s3, 96
  s_add_u32 s91, s91, 160448
  v_lshl_add_u32 v58, v58, 1, s91
  v_lshrrev_b32 v61, 2, v6
  v_add_u32 v61, 161504, v61
  s_cmp_lg_u32 s77, 0
  s_cbranch_scc1 L_wz_34
  s_waitcnt vmcnt(6)
L_wb_35:
L_chk_36:
  v_bitop3_b32 v75, v37, v29, s73 bitop3:0x7e
  v_bitop3_b32 v75, v75, v33, s73 bitop3:0xf6
  v_bitop3_b32 v75, v75, v41, s73 bitop3:0xf6
  v_bitop3_b32 v75, v75, v45, s73 bitop3:0xf6
  v_cmp_ne_u32 vcc, 0, v75
  s_nop 0
  s_cbranch_vccnz L_retry_37
  v_pk_add_f32 v[26:27], v[26:27], v[30:31]
  v_add_f32 v28, v28, v32
  v_mov_b32 v29, v28
  v_add_f32_dpp v34, v34, v34 quad_perm:[1,0,3,2] row_mask:0xf bank_mask:0xf
  v_add_f32_dpp v35, v35, v35 quad_perm:[1,0,3,2] row_mask:0xf bank_mask:0xf
  v_permlane32_swap_b32 v26, v27
  v_permlane32_swap_b32 v28, v29
  v_add_f32_dpp v34, v34, v34 quad_perm:[2,3,0,1] row_mask:0xf bank_mask:0xf
  v_add_f32_dpp v35, v35, v35 quad_perm:[2,3,0,1] row_mask:0xf bank_mask:0xf
  v_add_f32 v26, v26, v27
  v_add_f32 v28, v28, v29
  v_add_f32_dpp v34, v34, v34 row_half_mirror row_mask:0xf bank_mask:0xf
  v_add_f32_dpp v35, v35, v35 row_half_mirror row_mask:0xf bank_mask:0xf
  v_permlane16_swap_b32 v26, v28
  v_mul_f32 v35, 0x3acccccd, v35
  v_mul_f32 v34, 0x3acccccd, v34
  v_add_f32 v62, v26, v28
  v_fma_f32 v34, -v35, v35, v34
  v_max_f32 v34, 0, v34
  v_add_f32 v34, 0x3727c5ac, v34
  v_rsq_f32 v34, v34
  v_pk_add_f32 v[38:39], v[38:39], v[42:43]
  v_add_f32 v40, v40, v44
  v_mov_b32 v41, v40
  v_permlane32_swap_b32 v38, v39
  s_nop 0
  v_permlane32_swap_b32 v40, v41
  v_add_f32 v38, v38, v39
  v_add_f32 v40, v40, v41
  s_nop 1
  v_permlane16_swap_b32 v38, v40
  v_add_f32 v60, v38, v40
  ds_write_b32 v61, v60
  v_fma_f32 v62, -v35, v60, v62
  s_mov_b32 exec_hi, 0xffff
  v_mul_f32 v62, v62, v34
  v_cvt_pk_bf16_f32 v62, v62, v62
  ds_write_b16 v58, v62
  s_mov_b64 exec, -1
  s_waitcnt lgkmcnt(0)
  s_barrier
L_nw_44:
  s_cmp_ge_u32 s16, 30
  s_cbranch_scc1 L_nx_45
  s_cmp_lt_u32 s16, s17
  s_cbranch_scc0 L_nd_46
  s_waitcnt vmcnt(9)
  s_swappc_b64 s[28:29], s[0:1]
  s_branch L_nw_44
L_nx_45:
  s_waitcnt vmcnt(6)
L_nq_47:
  v_and_b32 v66, 7, v0
  v_lshlrev_b32 v66, 4, v66
  v_add_u32 v66, 160448, v66
  ds_read_b128 v[26:29], v66 offset:0
  ds_read_b128 v[30:33], v66 offset:128
  ds_read_b128 v[34:37], v66 offset:256
  s_waitcnt lgkmcnt(0)
.balignl 8, 0xBF800000
  v_mfma_f32_4x4x4_16b_bf16 v[44:47], v[26:27], v[76:77], 0
  v_mfma_f32_4x4x4_16b_bf16 v[48:51], v[26:27], v[88:89], 0
  v_nop_e64
  v_mfma_f32_4x4x4_16b_bf16 v[44:47], v[28:29], v[78:79], v[44:47]
  v_mfma_f32_4x4x4_16b_bf16 v[48:51], v[28:29], v[90:91], v[48:51]
  v_nop_e64
  v_mfma_f32_4x4x4_16b_bf16 v[44:47], v[30:31], v[80:81], v[44:47]
  v_mfma_f32_4x4x4_16b_bf16 v[48:51], v[30:31], v[92:93], v[48:51]
  v_nop_e64
  v_mfma_f32_4x4x4_16b_bf16 v[44:47], v[32:33], v[82:83], v[44:47]
  v_mfma_f32_4x4x4_16b_bf16 v[48:51], v[32:33], v[94:95], v[48:51]
  v_nop_e64
  v_mfma_f32_4x4x4_16b_bf16 v[44:47], v[34:35], v[84:85], v[44:47]
  v_mfma_f32_4x4x4_16b_bf16 v[48:51], v[34:35], v[96:97], v[48:51]
  v_nop_e64
  v_mfma_f32_4x4x4_16b_bf16 v[44:47], v[36:37], v[86:87], v[44:47]
  v_mfma_f32_4x4x4_16b_bf16 v[48:51], v[36:37], v[98:99], v[48:51]
  v_mfma_f32_4x4x4_16b_bf16 v[52:55], v[26:27], v[100:101], 0
  v_mfma_f32_4x4x4_16b_bf16 v[56:59], v[26:27], v[112:113], 0
  v_nop_e64
  v_mfma_f32_4x4x4_16b_bf16 v[52:55], v[28:29], v[102:103], v[52:55]
  v_mov_b32_dpp v60, v44 quad_perm:[0,0,0,0] row_mask:0xf bank_mask:0xf
  v_mfma_f32_4x4x4_16b_bf16 v[56:59], v[28:29], v[114:115], v[56:59]
  v_mov_b32_dpp v61, v48 quad_perm:[0,0,0,0] row_mask:0xf bank_mask:0xf
  v_mfma_f32_4x4x4_16b_bf16 v[52:55], v[30:31], v[104:105], v[52:55]
  v_add_f32_dpp v60, v45, v60 quad_perm:[1,1,1,1] row_mask:0xf bank_mask:0xf
  v_mfma_f32_4x4x4_16b_bf16 v[56:59], v[30:31], v[116:117], v[56:59]
  v_add_f32_dpp v61, v49, v61 quad_perm:[1,1,1,1] row_mask:0xf bank_mask:0xf
  v_mfma_f32_4x4x4_16b_bf16 v[52:55], v[32:33], v[106:107], v[52:55]
  v_add_f32_dpp v60, v46, v60 quad_perm:[2,2,2,2] row_mask:0xf bank_mask:0xf
  v_mfma_f32_4x4x4_16b_bf16 v[56:59], v[32:33], v[118:119], v[56:59]
  v_add_f32_dpp v61, v50, v61 quad_perm:[2,2,2,2] row_mask:0xf bank_mask:0xf
  v_mfma_f32_4x4x4_16b_bf16 v[52:55], v[34:35], v[108:109], v[52:55]
  v_add_f32_dpp v38, v47, v60 quad_perm:[3,3,3,3] row_mask:0xf bank_mask:0xf
  v_mfma_f32_4x4x4_16b_bf16 v[56:59], v[34:35], v[120:121], v[56:59]
  v_add_f32_dpp v61, v51, v61 quad_perm:[3,3,3,3] row_mask:0xf bank_mask:0xf
  v_mfma_f32_4x4x4_16b_bf16 v[52:55], v[36:37], v[110:111], v[52:55]
  v_mfma_f32_4x4x4_16b_bf16 v[56:59], v[36:37], v[122:123], v[56:59]
  v_cndmask_b32 v38, v38, v61, s[84:85]
  s_nop 0
  s_nop 1
  v_mov_b32_dpp v62, v52 quad_perm:[0,0,0,0] row_mask:0xf bank_mask:0xf
  v_mov_b32_dpp v63, v56 quad_perm:[0,0,0,0] row_mask:0xf bank_mask:0xf
  v_nop_e64
  v_add_f32_dpp v62, v53, v62 quad_perm:[1,1,1,1] row_mask:0xf bank_mask:0xf
  v_add_f32_dpp v63, v57, v63 quad_perm:[1,1,1,1] row_mask:0xf bank_mask:0xf
  v_nop_e64
  v_add_f32_dpp v62, v54, v62 quad_perm:[2,2,2,2] row_mask:0xf bank_mask:0xf
  v_add_f32_dpp v63, v58, v63 quad_perm:[2,2,2,2] row_mask:0xf bank_mask:0xf
  v_nop_e64
  v_add_f32_dpp v62, v55, v62 quad_perm:[3,3,3,3] row_mask:0xf bank_mask:0xf
  v_add_f32_dpp v63, v59, v63 quad_perm:[3,3,3,3] row_mask:0xf bank_mask:0xf
  v_cndmask_b32 v38, v38, v62, s[86:87]
  v_cndmask_b32 v38, v38, v63, s[88:89]
  s_nop 0
  s_nop 0
  v_add_f32_dpp v38, v38, v38 row_half_mirror row_mask:0xf bank_mask:0xf
  s_nop 1
  v_max_f32_dpp v66, v38, v38 quad_perm:[1,0,3,2] row_mask:0xf bank_mask:0xf
  s_nop 1
  v_max_f32_dpp v66, v66, v66 quad_perm:[2,3,0,1] row_mask:0xf bank_mask:0xf
  s_nop 1
  v_max_f32_dpp v66, v66, v66 row_ror:8 row_mask:0xf bank_mask:0xf
  s_nop 1
  v_max_f32_dpp v66, v66, v66 row_bcast:15 row_mask:0xa bank_mask:0xf
  s_nop 1
  v_max_f32_dpp v66, v66, v66 row_bcast:31 row_mask:0xc bank_mask:0xf
  s_nop 0
  v_readlane_b32 s95, v66, 63
  v_mov_b32 v67, s21
  s_nop 0
  v_subrev_f32 v38, s95, v38
  v_mov_b32 v66, s95
  v_mul_f32 v38, 0x3dd53b95, v38
  ds_write_b32 v67, v66 offset:0
  v_exp_f32 v38, v38
  s_nop 1
  v_add_f32_dpp v68, v38, v38 quad_perm:[1,0,3,2] row_mask:0xf bank_mask:0xf
  v_cvt_pk_bf16_f32 v38, v38, v38
.balignl 8, 0xBF800000
  s_nop 0
  s_nop 0
  v_and_b32_dpp v46, v38, v2 quad_perm:[0,0,0,0] row_mask:0xf bank_mask:0xf
  v_and_b32_dpp v47, v38, v3 quad_perm:[0,0,0,0] row_mask:0xf bank_mask:0xf
  v_and_b32_dpp v48, v38, v4 quad_perm:[3,3,3,3] row_mask:0xf bank_mask:0xf
  v_and_b32_dpp v49, v38, v5 quad_perm:[3,3,3,3] row_mask:0xf bank_mask:0xf
  s_cmp_lt_u32 s16, s17
  s_cbranch_scc0 L_tg_48
  s_waitcnt vmcnt(9)
  s_swappc_b64 s[28:29], s[0:1]
L_tb_49:
.balignl 8, 0xBF800000
  v_mfma_f32_16x16x32_bf16 v[26:29], v[46:49], v[124:127], 0
  v_and_b32_dpp v50, v38, v2 quad_perm:[1,1,1,1] row_mask:0xf bank_mask:0xf
  v_and_b32_dpp v51, v38, v3 quad_perm:[1,1,1,1] row_mask:0xf bank_mask:0xf
  v_mfma_f32_16x16x32_bf16 v[30:33], v[46:49], v[128:131], 0
  v_and_b32_dpp v52, v38, v4 quad_perm:[2,2,2,2] row_mask:0xf bank_mask:0xf
  v_and_b32_dpp v53, v38, v5 quad_perm:[2,2,2,2] row_mask:0xf bank_mask:0xf
  v_mfma_f32_16x16x32_bf16 v[34:37], v[46:49], v[132:135], 0
  v_add_f32_dpp v68, v68, v68 quad_perm:[2,3,0,1] row_mask:0xf bank_mask:0xf
  v_mfma_f32_16x16x32_bf16 v[26:29], v[50:53], v[136:139], v[26:29]
  v_and_b32_dpp v46, v38, v2 quad_perm:[2,2,2,2] row_mask:0xf bank_mask:0xf
  v_and_b32_dpp v47, v38, v3 quad_perm:[2,2,2,2] row_mask:0xf bank_mask:0xf
  v_mfma_f32_16x16x32_bf16 v[30:33], v[50:53], v[140:143], v[30:33]
  v_and_b32_dpp v48, v38, v4 quad_perm:[1,1,1,1] row_mask:0xf bank_mask:0xf
  v_and_b32_dpp v49, v38, v5 quad_perm:[1,1,1,1] row_mask:0xf bank_mask:0xf
  v_mfma_f32_16x16x32_bf16 v[34:37], v[50:53], v[144:147], v[34:37]
  v_add_f32_dpp v68, v68, v68 row_ror:8 row_mask:0xf bank_mask:0xf
  v_mfma_f32_16x16x32_bf16 v[26:29], v[46:49], v[148:151], v[26:29]
  v_and_b32_dpp v50, v38, v2 quad_perm:[3,3,3,3] row_mask:0xf bank_mask:0xf
  v_and_b32_dpp v51, v38, v3 quad_perm:[3,3,3,3] row_mask:0xf bank_mask:0xf
  v_mfma_f32_16x16x32_bf16 v[30:33], v[46:49], v[152:155], v[30:33]
  v_and_b32_dpp v52, v38, v4 quad_perm:[0,0,0,0] row_mask:0xf bank_mask:0xf
  v_and_b32_dpp v53, v38, v5 quad_perm:[0,0,0,0] row_mask:0xf bank_mask:0xf
  v_mfma_f32_16x16x32_bf16 v[34:37], v[46:49], v[156:159], v[34:37]
  v_add_f32_dpp v68, v68, v68 row_bcast:15 row_mask:0xa bank_mask:0xf
  v_mfma_f32_16x16x32_bf16 v[26:29], v[50:53], v[160:163], v[26:29]
  v_mfma_f32_16x16x32_bf16 v[30:33], v[50:53], v[164:167], v[30:33]
  v_mfma_f32_16x16x32_bf16 v[34:37], v[50:53], v[168:171], v[34:37]
  v_add_f32_dpp v68, v68, v68 row_bcast:31 row_mask:0xc bank_mask:0xf
  s_nop 0
  v_readlane_b32 s96, v68, 63
  v_lshrrev_b32 v60, 4, v0
  v_and_b32 v59, 15, v0
  v_lshlrev_b32 v58, 10, v60
  v_lshl_add_u32 v58, v59, 4, v58
  s_lshl_b32 s91, s3, 8
  s_add_u32 s91, s91, 155648
  v_add_u32 v58, s91, v58
  v_add_u32 v59, 155648, v6
  v_mov_b32 v49, s96
  v_permlane32_swap_b32 v26, v27
  v_permlane32_swap_b32 v28, v29
  v_permlane32_swap_b32 v30, v31
  v_permlane32_swap_b32 v32, v33
  v_permlane32_swap_b32 v34, v35
  v_permlane32_swap_b32 v36, v37
  v_add_f32_dpp v46, v27, v26 row_ror:8 row_mask:0xf bank_mask:0x3
  v_add_f32_dpp v47, v31, v30 row_ror:8 row_mask:0xf bank_mask:0x3
  v_add_f32_dpp v48, v35, v34 row_ror:8 row_mask:0xf bank_mask:0x3
  v_add_f32_dpp v46, v28, v29 row_ror:8 row_mask:0xf bank_mask:0xc
  v_add_f32_dpp v47, v32, v33 row_ror:8 row_mask:0xf bank_mask:0xc
  v_add_f32_dpp v48, v36, v37 row_ror:8 row_mask:0xf bank_mask:0xc
  ds_write_b128 v59, v[46:49]
  v_lshlrev_b32 v60, 2, v60
  v_add_u32 v60, 161376, v60
  v_mov_b32 v62, 161376
  s_waitcnt lgkmcnt(0)
  s_barrier
  ds_read_b128 v[54:57], v62
  ds_read_b32 v62, v60
  ds_read_b128 v[50:53], v58
  s_add_u32 s73, s72, 0
  s_mul_i32 s91, s31, 240
  s_sub_u32 s91, 2048, s91
  v_lshlrev_b32 v59, 4, v0
  v_writelane_b32 v59, s91, 16
  v_mov_b32 v49, s73
  s_add_u32 s76, s78, 0
  s_cmp_lt_u32 s16, s17
  s_cbranch_scc0 L_tg_50
  s_waitcnt vmcnt(9)
  s_swappc_b64 s[28:29], s[0:1]
L_tb_51:
  s_waitcnt lgkmcnt(1)
  v_max3_f32 v54, v54, v55, v56
  v_max_f32 v54, v54, v57
  v_sub_f32 v62, v62, v54
  v_mul_f32 v62, 0x3dd53b95, v62
  v_exp_f32 v62, v62
  s_waitcnt lgkmcnt(0)
  v_pk_mul_f32 v[50:51], v[50:51], v[62:63] op_sel_hi:[1,0]
  v_pk_mul_f32 v[52:53], v[52:53], v[62:63] op_sel_hi:[1,0]
  s_nop 0
  v_permlane32_swap_b32 v50, v51
  v_permlane32_swap_b32 v52, v53
  v_add_f32 v50, v50, v51
  v_add_f32 v52, v52, v53
  s_nop 1
  v_permlane16_swap_b32 v50, v52
  v_add_f32 v46, v50, v52
  v_add_f32 v47, v50, v52
  s_nop 1
  v_permlane32_swap_b32 v46, v47
  v_mov_b32 v48, v46
  s_nop 1
  v_permlane16_swap_b32 v46, v48
  s_nop 1
  v_mov_b32_dpp v46, v54 quad_perm:[0,1,2,3] row_mask:0x2 bank_mask:0xf
  s_mov_b64 exec, 0x1ffff
  buffer_store_dwordx4 v[46:49], v59, s[64:67], s76 offen
  s_mov_b64 exec, -1
  v_lshrrev_b32 v71, 3, v0
  v_bfe_u32 v72, v0, 4, 2
  v_lshlrev_b32 v72, 1, v72
  v_and_b32 v73, 7, v0
  v_xor_b32 v72, v72, v73
  v_mul_u32_u24 v71, 12288, v71
  v_lshl_add_u32 v71, v72, 4, v71
  s_waitcnt vmcnt(10)
  s_add_u32 m0, s27, 63488
  s_add_u32 s91, s3, 0
  s_mul_i32 s92, s91, 11
  s_lshr_b32 s92, s92, 5
  s_mul_i32 s76, s92, 97920
  s_lshl_b32 s92, s91, 7
  s_add_u32 s76, s76, s92
  buffer_load_dwordx4 v71, s[52:55], s76 offen nt lds
  s_waitcnt vmcnt(10)
  s_add_u32 m0, s27, 67584
  s_add_u32 s91, s3, 4
  s_mul_i32 s92, s91, 11
  s_lshr_b32 s92, s92, 5
  s_mul_i32 s76, s92, 97920
  s_lshl_b32 s92, s91, 7
  s_add_u32 s76, s76, s92
  buffer_load_dwordx4 v71, s[52:55], s76 offen nt lds
  s_waitcnt vmcnt(10)
  s_add_u32 m0, s27, 71680
  s_add_u32 s91, s3, 8
  s_mul_i32 s92, s91, 11
  s_lshr_b32 s92, s92, 5
  s_mul_i32 s76, s92, 97920
  s_lshl_b32 s92, s91, 7
  s_add_u32 s76, s76, s92
  buffer_load_dwordx4 v71, s[52:55], s76 offen nt lds
  s_waitcnt vmcnt(10)
  s_add_u32 m0, s27, 75776
  s_add_u32 s91, s3, 12
  s_mul_i32 s92, s91, 11
  s_lshr_b32 s92, s92, 5
  s_mul_i32 s76, s92, 97920
  s_lshl_b32 s92, s91, 7
  s_add_u32 s76, s76, s92
  buffer_load_dwordx4 v71, s[52:55], s76 offen nt lds
  s_waitcnt vmcnt(10)
  s_add_u32 m0, s27, 79872
  s_add_u32 s91, s3, 16
  s_mul_i32 s92, s91, 11
  s_lshr_b32 s92, s92, 5
  s_mul_i32 s76, s92, 97920
  s_lshl_b32 s92, s91, 7
  s_add_u32 s76, s76, s92
  buffer_load_dwordx4 v71, s[52:55], s76 offen nt lds
  s_waitcnt vmcnt(10)
  s_add_u32 m0, s27, 83968
  s_add_u32 s91, s3, 20
  s_mul_i32 s92, s91, 11
  s_lshr_b32 s92, s92, 5
  s_mul_i32 s76, s92, 97920
  s_lshl_b32 s92, s91, 7
  s_add_u32 s76, s76, s92
  buffer_load_dwordx4 v71, s[52:55], s76 offen nt lds
  s_waitcnt vmcnt(10)
  s_add_u32 m0, s27, 88064
  s_add_u32 s91, s3, 24
  s_mul_i32 s92, s91, 11
  s_lshr_b32 s92, s92, 5
  s_mul_i32 s76, s92, 97920
  s_lshl_b32 s92, s91, 7
  s_add_u32 s76, s76, s92
  buffer_load_dwordx4 v71, s[52:55], s76 offen nt lds
  s_waitcnt vmcnt(10)
  s_cmp_ge_u32 s3, 2
  s_cbranch_scc1 L_wqskip_52
  s_add_u32 m0, s27, 92160
  s_add_u32 s91, s3, 28
  s_mul_i32 s92, s91, 11
  s_lshr_b32 s92, s92, 5
  s_mul_i32 s76, s92, 97920
  s_lshl_b32 s92, s91, 7
  s_add_u32 s76, s76, s92
  buffer_load_dwordx4 v71, s[52:55], s76 offen nt lds
L_wqskip_52:
  s_cmp_lt_u32 s16, s17
  s_cbranch_scc0 L_tg_53
  s_waitcnt vmcnt(10)
  s_swappc_b64 s[28:29], s[0:1]
L_tb_54:
  s_mov_b32 s77, 0
  s_add_u32 s73, s72, 0
  v_lshrrev_b32 v45, 4, v0
  v_and_b32 v44, 1, v0
  v_lshl_add_u32 v45, v44, 2, v45
  s_add_u32 s91, s27, 2048
  v_lshl_add_u32 v45, v45, 4, s91
  s_add_u32 s97, s79, 0
  buffer_load_dwordx4 v[34:37], v45, s[64:67], s97 offen nt
  buffer_load_dwordx4 v[26:29], v6, s[64:67], s97 offen offset:0 nt
  buffer_load_dwordx4 v[30:33], v6, s[64:67], s97 offen offset:1024 nt
  s_cmp_lt_u32 s16, s17
  s_cbranch_scc0 L_tg_55
  s_waitcnt vmcnt(12)
  s_swappc_b64 s[28:29], s[0:1]
L_tb_56:
  s_cmp_lt_u32 s16, s17
  s_cbranch_scc0 L_tg_57
  s_waitcnt vmcnt(12)
  s_swappc_b64 s[28:29], s[0:1]
L_tb_58:
  v_lshrrev_b32 v46, 2, v0
  v_and_b32 v47, 3, v0
  v_mul_u32_u24 v46, 160, v46
  v_lshl_add_u32 v47, v47, 3, v46
  s_lshl_b32 s91, s3, 5
  s_add_u32 s91, s91, 94208
  v_add_u32 v46, s91, v47
  v_add_u32 v47, 94336, v47
  v_bfe_u32 v49, v0, 4, 1
  v_lshlrev_b32 v49, 8, v49
  v_lshrrev_b32 v48, 5, v0
  v_lshl_add_u32 v49, v48, 7, v49
  v_and_b32 v48, 7, v0
  v_lshl_add_u32 v49, v48, 4, v49
  v_bfe_u32 v48, v0, 3, 1
  v_lshl_add_u32 v49, v48, 2, v49
  s_and_b32 s91, s3, 1
  s_lshl_b32 s91, s91, 3
  s_and_b32 s92, s3, 2
  s_add_u32 s91, s91, s92
  s_add_u32 s91, s91, 159744
  v_add_u32 v49, s91, v49
  v_and_b32 v74, 0x30, v0
  s_lshl_b32 s91, s3, 4
  s_add_u32 s91, s91, 1
  v_writelane_b32 v74, 64, s91
  s_movk_i32 s91, 80
  v_writelane_b32 v74, s91, 2
  s_movk_i32 s91, 96
  v_writelane_b32 v74, s91, 3
  s_movk_i32 s91, 112
  v_writelane_b32 v74, s91, 4
  s_bfe_u32 s68, s73, 0x80000
  s_bfe_u32 s69, s73, 0x80008
  s_bfe_u32 s70, s73, 0x80010
  s_bfe_u32 s90, s73, 0x80018
  s_cmp_lg_u32 s77, 0
  s_cbranch_scc1 L_wz_59
  s_waitcnt vmcnt(6)
L_wb_60:
L_chk_61:
  v_bitop3_b32 v75, v37, v29, s73 bitop3:0x7e
  v_bitop3_b32 v75, v75, v33, s73 bitop3:0xf6
  v_cmp_ne_u32 vcc, 0, v75
  s_nop 0
  s_cbranch_vccnz L_retry_62
  v_max_f32_dpp v43, v34, v34 quad_perm:[1,0,3,2] row_mask:0xf bank_mask:0xf
  v_mov_b32 v42, v43
  ds_read_b64_tr_b16 v[50:51], v46 offset:0
  ds_read_b64_tr_b16 v[52:53], v46 offset:2560
  ds_read_b64_tr_b16 v[54:55], v47 offset:0
  ds_read_b64_tr_b16 v[56:57], v47 offset:2560
  v_permlane32_swap_b32 v43, v42
  v_max_f32 v43, v43, v42
  v_mov_b32 v42, v43
  ds_read_b64_tr_b16 v[58:59], v46 offset:5120
  ds_read_b64_tr_b16 v[60:61], v46 offset:7680
  ds_read_b64_tr_b16 v[62:63], v47 offset:5120
  ds_read_b64_tr_b16 v[64:65], v47 offset:7680
  v_permlane16_swap_b32 v43, v42
  v_max_f32 v43, v43, v42
  v_sub_f32 v43, v34, v43
  v_mul_f32 v43, 0x3dd53b95, v43
  v_exp_f32 v43, v43
  ds_read_b64_tr_b16 v[66:67], v46 offset:10240
  ds_read_b64_tr_b16 v[68:69], v46 offset:12800
  ds_read_b64_tr_b16 v[70:71], v47 offset:10240
  ds_read_b64_tr_b16 v[72:73], v47 offset:12800
  v_mul_f32 v35, v35, v43
  v_mul_f32_dpp v26, v43, v26 quad_perm:[0,0,2,2] row_mask:0xf bank_mask:0xf
  v_mul_f32_dpp v27, v43, v27 quad_perm:[0,0,2,2] row_mask:0xf bank_mask:0xf
  v_mul_f32_dpp v28, v43, v28 quad_perm:[0,0,2,2] row_mask:0xf bank_mask:0xf
  v_add_f32_dpp v29, v35, v35 quad_perm:[1,0,3,2] row_mask:0xf bank_mask:0xf
  v_fmac_f32_dpp v26, v43, v30 quad_perm:[1,1,3,3] row_mask:0xf bank_mask:0xf
  v_fmac_f32_dpp v27, v43, v31 quad_perm:[1,1,3,3] row_mask:0xf bank_mask:0xf
  v_fmac_f32_dpp v28, v43, v32 quad_perm:[1,1,3,3] row_mask:0xf bank_mask:0xf
  s_nop 0
  v_permlane32_swap_b32 v26, v27
  v_permlane32_swap_b32 v28, v29
  v_add_f32 v26, v26, v27
  v_add_f32 v28, v28, v29
  s_nop 1
  v_permlane16_swap_b32 v26, v28
  v_add_f32 v48, v26, v28
  v_lshrrev_b32 v45, 4, v0
  v_readlane_b32 s92, v48, 48
  v_lshlrev_b32 v45, 3, v45
  v_add_u32 v44, 159744, v45
  v_rcp_f32 v43, s92
  s_mov_b32 exec_hi, 0xffff
  v_mul_f32 v48, v48, v43
  v_cvt_pk_bf16_f32 v48, v48, v48
  ds_write_b16 v49, v48
  s_mov_b64 exec, -1
  s_waitcnt lgkmcnt(0)
  s_barrier
  ds_read2_b64 v[26:29], v44 offset0:0 offset1:4
  ds_read2_b64 v[30:33], v44 offset0:8 offset1:12
  ds_read2_b64 v[34:37], v44 offset0:16 offset1:20
  v_mov_b32 v48, v44
  s_add_u32 s76, s82, 0
  s_lshl_b32 s91, s3, 4
  s_lshl_b64 vcc, 2, s91
  s_or_b32 s91, vcc_lo, 0x1001d
  s_or_b32 s92, vcc_hi, 0x10001
  v_mov_b32 v49, 0xffffff00
  s_waitcnt lgkmcnt(2)
  v_mfma_f32_16x16x32_bf16 v[38:41], v[50:53], v[26:29], 0
  v_mfma_f32_16x16x32_bf16 v[42:45], v[54:57], v[26:29], 0
  ds_read2_b64 v[26:29], v48 offset0:24 offset1:28
  ds_read_b64_tr_b16 v[50:51], v46 offset:15360
  ds_read_b64_tr_b16 v[52:53], v46 offset:17920
  ds_read_b64_tr_b16 v[54:55], v47 offset:15360
  ds_read_b64_tr_b16 v[56:57], v47 offset:17920
  s_waitcnt lgkmcnt(6)
  v_mfma_f32_16x16x32_bf16 v[38:41], v[58:61], v[30:33], v[38:41]
  v_mfma_f32_16x16x32_bf16 v[42:45], v[62:65], v[30:33], v[42:45]
  ds_read2_b64 v[30:33], v48 offset0:32 offset1:36
  ds_read_b64_tr_b16 v[58:59], v46 offset:20480
  ds_read_b64_tr_b16 v[60:61], v46 offset:23040
  ds_read_b64_tr_b16 v[62:63], v47 offset:20480
  ds_read_b64_tr_b16 v[64:65], v47 offset:23040
  s_waitcnt lgkmcnt(10)
  v_mfma_f32_16x16x32_bf16 v[38:41], v[66:69], v[34:37], v[38:41]
  v_mfma_f32_16x16x32_bf16 v[42:45], v[70:73], v[34:37], v[42:45]
  ds_read2_b64 v[34:37], v48 offset0:40 offset1:44
  ds_read_b64_tr_b16 v[66:67], v46 offset:25600
  ds_read_b64_tr_b16 v[68:69], v46 offset:28160
  ds_read_b64_tr_b16 v[70:71], v47 offset:25600
  ds_read_b64_tr_b16 v[72:73], v47 offset:28160
  s_cmp_lt_u32 s16, s17
  s_cbranch_scc0 L_tg_69
  s_swappc_b64 s[28:29], s[0:1]
L_tb_70:
  s_waitcnt lgkmcnt(10)
  v_mfma_f32_16x16x32_bf16 v[38:41], v[50:53], v[26:29], v[38:41]
  v_mfma_f32_16x16x32_bf16 v[42:45], v[54:57], v[26:29], v[42:45]
  s_waitcnt lgkmcnt(5)
  v_mfma_f32_16x16x32_bf16 v[38:41], v[58:61], v[30:33], v[38:41]
  v_mfma_f32_16x16x32_bf16 v[42:45], v[62:65], v[30:33], v[42:45]
  s_waitcnt lgkmcnt(0)
  v_mfma_f32_16x16x32_bf16 v[38:41], v[66:69], v[34:37], v[38:41]
  v_mfma_f32_16x16x32_bf16 v[42:45], v[70:73], v[34:37], v[42:45]
  s_cmp_lt_u32 s16, s17
  s_cbranch_scc0 L_tg_71
  s_swappc_b64 s[28:29], s[0:1]
L_tb_72:
  s_nop 4
  v_cndmask_b32 v26, v38, v42, vcc
  v_cndmask_b32 v27, v39, v43, vcc
  v_cndmask_b32 v28, v40, v44, vcc
  v_cndmask_b32 v29, v41, v45, vcc
  s_mov_b32 exec_lo, s91
  s_mov_b32 exec_hi, s92
  v_and_or_b32 v26, v26, v49, s68
  v_and_or_b32 v27, v27, v49, s69
  v_and_or_b32 v28, v28, v49, s70
  v_and_or_b32 v29, v29, v49, s90
  buffer_store_dwordx4 v[26:29], v74, s[64:67], s76 offen sc1
  s_mov_b64 exec, -1
  v_mul_u32_u24 v71, 26, v0
  v_lshrrev_b32 v71, 8, v71
  v_mul_u32_u24 v71, 1120, v71
  v_lshl_add_u32 v71, v0, 4, v71
  s_mul_i32 s76, s3, 7680
  s_mul_i32 s91, s3, 960
  s_mov_b32 exec_hi, 0xfffffff
  s_waitcnt vmcnt(10)
  s_add_u32 m0, s91, 124928
  s_nop 0
  buffer_load_dwordx4 v71, s[60:63], s76 offen nt lds
  s_waitcnt vmcnt(10)
  s_add_u32 m0, s91, 128768
  s_add_u32 s76, s76, 30720
  buffer_load_dwordx4 v71, s[60:63], s76 offen nt lds
  s_waitcnt vmcnt(10)
  s_add_u32 m0, s91, 132608
  s_add_u32 s76, s76, 30720
  buffer_load_dwordx4 v71, s[60:63], s76 offen nt lds
  s_waitcnt vmcnt(10)
  s_add_u32 m0, s91, 136448
  s_add_u32 s76, s76, 30720
  buffer_load_dwordx4 v71, s[60:63], s76 offen nt lds
  s_waitcnt vmcnt(10)
  s_add_u32 m0, s91, 140288
  s_add_u32 s76, s76, 30720
  buffer_load_dwordx4 v71, s[60:63], s76 offen nt lds
  s_waitcnt vmcnt(10)
  s_add_u32 m0, s91, 144128
  s_add_u32 s76, s76, 30720
  buffer_load_dwordx4 v71, s[60:63], s76 offen nt lds
  s_waitcnt vmcnt(10)
  s_add_u32 m0, s91, 147968
  s_add_u32 s76, s76, 30720
  buffer_load_dwordx4 v71, s[60:63], s76 offen nt lds
  s_waitcnt vmcnt(10)
  s_add_u32 m0, s91, 151808
  s_add_u32 s76, s76, 30720
  buffer_load_dwordx4 v71, s[60:63], s76 offen nt lds
  s_mov_b64 exec, -1
  s_mov_b64 exec, 0x1
  s_mov_b32 s22, 50331648
  buffer_load_dword v50, off, s[32:35], s22 nt
  s_mov_b32 s22, 50331648
  buffer_load_dword v51, off, s[36:39], s22 nt
  s_mov_b32 s22, 50331648
  buffer_load_dword v52, off, s[40:43], s22 nt
  s_mov_b32 s22, 50331648
  buffer_load_dword v53, off, s[44:47], s22 nt
  s_mov_b32 s22, 51806208
  buffer_load_dword v54, off, s[40:43], s22 nt
  s_mov_b32 s22, 51806208
  buffer_load_dword v55, off, s[44:47], s22 nt
  s_mov_b64 exec, -1
  s_cmp_lt_u32 s16, s17
  s_cbranch_scc0 L_tg_73
  s_waitcnt vmcnt(16)
  s_swappc_b64 s[28:29], s[0:1]
L_tb_74:
  s_cmp_lt_u32 s16, s17
  s_cbranch_scc0 L_tg_75
  s_waitcnt vmcnt(15)
  s_swappc_b64 s[28:29], s[0:1]
L_tb_76:
  s_cmp_lt_u32 s16, s17
  s_cbranch_scc0 L_tg_77
  s_waitcnt vmcnt(15)
  s_swappc_b64 s[28:29], s[0:1]
L_tb_78:
  s_cmp_lt_u32 s16, s17
  s_cbranch_scc0 L_tg_79
  s_waitcnt vmcnt(15)
  s_swappc_b64 s[28:29], s[0:1]
L_tb_80:
  s_cmp_lt_u32 s16, s17
  s_cbranch_scc0 L_tg_81
  s_waitcnt vmcnt(9)
  s_swappc_b64 s[28:29], s[0:1]
L_tb_82:
  s_cmp_lt_u32 s16, s17
  s_cbranch_scc0 L_tg_83
  s_waitcnt vmcnt(9)
  s_swappc_b64 s[28:29], s[0:1]
L_tb_84:
  s_mov_b32 s77, 0
  s_add_u32 s73, s72, 0
  v_lshrrev_b32 v74, 3, v0
  v_and_b32 v75, 7, v0
  v_mul_u32_u24 v74, 128, v74
  v_lshl_add_u32 v74, v75, 4, v74
  s_add_u32 s97, s83, 0
  s_mov_b32 exec_lo, 0x1f1f1f1f
  s_mov_b32 exec_hi, 0x1f1f1f1f
  buffer_load_dwordx4 v[26:29], v74, s[64:67], s97 offen offset:0 sc1
  buffer_load_dwordx4 v[30:33], v74, s[64:67], s97 offen offset:1024 sc1
  buffer_load_dwordx4 v[34:37], v74, s[64:67], s97 offen offset:2048 sc1
  buffer_load_dwordx4 v[38:41], v74, s[64:67], s97 offen offset:3072 sc1
  s_mov_b64 exec, -1
  s_bfe_u32 s68, s73, 0x80000
  s_bfe_u32 s69, s73, 0x80008
  s_bfe_u32 s70, s73, 0x80010
  s_bfe_u32 s90, s73, 0x80018
  s_cmp_lt_u32 s16, s17
  s_cbranch_scc0 L_tg_85
  s_waitcnt vmcnt(13)
  s_swappc_b64 s[28:29], s[0:1]
L_tb_86:
  s_cmp_lt_u32 s16, s17
  s_cbranch_scc0 L_tg_87
  s_waitcnt vmcnt(13)
  s_swappc_b64 s[28:29], s[0:1]
L_tb_88:
  s_cmp_lg_u32 s77, 0
  s_cbranch_scc1 L_wz_89
  s_waitcnt vmcnt(6)
L_wb_90:
  s_mov_b32 exec_lo, 0x1f1f1f1f
  s_mov_b32 exec_hi, 0x1f1f1f1f
L_chk_91:
  v_xor_b32 v26, s68, v26
  v_xor_b32 v30, s68, v30
  v_xor_b32 v34, s68, v34
  v_xor_b32 v38, s68, v38
  v_xor_b32 v27, s69, v27
  v_xor_b32 v31, s69, v31
  v_xor_b32 v35, s69, v35
  v_xor_b32 v39, s69, v39
  v_xor_b32 v28, s70, v28
  v_xor_b32 v32, s70, v32
  v_xor_b32 v36, s70, v36
  v_xor_b32 v40, s70, v40
  v_xor_b32 v29, s90, v29
  v_xor_b32 v33, s90, v33
  v_xor_b32 v37, s90, v37
  v_xor_b32 v41, s90, v41
  v_or3_b32 v75, v26, v30, v34
  v_or3_b32 v75, v75, v38, v27
  v_or3_b32 v75, v75, v31, v35
  v_or3_b32 v75, v75, v39, v28
  v_or3_b32 v75, v75, v32, v36
  v_or3_b32 v75, v75, v40, v29
  v_or3_b32 v75, v75, v33, v37
  v_or3_b32 v75, v75, v41, v41
  v_and_b32 v75, 0xff, v75
  v_cmp_ne_u32 vcc, 0, v75
  s_nop 0
  s_cbranch_vccnz L_retry_92
  v_pk_add_f32 v[26:27], v[26:27], v[30:31]
  v_pk_add_f32 v[28:29], v[28:29], v[32:33]
  v_pk_add_f32 v[34:35], v[34:35], v[38:39]
  v_pk_add_f32 v[36:37], v[36:37], v[40:41]
  v_pk_add_f32 v[26:27], v[26:27], v[34:35]
  v_pk_add_f32 v[28:29], v[28:29], v[36:37]
  v_add_u32 v33, 160128, v24
  v_add_f32_dpp v30, v26, v26 row_ror:8 row_mask:0xf bank_mask:0x3
  v_add_f32_dpp v31, v28, v28 row_ror:8 row_mask:0xf bank_mask:0x3
  s_nop 0
  v_add_f32_dpp v30, v27, v27 row_ror:8 row_mask:0xf bank_mask:0xc
  v_add_f32_dpp v31, v29, v29 row_ror:8 row_mask:0xf bank_mask:0xc
  s_nop 1
  v_permlane32_swap_b32 v30, v31
  v_add_f32 v30, v30, v31
  v_mov_b32 v31, v30
  s_nop 1
  v_permlane16_swap_b32 v30, v31
  v_add_f32 v30, v30, v31
  v_cvt_pk_bf16_f32 v30, v30, v30
  v_and_b32 v30, 0xffff0000, v30
  v_add_f32 v30, v30, v7
  v_cvt_pk_bf16_f32 v31, v30, v30
  ds_write_b16 v33, v31
  v_and_b32 v7, 0xffff0000, v31
  s_mov_b64 exec, -1
  v_bfe_u32 v72, v0, 2, 3
  v_lshrrev_b32 v71, 5, v0
  v_mul_u32_u24 v71, 3072, v71
  v_lshl_add_u32 v71, v72, 7, v71
  v_and_b32 v73, 3, v0
  v_lshl_add_u32 v71, v73, 3, v71
  v_lshrrev_b32 v72, 1, v72
  s_mul_i32 s91, s3, 3
  s_add_u32 s91, s91, 0
  s_and_b32 s92, s91, 3
  s_lshr_b32 s91, s91, 2
  v_xor_b32 v73, s92, v72
  s_lshl_b32 s91, s91, 10
  s_add_u32 s91, s91, 63488
  v_lshl_add_u32 v73, v73, 5, v71
  v_add_u32 v42, s91, v73
  ds_read_b64_tr_b16 v[44:45], v42 offset:0
  ds_read_b64_tr_b16 v[46:47], v42 offset:6144
  ds_read_b64_tr_b16 v[48:49], v42 offset:12288
  ds_read_b64_tr_b16 v[50:51], v42 offset:18432
  ds_read_b64_tr_b16 v[52:53], v42 offset:24576
  s_mul_i32 s91, s3, 3
  s_add_u32 s91, s91, 1
  s_and_b32 s92, s91, 3
  s_lshr_b32 s91, s91, 2
  v_xor_b32 v73, s92, v72
  s_lshl_b32 s91, s91, 10
  s_add_u32 s91, s91, 63488
  v_lshl_add_u32 v73, v73, 5, v71
  v_add_u32 v43, s91, v73
  ds_read_b64_tr_b16 v[54:55], v43 offset:0
  ds_read_b64_tr_b16 v[56:57], v43 offset:6144
  ds_read_b64_tr_b16 v[58:59], v43 offset:12288
  ds_read_b64_tr_b16 v[60:61], v43 offset:18432
  ds_read_b64_tr_b16 v[62:63], v43 offset:24576
  s_mul_i32 s91, s3, 3
  s_add_u32 s91, s91, 2
  s_and_b32 s92, s91, 3
  s_lshr_b32 s91, s91, 2
  v_xor_b32 v73, s92, v72
  s_lshl_b32 s91, s91, 10
  s_add_u32 s91, s91, 63488
  v_lshl_add_u32 v73, v73, 5, v71
  v_add_u32 v42, s91, v73
  ds_read_b64_tr_b16 v[64:65], v42 offset:0
  ds_read_b64_tr_b16 v[66:67], v42 offset:6144
  ds_read_b64_tr_b16 v[68:69], v42 offset:12288
  ds_read_b64_tr_b16 v[70:71], v42 offset:18432
  ds_read_b64_tr_b16 v[72:73], v42 offset:24576
  v_mov_b32 v75, 160128
  v_mov_b32 v32, 161216
  s_mov_b32 vcc_lo, 0x00f000f0
  s_mov_b32 vcc_hi, 0x00f000f0
  v_cndmask_b32 v75, v75, v32, vcc
  v_lshrrev_b32 v32, 4, v0
  v_lshl_add_u32 v75, v32, 3, v75
  s_waitcnt lgkmcnt(0)
  s_barrier
  ds_read2_b64 v[34:37], v75 offset0:0 offset1:4
  ds_read2_b64 v[38:41], v75 offset0:8 offset1:12
  ds_read_b64 v[42:43], v75 offset:128
  s_add_u32 s73, s72, 1
  s_add_u32 s76, s80, 2097152
  s_mul_i32 s91, s31, 240
  s_sub_u32 s91, 2048, s91
  v_lshlrev_b32 v74, 4, v0
  v_add_u32 v32, 3840, v74
  s_nop 1
  v_mov_b32_dpp v74, v32 quad_perm:[0,1,2,3] row_mask:0x2 bank_mask:0xf
  v_writelane_b32 v74, s91, 32
  s_cmp_lt_u32 s16, s17
  s_cbranch_scc0 L_tg_99
  s_swappc_b64 s[28:29], s[0:1]
L_tb_100:
  s_waitcnt lgkmcnt(0)
  v_mfma_f32_16x16x32_bf16 v[26:29], v[34:37], v[44:47], 0
  v_mfma_f32_16x16x32_bf16 v[30:33], v[34:37], v[54:57], 0
  v_mfma_f32_16x16x32_bf16 v[26:29], v[38:41], v[48:51], v[26:29]
  v_mfma_f32_16x16x32_bf16 v[30:33], v[38:41], v[58:61], v[30:33]
  v_mfma_f32_16x16x16_bf16 v[26:29], v[42:43], v[52:53], v[26:29]
  v_mfma_f32_16x16x16_bf16 v[30:33], v[42:43], v[62:63], v[30:33]
  v_mfma_f32_16x16x32_bf16 v[48:51], v[34:37], v[34:37], 0
  v_mfma_f32_16x16x32_bf16 v[44:47], v[34:37], v[64:67], 0
  v_mfma_f32_16x16x32_bf16 v[48:51], v[38:41], v[38:41], v[48:51]
  v_mfma_f32_16x16x32_bf16 v[44:47], v[38:41], v[68:71], v[44:47]
  v_mfma_f32_16x16x16_bf16 v[48:51], v[42:43], v[42:43], v[48:51]
  v_mfma_f32_16x16x16_bf16 v[44:47], v[42:43], v[72:73], v[44:47]
  s_nop 0
  v_mov_b32 v29, s73
  v_mov_b32 v27, v30
  s_nop 4
  v_mov_b32 v28, v44
  v_mov_b32_dpp v26, v48 quad_perm:[0,1,2,3] row_mask:0x4 bank_mask:0xf
  v_mov_b32_dpp v27, v48 row_ror:12 row_mask:0x4 bank_mask:0xf
  s_mov_b32 exec_lo, -1
  s_mov_b32 exec_hi, 1
  buffer_store_dwordx4 v[26:29], v74, s[64:67], s76 offen
  s_mov_b64 exec, -1
  s_cmp_lt_u32 s16, s17
  s_cbranch_scc0 L_tg_101
  s_swappc_b64 s[28:29], s[0:1]
L_tb_102:
  s_cmp_lt_u32 s16, s17
  s_cbranch_scc0 L_tg_103
  s_waitcnt vmcnt(10)
  s_swappc_b64 s[28:29], s[0:1]
L_tb_104:
  s_mov_b32 s77, 0
  s_add_u32 s73, s72, 1
  v_and_b32 v59, 7, v0
  s_add_u32 s91, s27, 2048
  v_lshl_add_u32 v59, v59, 4, s91
  s_add_u32 s97, s81, 2097152
  s_add_u32 s100, s97, 4096
  buffer_load_dwordx4 v[34:37], v59, s[64:67], s97 offen nt
  buffer_load_dwordx4 v[26:29], v6, s[64:67], s97 offen offset:0 nt
  buffer_load_dwordx4 v[30:33], v6, s[64:67], s97 offen offset:1024 nt
  buffer_load_dwordx4 v[38:41], v6, s[64:67], s100 offen offset:0 nt
  buffer_load_dwordx4 v[42:45], v6, s[64:67], s100 offen offset:1024 nt
  s_cmp_lt_u32 s16, s17
  s_cbranch_scc0 L_tg_105
  s_waitcnt vmcnt(15)
  s_swappc_b64 s[28:29], s[0:1]
L_tb_106:
  s_cmp_lt_u32 s16, s17
  s_cbranch_scc0 L_tg_107
  s_waitcnt vmcnt(15)
  s_swappc_b64 s[28:29], s[0:1]
L_tb_108:
  v_and_b32 v58, 15, v0
  v_bfe_u32 v60, v0, 4, 1
  v_lshl_add_u32 v58, v60, 5, v58
  v_lshrrev_b32 v60, 5, v0
  v_lshl_add_u32 v58, v60, 4, v58
  s_mul_i32 s91, s3, 96
  s_add_u32 s91, s91, 160448
  v_lshl_add_u32 v58, v58, 1, s91
  v_lshrrev_b32 v61, 2, v6
  v_add_u32 v61, 162528, v61
  s_cmp_lg_u32 s77, 0
  s_cbranch_scc1 L_wz_109
  s_waitcnt vmcnt(6)
L_wb_110:
L_chk_111:
  v_bitop3_b32 v75, v37, v29, s73 bitop3:0x7e
  v_bitop3_b32 v75, v75, v33, s73 bitop3:0xf6
  v_bitop3_b32 v75, v75, v41, s73 bitop3:0xf6
  v_bitop3_b32 v75, v75, v45, s73 bitop3:0xf6
  v_cmp_ne_u32 vcc, 0, v75
  s_nop 0
  s_cbranch_vccnz L_retry_112
  v_pk_add_f32 v[26:27], v[26:27], v[30:31]
  v_add_f32 v28, v28, v32
  v_mov_b32 v29, v28
  v_add_f32_dpp v34, v34, v34 quad_perm:[1,0,3,2] row_mask:0xf bank_mask:0xf
  v_add_f32_dpp v35, v35, v35 quad_perm:[1,0,3,2] row_mask:0xf bank_mask:0xf
  v_permlane32_swap_b32 v26, v27
  v_permlane32_swap_b32 v28, v29
  v_add_f32_dpp v34, v34, v34 quad_perm:[2,3,0,1] row_mask:0xf bank_mask:0xf
  v_add_f32_dpp v35, v35, v35 quad_perm:[2,3,0,1] row_mask:0xf bank_mask:0xf
  v_add_f32 v26, v26, v27
  v_add_f32 v28, v28, v29
  v_add_f32_dpp v34, v34, v34 row_half_mirror row_mask:0xf bank_mask:0xf
  v_add_f32_dpp v35, v35, v35 row_half_mirror row_mask:0xf bank_mask:0xf
  v_permlane16_swap_b32 v26, v28
  v_mul_f32 v35, 0x3acccccd, v35
  v_mul_f32 v34, 0x3acccccd, v34
  v_add_f32 v62, v26, v28
  v_fma_f32 v34, -v35, v35, v34
  v_max_f32 v34, 0, v34
  v_add_f32 v34, 0x3727c5ac, v34
  v_rsq_f32 v34, v34
  v_pk_add_f32 v[38:39], v[38:39], v[42:43]
  v_add_f32 v40, v40, v44
  v_mov_b32 v41, v40
  v_permlane32_swap_b32 v38, v39
  s_nop 0
  v_permlane32_swap_b32 v40, v41
  v_add_f32 v38, v38, v39
  v_add_f32 v40, v40, v41
  s_nop 1
  v_permlane16_swap_b32 v38, v40
  v_add_f32 v60, v38, v40
  ds_write_b32 v61, v60
  v_fma_f32 v62, -v35, v60, v62
  s_mov_b32 exec_hi, 0xffff
  v_mul_f32 v62, v62, v34
  v_cvt_pk_bf16_f32 v62, v62, v62
  ds_write_b16 v58, v62
  s_mov_b64 exec, -1
  s_waitcnt lgkmcnt(0)
  s_barrier
  s_mov_b32 s20, 42
  s_cmp_eq_u32 s20, -1
  s_cbranch_scc1 L_ux_120
L_uw_119:
  s_cmp_lt_u32 s16, s17
  s_cbranch_scc0 L_ud_122
  s_waitcnt vmcnt(12)
  s_swappc_b64 s[28:29], s[0:1]
  s_cmp_ge_u32 s16, s20
  s_cbranch_scc0 L_uw_119
L_uc_121:
  s_swappc_b64 s[28:29], s[14:15]
  s_cmp_ge_u32 s16, s20
  s_cbranch_scc0 L_ut_123
  s_swappc_b64 s[28:29], s[14:15]
  s_cmp_ge_u32 s16, s20
  s_cbranch_scc0 L_ut_123
  s_swappc_b64 s[28:29], s[14:15]
L_ut_123:
  s_cmp_eq_u32 s20, -1
  s_cbranch_scc0 L_uw_119
L_ux_120:
  v_lshrrev_b32 v60, 4, v0
  v_and_b32 v59, 15, v0
  v_lshlrev_b32 v58, 10, v60
  v_lshl_add_u32 v58, v59, 4, v58
  s_lshl_b32 s91, s3, 8
  s_add_u32 s91, s91, 155648
  v_add_u32 v58, s91, v58
  v_add_u32 v59, 155648, v6
  v_mov_b32 v49, s94
  v_permlane32_swap_b32 v8, v9
  v_permlane32_swap_b32 v10, v11
  v_permlane32_swap_b32 v12, v13
  v_permlane32_swap_b32 v14, v15
  v_permlane32_swap_b32 v16, v17
  v_permlane32_swap_b32 v18, v19
  v_add_f32_dpp v46, v9, v8 row_ror:8 row_mask:0xf bank_mask:0x3
  v_add_f32_dpp v47, v13, v12 row_ror:8 row_mask:0xf bank_mask:0x3
  v_add_f32_dpp v48, v17, v16 row_ror:8 row_mask:0xf bank_mask:0x3
  v_add_f32_dpp v46, v10, v11 row_ror:8 row_mask:0xf bank_mask:0xc
  v_add_f32_dpp v47, v14, v15 row_ror:8 row_mask:0xf bank_mask:0xc
  v_add_f32_dpp v48, v18, v19 row_ror:8 row_mask:0xf bank_mask:0xc
  ds_write_b128 v59, v[46:49]
  v_lshlrev_b32 v60, 2, v60
  v_add_u32 v60, 161408, v60
  v_mov_b32 v62, 161408
  s_waitcnt lgkmcnt(0)
  s_barrier
  ds_read_b128 v[54:57], v62
  ds_read_b32 v62, v60
  ds_read_b128 v[50:53], v58
  s_add_u32 s73, s72, 1
  s_mul_i32 s91, s31, 240
  s_sub_u32 s91, 2048, s91
  v_lshlrev_b32 v59, 4, v0
  v_writelane_b32 v59, s91, 16
  v_mov_b32 v49, s73
  s_add_u32 s76, s78, 0
  s_waitcnt lgkmcnt(1)
  v_max3_f32 v54, v54, v55, v56
  v_max_f32 v54, v54, v57
  v_sub_f32 v62, v62, v54
  v_mul_f32 v62, 0x3dd53b95, v62
  v_exp_f32 v62, v62
  s_waitcnt lgkmcnt(0)
  v_pk_mul_f32 v[50:51], v[50:51], v[62:63] op_sel_hi:[1,0]
  v_pk_mul_f32 v[52:53], v[52:53], v[62:63] op_sel_hi:[1,0]
  s_nop 0
  v_permlane32_swap_b32 v50, v51
  v_permlane32_swap_b32 v52, v53
  v_add_f32 v50, v50, v51
  v_add_f32 v52, v52, v53
  s_nop 1
  v_permlane16_swap_b32 v50, v52
  v_add_f32 v46, v50, v52
  v_add_f32 v47, v50, v52
  s_nop 1
  v_permlane32_swap_b32 v46, v47
  v_mov_b32 v48, v46
  s_nop 1
  v_permlane16_swap_b32 v46, v48
  s_nop 1
  v_mov_b32_dpp v46, v54 quad_perm:[0,1,2,3] row_mask:0x2 bank_mask:0xf
  s_mov_b64 exec, 0x1ffff
  buffer_store_dwordx4 v[46:49], v59, s[64:67], s76 offen
  s_mov_b64 exec, -1
  s_add_u32 s73, s72, 1
  v_lshrrev_b32 v45, 4, v0
  v_and_b32 v44, 1, v0
  v_lshl_add_u32 v45, v44, 2, v45
  s_add_u32 s91, s27, 2048
  v_lshl_add_u32 v45, v45, 4, s91
  s_add_u32 s97, s79, 0
  buffer_load_dwordx4 v[34:37], v45, s[64:67], s97 offen nt
  buffer_load_dwordx4 v[26:29], v6, s[64:67], s97 offen offset:0 nt
  buffer_load_dwordx4 v[30:33], v6, s[64:67], s97 offen offset:1024 nt
  v_lshrrev_b32 v46, 2, v0
  v_and_b32 v47, 3, v0
  v_mul_u32_u24 v46, 160, v46
  v_lshl_add_u32 v47, v47, 3, v46
  s_lshl_b32 s91, s3, 5
  s_add_u32 s91, s91, 124928
  v_add_u32 v46, s91, v47
  v_add_u32 v47, 125056, v47
  v_bfe_u32 v49, v0, 4, 1
  v_lshlrev_b32 v49, 8, v49
  v_lshrrev_b32 v48, 5, v0
  v_lshl_add_u32 v49, v48, 7, v49
  v_and_b32 v48, 7, v0
  v_lshl_add_u32 v49, v48, 4, v49
  v_bfe_u32 v48, v0, 3, 1
  v_lshl_add_u32 v49, v48, 2, v49
  s_and_b32 s91, s3, 1
  s_lshl_b32 s91, s91, 3
  s_and_b32 s92, s3, 2
  s_add_u32 s91, s91, s92
  s_add_u32 s91, s91, 159744
  v_add_u32 v49, s91, v49
  v_and_b32 v74, 0x30, v0
  s_lshl_b32 s91, s3, 4
  s_add_u32 s91, s91, 1
  v_writelane_b32 v74, 64, s91
  s_movk_i32 s91, 80
  v_writelane_b32 v74, s91, 2
  s_movk_i32 s91, 96
  v_writelane_b32 v74, s91, 3
  s_movk_i32 s91, 112
  v_writelane_b32 v74, s91, 4
  s_bfe_u32 s68, s73, 0x80000
  s_bfe_u32 s69, s73, 0x80008
  s_bfe_u32 s70, s73, 0x80010
  s_bfe_u32 s90, s73, 0x80018
  ds_read_b64_tr_b16 v[50:51], v46 offset:0
  ds_read_b64_tr_b16 v[52:53], v46 offset:2560
  ds_read_b64_tr_b16 v[54:55], v47 offset:0
  ds_read_b64_tr_b16 v[56:57], v47 offset:2560
  ds_read_b64_tr_b16 v[58:59], v46 offset:5120
  ds_read_b64_tr_b16 v[60:61], v46 offset:7680
  ds_read_b64_tr_b16 v[62:63], v47 offset:5120
  ds_read_b64_tr_b16 v[64:65], v47 offset:7680
  ds_read_b64_tr_b16 v[66:67], v46 offset:10240
  ds_read_b64_tr_b16 v[68:69], v46 offset:12800
  ds_read_b64_tr_b16 v[70:71], v47 offset:10240
  ds_read_b64_tr_b16 v[72:73], v47 offset:12800
  s_waitcnt vmcnt(0)
L_chk_124:
  v_bitop3_b32 v75, v37, v29, s73 bitop3:0x7e
  v_bitop3_b32 v75, v75, v33, s73 bitop3:0xf6
  v_cmp_ne_u32 vcc, 0, v75
  s_nop 0
  s_cbranch_vccz L_retry_125
  buffer_load_dwordx4 v[34:37], v45, s[64:67], s97 offen nt
  buffer_load_dwordx4 v[26:29], v6, s[64:67], s97 offen offset:0 nt
  buffer_load_dwordx4 v[30:33], v6, s[64:67], s97 offen offset:1024 nt
  s_sub_u32 s75, s75, 1
  s_cbranch_scc1 L_end
  s_waitcnt vmcnt(0)
  s_branch L_chk_124
L_retry_125:
  s_mov_b32 s22, 50528256
  buffer_load_dwordx4 a[144:147], v1, s[32:35], s22 offen offset:0 nt
  buffer_load_dwordx4 a[148:151], v1, s[32:35], s22 offen offset:128 nt
  buffer_load_dwordx4 a[152:155], v1, s[32:35], s22 offen offset:256 nt
  s_mov_b32 s22, 50626560
  buffer_load_dwordx4 a[156:159], v1, s[32:35], s22 offen offset:0 nt
  buffer_load_dwordx4 a[160:163], v1, s[32:35], s22 offen offset:128 nt
  buffer_load_dwordx4 a[164:167], v1, s[32:35], s22 offen offset:256 nt
  v_max_f32_dpp v43, v34, v34 quad_perm:[1,0,3,2] row_mask:0xf bank_mask:0xf
  v_mov_b32 v42, v43
  s_nop 1
  v_permlane32_swap_b32 v43, v42
  v_max_f32 v43, v43, v42
  v_mov_b32 v42, v43
  s_nop 1
  v_permlane16_swap_b32 v43, v42
  v_max_f32 v43, v43, v42
  v_sub_f32 v43, v34, v43
  v_mul_f32 v43, 0x3dd53b95, v43
  v_exp_f32 v43, v43
  s_nop 0
  v_mul_f32 v35, v35, v43
  v_mul_f32_dpp v26, v43, v26 quad_perm:[0,0,2,2] row_mask:0xf bank_mask:0xf
  v_mul_f32_dpp v27, v43, v27 quad_perm:[0,0,2,2] row_mask:0xf bank_mask:0xf
  v_mul_f32_dpp v28, v43, v28 quad_perm:[0,0,2,2] row_mask:0xf bank_mask:0xf
  v_add_f32_dpp v29, v35, v35 quad_perm:[1,0,3,2] row_mask:0xf bank_mask:0xf
  v_fmac_f32_dpp v26, v43, v30 quad_perm:[1,1,3,3] row_mask:0xf bank_mask:0xf
  v_fmac_f32_dpp v27, v43, v31 quad_perm:[1,1,3,3] row_mask:0xf bank_mask:0xf
  v_fmac_f32_dpp v28, v43, v32 quad_perm:[1,1,3,3] row_mask:0xf bank_mask:0xf
  s_nop 0
  v_permlane32_swap_b32 v26, v27
  v_permlane32_swap_b32 v28, v29
  v_add_f32 v26, v26, v27
  v_add_f32 v28, v28, v29
  s_nop 1
  v_permlane16_swap_b32 v26, v28
  v_add_f32 v48, v26, v28
  v_lshrrev_b32 v45, 4, v0
  v_readlane_b32 s92, v48, 48
  v_lshlrev_b32 v45, 3, v45
  v_add_u32 v44, 159744, v45
  v_rcp_f32 v43, s92
  s_mov_b32 exec_hi, 0xffff
  v_mul_f32 v48, v48, v43
  v_cvt_pk_bf16_f32 v48, v48, v48
  ds_write_b16 v49, v48
  s_mov_b64 exec, -1
  s_waitcnt lgkmcnt(0)
  s_barrier
  ds_read2_b64 v[26:29], v44 offset0:0 offset1:4
  ds_read2_b64 v[30:33], v44 offset0:8 offset1:12
  ds_read2_b64 v[34:37], v44 offset0:16 offset1:20
  v_mov_b32 v48, v44
  s_add_u32 s76, s82, 262144
  s_lshl_b32 s91, s3, 4
  s_lshl_b64 vcc, 2, s91
  s_or_b32 s91, vcc_lo, 0x1001d
  s_or_b32 s92, vcc_hi, 0x10001
  v_mov_b32 v49, 0xffffff00
  s_waitcnt lgkmcnt(2)
  v_mfma_f32_16x16x32_bf16 v[38:41], v[50:53], v[26:29], 0
  v_mfma_f32_16x16x32_bf16 v[42:45], v[54:57], v[26:29], 0
  ds_read2_b64 v[26:29], v48 offset0:24 offset1:28
  ds_read_b64_tr_b16 v[50:51], v46 offset:15360
  ds_read_b64_tr_b16 v[52:53], v46 offset:17920
  ds_read_b64_tr_b16 v[54:55], v47 offset:15360
  ds_read_b64_tr_b16 v[56:57], v47 offset:17920
  s_waitcnt lgkmcnt(6)
  v_mfma_f32_16x16x32_bf16 v[38:41], v[58:61], v[30:33], v[38:41]
  v_mfma_f32_16x16x32_bf16 v[42:45], v[62:65], v[30:33], v[42:45]
  ds_read2_b64 v[30:33], v48 offset0:32 offset1:36
  ds_read_b64_tr_b16 v[58:59], v46 offset:20480
  ds_read_b64_tr_b16 v[60:61], v46 offset:23040
  ds_read_b64_tr_b16 v[62:63], v47 offset:20480
  ds_read_b64_tr_b16 v[64:65], v47 offset:23040
  s_waitcnt lgkmcnt(10)
  v_mfma_f32_16x16x32_bf16 v[38:41], v[66:69], v[34:37], v[38:41]
  v_mfma_f32_16x16x32_bf16 v[42:45], v[70:73], v[34:37], v[42:45]
  ds_read2_b64 v[34:37], v48 offset0:40 offset1:44
  ds_read_b64_tr_b16 v[66:67], v46 offset:25600
  ds_read_b64_tr_b16 v[68:69], v46 offset:28160
  ds_read_b64_tr_b16 v[70:71], v47 offset:25600
  ds_read_b64_tr_b16 v[72:73], v47 offset:28160
  s_waitcnt lgkmcnt(10)
  v_mfma_f32_16x16x32_bf16 v[38:41], v[50:53], v[26:29], v[38:41]
  v_mfma_f32_16x16x32_bf16 v[42:45], v[54:57], v[26:29], v[42:45]
  s_waitcnt lgkmcnt(5)
  v_mfma_f32_16x16x32_bf16 v[38:41], v[58:61], v[30:33], v[38:41]
  v_mfma_f32_16x16x32_bf16 v[42:45], v[62:65], v[30:33], v[42:45]
  s_waitcnt lgkmcnt(0)
  v_mfma_f32_16x16x32_bf16 v[38:41], v[66:69], v[34:37], v[38:41]
  v_mfma_f32_16x16x32_bf16 v[42:45], v[70:73], v[34:37], v[42:45]
  s_nop 7
  v_cndmask_b32 v26, v38, v42, vcc
  v_cndmask_b32 v27, v39, v43, vcc
  v_cndmask_b32 v28, v40, v44, vcc
  v_cndmask_b32 v29, v41, v45, vcc
  s_mov_b32 exec_lo, s91
  s_mov_b32 exec_hi, s92
  v_and_or_b32 v26, v26, v49, s68
  v_and_or_b32 v27, v27, v49, s69
  v_and_or_b32 v28, v28, v49, s70
  v_and_or_b32 v29, v29, v49, s90
  buffer_store_dwordx4 v[26:29], v74, s[64:67], s76 offen sc1
  s_mov_b64 exec, -1
  v_bfe_u32 v72, v0, 2, 3
  v_lshrrev_b32 v71, 5, v0
  v_mul_u32_u24 v71, 3072, v71
  v_lshl_add_u32 v71, v72, 7, v71
  v_and_b32 v73, 3, v0
  v_lshl_add_u32 v71, v73, 3, v71
  v_lshrrev_b32 v72, 1, v72
  s_mul_i32 s91, s3, 3
  s_add_u32 s91, s91, 0
  s_and_b32 s92, s91, 3
  s_lshr_b32 s91, s91, 2
  v_xor_b32 v73, s92, v72
  s_lshl_b32 s91, s91, 10
  s_add_u32 s91, s91, 32768
  v_lshl_add_u32 v73, v73, 5, v71
  v_add_u32 v42, s91, v73
  ds_read_b64_tr_b16 v[44:45], v42 offset:0
  ds_read_b64_tr_b16 v[46:47], v42 offset:6144
  ds_read_b64_tr_b16 v[48:49], v42 offset:12288
  ds_read_b64_tr_b16 v[50:51], v42 offset:18432
  ds_read_b64_tr_b16 v[52:53], v42 offset:24576
  s_mul_i32 s91, s3, 3
  s_add_u32 s91, s91, 1
  s_and_b32 s92, s91, 3
  s_lshr_b32 s91, s91, 2
  v_xor_b32 v73, s92, v72
  s_lshl_b32 s91, s91, 10
  s_add_u32 s91, s91, 32768
  v_lshl_add_u32 v73, v73, 5, v71
  v_add_u32 v43, s91, v73
  ds_read_b64_tr_b16 v[54:55], v43 offset:0
  ds_read_b64_tr_b16 v[56:57], v43 offset:6144
  ds_read_b64_tr_b16 v[58:59], v43 offset:12288
  ds_read_b64_tr_b16 v[60:61], v43 offset:18432
  ds_read_b64_tr_b16 v[62:63], v43 offset:24576
  s_mul_i32 s91, s3, 3
  s_add_u32 s91, s91, 2
  s_and_b32 s92, s91, 3
  s_lshr_b32 s91, s91, 2
  v_xor_b32 v73, s92, v72
  s_lshl_b32 s91, s91, 10
  s_add_u32 s91, s91, 32768
  v_lshl_add_u32 v73, v73, 5, v71
  v_add_u32 v42, s91, v73
  ds_read_b64_tr_b16 v[64:65], v42 offset:0
  ds_read_b64_tr_b16 v[66:67], v42 offset:6144
  ds_read_b64_tr_b16 v[68:69], v42 offset:12288
  ds_read_b64_tr_b16 v[70:71], v42 offset:18432
  ds_read_b64_tr_b16 v[72:73], v42 offset:24576
  v_mov_b32 v75, 160288
  v_mov_b32 v32, 161216
  s_mov_b32 vcc_lo, 0x00f000f0
  s_mov_b32 vcc_hi, 0x00f000f0
  v_cndmask_b32 v75, v75, v32, vcc
  v_lshrrev_b32 v32, 4, v0
  v_lshl_add_u32 v75, v32, 3, v75
  ds_read2_b64 v[34:37], v75 offset0:0 offset1:4
  ds_read2_b64 v[38:41], v75 offset0:8 offset1:12
  ds_read_b64 v[42:43], v75 offset:128
  s_add_u32 s73, s72, 0
  s_add_u32 s76, s80, 1048576
  s_mul_i32 s91, s31, 240
  s_sub_u32 s91, 2048, s91
  v_lshlrev_b32 v74, 4, v0
  v_writelane_b32 v74, s91, 32
  s_waitcnt lgkmcnt(0)
  v_mfma_f32_16x16x32_bf16 v[26:29], v[34:37], v[44:47], 0
  v_mfma_f32_16x16x32_bf16 v[30:33], v[34:37], v[54:57], 0
  v_mfma_f32_16x16x32_bf16 v[26:29], v[38:41], v[48:51], v[26:29]
  v_mfma_f32_16x16x32_bf16 v[30:33], v[38:41], v[58:61], v[30:33]
  v_mfma_f32_16x16x16_bf16 v[26:29], v[42:43], v[52:53], v[26:29]
  v_mfma_f32_16x16x16_bf16 v[30:33], v[42:43], v[62:63], v[30:33]
  v_mfma_f32_16x16x32_bf16 v[48:51], v[34:37], v[34:37], 0
  v_mfma_f32_16x16x32_bf16 v[44:47], v[34:37], v[64:67], 0
  v_mfma_f32_16x16x32_bf16 v[48:51], v[38:41], v[38:41], v[48:51]
  v_mfma_f32_16x16x32_bf16 v[44:47], v[38:41], v[68:71], v[44:47]
  v_mfma_f32_16x16x16_bf16 v[48:51], v[42:43], v[42:43], v[48:51]
  v_mfma_f32_16x16x16_bf16 v[44:47], v[42:43], v[72:73], v[44:47]
  s_nop 0
  v_mov_b32 v29, s73
  v_mov_b32 v27, v30
  s_nop 4
  v_mov_b32 v28, v44
  v_mov_b32_dpp v26, v48 quad_perm:[0,1,2,3] row_mask:0x4 bank_mask:0xf
  v_mov_b32_dpp v27, v48 row_ror:12 row_mask:0x4 bank_mask:0xf
  s_mov_b32 exec_lo, 0xffff
  s_mov_b32 exec_hi, 1
  buffer_store_dwordx4 v[26:29], v74, s[64:67], s76 offen
  s_mov_b64 exec, -1
  s_waitcnt vmcnt(0)
  v_bfe_u32 v72, v0, 2, 3
  v_lshrrev_b32 v71, 5, v0
  v_mul_u32_u24 v71, 3072, v71
  v_lshl_add_u32 v71, v72, 7, v71
  v_and_b32 v73, 3, v0
  v_lshl_add_u32 v71, v73, 3, v71
  v_lshrrev_b32 v72, 1, v72
  s_mul_i32 s91, s3, 3
  s_add_u32 s91, s91, 0
  s_and_b32 s92, s91, 3
  s_lshr_b32 s91, s91, 2
  v_xor_b32 v73, s92, v72
  s_lshl_b32 s91, s91, 10
  s_add_u32 s91, s91, 32768
  v_lshl_add_u32 v73, v73, 5, v71
  v_add_u32 v42, s91, v73
  ds_read_b64_tr_b16 v[44:45], v42 offset:0
  ds_read_b64_tr_b16 v[46:47], v42 offset:6144
  ds_read_b64_tr_b16 v[48:49], v42 offset:12288
  ds_read_b64_tr_b16 v[50:51], v42 offset:18432
  ds_read_b64_tr_b16 v[52:53], v42 offset:24576
  s_mul_i32 s91, s3, 3
  s_add_u32 s91, s91, 1
  s_and_b32 s92, s91, 3
  s_lshr_b32 s91, s91, 2
  v_xor_b32 v73, s92, v72
  s_lshl_b32 s91, s91, 10
  s_add_u32 s91, s91, 32768
  v_lshl_add_u32 v73, v73, 5, v71
  v_add_u32 v43, s91, v73
  ds_read_b64_tr_b16 v[54:55], v43 offset:0
  ds_read_b64_tr_b16 v[56:57], v43 offset:6144
  ds_read_b64_tr_b16 v[58:59], v43 offset:12288
  ds_read_b64_tr_b16 v[60:61], v43 offset:18432
  ds_read_b64_tr_b16 v[62:63], v43 offset:24576
  s_mul_i32 s91, s3, 3
  s_add_u32 s91, s91, 2
  s_and_b32 s92, s91, 3
  s_lshr_b32 s91, s91, 2
  v_xor_b32 v73, s92, v72
  s_lshl_b32 s91, s91, 10
  s_add_u32 s91, s91, 32768
  v_lshl_add_u32 v73, v73, 5, v71
  v_add_u32 v42, s91, v73
  ds_read_b64_tr_b16 v[64:65], v42 offset:0
  ds_read_b64_tr_b16 v[66:67], v42 offset:6144
  ds_read_b64_tr_b16 v[68:69], v42 offset:12288
  ds_read_b64_tr_b16 v[70:71], v42 offset:18432
  ds_read_b64_tr_b16 v[72:73], v42 offset:24576
  s_add_u32 s73, s72, 1
  v_lshrrev_b32 v74, 3, v0
  v_and_b32 v75, 7, v0
  v_mul_u32_u24 v74, 128, v74
  v_lshl_add_u32 v74, v75, 4, v74
  s_add_u32 s97, s83, 262144
  s_mov_b32 exec_lo, 0x1f1f1f1f
  s_mov_b32 exec_hi, 0x1f1f1f1f
  buffer_load_dwordx4 v[26:29], v74, s[64:67], s97 offen offset:0 sc1
  buffer_load_dwordx4 v[30:33], v74, s[64:67], s97 offen offset:1024 sc1
  buffer_load_dwordx4 v[34:37], v74, s[64:67], s97 offen offset:2048 sc1
  buffer_load_dwordx4 v[38:41], v74, s[64:67], s97 offen offset:3072 sc1
  s_mov_b64 exec, -1
  s_bfe_u32 s68, s73, 0x80000
  s_bfe_u32 s69, s73, 0x80008
  s_bfe_u32 s70, s73, 0x80010
  s_bfe_u32 s90, s73, 0x80018
  s_waitcnt vmcnt(0)
  s_mov_b32 exec_lo, 0x1f1f1f1f
  s_mov_b32 exec_hi, 0x1f1f1f1f
L_chk_126:
  v_xor_b32 v26, s68, v26
  v_xor_b32 v30, s68, v30
  v_xor_b32 v34, s68, v34
  v_xor_b32 v38, s68, v38
  v_xor_b32 v27, s69, v27
  v_xor_b32 v31, s69, v31
  v_xor_b32 v35, s69, v35
  v_xor_b32 v39, s69, v39
  v_xor_b32 v28, s70, v28
  v_xor_b32 v32, s70, v32
  v_xor_b32 v36, s70, v36
  v_xor_b32 v40, s70, v40
  v_xor_b32 v29, s90, v29
  v_xor_b32 v33, s90, v33
  v_xor_b32 v37, s90, v37
  v_xor_b32 v41, s90, v41
  v_or3_b32 v75, v26, v30, v34
  v_or3_b32 v75, v75, v38, v27
  v_or3_b32 v75, v75, v31, v35
  v_or3_b32 v75, v75, v39, v28
  v_or3_b32 v75, v75, v32, v36
  v_or3_b32 v75, v75, v40, v29
  v_or3_b32 v75, v75, v33, v37
  v_or3_b32 v75, v75, v41, v41
  v_and_b32 v75, 0xff, v75
  v_cmp_ne_u32 vcc, 0, v75
  s_nop 0
  s_cbranch_vccz L_retry_127
  buffer_load_dwordx4 v[26:29], v74, s[64:67], s97 offen offset:0 sc1
  buffer_load_dwordx4 v[30:33], v74, s[64:67], s97 offen offset:1024 sc1
  buffer_load_dwordx4 v[34:37], v74, s[64:67], s97 offen offset:2048 sc1
  buffer_load_dwordx4 v[38:41], v74, s[64:67], s97 offen offset:3072 sc1
  s_sub_u32 s75, s75, 1
  s_cbranch_scc1 L_end
  s_waitcnt vmcnt(0)
  s_branch L_chk_126
L_retry_127:
  v_pk_add_f32 v[26:27], v[26:27], v[30:31]
  v_pk_add_f32 v[28:29], v[28:29], v[32:33]
  v_pk_add_f32 v[34:35], v[34:35], v[38:39]
  v_pk_add_f32 v[36:37], v[36:37], v[40:41]
  v_pk_add_f32 v[26:27], v[26:27], v[34:35]
  v_pk_add_f32 v[28:29], v[28:29], v[36:37]
  v_add_u32 v33, 160128, v24
  v_add_f32_dpp v30, v26, v26 row_ror:8 row_mask:0xf bank_mask:0x3
  v_add_f32_dpp v31, v28, v28 row_ror:8 row_mask:0xf bank_mask:0x3
  s_nop 0
  v_add_f32_dpp v30, v27, v27 row_ror:8 row_mask:0xf bank_mask:0xc
  v_add_f32_dpp v31, v29, v29 row_ror:8 row_mask:0xf bank_mask:0xc
  s_nop 1
  v_permlane32_swap_b32 v30, v31
  v_add_f32 v30, v30, v31
  v_mov_b32 v31, v30
  s_nop 1
  v_permlane16_swap_b32 v30, v31
  v_add_f32 v30, v30, v31
  v_cvt_pk_bf16_f32 v30, v30, v30
  v_and_b32 v30, 0xffff0000, v30
  v_add_f32 v30, v30, v7
  v_cvt_pk_bf16_f32 v31, v30, v30
  ds_write_b16 v33, v31
  v_and_b32 v7, 0xffff0000, v31
  s_mov_b64 exec, -1
  v_mov_b32 v75, 160128
  v_mov_b32 v32, 161216
  s_mov_b32 vcc_lo, 0x00f000f0
  s_mov_b32 vcc_hi, 0x00f000f0
  v_cndmask_b32 v75, v75, v32, vcc
  v_lshrrev_b32 v32, 4, v0
  v_lshl_add_u32 v75, v32, 3, v75
  s_waitcnt lgkmcnt(0)
  s_barrier
  ds_read2_b64 v[34:37], v75 offset0:0 offset1:4
  ds_read2_b64 v[38:41], v75 offset0:8 offset1:12
  ds_read_b64 v[42:43], v75 offset:128
  s_add_u32 s73, s72, 2
  s_add_u32 s76, s80, 2097152
  s_mul_i32 s91, s31, 240
  s_sub_u32 s91, 2048, s91
  v_lshlrev_b32 v74, 4, v0
  v_writelane_b32 v74, s91, 32
  s_waitcnt lgkmcnt(0)
  v_mfma_f32_16x16x32_bf16 v[26:29], v[34:37], v[44:47], 0
  v_mfma_f32_16x16x32_bf16 v[30:33], v[34:37], v[54:57], 0
  v_mfma_f32_16x16x32_bf16 v[26:29], v[38:41], v[48:51], v[26:29]
  v_mfma_f32_16x16x32_bf16 v[30:33], v[38:41], v[58:61], v[30:33]
  v_mfma_f32_16x16x16_bf16 v[26:29], v[42:43], v[52:53], v[26:29]
  v_mfma_f32_16x16x16_bf16 v[30:33], v[42:43], v[62:63], v[30:33]
  v_mfma_f32_16x16x32_bf16 v[48:51], v[34:37], v[34:37], 0
  v_mfma_f32_16x16x32_bf16 v[44:47], v[34:37], v[64:67], 0
  v_mfma_f32_16x16x32_bf16 v[48:51], v[38:41], v[38:41], v[48:51]
  v_mfma_f32_16x16x32_bf16 v[44:47], v[38:41], v[68:71], v[44:47]
  v_mfma_f32_16x16x16_bf16 v[48:51], v[42:43], v[42:43], v[48:51]
  v_mfma_f32_16x16x16_bf16 v[44:47], v[42:43], v[72:73], v[44:47]
  s_nop 0
  v_mov_b32 v29, s73
  v_mov_b32 v27, v30
  s_nop 4
  v_mov_b32 v28, v44
  v_mov_b32_dpp v26, v48 quad_perm:[0,1,2,3] row_mask:0x4 bank_mask:0xf
  v_mov_b32_dpp v27, v48 row_ror:12 row_mask:0x4 bank_mask:0xf
  s_mov_b32 exec_lo, 0xffff
  s_mov_b32 exec_hi, 1
  buffer_store_dwordx4 v[26:29], v74, s[64:67], s76 offen
  s_mov_b64 exec, -1
  s_add_u32 s73, s72, 2
  v_and_b32 v38, 7, v0
  s_add_u32 s91, s27, 2048
  v_lshl_add_u32 v38, v38, 4, s91
  s_add_u32 s97, s81, 2097152
  buffer_load_dwordx4 v[34:37], v38, s[64:67], s97 offen nt
  buffer_load_dwordx4 v[26:29], v6, s[64:67], s97 offen offset:0 nt
  buffer_load_dwordx4 v[30:33], v6, s[64:67], s97 offen offset:1024 nt
  v_and_b32 v58, 15, v0
  v_bfe_u32 v60, v0, 4, 1
  v_lshl_add_u32 v58, v60, 5, v58
  v_lshrrev_b32 v60, 5, v0
  v_lshl_add_u32 v58, v60, 4, v58
  s_mul_i32 s91, s3, 96
  s_add_u32 s91, s91, 160448
  v_lshl_add_u32 v58, v58, 1, s91
  v_lshrrev_b32 v61, 2, v6
  v_add_u32 v61, 161504, v61
  ds_read_b32 v60, v61
  s_waitcnt vmcnt(0)
L_chk_128:
  v_bitop3_b32 v75, v37, v29, s73 bitop3:0x7e
  v_bitop3_b32 v75, v75, v33, s73 bitop3:0xf6
  v_cmp_ne_u32 vcc, 0, v75
  s_nop 0
  s_cbranch_vccz L_retry_129
  buffer_load_dwordx4 v[34:37], v38, s[64:67], s97 offen nt
  buffer_load_dwordx4 v[26:29], v6, s[64:67], s97 offen offset:0 nt
  buffer_load_dwordx4 v[30:33], v6, s[64:67], s97 offen offset:1024 nt
  s_sub_u32 s75, s75, 1
  s_cbranch_scc1 L_end
  s_waitcnt vmcnt(0)
  s_branch L_chk_128
L_retry_129:
  s_mov_b32 s22, 50331648
  buffer_load_dwordx4 a[108:111], v1, s[36:39], s22 offen offset:0 nt
  buffer_load_dwordx4 a[112:115], v1, s[36:39], s22 offen offset:128 nt
  buffer_load_dwordx4 a[116:119], v1, s[36:39], s22 offen offset:256 nt
  v_pk_add_f32 v[26:27], v[26:27], v[30:31]
  v_add_f32 v28, v28, v32
  v_mov_b32 v29, v28
  v_add_f32_dpp v34, v34, v34 quad_perm:[1,0,3,2] row_mask:0xf bank_mask:0xf
  v_add_f32_dpp v35, v35, v35 quad_perm:[1,0,3,2] row_mask:0xf bank_mask:0xf
  v_permlane32_swap_b32 v26, v27
  v_permlane32_swap_b32 v28, v29
  v_add_f32_dpp v34, v34, v34 quad_perm:[2,3,0,1] row_mask:0xf bank_mask:0xf
  v_add_f32_dpp v35, v35, v35 quad_perm:[2,3,0,1] row_mask:0xf bank_mask:0xf
  v_add_f32 v26, v26, v27
  v_add_f32 v28, v28, v29
  v_add_f32_dpp v34, v34, v34 row_half_mirror row_mask:0xf bank_mask:0xf
  v_add_f32_dpp v35, v35, v35 row_half_mirror row_mask:0xf bank_mask:0xf
  v_permlane16_swap_b32 v26, v28
  v_mul_f32 v35, 0x3acccccd, v35
  v_mul_f32 v34, 0x3acccccd, v34
  v_add_f32 v62, v26, v28
  v_fma_f32 v34, -v35, v35, v34
  v_max_f32 v34, 0, v34
  v_add_f32 v34, 0x3727c5ac, v34
  v_rsq_f32 v34, v34
  s_waitcnt lgkmcnt(0)
  v_fma_f32 v62, -v35, v60, v62
  s_mov_b32 exec_hi, 0xffff
  v_mul_f32 v62, v62, v34
  v_cvt_pk_bf16_f32 v62, v62, v62
  ds_write_b16 v58, v62
  s_mov_b64 exec, -1
  s_waitcnt lgkmcnt(0)
  s_barrier
  v_and_b32 v66, 7, v0
  v_lshlrev_b32 v66, 4, v66
  v_add_u32 v66, 160448, v66
  ds_read_b128 v[26:29], v66 offset:0
  ds_read_b128 v[30:33], v66 offset:128
  ds_read_b128 v[34:37], v66 offset:256
  s_waitcnt lgkmcnt(0)
.balignl 8, 0xBF800000
  v_mfma_f32_4x4x4_16b_bf16 v[44:47], v[26:27], v[76:77], 0
  v_mfma_f32_4x4x4_16b_bf16 v[48:51], v[26:27], v[88:89], 0
  v_nop_e64
  v_mfma_f32_4x4x4_16b_bf16 v[44:47], v[28:29], v[78:79], v[44:47]
  v_mfma_f32_4x4x4_16b_bf16 v[48:51], v[28:29], v[90:91], v[48:51]
  v_nop_e64
  v_mfma_f32_4x4x4_16b_bf16 v[44:47], v[30:31], v[80:81], v[44:47]
  v_mfma_f32_4x4x4_16b_bf16 v[48:51], v[30:31], v[92:93], v[48:51]
  v_nop_e64
  v_mfma_f32_4x4x4_16b_bf16 v[44:47], v[32:33], v[82:83], v[44:47]
  v_mfma_f32_4x4x4_16b_bf16 v[48:51], v[32:33], v[94:95], v[48:51]
  v_nop_e64
  v_mfma_f32_4x4x4_16b_bf16 v[44:47], v[34:35], v[84:85], v[44:47]
  v_mfma_f32_4x4x4_16b_bf16 v[48:51], v[34:35], v[96:97], v[48:51]
  v_nop_e64
  v_mfma_f32_4x4x4_16b_bf16 v[44:47], v[36:37], v[86:87], v[44:47]
  v_mfma_f32_4x4x4_16b_bf16 v[48:51], v[36:37], v[98:99], v[48:51]
  v_mfma_f32_4x4x4_16b_bf16 v[52:55], v[26:27], v[100:101], 0
  v_mfma_f32_4x4x4_16b_bf16 v[56:59], v[26:27], v[112:113], 0
  v_nop_e64
  v_mfma_f32_4x4x4_16b_bf16 v[52:55], v[28:29], v[102:103], v[52:55]
  v_mov_b32_dpp v60, v44 quad_perm:[0,0,0,0] row_mask:0xf bank_mask:0xf
  v_mfma_f32_4x4x4_16b_bf16 v[56:59], v[28:29], v[114:115], v[56:59]
  v_mov_b32_dpp v61, v48 quad_perm:[0,0,0,0] row_mask:0xf bank_mask:0xf
  v_mfma_f32_4x4x4_16b_bf16 v[52:55], v[30:31], v[104:105], v[52:55]
  v_add_f32_dpp v60, v45, v60 quad_perm:[1,1,1,1] row_mask:0xf bank_mask:0xf
  v_mfma_f32_4x4x4_16b_bf16 v[56:59], v[30:31], v[116:117], v[56:59]
  v_add_f32_dpp v61, v49, v61 quad_perm:[1,1,1,1] row_mask:0xf bank_mask:0xf
  v_mfma_f32_4x4x4_16b_bf16 v[52:55], v[32:33], v[106:107], v[52:55]
  v_add_f32_dpp v60, v46, v60 quad_perm:[2,2,2,2] row_mask:0xf bank_mask:0xf
  v_mfma_f32_4x4x4_16b_bf16 v[56:59], v[32:33], v[118:119], v[56:59]
  v_add_f32_dpp v61, v50, v61 quad_perm:[2,2,2,2] row_mask:0xf bank_mask:0xf
  v_mfma_f32_4x4x4_16b_bf16 v[52:55], v[34:35], v[108:109], v[52:55]
  v_add_f32_dpp v38, v47, v60 quad_perm:[3,3,3,3] row_mask:0xf bank_mask:0xf
  v_mfma_f32_4x4x4_16b_bf16 v[56:59], v[34:35], v[120:121], v[56:59]
  v_add_f32_dpp v61, v51, v61 quad_perm:[3,3,3,3] row_mask:0xf bank_mask:0xf
  v_mfma_f32_4x4x4_16b_bf16 v[52:55], v[36:37], v[110:111], v[52:55]
  v_mfma_f32_4x4x4_16b_bf16 v[56:59], v[36:37], v[122:123], v[56:59]
  v_cndmask_b32 v38, v38, v61, s[84:85]
  s_nop 0
  s_nop 1
  v_mov_b32_dpp v62, v52 quad_perm:[0,0,0,0] row_mask:0xf bank_mask:0xf
  v_mov_b32_dpp v63, v56 quad_perm:[0,0,0,0] row_mask:0xf bank_mask:0xf
  v_nop_e64
  v_add_f32_dpp v62, v53, v62 quad_perm:[1,1,1,1] row_mask:0xf bank_mask:0xf
  v_add_f32_dpp v63, v57, v63 quad_perm:[1,1,1,1] row_mask:0xf bank_mask:0xf
  v_nop_e64
  v_add_f32_dpp v62, v54, v62 quad_perm:[2,2,2,2] row_mask:0xf bank_mask:0xf
  v_add_f32_dpp v63, v58, v63 quad_perm:[2,2,2,2] row_mask:0xf bank_mask:0xf
  v_nop_e64
  v_add_f32_dpp v62, v55, v62 quad_perm:[3,3,3,3] row_mask:0xf bank_mask:0xf
  v_add_f32_dpp v63, v59, v63 quad_perm:[3,3,3,3] row_mask:0xf bank_mask:0xf
  v_cndmask_b32 v38, v38, v62, s[86:87]
  v_cndmask_b32 v38, v38, v63, s[88:89]
  s_nop 0
  s_nop 0
  v_add_f32_dpp v38, v38, v38 row_half_mirror row_mask:0xf bank_mask:0xf
  s_nop 1
  v_max_f32_dpp v66, v38, v38 quad_perm:[1,0,3,2] row_mask:0xf bank_mask:0xf
  s_nop 1
  v_max_f32_dpp v66, v66, v66 quad_perm:[2,3,0,1] row_mask:0xf bank_mask:0xf
  s_nop 1
  v_max_f32_dpp v66, v66, v66 row_ror:8 row_mask:0xf bank_mask:0xf
  s_nop 1
  v_max_f32_dpp v66, v66, v66 row_bcast:15 row_mask:0xa bank_mask:0xf
  s_nop 1
  v_max_f32_dpp v66, v66, v66 row_bcast:31 row_mask:0xc bank_mask:0xf
  s_nop 0
  v_readlane_b32 s95, v66, 63
  v_mov_b32 v67, s21
  s_nop 0
  v_subrev_f32 v38, s95, v38
  v_mov_b32 v66, s95
  v_mul_f32 v38, 0x3dd53b95, v38
  ds_write_b32 v67, v66 offset:64
  v_exp_f32 v38, v38
  s_nop 1
  v_add_f32_dpp v68, v38, v38 quad_perm:[1,0,3,2] row_mask:0xf bank_mask:0xf
  v_cvt_pk_bf16_f32 v38, v38, v38
.balignl 8, 0xBF800000
  s_nop 0
  s_nop 0
  v_and_b32_dpp v46, v38, v2 quad_perm:[0,0,0,0] row_mask:0xf bank_mask:0xf
  v_and_b32_dpp v47, v38, v3 quad_perm:[0,0,0,0] row_mask:0xf bank_mask:0xf
  v_and_b32_dpp v48, v38, v4 quad_perm:[3,3,3,3] row_mask:0xf bank_mask:0xf
  v_and_b32_dpp v49, v38, v5 quad_perm:[3,3,3,3] row_mask:0xf bank_mask:0xf
  s_nop 0
  s_nop 0
  v_mfma_f32_16x16x32_bf16 v[26:29], v[46:49], v[124:127], 0
  v_and_b32_dpp v50, v38, v2 quad_perm:[1,1,1,1] row_mask:0xf bank_mask:0xf
  v_and_b32_dpp v51, v38, v3 quad_perm:[1,1,1,1] row_mask:0xf bank_mask:0xf
  v_mfma_f32_16x16x32_bf16 v[30:33], v[46:49], v[128:131], 0
  v_and_b32_dpp v52, v38, v4 quad_perm:[2,2,2,2] row_mask:0xf bank_mask:0xf
  v_and_b32_dpp v53, v38, v5 quad_perm:[2,2,2,2] row_mask:0xf bank_mask:0xf
  v_mfma_f32_16x16x32_bf16 v[34:37], v[46:49], v[132:135], 0
  v_add_f32_dpp v68, v68, v68 quad_perm:[2,3,0,1] row_mask:0xf bank_mask:0xf
  v_mfma_f32_16x16x32_bf16 v[26:29], v[50:53], v[136:139], v[26:29]
  v_and_b32_dpp v46, v38, v2 quad_perm:[2,2,2,2] row_mask:0xf bank_mask:0xf
  v_and_b32_dpp v47, v38, v3 quad_perm:[2,2,2,2] row_mask:0xf bank_mask:0xf
  v_mfma_f32_16x16x32_bf16 v[30:33], v[50:53], v[140:143], v[30:33]
  v_and_b32_dpp v48, v38, v4 quad_perm:[1,1,1,1] row_mask:0xf bank_mask:0xf
  v_and_b32_dpp v49, v38, v5 quad_perm:[1,1,1,1] row_mask:0xf bank_mask:0xf
  v_mfma_f32_16x16x32_bf16 v[34:37], v[50:53], v[144:147], v[34:37]
  v_add_f32_dpp v68, v68, v68 row_ror:8 row_mask:0xf bank_mask:0xf
  v_mfma_f32_16x16x32_bf16 v[26:29], v[46:49], v[148:151], v[26:29]
  v_and_b32_dpp v50, v38, v2 quad_perm:[3,3,3,3] row_mask:0xf bank_mask:0xf
  v_and_b32_dpp v51, v38, v3 quad_perm:[3,3,3,3] row_mask:0xf bank_mask:0xf
  v_mfma_f32_16x16x32_bf16 v[30:33], v[46:49], v[152:155], v[30:33]
  v_and_b32_dpp v52, v38, v4 quad_perm:[0,0,0,0] row_mask:0xf bank_mask:0xf
  v_and_b32_dpp v53, v38, v5 quad_perm:[0,0,0,0] row_mask:0xf bank_mask:0xf
  v_mfma_f32_16x16x32_bf16 v[34:37], v[46:49], v[156:159], v[34:37]
  v_add_f32_dpp v68, v68, v68 row_bcast:15 row_mask:0xa bank_mask:0xf
  v_mfma_f32_16x16x32_bf16 v[26:29], v[50:53], v[160:163], v[26:29]
  v_mfma_f32_16x16x32_bf16 v[30:33], v[50:53], v[164:167], v[30:33]
  v_mfma_f32_16x16x32_bf16 v[34:37], v[50:53], v[168:171], v[34:37]
  v_add_f32_dpp v68, v68, v68 row_bcast:31 row_mask:0xc bank_mask:0xf
  s_nop 0
  v_readlane_b32 s96, v68, 63
  v_lshrrev_b32 v60, 4, v0
  v_and_b32 v59, 15, v0
  v_lshlrev_b32 v58, 10, v60
  v_lshl_add_u32 v58, v59, 4, v58
  s_lshl_b32 s91, s3, 8
  s_add_u32 s91, s91, 155648
  v_add_u32 v58, s91, v58
  v_add_u32 v59, 155648, v6
  v_mov_b32 v49, s96
  v_permlane32_swap_b32 v26, v27
  v_permlane32_swap_b32 v28, v29
  v_permlane32_swap_b32 v30, v31
  v_permlane32_swap_b32 v32, v33
  v_permlane32_swap_b32 v34, v35
  v_permlane32_swap_b32 v36, v37
  v_add_f32_dpp v46, v27, v26 row_ror:8 row_mask:0xf bank_mask:0x3
  v_add_f32_dpp v47, v31, v30 row_ror:8 row_mask:0xf bank_mask:0x3
  v_add_f32_dpp v48, v35, v34 row_ror:8 row_mask:0xf bank_mask:0x3
  v_add_f32_dpp v46, v28, v29 row_ror:8 row_mask:0xf bank_mask:0xc
  v_add_f32_dpp v47, v32, v33 row_ror:8 row_mask:0xf bank_mask:0xc
  v_add_f32_dpp v48, v36, v37 row_ror:8 row_mask:0xf bank_mask:0xc
  ds_write_b128 v59, v[46:49]
  v_lshlrev_b32 v60, 2, v60
  v_add_u32 v60, 161440, v60
  v_mov_b32 v62, 161440
  s_waitcnt lgkmcnt(0)
  s_barrier
  ds_read_b128 v[54:57], v62
  ds_read_b32 v62, v60
  ds_read_b128 v[50:53], v58
  s_add_u32 s73, s72, 2
  s_mul_i32 s91, s31, 240
  s_sub_u32 s91, 2048, s91
  v_lshlrev_b32 v59, 4, v0
  v_writelane_b32 v59, s91, 16
  v_mov_b32 v49, s73
  s_add_u32 s76, s78, 0
  s_waitcnt lgkmcnt(1)
  v_max3_f32 v54, v54, v55, v56
  v_max_f32 v54, v54, v57
  v_sub_f32 v62, v62, v54
  v_mul_f32 v62, 0x3dd53b95, v62
  v_exp_f32 v62, v62
  s_waitcnt lgkmcnt(0)
  v_pk_mul_f32 v[50:51], v[50:51], v[62:63] op_sel_hi:[1,0]
  v_pk_mul_f32 v[52:53], v[52:53], v[62:63] op_sel_hi:[1,0]
  s_nop 0
  v_permlane32_swap_b32 v50, v51
  v_permlane32_swap_b32 v52, v53
  v_add_f32 v50, v50, v51
  v_add_f32 v52, v52, v53
  s_nop 1
  v_permlane16_swap_b32 v50, v52
  v_add_f32 v46, v50, v52
  v_add_f32 v47, v50, v52
  s_nop 1
  v_permlane32_swap_b32 v46, v47
  v_mov_b32 v48, v46
  s_nop 1
  v_permlane16_swap_b32 v46, v48
  s_nop 1
  v_mov_b32_dpp v46, v54 quad_perm:[0,1,2,3] row_mask:0x2 bank_mask:0xf
  s_mov_b64 exec, 0x1ffff
  buffer_store_dwordx4 v[46:49], v59, s[64:67], s76 offen
  s_mov_b64 exec, -1
  s_add_u32 s73, s72, 2
  v_lshrrev_b32 v45, 4, v0
  v_and_b32 v44, 1, v0
  v_lshl_add_u32 v45, v44, 2, v45
  s_add_u32 s91, s27, 2048
  v_lshl_add_u32 v45, v45, 4, s91
  s_add_u32 s97, s79, 0
  buffer_load_dwordx4 v[34:37], v45, s[64:67], s97 offen nt
  buffer_load_dwordx4 v[26:29], v6, s[64:67], s97 offen offset:0 nt
  buffer_load_dwordx4 v[30:33], v6, s[64:67], s97 offen offset:1024 nt
  v_lshrrev_b32 v46, 2, v0
  v_and_b32 v47, 3, v0
  v_mul_u32_u24 v46, 160, v46
  v_lshl_add_u32 v47, v47, 3, v46
  s_lshl_b32 s91, s3, 5
  s_add_u32 s91, s91, 94208
  v_add_u32 v46, s91, v47
  v_add_u32 v47, 94336, v47
  v_bfe_u32 v49, v0, 4, 1
  v_lshlrev_b32 v49, 8, v49
  v_lshrrev_b32 v48, 5, v0
  v_lshl_add_u32 v49, v48, 7, v49
  v_and_b32 v48, 7, v0
  v_lshl_add_u32 v49, v48, 4, v49
  v_bfe_u32 v48, v0, 3, 1
  v_lshl_add_u32 v49, v48, 2, v49
  s_and_b32 s91, s3, 1
  s_lshl_b32 s91, s91, 3
  s_and_b32 s92, s3, 2
  s_add_u32 s91, s91, s92
  s_add_u32 s91, s91, 159744
  v_add_u32 v49, s91, v49
  v_and_b32 v74, 0x30, v0
  s_lshl_b32 s91, s3, 4
  s_add_u32 s91, s91, 1
  v_writelane_b32 v74, 64, s91
  s_movk_i32 s91, 80
  v_writelane_b32 v74, s91, 2
  s_movk_i32 s91, 96
  v_writelane_b32 v74, s91, 3
  s_movk_i32 s91, 112
  v_writelane_b32 v74, s91, 4
  s_bfe_u32 s68, s73, 0x80000
  s_bfe_u32 s69, s73, 0x80008
  s_bfe_u32 s70, s73, 0x80010
  s_bfe_u32 s90, s73, 0x80018
  ds_read_b64_tr_b16 v[50:51], v46 offset:0
  ds_read_b64_tr_b16 v[52:53], v46 offset:2560
  ds_read_b64_tr_b16 v[54:55], v47 offset:0
  ds_read_b64_tr_b16 v[56:57], v47 offset:2560
  ds_read_b64_tr_b16 v[58:59], v46 offset:5120
  ds_read_b64_tr_b16 v[60:61], v46 offset:7680
  ds_read_b64_tr_b16 v[62:63], v47 offset:5120
  ds_read_b64_tr_b16 v[64:65], v47 offset:7680
  ds_read_b64_tr_b16 v[66:67], v46 offset:10240
  ds_read_b64_tr_b16 v[68:69], v46 offset:12800
  ds_read_b64_tr_b16 v[70:71], v47 offset:10240
  ds_read_b64_tr_b16 v[72:73], v47 offset:12800
  s_waitcnt vmcnt(0)
L_chk_130:
  v_bitop3_b32 v75, v37, v29, s73 bitop3:0x7e
  v_bitop3_b32 v75, v75, v33, s73 bitop3:0xf6
  v_cmp_ne_u32 vcc, 0, v75
  s_nop 0
  s_cbranch_vccz L_retry_131
  buffer_load_dwordx4 v[34:37], v45, s[64:67], s97 offen nt
  buffer_load_dwordx4 v[26:29], v6, s[64:67], s97 offen offset:0 nt
  buffer_load_dwordx4 v[30:33], v6, s[64:67], s97 offen offset:1024 nt
  s_sub_u32 s75, s75, 1
  s_cbranch_scc1 L_end
  s_waitcnt vmcnt(0)
  s_branch L_chk_130
L_retry_131:
  s_mov_b32 s22, 50429952
  buffer_load_dwordx4 v[76:79], v1, s[36:39], s22 offen offset:0 nt
  buffer_load_dwordx4 v[80:83], v1, s[36:39], s22 offen offset:128 nt
  buffer_load_dwordx4 v[84:87], v1, s[36:39], s22 offen offset:256 nt
  s_mov_b32 s22, 50528256
  buffer_load_dwordx4 v[88:91], v1, s[36:39], s22 offen offset:0 nt
  buffer_load_dwordx4 v[92:95], v1, s[36:39], s22 offen offset:128 nt
  buffer_load_dwordx4 v[96:99], v1, s[36:39], s22 offen offset:256 nt
  v_max_f32_dpp v43, v34, v34 quad_perm:[1,0,3,2] row_mask:0xf bank_mask:0xf
  v_mov_b32 v42, v43
  s_nop 1
  v_permlane32_swap_b32 v43, v42
  v_max_f32 v43, v43, v42
  v_mov_b32 v42, v43
  s_nop 1
  v_permlane16_swap_b32 v43, v42
  v_max_f32 v43, v43, v42
  v_sub_f32 v43, v34, v43
  v_mul_f32 v43, 0x3dd53b95, v43
  v_exp_f32 v43, v43
  s_nop 0
  v_mul_f32 v35, v35, v43
  v_mul_f32_dpp v26, v43, v26 quad_perm:[0,0,2,2] row_mask:0xf bank_mask:0xf
  v_mul_f32_dpp v27, v43, v27 quad_perm:[0,0,2,2] row_mask:0xf bank_mask:0xf
  v_mul_f32_dpp v28, v43, v28 quad_perm:[0,0,2,2] row_mask:0xf bank_mask:0xf
  v_add_f32_dpp v29, v35, v35 quad_perm:[1,0,3,2] row_mask:0xf bank_mask:0xf
  v_fmac_f32_dpp v26, v43, v30 quad_perm:[1,1,3,3] row_mask:0xf bank_mask:0xf
  v_fmac_f32_dpp v27, v43, v31 quad_perm:[1,1,3,3] row_mask:0xf bank_mask:0xf
  v_fmac_f32_dpp v28, v43, v32 quad_perm:[1,1,3,3] row_mask:0xf bank_mask:0xf
  s_nop 0
  v_permlane32_swap_b32 v26, v27
  v_permlane32_swap_b32 v28, v29
  v_add_f32 v26, v26, v27
  v_add_f32 v28, v28, v29
  s_nop 1
  v_permlane16_swap_b32 v26, v28
  v_add_f32 v48, v26, v28
  v_lshrrev_b32 v45, 4, v0
  v_readlane_b32 s92, v48, 48
  v_lshlrev_b32 v45, 3, v45
  v_add_u32 v44, 159744, v45
  v_rcp_f32 v43, s92
  s_mov_b32 exec_hi, 0xffff
  v_mul_f32 v48, v48, v43
  v_cvt_pk_bf16_f32 v48, v48, v48
  ds_write_b16 v49, v48
  s_mov_b64 exec, -1
  s_waitcnt lgkmcnt(0)
  s_barrier
  ds_read2_b64 v[26:29], v44 offset0:0 offset1:4
  ds_read2_b64 v[30:33], v44 offset0:8 offset1:12
  ds_read2_b64 v[34:37], v44 offset0:16 offset1:20
  v_mov_b32 v48, v44
  s_add_u32 s76, s82, 524288
  s_lshl_b32 s91, s3, 4
  s_lshl_b64 vcc, 2, s91
  s_or_b32 s91, vcc_lo, 0x1001d
  s_or_b32 s92, vcc_hi, 0x10001
  v_mov_b32 v49, 0xffffff00
  s_waitcnt lgkmcnt(2)
  v_mfma_f32_16x16x32_bf16 v[38:41], v[50:53], v[26:29], 0
  v_mfma_f32_16x16x32_bf16 v[42:45], v[54:57], v[26:29], 0
  ds_read2_b64 v[26:29], v48 offset0:24 offset1:28
  ds_read_b64_tr_b16 v[50:51], v46 offset:15360
  ds_read_b64_tr_b16 v[52:53], v46 offset:17920
  ds_read_b64_tr_b16 v[54:55], v47 offset:15360
  ds_read_b64_tr_b16 v[56:57], v47 offset:17920
  s_waitcnt lgkmcnt(6)
  v_mfma_f32_16x16x32_bf16 v[38:41], v[58:61], v[30:33], v[38:41]
  v_mfma_f32_16x16x32_bf16 v[42:45], v[62:65], v[30:33], v[42:45]
  ds_read2_b64 v[30:33], v48 offset0:32 offset1:36
  ds_read_b64_tr_b16 v[58:59], v46 offset:20480
  ds_read_b64_tr_b16 v[60:61], v46 offset:23040
  ds_read_b64_tr_b16 v[62:63], v47 offset:20480
  ds_read_b64_tr_b16 v[64:65], v47 offset:23040
  s_waitcnt lgkmcnt(10)
  v_mfma_f32_16x16x32_bf16 v[38:41], v[66:69], v[34:37], v[38:41]
  v_mfma_f32_16x16x32_bf16 v[42:45], v[70:73], v[34:37], v[42:45]
  ds_read2_b64 v[34:37], v48 offset0:40 offset1:44
  ds_read_b64_tr_b16 v[66:67], v46 offset:25600
  ds_read_b64_tr_b16 v[68:69], v46 offset:28160
  ds_read_b64_tr_b16 v[70:71], v47 offset:25600
  ds_read_b64_tr_b16 v[72:73], v47 offset:28160
  s_waitcnt lgkmcnt(10)
  v_mfma_f32_16x16x32_bf16 v[38:41], v[50:53], v[26:29], v[38:41]
  v_mfma_f32_16x16x32_bf16 v[42:45], v[54:57], v[26:29], v[42:45]
  s_waitcnt lgkmcnt(5)
  v_mfma_f32_16x16x32_bf16 v[38:41], v[58:61], v[30:33], v[38:41]
  v_mfma_f32_16x16x32_bf16 v[42:45], v[62:65], v[30:33], v[42:45]
  s_waitcnt lgkmcnt(0)
  v_mfma_f32_16x16x32_bf16 v[38:41], v[66:69], v[34:37], v[38:41]
  v_mfma_f32_16x16x32_bf16 v[42:45], v[70:73], v[34:37], v[42:45]
  s_nop 7
  v_cndmask_b32 v26, v38, v42, vcc
  v_cndmask_b32 v27, v39, v43, vcc
  v_cndmask_b32 v28, v40, v44, vcc
  v_cndmask_b32 v29, v41, v45, vcc
  s_mov_b32 exec_lo, s91
  s_mov_b32 exec_hi, s92
  v_and_or_b32 v26, v26, v49, s68
  v_and_or_b32 v27, v27, v49, s69
  v_and_or_b32 v28, v28, v49, s70
  v_and_or_b32 v29, v29, v49, s90
  buffer_store_dwordx4 v[26:29], v74, s[64:67], s76 offen sc1
  s_mov_b64 exec, -1
  s_waitcnt vmcnt(0)
  v_bfe_u32 v72, v0, 2, 3
  v_lshrrev_b32 v71, 5, v0
  v_mul_u32_u24 v71, 3072, v71
  v_lshl_add_u32 v71, v72, 7, v71
  v_and_b32 v73, 3, v0
  v_lshl_add_u32 v71, v73, 3, v71
  v_lshrrev_b32 v72, 1, v72
  s_mul_i32 s91, s3, 3
  s_add_u32 s91, s91, 0
  s_and_b32 s92, s91, 3
  s_lshr_b32 s91, s91, 2
  v_xor_b32 v73, s92, v72
  s_lshl_b32 s91, s91, 10
  s_add_u32 s91, s91, 63488
  v_lshl_add_u32 v73, v73, 5, v71
  v_add_u32 v42, s91, v73
  ds_read_b64_tr_b16 v[44:45], v42 offset:0
  ds_read_b64_tr_b16 v[46:47], v42 offset:6144
  ds_read_b64_tr_b16 v[48:49], v42 offset:12288
  ds_read_b64_tr_b16 v[50:51], v42 offset:18432
  ds_read_b64_tr_b16 v[52:53], v42 offset:24576
  s_mul_i32 s91, s3, 3
  s_add_u32 s91, s91, 1
  s_and_b32 s92, s91, 3
  s_lshr_b32 s91, s91, 2
  v_xor_b32 v73, s92, v72
  s_lshl_b32 s91, s91, 10
  s_add_u32 s91, s91, 63488
  v_lshl_add_u32 v73, v73, 5, v71
  v_add_u32 v43, s91, v73
  ds_read_b64_tr_b16 v[54:55], v43 offset:0
  ds_read_b64_tr_b16 v[56:57], v43 offset:6144
  ds_read_b64_tr_b16 v[58:59], v43 offset:12288
  ds_read_b64_tr_b16 v[60:61], v43 offset:18432
  ds_read_b64_tr_b16 v[62:63], v43 offset:24576
  s_mul_i32 s91, s3, 3
  s_add_u32 s91, s91, 2
  s_and_b32 s92, s91, 3
  s_lshr_b32 s91, s91, 2
  v_xor_b32 v73, s92, v72
  s_lshl_b32 s91, s91, 10
  s_add_u32 s91, s91, 63488
  v_lshl_add_u32 v73, v73, 5, v71
  v_add_u32 v42, s91, v73
  ds_read_b64_tr_b16 v[64:65], v42 offset:0
  ds_read_b64_tr_b16 v[66:67], v42 offset:6144
  ds_read_b64_tr_b16 v[68:69], v42 offset:12288
  ds_read_b64_tr_b16 v[70:71], v42 offset:18432
  ds_read_b64_tr_b16 v[72:73], v42 offset:24576
  s_add_u32 s73, s72, 2
  v_lshrrev_b32 v74, 3, v0
  v_and_b32 v75, 7, v0
  v_mul_u32_u24 v74, 128, v74
  v_lshl_add_u32 v74, v75, 4, v74
  s_add_u32 s97, s83, 524288
  s_mov_b32 exec_lo, 0x1f1f1f1f
  s_mov_b32 exec_hi, 0x1f1f1f1f
  buffer_load_dwordx4 v[26:29], v74, s[64:67], s97 offen offset:0 sc1
  buffer_load_dwordx4 v[30:33], v74, s[64:67], s97 offen offset:1024 sc1
  buffer_load_dwordx4 v[34:37], v74, s[64:67], s97 offen offset:2048 sc1
  buffer_load_dwordx4 v[38:41], v74, s[64:67], s97 offen offset:3072 sc1
  s_mov_b64 exec, -1
  s_bfe_u32 s68, s73, 0x80000
  s_bfe_u32 s69, s73, 0x80008
  s_bfe_u32 s70, s73, 0x80010
  s_bfe_u32 s90, s73, 0x80018
  s_waitcnt vmcnt(0)
  s_mov_b32 exec_lo, 0x1f1f1f1f
  s_mov_b32 exec_hi, 0x1f1f1f1f
L_chk_132:
  v_xor_b32 v26, s68, v26
  v_xor_b32 v30, s68, v30
  v_xor_b32 v34, s68, v34
  v_xor_b32 v38, s68, v38
  v_xor_b32 v27, s69, v27
  v_xor_b32 v31, s69, v31
  v_xor_b32 v35, s69, v35
  v_xor_b32 v39, s69, v39
  v_xor_b32 v28, s70, v28
  v_xor_b32 v32, s70, v32
  v_xor_b32 v36, s70, v36
  v_xor_b32 v40, s70, v40
  v_xor_b32 v29, s90, v29
  v_xor_b32 v33, s90, v33
  v_xor_b32 v37, s90, v37
  v_xor_b32 v41, s90, v41
  v_or3_b32 v75, v26, v30, v34
  v_or3_b32 v75, v75, v38, v27
  v_or3_b32 v75, v75, v31, v35
  v_or3_b32 v75, v75, v39, v28
  v_or3_b32 v75, v75, v32, v36
  v_or3_b32 v75, v75, v40, v29
  v_or3_b32 v75, v75, v33, v37
  v_or3_b32 v75, v75, v41, v41
  v_and_b32 v75, 0xff, v75
  v_cmp_ne_u32 vcc, 0, v75
  s_nop 0
  s_cbranch_vccz L_retry_133
  buffer_load_dwordx4 v[26:29], v74, s[64:67], s97 offen offset:0 sc1
  buffer_load_dwordx4 v[30:33], v74, s[64:67], s97 offen offset:1024 sc1
  buffer_load_dwordx4 v[34:37], v74, s[64:67], s97 offen offset:2048 sc1
  buffer_load_dwordx4 v[38:41], v74, s[64:67], s97 offen offset:3072 sc1
  s_sub_u32 s75, s75, 1
  s_cbranch_scc1 L_end
  s_waitcnt vmcnt(0)
  s_branch L_chk_132
L_retry_133:
  s_mov_b64 exec, -1
  s_mov_b32 s22, 50626560
  buffer_load_dwordx4 v[100:103], v1, s[36:39], s22 offen offset:0 nt
  buffer_load_dwordx4 v[104:107], v1, s[36:39], s22 offen offset:128 nt
  buffer_load_dwordx4 v[108:111], v1, s[36:39], s22 offen offset:256 nt
  s_mov_b32 exec_lo, 0x1f1f1f1f
  s_mov_b32 exec_hi, 0x1f1f1f1f
  v_pk_add_f32 v[26:27], v[26:27], v[30:31]
  v_pk_add_f32 v[28:29], v[28:29], v[32:33]
  v_pk_add_f32 v[34:35], v[34:35], v[38:39]
  v_pk_add_f32 v[36:37], v[36:37], v[40:41]
  v_pk_add_f32 v[26:27], v[26:27], v[34:35]
  v_pk_add_f32 v[28:29], v[28:29], v[36:37]
  v_add_u32 v33, 160128, v24
  v_add_f32_dpp v30, v26, v26 row_ror:8 row_mask:0xf bank_mask:0x3
  v_add_f32_dpp v31, v28, v28 row_ror:8 row_mask:0xf bank_mask:0x3
  s_nop 0
  v_add_f32_dpp v30, v27, v27 row_ror:8 row_mask:0xf bank_mask:0xc
  v_add_f32_dpp v31, v29, v29 row_ror:8 row_mask:0xf bank_mask:0xc
  s_nop 1
  v_permlane32_swap_b32 v30, v31
  v_add_f32 v30, v30, v31
  v_mov_b32 v31, v30
  s_nop 1
  v_permlane16_swap_b32 v30, v31
  v_add_f32 v30, v30, v31
  v_cvt_pk_bf16_f32 v30, v30, v30
  v_and_b32 v30, 0xffff0000, v30
  v_add_f32 v30, v30, v7
  v_cvt_pk_bf16_f32 v31, v30, v30
  ds_write_b16 v33, v31
  v_and_b32 v7, 0xffff0000, v31
  s_mov_b64 exec, -1
  v_mov_b32 v75, 160128
  v_mov_b32 v32, 161216
  s_mov_b32 vcc_lo, 0x00f000f0
  s_mov_b32 vcc_hi, 0x00f000f0
  v_cndmask_b32 v75, v75, v32, vcc
  v_lshrrev_b32 v32, 4, v0
  v_lshl_add_u32 v75, v32, 3, v75
  s_waitcnt lgkmcnt(0)
  s_barrier
  ds_read2_b64 v[34:37], v75 offset0:0 offset1:4
  ds_read2_b64 v[38:41], v75 offset0:8 offset1:12
  ds_read_b64 v[42:43], v75 offset:128
  s_add_u32 s73, s72, 3
  s_add_u32 s76, s80, 2097152
  s_mul_i32 s91, s31, 240
  s_sub_u32 s91, 2048, s91
  v_lshlrev_b32 v74, 4, v0
  v_writelane_b32 v74, s91, 32
  s_waitcnt lgkmcnt(0)
  v_mfma_f32_16x16x32_bf16 v[26:29], v[34:37], v[44:47], 0
  v_mfma_f32_16x16x32_bf16 v[30:33], v[34:37], v[54:57], 0
  v_mfma_f32_16x16x32_bf16 v[26:29], v[38:41], v[48:51], v[26:29]
  v_mfma_f32_16x16x32_bf16 v[30:33], v[38:41], v[58:61], v[30:33]
  v_mfma_f32_16x16x16_bf16 v[26:29], v[42:43], v[52:53], v[26:29]
  v_mfma_f32_16x16x16_bf16 v[30:33], v[42:43], v[62:63], v[30:33]
  v_mfma_f32_16x16x32_bf16 v[48:51], v[34:37], v[34:37], 0
  v_mfma_f32_16x16x32_bf16 v[44:47], v[34:37], v[64:67], 0
  v_mfma_f32_16x16x32_bf16 v[48:51], v[38:41], v[38:41], v[48:51]
  v_mfma_f32_16x16x32_bf16 v[44:47], v[38:41], v[68:71], v[44:47]
  v_mfma_f32_16x16x16_bf16 v[48:51], v[42:43], v[42:43], v[48:51]
  v_mfma_f32_16x16x16_bf16 v[44:47], v[42:43], v[72:73], v[44:47]
  s_nop 0
  v_mov_b32 v29, s73
  v_mov_b32 v27, v30
  s_nop 4
  v_mov_b32 v28, v44
  v_mov_b32_dpp v26, v48 quad_perm:[0,1,2,3] row_mask:0x4 bank_mask:0xf
  v_mov_b32_dpp v27, v48 row_ror:12 row_mask:0x4 bank_mask:0xf
  s_mov_b32 exec_lo, 0xffff
  s_mov_b32 exec_hi, 1
  buffer_store_dwordx4 v[26:29], v74, s[64:67], s76 offen
  s_mov_b64 exec, -1
  s_getpc_b64 s[0:1]
L_pc_134:
  s_add_u32 s0, s0, L_S144-L_pc_134
  s_addc_u32 s1, s1, 0
  s_mov_b32 s16, 144
  s_mov_b32 s19, 159
  s_min_u32 s17, s18, s19
  s_cmp_lt_u32 s16, s17
  s_cbranch_scc0 L_tg_135
  s_swappc_b64 s[28:29], s[0:1]
L_tb_136:
  s_mov_b32 s77, 0
  s_add_u32 s73, s72, 3
  v_and_b32 v38, 7, v0
  s_add_u32 s91, s27, 2048
  v_lshl_add_u32 v38, v38, 4, s91
  s_add_u32 s97, s81, 2097152
  buffer_load_dwordx4 v[34:37], v38, s[64:67], s97 offen nt
  buffer_load_dwordx4 v[26:29], v6, s[64:67], s97 offen offset:0 nt
  buffer_load_dwordx4 v[30:33], v6, s[64:67], s97 offen offset:1024 nt
  s_cmp_lt_u32 s16, s17
  s_cbranch_scc0 L_tg_137
  s_waitcnt vmcnt(7)
  s_swappc_b64 s[28:29], s[0:1]
L_tb_138:
  v_and_b32 v58, 15, v0
  v_bfe_u32 v60, v0, 4, 1
  v_lshl_add_u32 v58, v60, 5, v58
  v_lshrrev_b32 v60, 5, v0
  v_lshl_add_u32 v58, v60, 4, v58
  s_mul_i32 s91, s3, 96
  s_add_u32 s91, s91, 160448
  v_lshl_add_u32 v58, v58, 1, s91
  v_lshrrev_b32 v61, 2, v6
  v_add_u32 v61, 162528, v61
  ds_read_b32 v60, v61
  s_cmp_lg_u32 s77, 0
  s_cbranch_scc1 L_wz_139
  s_waitcnt vmcnt(3)
L_wb_140:
L_chk_141:
  v_bitop3_b32 v75, v37, v29, s73 bitop3:0x7e
  v_bitop3_b32 v75, v75, v33, s73 bitop3:0xf6
  v_cmp_ne_u32 vcc, 0, v75
  s_nop 0
  s_cbranch_vccnz L_retry_142
  v_pk_add_f32 v[26:27], v[26:27], v[30:31]
  v_add_f32 v28, v28, v32
  v_mov_b32 v29, v28
  v_add_f32_dpp v34, v34, v34 quad_perm:[1,0,3,2] row_mask:0xf bank_mask:0xf
  v_add_f32_dpp v35, v35, v35 quad_perm:[1,0,3,2] row_mask:0xf bank_mask:0xf
  v_permlane32_swap_b32 v26, v27
  v_permlane32_swap_b32 v28, v29
  v_add_f32_dpp v34, v34, v34 quad_perm:[2,3,0,1] row_mask:0xf bank_mask:0xf
  v_add_f32_dpp v35, v35, v35 quad_perm:[2,3,0,1] row_mask:0xf bank_mask:0xf
  v_add_f32 v26, v26, v27
  v_add_f32 v28, v28, v29
  v_add_f32_dpp v34, v34, v34 row_half_mirror row_mask:0xf bank_mask:0xf
  v_add_f32_dpp v35, v35, v35 row_half_mirror row_mask:0xf bank_mask:0xf
  v_permlane16_swap_b32 v26, v28
  v_mul_f32 v35, 0x3acccccd, v35
  v_mul_f32 v34, 0x3acccccd, v34
  v_add_f32 v62, v26, v28
  v_fma_f32 v34, -v35, v35, v34
  v_max_f32 v34, 0, v34
  v_add_f32 v34, 0x3727c5ac, v34
  v_rsq_f32 v34, v34
  s_waitcnt lgkmcnt(0)
  v_fma_f32 v62, -v35, v60, v62
  s_mov_b32 exec_hi, 0xffff
  v_mul_f32 v62, v62, v34
  v_cvt_pk_bf16_f32 v62, v62, v62
  ds_write_b16 v58, v62
  s_mov_b64 exec, -1
  s_waitcnt lgkmcnt(0)
  s_barrier
  s_add_u32 s73, s72, 0
  v_and_b32 v38, 7, v0
  s_add_u32 s91, s27, 2048
  v_lshl_add_u32 v38, v38, 4, s91
  s_add_u32 s97, s81, 1048576
  buffer_load_dwordx4 v[34:37], v38, s[64:67], s97 offen nt
  buffer_load_dwordx4 v[26:29], v6, s[64:67], s97 offen offset:0 nt
  buffer_load_dwordx4 v[30:33], v6, s[64:67], s97 offen offset:1024 nt
  s_mov_b32 s77, 0
  s_cmp_lt_u32 s16, s17
  s_cbranch_scc0 L_tg_147
  s_swappc_b64 s[28:29], s[0:1]
L_tb_148:
  s_cmp_lt_u32 s16, s17
  s_cbranch_scc0 L_tg_149
  s_swappc_b64 s[28:29], s[0:1]
L_tb_150:
  v_and_b32 v66, 7, v0
  v_lshlrev_b32 v66, 4, v66
  v_add_u32 v66, 160448, v66
  ds_read_b128 v[8:11], v66 offset:0
  ds_read_b128 v[12:15], v66 offset:128
  ds_read_b128 v[16:19], v66 offset:256
  s_waitcnt lgkmcnt(0)
.balignl 8, 0xBF800000
  v_mfma_f32_4x4x4_16b_bf16 v[44:47], v[8:9], v[172:173], 0
  v_mfma_f32_4x4x4_16b_bf16 v[48:51], v[8:9], v[184:185], 0
  v_nop_e64
  v_mfma_f32_4x4x4_16b_bf16 v[44:47], v[10:11], v[174:175], v[44:47]
  v_mfma_f32_4x4x4_16b_bf16 v[48:51], v[10:11], v[186:187], v[48:51]
  v_nop_e64
  v_mfma_f32_4x4x4_16b_bf16 v[44:47], v[12:13], v[176:177], v[44:47]
  v_mfma_f32_4x4x4_16b_bf16 v[48:51], v[12:13], v[188:189], v[48:51]
  v_nop_e64
  v_mfma_f32_4x4x4_16b_bf16 v[44:47], v[14:15], v[178:179], v[44:47]
  v_mfma_f32_4x4x4_16b_bf16 v[48:51], v[14:15], v[190:191], v[48:51]
  v_nop_e64
  v_mfma_f32_4x4x4_16b_bf16 v[44:47], v[16:17], v[180:181], v[44:47]
  v_mfma_f32_4x4x4_16b_bf16 v[48:51], v[16:17], v[192:193], v[48:51]
  v_nop_e64
  v_mfma_f32_4x4x4_16b_bf16 v[44:47], v[18:19], v[182:183], v[44:47]
  v_mfma_f32_4x4x4_16b_bf16 v[48:51], v[18:19], v[194:195], v[48:51]
  v_mfma_f32_4x4x4_16b_bf16 v[52:55], v[8:9], v[196:197], 0
  v_mfma_f32_4x4x4_16b_bf16 v[56:59], v[8:9], v[208:209], 0
  v_nop_e64
  v_mfma_f32_4x4x4_16b_bf16 v[52:55], v[10:11], v[198:199], v[52:55]
  v_mov_b32_dpp v60, v44 quad_perm:[0,0,0,0] row_mask:0xf bank_mask:0xf
  v_mfma_f32_4x4x4_16b_bf16 v[56:59], v[10:11], v[210:211], v[56:59]
  v_mov_b32_dpp v61, v48 quad_perm:[0,0,0,0] row_mask:0xf bank_mask:0xf
  v_mfma_f32_4x4x4_16b_bf16 v[52:55], v[12:13], v[200:201], v[52:55]
  v_add_f32_dpp v60, v45, v60 quad_perm:[1,1,1,1] row_mask:0xf bank_mask:0xf
  v_mfma_f32_4x4x4_16b_bf16 v[56:59], v[12:13], v[212:213], v[56:59]
  v_add_f32_dpp v61, v49, v61 quad_perm:[1,1,1,1] row_mask:0xf bank_mask:0xf
  v_mfma_f32_4x4x4_16b_bf16 v[52:55], v[14:15], v[202:203], v[52:55]
  v_add_f32_dpp v60, v46, v60 quad_perm:[2,2,2,2] row_mask:0xf bank_mask:0xf
  v_mfma_f32_4x4x4_16b_bf16 v[56:59], v[14:15], v[214:215], v[56:59]
  v_add_f32_dpp v61, v50, v61 quad_perm:[2,2,2,2] row_mask:0xf bank_mask:0xf
  v_mfma_f32_4x4x4_16b_bf16 v[52:55], v[16:17], v[204:205], v[52:55]
  v_add_f32_dpp v20, v47, v60 quad_perm:[3,3,3,3] row_mask:0xf bank_mask:0xf
  v_mfma_f32_4x4x4_16b_bf16 v[56:59], v[16:17], v[216:217], v[56:59]
  v_add_f32_dpp v61, v51, v61 quad_perm:[3,3,3,3] row_mask:0xf bank_mask:0xf
  v_mfma_f32_4x4x4_16b_bf16 v[52:55], v[18:19], v[206:207], v[52:55]
  v_mfma_f32_4x4x4_16b_bf16 v[56:59], v[18:19], v[218:219], v[56:59]
  v_mfma_f32_4x4x4_16b_bf16 v[44:47], v[8:9], v[220:221], 0
  v_cndmask_b32 v20, v20, v61, s[84:85]
  v_mfma_f32_4x4x4_16b_bf16 v[48:51], v[8:9], v[232:233], 0
  v_mfma_f32_4x4x4_16b_bf16 v[44:47], v[10:11], v[222:223], v[44:47]
  v_mov_b32_dpp v62, v52 quad_perm:[0,0,0,0] row_mask:0xf bank_mask:0xf
  v_mfma_f32_4x4x4_16b_bf16 v[48:51], v[10:11], v[234:235], v[48:51]
  v_mov_b32_dpp v63, v56 quad_perm:[0,0,0,0] row_mask:0xf bank_mask:0xf
  v_mfma_f32_4x4x4_16b_bf16 v[44:47], v[12:13], v[224:225], v[44:47]
  v_add_f32_dpp v62, v53, v62 quad_perm:[1,1,1,1] row_mask:0xf bank_mask:0xf
  v_mfma_f32_4x4x4_16b_bf16 v[48:51], v[12:13], v[236:237], v[48:51]
  v_add_f32_dpp v63, v57, v63 quad_perm:[1,1,1,1] row_mask:0xf bank_mask:0xf
  v_mfma_f32_4x4x4_16b_bf16 v[44:47], v[14:15], v[226:227], v[44:47]
  v_add_f32_dpp v62, v54, v62 quad_perm:[2,2,2,2] row_mask:0xf bank_mask:0xf
  v_mfma_f32_4x4x4_16b_bf16 v[48:51], v[14:15], v[238:239], v[48:51]
  v_add_f32_dpp v63, v58, v63 quad_perm:[2,2,2,2] row_mask:0xf bank_mask:0xf
  v_mfma_f32_4x4x4_16b_bf16 v[44:47], v[16:17], v[228:229], v[44:47]
  v_add_f32_dpp v62, v55, v62 quad_perm:[3,3,3,3] row_mask:0xf bank_mask:0xf
  v_mfma_f32_4x4x4_16b_bf16 v[48:51], v[16:17], v[240:241], v[48:51]
  v_add_f32_dpp v63, v59, v63 quad_perm:[3,3,3,3] row_mask:0xf bank_mask:0xf
  v_mfma_f32_4x4x4_16b_bf16 v[44:47], v[18:19], v[230:231], v[44:47]
  v_mfma_f32_4x4x4_16b_bf16 v[48:51], v[18:19], v[242:243], v[48:51]
  v_mfma_f32_4x4x4_16b_bf16 v[52:55], v[8:9], v[244:245], 0
  v_cndmask_b32 v20, v20, v62, s[86:87]
  v_mfma_f32_4x4x4_16b_bf16 v[56:59], v[8:9], a[0:1], 0
  v_cndmask_b32 v20, v20, v63, s[88:89]
  v_mfma_f32_4x4x4_16b_bf16 v[52:55], v[10:11], v[246:247], v[52:55]
  v_mov_b32_dpp v60, v44 quad_perm:[0,0,0,0] row_mask:0xf bank_mask:0xf
  v_mfma_f32_4x4x4_16b_bf16 v[56:59], v[10:11], a[2:3], v[56:59]
  v_mov_b32_dpp v61, v48 quad_perm:[0,0,0,0] row_mask:0xf bank_mask:0xf
  v_mfma_f32_4x4x4_16b_bf16 v[52:55], v[12:13], v[248:249], v[52:55]
  v_add_f32_dpp v20, v20, v20 row_half_mirror row_mask:0xf bank_mask:0xf
  v_mfma_f32_4x4x4_16b_bf16 v[56:59], v[12:13], a[4:5], v[56:59]
  v_add_f32_dpp v60, v45, v60 quad_perm:[1,1,1,1] row_mask:0xf bank_mask:0xf
  v_mfma_f32_4x4x4_16b_bf16 v[52:55], v[14:15], v[250:251], v[52:55]
  v_add_f32_dpp v61, v49, v61 quad_perm:[1,1,1,1] row_mask:0xf bank_mask:0xf
  v_mfma_f32_4x4x4_16b_bf16 v[56:59], v[14:15], a[6:7], v[56:59]
  v_add_f32_dpp v60, v46, v60 quad_perm:[2,2,2,2] row_mask:0xf bank_mask:0xf
  v_mfma_f32_4x4x4_16b_bf16 v[52:55], v[16:17], v[252:253], v[52:55]
  v_add_f32_dpp v61, v50, v61 quad_perm:[2,2,2,2] row_mask:0xf bank_mask:0xf
  v_mfma_f32_4x4x4_16b_bf16 v[56:59], v[16:17], a[8:9], v[56:59]
  v_add_f32_dpp v21, v47, v60 quad_perm:[3,3,3,3] row_mask:0xf bank_mask:0xf
  v_mfma_f32_4x4x4_16b_bf16 v[52:55], v[18:19], v[254:255], v[52:55]
  v_add_f32_dpp v61, v51, v61 quad_perm:[3,3,3,3] row_mask:0xf bank_mask:0xf
  v_mfma_f32_4x4x4_16b_bf16 v[56:59], v[18:19], a[10:11], v[56:59]
  v_mfma_f32_4x4x4_16b_bf16 v[44:47], v[8:9], a[12:13], 0
  v_cndmask_b32 v21, v21, v61, s[84:85]
  v_mfma_f32_4x4x4_16b_bf16 v[48:51], v[8:9], a[24:25], 0
  v_mfma_f32_4x4x4_16b_bf16 v[44:47], v[10:11], a[14:15], v[44:47]
  v_mov_b32_dpp v62, v52 quad_perm:[0,0,0,0] row_mask:0xf bank_mask:0xf
  v_mfma_f32_4x4x4_16b_bf16 v[48:51], v[10:11], a[26:27], v[48:51]
  v_mov_b32_dpp v63, v56 quad_perm:[0,0,0,0] row_mask:0xf bank_mask:0xf
  v_mfma_f32_4x4x4_16b_bf16 v[44:47], v[12:13], a[16:17], v[44:47]
  v_add_f32_dpp v62, v53, v62 quad_perm:[1,1,1,1] row_mask:0xf bank_mask:0xf
  v_mfma_f32_4x4x4_16b_bf16 v[48:51], v[12:13], a[28:29], v[48:51]
  v_add_f32_dpp v63, v57, v63 quad_perm:[1,1,1,1] row_mask:0xf bank_mask:0xf
  v_mfma_f32_4x4x4_16b_bf16 v[44:47], v[14:15], a[18:19], v[44:47]
  v_add_f32_dpp v62, v54, v62 quad_perm:[2,2,2,2] row_mask:0xf bank_mask:0xf
  v_mfma_f32_4x4x4_16b_bf16 v[48:51], v[14:15], a[30:31], v[48:51]
  v_add_f32_dpp v63, v58, v63 quad_perm:[2,2,2,2] row_mask:0xf bank_mask:0xf
  v_mfma_f32_4x4x4_16b_bf16 v[44:47], v[16:17], a[20:21], v[44:47]
  v_add_f32_dpp v62, v55, v62 quad_perm:[3,3,3,3] row_mask:0xf bank_mask:0xf
  v_mfma_f32_4x4x4_16b_bf16 v[48:51], v[16:17], a[32:33], v[48:51]
  v_add_f32_dpp v63, v59, v63 quad_perm:[3,3,3,3] row_mask:0xf bank_mask:0xf
  v_mfma_f32_4x4x4_16b_bf16 v[44:47], v[18:19], a[22:23], v[44:47]
  v_mfma_f32_4x4x4_16b_bf16 v[48:51], v[18:19], a[34:35], v[48:51]
  v_mfma_f32_4x4x4_16b_bf16 v[52:55], v[8:9], a[36:37], 0
  v_cndmask_b32 v21, v21, v62, s[86:87]
  v_mfma_f32_4x4x4_16b_bf16 v[56:59], v[8:9], a[48:49], 0
  v_cndmask_b32 v21, v21, v63, s[88:89]
  v_mfma_f32_4x4x4_16b_bf16 v[52:55], v[10:11], a[38:39], v[52:55]
  v_mov_b32_dpp v60, v44 quad_perm:[0,0,0,0] row_mask:0xf bank_mask:0xf
  v_mfma_f32_4x4x4_16b_bf16 v[56:59], v[10:11], a[50:51], v[56:59]
  v_mov_b32_dpp v61, v48 quad_perm:[0,0,0,0] row_mask:0xf bank_mask:0xf
  v_mfma_f32_4x4x4_16b_bf16 v[52:55], v[12:13], a[40:41], v[52:55]
  v_add_f32_dpp v21, v21, v21 row_half_mirror row_mask:0xf bank_mask:0xf
  v_mfma_f32_4x4x4_16b_bf16 v[56:59], v[12:13], a[52:53], v[56:59]
  v_add_f32_dpp v60, v45, v60 quad_perm:[1,1,1,1] row_mask:0xf bank_mask:0xf
  v_mfma_f32_4x4x4_16b_bf16 v[52:55], v[14:15], a[42:43], v[52:55]
  v_add_f32_dpp v61, v49, v61 quad_perm:[1,1,1,1] row_mask:0xf bank_mask:0xf
  v_mfma_f32_4x4x4_16b_bf16 v[56:59], v[14:15], a[54:55], v[56:59]
  v_add_f32_dpp v60, v46, v60 quad_perm:[2,2,2,2] row_mask:0xf bank_mask:0xf
  v_mfma_f32_4x4x4_16b_bf16 v[52:55], v[16:17], a[44:45], v[52:55]
  v_add_f32_dpp v61, v50, v61 quad_perm:[2,2,2,2] row_mask:0xf bank_mask:0xf
  v_mfma_f32_4x4x4_16b_bf16 v[56:59], v[16:17], a[56:57], v[56:59]
  v_add_f32_dpp v22, v47, v60 quad_perm:[3,3,3,3] row_mask:0xf bank_mask:0xf
  v_mfma_f32_4x4x4_16b_bf16 v[52:55], v[18:19], a[46:47], v[52:55]
  v_add_f32_dpp v61, v51, v61 quad_perm:[3,3,3,3] row_mask:0xf bank_mask:0xf
  v_mfma_f32_4x4x4_16b_bf16 v[56:59], v[18:19], a[58:59], v[56:59]
  v_mfma_f32_4x4x4_16b_bf16 v[44:47], v[8:9], a[60:61], 0
  v_cndmask_b32 v22, v22, v61, s[84:85]
  v_mfma_f32_4x4x4_16b_bf16 v[48:51], v[8:9], a[72:73], 0
  v_mfma_f32_4x4x4_16b_bf16 v[44:47], v[10:11], a[62:63], v[44:47]
  v_mov_b32_dpp v62, v52 quad_perm:[0,0,0,0] row_mask:0xf bank_mask:0xf
  v_mfma_f32_4x4x4_16b_bf16 v[48:51], v[10:11], a[74:75], v[48:51]
  v_mov_b32_dpp v63, v56 quad_perm:[0,0,0,0] row_mask:0xf bank_mask:0xf
  v_mfma_f32_4x4x4_16b_bf16 v[44:47], v[12:13], a[64:65], v[44:47]
  v_add_f32_dpp v62, v53, v62 quad_perm:[1,1,1,1] row_mask:0xf bank_mask:0xf
  v_mfma_f32_4x4x4_16b_bf16 v[48:51], v[12:13], a[76:77], v[48:51]
  v_add_f32_dpp v63, v57, v63 quad_perm:[1,1,1,1] row_mask:0xf bank_mask:0xf
  v_mfma_f32_4x4x4_16b_bf16 v[44:47], v[14:15], a[66:67], v[44:47]
  v_add_f32_dpp v62, v54, v62 quad_perm:[2,2,2,2] row_mask:0xf bank_mask:0xf
  v_mfma_f32_4x4x4_16b_bf16 v[48:51], v[14:15], a[78:79], v[48:51]
  v_add_f32_dpp v63, v58, v63 quad_perm:[2,2,2,2] row_mask:0xf bank_mask:0xf
  v_mfma_f32_4x4x4_16b_bf16 v[44:47], v[16:17], a[68:69], v[44:47]
  v_add_f32_dpp v62, v55, v62 quad_perm:[3,3,3,3] row_mask:0xf bank_mask:0xf
  v_mfma_f32_4x4x4_16b_bf16 v[48:51], v[16:17], a[80:81], v[48:51]
  v_add_f32_dpp v63, v59, v63 quad_perm:[3,3,3,3] row_mask:0xf bank_mask:0xf
  v_mfma_f32_4x4x4_16b_bf16 v[44:47], v[18:19], a[70:71], v[44:47]
  v_mfma_f32_4x4x4_16b_bf16 v[48:51], v[18:19], a[82:83], v[48:51]
  v_mfma_f32_4x4x4_16b_bf16 v[52:55], v[8:9], a[84:85], 0
  v_cndmask_b32 v22, v22, v62, s[86:87]
  v_mfma_f32_4x4x4_16b_bf16 v[56:59], v[8:9], a[96:97], 0
  v_cndmask_b32 v22, v22, v63, s[88:89]
  v_mfma_f32_4x4x4_16b_bf16 v[52:55], v[10:11], a[86:87], v[52:55]
  v_mov_b32_dpp v60, v44 quad_perm:[0,0,0,0] row_mask:0xf bank_mask:0xf
  v_mfma_f32_4x4x4_16b_bf16 v[56:59], v[10:11], a[98:99], v[56:59]
  v_mov_b32_dpp v61, v48 quad_perm:[0,0,0,0] row_mask:0xf bank_mask:0xf
  v_mfma_f32_4x4x4_16b_bf16 v[52:55], v[12:13], a[88:89], v[52:55]
  v_add_f32_dpp v22, v22, v22 row_half_mirror row_mask:0xf bank_mask:0xf
  v_mfma_f32_4x4x4_16b_bf16 v[56:59], v[12:13], a[100:101], v[56:59]
  v_add_f32_dpp v60, v45, v60 quad_perm:[1,1,1,1] row_mask:0xf bank_mask:0xf
  v_mfma_f32_4x4x4_16b_bf16 v[52:55], v[14:15], a[90:91], v[52:55]
  v_add_f32_dpp v61, v49, v61 quad_perm:[1,1,1,1] row_mask:0xf bank_mask:0xf
  v_mfma_f32_4x4x4_16b_bf16 v[56:59], v[14:15], a[102:103], v[56:59]
  v_add_f32_dpp v60, v46, v60 quad_perm:[2,2,2,2] row_mask:0xf bank_mask:0xf
  v_mfma_f32_4x4x4_16b_bf16 v[52:55], v[16:17], a[92:93], v[52:55]
  v_add_f32_dpp v61, v50, v61 quad_perm:[2,2,2,2] row_mask:0xf bank_mask:0xf
  v_mfma_f32_4x4x4_16b_bf16 v[56:59], v[16:17], a[104:105], v[56:59]
  v_add_f32_dpp v23, v47, v60 quad_perm:[3,3,3,3] row_mask:0xf bank_mask:0xf
  v_mfma_f32_4x4x4_16b_bf16 v[52:55], v[18:19], a[94:95], v[52:55]
  v_add_f32_dpp v61, v51, v61 quad_perm:[3,3,3,3] row_mask:0xf bank_mask:0xf
  v_mfma_f32_4x4x4_16b_bf16 v[56:59], v[18:19], a[106:107], v[56:59]
  v_cndmask_b32 v23, v23, v61, s[84:85]
  s_nop 0
  s_nop 0
  v_mov_b32_dpp v62, v52 quad_perm:[0,0,0,0] row_mask:0xf bank_mask:0xf
  v_nop_e64
  v_mov_b32_dpp v63, v56 quad_perm:[0,0,0,0] row_mask:0xf bank_mask:0xf
  v_add_f32_dpp v62, v53, v62 quad_perm:[1,1,1,1] row_mask:0xf bank_mask:0xf
  v_nop_e64
  v_add_f32_dpp v63, v57, v63 quad_perm:[1,1,1,1] row_mask:0xf bank_mask:0xf
  v_add_f32_dpp v62, v54, v62 quad_perm:[2,2,2,2] row_mask:0xf bank_mask:0xf
  v_nop_e64
  v_add_f32_dpp v63, v58, v63 quad_perm:[2,2,2,2] row_mask:0xf bank_mask:0xf
  v_add_f32_dpp v62, v55, v62 quad_perm:[3,3,3,3] row_mask:0xf bank_mask:0xf
  v_nop_e64
  v_add_f32_dpp v63, v59, v63 quad_perm:[3,3,3,3] row_mask:0xf bank_mask:0xf
  v_cndmask_b32 v23, v23, v62, s[86:87]
  v_cndmask_b32 v23, v23, v63, s[88:89]
  s_nop 0
  s_nop 0
  v_add_f32_dpp v23, v23, v23 row_half_mirror row_mask:0xf bank_mask:0xf
  s_mov_b32 s22, 0
  buffer_load_dwordx4 v[172:175], v1, s[44:47], s22 offen offset:0 nt
  buffer_load_dwordx4 v[176:179], v1, s[44:47], s22 offen offset:128 nt
  buffer_load_dwordx4 v[180:183], v1, s[44:47], s22 offen offset:256 nt
  s_mov_b32 s22, 98304
  buffer_load_dwordx4 v[184:187], v1, s[44:47], s22 offen offset:0 nt
  buffer_load_dwordx4 v[188:191], v1, s[44:47], s22 offen offset:128 nt
  buffer_load_dwordx4 v[192:195], v1, s[44:47], s22 offen offset:256 nt
  s_mov_b32 s22, 196608
  buffer_load_dwordx4 v[196:199], v1, s[44:47], s22 offen offset:0 nt
  buffer_load_dwordx4 v[200:203], v1, s[44:47], s22 offen offset:128 nt
  buffer_load_dwordx4 v[204:207], v1, s[44:47], s22 offen offset:256 nt
  s_mov_b32 s22, 294912
  buffer_load_dwordx4 v[208:211], v1, s[44:47], s22 offen offset:0 nt
  buffer_load_dwordx4 v[212:215], v1, s[44:47], s22 offen offset:128 nt
  buffer_load_dwordx4 v[216:219], v1, s[44:47], s22 offen offset:256 nt
  s_mov_b32 s22, 393216
  buffer_load_dwordx4 v[220:223], v1, s[44:47], s22 offen offset:0 nt
  buffer_load_dwordx4 v[224:227], v1, s[44:47], s22 offen offset:128 nt
  buffer_load_dwordx4 v[228:231], v1, s[44:47], s22 offen offset:256 nt
  s_mov_b32 s22, 491520
  buffer_load_dwordx4 v[232:235], v1, s[44:47], s22 offen offset:0 nt
  buffer_load_dwordx4 v[236:239], v1, s[44:47], s22 offen offset:128 nt
  buffer_load_dwordx4 v[240:243], v1, s[44:47], s22 offen offset:256 nt
  s_mov_b32 s19, 189
  s_min_u32 s17, s18, s19
  s_cmp_lt_u32 s16, s17
  s_cbranch_scc0 L_tg_151
  s_waitcnt vmcnt(9)
  s_swappc_b64 s[28:29], s[0:1]
L_tb_152:
  s_cmp_lt_u32 s16, s17
  s_cbranch_scc0 L_tg_153
  s_waitcnt vmcnt(9)
  s_swappc_b64 s[28:29], s[0:1]
L_tb_154:
  v_and_b32 v58, 15, v0
  v_bfe_u32 v60, v0, 4, 1
  v_lshl_add_u32 v58, v60, 5, v58
  v_lshrrev_b32 v60, 5, v0
  v_lshl_add_u32 v58, v60, 4, v58
  s_mul_i32 s91, s3, 96
  s_add_u32 s91, s91, 160832
  v_lshl_add_u32 v58, v58, 1, s91
  v_lshrrev_b32 v61, 2, v6
  v_add_u32 v61, 161504, v61
  ds_read_b32 v60, v61
  s_cmp_lg_u32 s77, 0
  s_cbranch_scc1 L_wz_155
  s_waitcnt vmcnt(24)
L_wb_156:
L_chk_157:
  v_bitop3_b32 v75, v37, v29, s73 bitop3:0x7e
  v_bitop3_b32 v75, v75, v33, s73 bitop3:0xf6
  v_cmp_ne_u32 vcc, 0, v75
  s_nop 0
  s_cbranch_vccnz L_retry_158
  v_pk_add_f32 v[26:27], v[26:27], v[30:31]
  v_add_f32 v28, v28, v32
  v_mov_b32 v29, v28
  v_add_f32_dpp v34, v34, v34 quad_perm:[1,0,3,2] row_mask:0xf bank_mask:0xf
  v_add_f32_dpp v35, v35, v35 quad_perm:[1,0,3,2] row_mask:0xf bank_mask:0xf
  v_permlane32_swap_b32 v26, v27
  v_permlane32_swap_b32 v28, v29
  v_add_f32_dpp v34, v34, v34 quad_perm:[2,3,0,1] row_mask:0xf bank_mask:0xf
  v_add_f32_dpp v35, v35, v35 quad_perm:[2,3,0,1] row_mask:0xf bank_mask:0xf
  v_add_f32 v26, v26, v27
  v_add_f32 v28, v28, v29
  v_add_f32_dpp v34, v34, v34 row_half_mirror row_mask:0xf bank_mask:0xf
  v_add_f32_dpp v35, v35, v35 row_half_mirror row_mask:0xf bank_mask:0xf
  v_permlane16_swap_b32 v26, v28
  v_mul_f32 v35, 0x3acccccd, v35
  v_mul_f32 v34, 0x3acccccd, v34
  v_add_f32 v62, v26, v28
  v_fma_f32 v34, -v35, v35, v34
  v_max_f32 v34, 0, v34
  v_add_f32 v34, 0x3727c5ac, v34
  v_rsq_f32 v34, v34
  s_waitcnt lgkmcnt(0)
  v_fma_f32 v62, -v35, v60, v62
  s_mov_b32 exec_hi, 0xffff
  v_mul_f32 v62, v62, v34
  v_cvt_pk_bf16_f32 v62, v62, v62
  ds_write_b16 v58, v62
  s_mov_b64 exec, -1
  s_waitcnt lgkmcnt(0)
  s_barrier
L_nw_165:
  s_cmp_ge_u32 s16, 150
  s_cbranch_scc1 L_nx_166
  s_cmp_lt_u32 s16, s17
  s_cbranch_scc0 L_nd_167
  s_waitcnt vmcnt(9)
  s_swappc_b64 s[28:29], s[0:1]
  s_branch L_nw_165
L_nx_166:
  s_waitcnt vmcnt(6)
L_nq_168:
  v_and_b32 v66, 7, v0
  v_lshlrev_b32 v66, 4, v66
  v_add_u32 v66, 160832, v66
  ds_read_b128 v[26:29], v66 offset:0
  ds_read_b128 v[30:33], v66 offset:128
  ds_read_b128 v[34:37], v66 offset:256
  s_waitcnt lgkmcnt(0)
.balignl 8, 0xBF800000
  v_mfma_f32_4x4x4_16b_bf16 v[44:47], v[26:27], a[120:121], 0
  v_mfma_f32_4x4x4_16b_bf16 v[48:51], v[26:27], a[132:133], 0
  v_nop_e64
  v_mfma_f32_4x4x4_16b_bf16 v[44:47], v[28:29], a[122:123], v[44:47]
  v_mfma_f32_4x4x4_16b_bf16 v[48:51], v[28:29], a[134:135], v[48:51]
  v_nop_e64
  v_mfma_f32_4x4x4_16b_bf16 v[44:47], v[30:31], a[124:125], v[44:47]
  v_mfma_f32_4x4x4_16b_bf16 v[48:51], v[30:31], a[136:137], v[48:51]
  v_nop_e64
  v_mfma_f32_4x4x4_16b_bf16 v[44:47], v[32:33], a[126:127], v[44:47]
  v_mfma_f32_4x4x4_16b_bf16 v[48:51], v[32:33], a[138:139], v[48:51]
  v_nop_e64
  v_mfma_f32_4x4x4_16b_bf16 v[44:47], v[34:35], a[128:129], v[44:47]
  v_mfma_f32_4x4x4_16b_bf16 v[48:51], v[34:35], a[140:141], v[48:51]
  v_nop_e64
  v_mfma_f32_4x4x4_16b_bf16 v[44:47], v[36:37], a[130:131], v[44:47]
  v_mfma_f32_4x4x4_16b_bf16 v[48:51], v[36:37], a[142:143], v[48:51]
  v_mfma_f32_4x4x4_16b_bf16 v[52:55], v[26:27], a[144:145], 0
  v_mfma_f32_4x4x4_16b_bf16 v[56:59], v[26:27], a[156:157], 0
  v_nop_e64
  v_mfma_f32_4x4x4_16b_bf16 v[52:55], v[28:29], a[146:147], v[52:55]
  v_mov_b32_dpp v60, v44 quad_perm:[0,0,0,0] row_mask:0xf bank_mask:0xf
  v_mfma_f32_4x4x4_16b_bf16 v[56:59], v[28:29], a[158:159], v[56:59]
  v_mov_b32_dpp v61, v48 quad_perm:[0,0,0,0] row_mask:0xf bank_mask:0xf
  v_mfma_f32_4x4x4_16b_bf16 v[52:55], v[30:31], a[148:149], v[52:55]
  v_add_f32_dpp v60, v45, v60 quad_perm:[1,1,1,1] row_mask:0xf bank_mask:0xf
  v_mfma_f32_4x4x4_16b_bf16 v[56:59], v[30:31], a[160:161], v[56:59]
  v_add_f32_dpp v61, v49, v61 quad_perm:[1,1,1,1] row_mask:0xf bank_mask:0xf
  v_mfma_f32_4x4x4_16b_bf16 v[52:55], v[32:33], a[150:151], v[52:55]
  v_add_f32_dpp v60, v46, v60 quad_perm:[2,2,2,2] row_mask:0xf bank_mask:0xf
  v_mfma_f32_4x4x4_16b_bf16 v[56:59], v[32:33], a[162:163], v[56:59]
  v_add_f32_dpp v61, v50, v61 quad_perm:[2,2,2,2] row_mask:0xf bank_mask:0xf
  v_mfma_f32_4x4x4_16b_bf16 v[52:55], v[34:35], a[152:153], v[52:55]
  v_add_f32_dpp v38, v47, v60 quad_perm:[3,3,3,3] row_mask:0xf bank_mask:0xf
  v_mfma_f32_4x4x4_16b_bf16 v[56:59], v[34:35], a[164:165], v[56:59]
  v_add_f32_dpp v61, v51, v61 quad_perm:[3,3,3,3] row_mask:0xf bank_mask:0xf
  v_mfma_f32_4x4x4_16b_bf16 v[52:55], v[36:37], a[154:155], v[52:55]
  v_mfma_f32_4x4x4_16b_bf16 v[56:59], v[36:37], a[166:167], v[56:59]
  v_cndmask_b32 v38, v38, v61, s[84:85]
  s_nop 0
  s_nop 1
  v_mov_b32_dpp v62, v52 quad_perm:[0,0,0,0] row_mask:0xf bank_mask:0xf
  v_mov_b32_dpp v63, v56 quad_perm:[0,0,0,0] row_mask:0xf bank_mask:0xf
  v_nop_e64
  v_add_f32_dpp v62, v53, v62 quad_perm:[1,1,1,1] row_mask:0xf bank_mask:0xf
  v_add_f32_dpp v63, v57, v63 quad_perm:[1,1,1,1] row_mask:0xf bank_mask:0xf
  v_nop_e64
  v_add_f32_dpp v62, v54, v62 quad_perm:[2,2,2,2] row_mask:0xf bank_mask:0xf
  v_add_f32_dpp v63, v58, v63 quad_perm:[2,2,2,2] row_mask:0xf bank_mask:0xf
  v_nop_e64
  v_add_f32_dpp v62, v55, v62 quad_perm:[3,3,3,3] row_mask:0xf bank_mask:0xf
  v_add_f32_dpp v63, v59, v63 quad_perm:[3,3,3,3] row_mask:0xf bank_mask:0xf
  v_cndmask_b32 v38, v38, v62, s[86:87]
  v_cndmask_b32 v38, v38, v63, s[88:89]
  s_nop 0
  s_nop 0
  v_add_f32_dpp v38, v38, v38 row_half_mirror row_mask:0xf bank_mask:0xf
  s_nop 1
  v_max_f32_dpp v66, v38, v38 quad_perm:[1,0,3,2] row_mask:0xf bank_mask:0xf
  s_nop 1
  v_max_f32_dpp v66, v66, v66 quad_perm:[2,3,0,1] row_mask:0xf bank_mask:0xf
  s_nop 1
  v_max_f32_dpp v66, v66, v66 row_ror:8 row_mask:0xf bank_mask:0xf
  s_nop 1
  v_max_f32_dpp v66, v66, v66 row_bcast:15 row_mask:0xa bank_mask:0xf
  s_nop 1
  v_max_f32_dpp v66, v66, v66 row_bcast:31 row_mask:0xc bank_mask:0xf
  s_nop 0
  v_readlane_b32 s95, v66, 63
  v_mov_b32 v67, s21
  s_nop 0
  v_subrev_f32 v38, s95, v38
  v_mov_b32 v66, s95
  v_mul_f32 v38, 0x3dd53b95, v38
  ds_write_b32 v67, v66 offset:16
  v_exp_f32 v38, v38
  s_nop 1
  v_add_f32_dpp v68, v38, v38 quad_perm:[1,0,3,2] row_mask:0xf bank_mask:0xf
  v_cvt_pk_bf16_f32 v38, v38, v38
.balignl 8, 0xBF800000
  s_nop 0
  s_nop 0
  v_and_b32_dpp v46, v38, v2 quad_perm:[0,0,0,0] row_mask:0xf bank_mask:0xf
  v_and_b32_dpp v47, v38, v3 quad_perm:[0,0,0,0] row_mask:0xf bank_mask:0xf
  v_and_b32_dpp v48, v38, v4 quad_perm:[3,3,3,3] row_mask:0xf bank_mask:0xf
  v_and_b32_dpp v49, v38, v5 quad_perm:[3,3,3,3] row_mask:0xf bank_mask:0xf
  s_nop 0
  s_nop 0
  v_mfma_f32_16x16x32_bf16 v[26:29], v[46:49], a[108:111], 0
  v_and_b32_dpp v50, v38, v2 quad_perm:[1,1,1,1] row_mask:0xf bank_mask:0xf
  v_and_b32_dpp v51, v38, v3 quad_perm:[1,1,1,1] row_mask:0xf bank_mask:0xf
  v_mfma_f32_16x16x32_bf16 v[30:33], v[46:49], a[112:115], 0
  v_and_b32_dpp v52, v38, v4 quad_perm:[2,2,2,2] row_mask:0xf bank_mask:0xf
  v_and_b32_dpp v53, v38, v5 quad_perm:[2,2,2,2] row_mask:0xf bank_mask:0xf
  v_mfma_f32_16x16x32_bf16 v[34:37], v[46:49], a[116:119], 0
  v_add_f32_dpp v68, v68, v68 quad_perm:[2,3,0,1] row_mask:0xf bank_mask:0xf
  s_cmp_lt_u32 s16, s17
  s_cbranch_scc0 L_tg_169
  s_waitcnt vmcnt(9)
  s_swappc_b64 s[28:29], s[0:1]
L_tb_170:
.balignl 8, 0xBF800000
  v_mfma_f32_16x16x32_bf16 v[26:29], v[50:53], v[76:79], v[26:29]
  v_and_b32_dpp v46, v38, v2 quad_perm:[2,2,2,2] row_mask:0xf bank_mask:0xf
  v_and_b32_dpp v47, v38, v3 quad_perm:[2,2,2,2] row_mask:0xf bank_mask:0xf
  v_mfma_f32_16x16x32_bf16 v[30:33], v[50:53], v[80:83], v[30:33]
  v_and_b32_dpp v48, v38, v4 quad_perm:[1,1,1,1] row_mask:0xf bank_mask:0xf
  v_and_b32_dpp v49, v38, v5 quad_perm:[1,1,1,1] row_mask:0xf bank_mask:0xf
  v_mfma_f32_16x16x32_bf16 v[34:37], v[50:53], v[84:87], v[34:37]
  v_add_f32_dpp v68, v68, v68 row_ror:8 row_mask:0xf bank_mask:0xf
  v_mfma_f32_16x16x32_bf16 v[26:29], v[46:49], v[88:91], v[26:29]
  v_and_b32_dpp v50, v38, v2 quad_perm:[3,3,3,3] row_mask:0xf bank_mask:0xf
  v_and_b32_dpp v51, v38, v3 quad_perm:[3,3,3,3] row_mask:0xf bank_mask:0xf
  v_mfma_f32_16x16x32_bf16 v[30:33], v[46:49], v[92:95], v[30:33]
  v_and_b32_dpp v52, v38, v4 quad_perm:[0,0,0,0] row_mask:0xf bank_mask:0xf
  v_and_b32_dpp v53, v38, v5 quad_perm:[0,0,0,0] row_mask:0xf bank_mask:0xf
  v_mfma_f32_16x16x32_bf16 v[34:37], v[46:49], v[96:99], v[34:37]
  v_add_f32_dpp v68, v68, v68 row_bcast:15 row_mask:0xa bank_mask:0xf
  v_mfma_f32_16x16x32_bf16 v[26:29], v[50:53], v[100:103], v[26:29]
  v_mfma_f32_16x16x32_bf16 v[30:33], v[50:53], v[104:107], v[30:33]
  v_mfma_f32_16x16x32_bf16 v[34:37], v[50:53], v[108:111], v[34:37]
  v_add_f32_dpp v68, v68, v68 row_bcast:31 row_mask:0xc bank_mask:0xf
  s_nop 0
  v_readlane_b32 s96, v68, 63
  v_lshrrev_b32 v60, 4, v0
  v_and_b32 v59, 15, v0
  v_lshlrev_b32 v58, 10, v60
  v_lshl_add_u32 v58, v59, 4, v58
  s_lshl_b32 s91, s3, 8
  s_add_u32 s91, s91, 155648
  v_add_u32 v58, s91, v58
  v_add_u32 v59, 155648, v6
  v_mov_b32 v49, s96
  v_permlane32_swap_b32 v26, v27
  v_permlane32_swap_b32 v28, v29
  v_permlane32_swap_b32 v30, v31
  v_permlane32_swap_b32 v32, v33
  v_permlane32_swap_b32 v34, v35
  v_permlane32_swap_b32 v36, v37
  v_add_f32_dpp v46, v27, v26 row_ror:8 row_mask:0xf bank_mask:0x3
  v_add_f32_dpp v47, v31, v30 row_ror:8 row_mask:0xf bank_mask:0x3
  v_add_f32_dpp v48, v35, v34 row_ror:8 row_mask:0xf bank_mask:0x3
  v_add_f32_dpp v46, v28, v29 row_ror:8 row_mask:0xf bank_mask:0xc
  v_add_f32_dpp v47, v32, v33 row_ror:8 row_mask:0xf bank_mask:0xc
  v_add_f32_dpp v48, v36, v37 row_ror:8 row_mask:0xf bank_mask:0xc
  ds_write_b128 v59, v[46:49]
  v_lshlrev_b32 v60, 2, v60
  v_add_u32 v60, 161392, v60
  v_mov_b32 v62, 161392
  s_waitcnt lgkmcnt(0)
  s_barrier
  ds_read_b128 v[54:57], v62
  ds_read_b32 v62, v60
  ds_read_b128 v[50:53], v58
  s_add_u32 s73, s72, 0
  s_mul_i32 s91, s31, 240
  s_sub_u32 s91, 2048, s91
  v_lshlrev_b32 v59, 4, v0
  v_writelane_b32 v59, s91, 16
  v_mov_b32 v49, s73
  s_add_u32 s76, s78, 524288
  s_waitcnt lgkmcnt(1)
  v_max3_f32 v54, v54, v55, v56
  v_max_f32 v54, v54, v57
  v_sub_f32 v62, v62, v54
  v_mul_f32 v62, 0x3dd53b95, v62
  v_exp_f32 v62, v62
  s_waitcnt lgkmcnt(0)
  v_pk_mul_f32 v[50:51], v[50:51], v[62:63] op_sel_hi:[1,0]
  v_pk_mul_f32 v[52:53], v[52:53], v[62:63] op_sel_hi:[1,0]
  s_nop 0
  v_permlane32_swap_b32 v50, v51
  v_permlane32_swap_b32 v52, v53
  v_add_f32 v50, v50, v51
  v_add_f32 v52, v52, v53
  s_nop 1
  v_permlane16_swap_b32 v50, v52
  v_add_f32 v46, v50, v52
  v_add_f32 v47, v50, v52
  s_nop 1
  v_permlane32_swap_b32 v46, v47
  v_mov_b32 v48, v46
  s_nop 1
  v_permlane16_swap_b32 v46, v48
  s_nop 1
  v_mov_b32_dpp v46, v54 quad_perm:[0,1,2,3] row_mask:0x2 bank_mask:0xf
  s_mov_b64 exec, 0x1ffff
  buffer_store_dwordx4 v[46:49], v59, s[64:67], s76 offen
  s_mov_b64 exec, -1
  v_max3_f32 v66, v20, v21, v22
  v_max_f32 v66, v66, v23
  s_nop 1
  v_max_f32_dpp v66, v66, v66 quad_perm:[1,0,3,2] row_mask:0xf bank_mask:0xf
  s_nop 1
  v_max_f32_dpp v66, v66, v66 quad_perm:[2,3,0,1] row_mask:0xf bank_mask:0xf
  s_nop 1
  v_max_f32_dpp v66, v66, v66 row_ror:8 row_mask:0xf bank_mask:0xf
  s_nop 1
  v_max_f32_dpp v66, v66, v66 row_bcast:15 row_mask:0xa bank_mask:0xf
  s_nop 1
  v_max_f32_dpp v66, v66, v66 row_bcast:31 row_mask:0xc bank_mask:0xf
  s_nop 0
  v_readlane_b32 s93, v66, 63
  s_cmp_lt_u32 s16, s17
  s_cbranch_scc0 L_tg_171
  s_waitcnt vmcnt(10)
  s_swappc_b64 s[28:29], s[0:1]
L_tb_172:
  v_mov_b32 v67, s21
  v_subrev_f32 v20, s93, v20
  v_subrev_f32 v21, s93, v21
  v_subrev_f32 v22, s93, v22
  v_subrev_f32 v23, s93, v23
  v_mov_b32 v66, s93
  v_mul_f32 v20, 0x3dd53b95, v20
  v_mul_f32 v21, 0x3dd53b95, v21
  v_mul_f32 v22, 0x3dd53b95, v22
  v_mul_f32 v23, 0x3dd53b95, v23
  ds_write_b32 v67, v66 offset:96
  v_exp_f32 v20, v20
  v_exp_f32 v21, v21
  v_exp_f32 v22, v22
  v_exp_f32 v23, v23
  v_add_f32 v66, v20, v21
  v_add_f32 v68, v22, v23
  v_add_f32 v68, v68, v66
  v_cvt_pk_bf16_f32 v20, v20, v20
  v_cvt_pk_bf16_f32 v21, v21, v21
  v_cvt_pk_bf16_f32 v22, v22, v22
  v_cvt_pk_bf16_f32 v23, v23, v23
.balignl 8, 0xBF800000
  v_and_b32_dpp v46, v21, v2 quad_perm:[2,2,2,2] row_mask:0xf bank_mask:0xf
  v_and_b32_dpp v47, v21, v3 quad_perm:[2,2,2,2] row_mask:0xf bank_mask:0xf
  v_and_b32_dpp v48, v21, v4 quad_perm:[1,1,1,1] row_mask:0xf bank_mask:0xf
  v_and_b32_dpp v49, v21, v5 quad_perm:[1,1,1,1] row_mask:0xf bank_mask:0xf
  s_nop 0
  s_nop 0
  v_mfma_f32_16x16x32_bf16 v[8:11], v[46:49], a[168:171], 0
  v_and_b32_dpp v50, v21, v2 quad_perm:[3,3,3,3] row_mask:0xf bank_mask:0xf
  v_and_b32_dpp v51, v21, v3 quad_perm:[3,3,3,3] row_mask:0xf bank_mask:0xf
  v_mfma_f32_16x16x32_bf16 v[12:15], v[46:49], a[172:175], 0
  v_and_b32_dpp v52, v21, v4 quad_perm:[0,0,0,0] row_mask:0xf bank_mask:0xf
  v_and_b32_dpp v53, v21, v5 quad_perm:[0,0,0,0] row_mask:0xf bank_mask:0xf
  v_mfma_f32_16x16x32_bf16 v[16:19], v[46:49], a[176:179], 0
  v_add_f32_dpp v68, v68, v68 quad_perm:[1,0,3,2] row_mask:0xf bank_mask:0xf
  v_mfma_f32_16x16x32_bf16 v[8:11], v[50:53], a[180:183], v[8:11]
  v_and_b32_dpp v46, v22, v2 quad_perm:[0,0,0,0] row_mask:0xf bank_mask:0xf
  v_and_b32_dpp v47, v22, v3 quad_perm:[0,0,0,0] row_mask:0xf bank_mask:0xf
  v_mfma_f32_16x16x32_bf16 v[12:15], v[50:53], a[184:187], v[12:15]
  v_and_b32_dpp v48, v22, v4 quad_perm:[3,3,3,3] row_mask:0xf bank_mask:0xf
  v_and_b32_dpp v49, v22, v5 quad_perm:[3,3,3,3] row_mask:0xf bank_mask:0xf
  v_mfma_f32_16x16x32_bf16 v[16:19], v[50:53], a[188:191], v[16:19]
  v_add_f32_dpp v68, v68, v68 quad_perm:[2,3,0,1] row_mask:0xf bank_mask:0xf
  v_mfma_f32_16x16x32_bf16 v[8:11], v[46:49], a[192:195], v[8:11]
  v_and_b32_dpp v50, v22, v2 quad_perm:[1,1,1,1] row_mask:0xf bank_mask:0xf
  v_and_b32_dpp v51, v22, v3 quad_perm:[1,1,1,1] row_mask:0xf bank_mask:0xf
  v_mfma_f32_16x16x32_bf16 v[12:15], v[46:49], a[196:199], v[12:15]
  v_and_b32_dpp v52, v22, v4 quad_perm:[2,2,2,2] row_mask:0xf bank_mask:0xf
  v_and_b32_dpp v53, v22, v5 quad_perm:[2,2,2,2] row_mask:0xf bank_mask:0xf
  v_mfma_f32_16x16x32_bf16 v[16:19], v[46:49], a[200:203], v[16:19]
  v_add_f32_dpp v68, v68, v68 row_ror:8 row_mask:0xf bank_mask:0xf
  v_mfma_f32_16x16x32_bf16 v[8:11], v[50:53], a[204:207], v[8:11]
  v_mfma_f32_16x16x32_bf16 v[12:15], v[50:53], a[208:211], v[12:15]
  v_mfma_f32_16x16x32_bf16 v[16:19], v[50:53], a[212:215], v[16:19]
  v_add_f32_dpp v68, v68, v68 row_bcast:15 row_mask:0xa bank_mask:0xf
  s_nop 1
  v_add_f32_dpp v68, v68, v68 row_bcast:31 row_mask:0xc bank_mask:0xf
  s_nop 0
  v_readlane_b32 s94, v68, 63
  s_cmp_lt_u32 s16, s17
  s_cbranch_scc0 L_tg_173
  s_waitcnt vmcnt(10)
  s_swappc_b64 s[28:29], s[0:1]
L_tb_174:
  s_mov_b32 s77, 0
  s_add_u32 s73, s72, 0
  v_lshrrev_b32 v45, 4, v0
  v_and_b32 v44, 1, v0
  v_lshl_add_u32 v45, v44, 2, v45
  s_add_u32 s91, s27, 2048
  v_lshl_add_u32 v45, v45, 4, s91
  s_add_u32 s97, s79, 524288
  buffer_load_dwordx4 v[34:37], v45, s[64:67], s97 offen nt
  buffer_load_dwordx4 v[26:29], v6, s[64:67], s97 offen offset:0 nt
  buffer_load_dwordx4 v[30:33], v6, s[64:67], s97 offen offset:1024 nt
  s_cmp_lt_u32 s16, s17
  s_cbranch_scc0 L_tg_175
  s_waitcnt vmcnt(13)
  s_swappc_b64 s[28:29], s[0:1]
L_tb_176:
  s_cmp_lt_u32 s16, s17
  s_cbranch_scc0 L_tg_177
  s_waitcnt vmcnt(13)
  s_swappc_b64 s[28:29], s[0:1]
L_tb_178:
  v_lshrrev_b32 v46, 2, v0
  v_and_b32 v47, 3, v0
  v_mul_u32_u24 v46, 160, v46
  v_lshl_add_u32 v47, v47, 3, v46
  s_lshl_b32 s91, s3, 5
  s_add_u32 s91, s91, 94208
  v_add_u32 v46, s91, v47
  v_add_u32 v47, 94336, v47
  v_bfe_u32 v49, v0, 4, 1
  v_lshlrev_b32 v49, 8, v49
  v_lshrrev_b32 v48, 5, v0
  v_lshl_add_u32 v49, v48, 7, v49
  v_and_b32 v48, 7, v0
  v_lshl_add_u32 v49, v48, 4, v49
  v_bfe_u32 v48, v0, 3, 1
  v_lshl_add_u32 v49, v48, 2, v49
  s_and_b32 s91, s3, 1
  s_lshl_b32 s91, s91, 3
  s_and_b32 s92, s3, 2
  s_add_u32 s91, s91, s92
  s_add_u32 s91, s91, 159744
  v_add_u32 v49, s91, v49
  v_and_b32 v74, 0x30, v0
  s_lshl_b32 s91, s3, 4
  s_add_u32 s91, s91, 1
  v_writelane_b32 v74, 64, s91
  s_movk_i32 s91, 80
  v_writelane_b32 v74, s91, 2
  s_movk_i32 s91, 96
  v_writelane_b32 v74, s91, 3
  s_movk_i32 s91, 112
  v_writelane_b32 v74, s91, 4
  s_bfe_u32 s68, s73, 0x80000
  s_bfe_u32 s69, s73, 0x80008
  s_bfe_u32 s70, s73, 0x80010
  s_bfe_u32 s90, s73, 0x80018
  s_cmp_lg_u32 s77, 0
  s_cbranch_scc1 L_wz_179
  s_waitcnt vmcnt(6)
L_wb_180:
L_chk_181:
  v_bitop3_b32 v75, v37, v29, s73 bitop3:0x7e
  v_bitop3_b32 v75, v75, v33, s73 bitop3:0xf6
  v_cmp_ne_u32 vcc, 0, v75
  s_nop 0
  s_cbranch_vccnz L_retry_182
  v_max_f32_dpp v43, v34, v34 quad_perm:[1,0,3,2] row_mask:0xf bank_mask:0xf
  v_mov_b32 v42, v43
  ds_read_b64_tr_b16 v[50:51], v46 offset:0
  ds_read_b64_tr_b16 v[52:53], v46 offset:2560
  ds_read_b64_tr_b16 v[54:55], v47 offset:0
  ds_read_b64_tr_b16 v[56:57], v47 offset:2560
  v_permlane32_swap_b32 v43, v42
  v_max_f32 v43, v43, v42
  v_mov_b32 v42, v43
  ds_read_b64_tr_b16 v[58:59], v46 offset:5120
  ds_read_b64_tr_b16 v[60:61], v46 offset:7680
  ds_read_b64_tr_b16 v[62:63], v47 offset:5120
  ds_read_b64_tr_b16 v[64:65], v47 offset:7680
  v_permlane16_swap_b32 v43, v42
  v_max_f32 v43, v43, v42
  v_sub_f32 v43, v34, v43
  v_mul_f32 v43, 0x3dd53b95, v43
  v_exp_f32 v43, v43
  ds_read_b64_tr_b16 v[66:67], v46 offset:10240
  ds_read_b64_tr_b16 v[68:69], v46 offset:12800
  ds_read_b64_tr_b16 v[70:71], v47 offset:10240
  ds_read_b64_tr_b16 v[72:73], v47 offset:12800
  v_mul_f32 v35, v35, v43
  v_mul_f32_dpp v26, v43, v26 quad_perm:[0,0,2,2] row_mask:0xf bank_mask:0xf
  v_mul_f32_dpp v27, v43, v27 quad_perm:[0,0,2,2] row_mask:0xf bank_mask:0xf
  v_mul_f32_dpp v28, v43, v28 quad_perm:[0,0,2,2] row_mask:0xf bank_mask:0xf
  v_add_f32_dpp v29, v35, v35 quad_perm:[1,0,3,2] row_mask:0xf bank_mask:0xf
  v_fmac_f32_dpp v26, v43, v30 quad_perm:[1,1,3,3] row_mask:0xf bank_mask:0xf
  v_fmac_f32_dpp v27, v43, v31 quad_perm:[1,1,3,3] row_mask:0xf bank_mask:0xf
  v_fmac_f32_dpp v28, v43, v32 quad_perm:[1,1,3,3] row_mask:0xf bank_mask:0xf
  s_nop 0
  v_permlane32_swap_b32 v26, v27
  v_permlane32_swap_b32 v28, v29
  v_add_f32 v26, v26, v27
  v_add_f32 v28, v28, v29
  s_nop 1
  v_permlane16_swap_b32 v26, v28
  v_add_f32 v48, v26, v28
  v_lshrrev_b32 v45, 4, v0
  v_readlane_b32 s92, v48, 48
  v_lshlrev_b32 v45, 3, v45
  v_add_u32 v44, 159744, v45
  v_rcp_f32 v43, s92
  s_mov_b32 exec_hi, 0xffff
  v_mul_f32 v48, v48, v43
  v_cvt_pk_bf16_f32 v48, v48, v48
  ds_write_b16 v49, v48
  s_mov_b64 exec, -1
  s_waitcnt lgkmcnt(0)
  s_barrier
  ds_read2_b64 v[26:29], v44 offset0:0 offset1:4
  ds_read2_b64 v[30:33], v44 offset0:8 offset1:12
  ds_read2_b64 v[34:37], v44 offset0:16 offset1:20
  v_mov_b32 v48, v44
  s_add_u32 s76, s82, 131072
  s_lshl_b32 s91, s3, 4
  s_lshl_b64 vcc, 2, s91
  s_or_b32 s91, vcc_lo, 0x1001d
  s_or_b32 s92, vcc_hi, 0x10001
  v_mov_b32 v49, 0xffffff00
  s_waitcnt lgkmcnt(2)
  v_mfma_f32_16x16x32_bf16 v[38:41], v[50:53], v[26:29], 0
  v_mfma_f32_16x16x32_bf16 v[42:45], v[54:57], v[26:29], 0
  ds_read2_b64 v[26:29], v48 offset0:24 offset1:28
  ds_read_b64_tr_b16 v[50:51], v46 offset:15360
  ds_read_b64_tr_b16 v[52:53], v46 offset:17920
  ds_read_b64_tr_b16 v[54:55], v47 offset:15360
  ds_read_b64_tr_b16 v[56:57], v47 offset:17920
  s_waitcnt lgkmcnt(6)
  v_mfma_f32_16x16x32_bf16 v[38:41], v[58:61], v[30:33], v[38:41]
  v_mfma_f32_16x16x32_bf16 v[42:45], v[62:65], v[30:33], v[42:45]
  ds_read2_b64 v[30:33], v48 offset0:32 offset1:36
  ds_read_b64_tr_b16 v[58:59], v46 offset:20480
  ds_read_b64_tr_b16 v[60:61], v46 offset:23040
  ds_read_b64_tr_b16 v[62:63], v47 offset:20480
  ds_read_b64_tr_b16 v[64:65], v47 offset:23040
  s_waitcnt lgkmcnt(10)
  v_mfma_f32_16x16x32_bf16 v[38:41], v[66:69], v[34:37], v[38:41]
  v_mfma_f32_16x16x32_bf16 v[42:45], v[70:73], v[34:37], v[42:45]
  ds_read2_b64 v[34:37], v48 offset0:40 offset1:44
  ds_read_b64_tr_b16 v[66:67], v46 offset:25600
  ds_read_b64_tr_b16 v[68:69], v46 offset:28160
  ds_read_b64_tr_b16 v[70:71], v47 offset:25600
  ds_read_b64_tr_b16 v[72:73], v47 offset:28160
  s_cmp_lt_u32 s16, s17
  s_cbranch_scc0 L_tg_189
  s_swappc_b64 s[28:29], s[0:1]
L_tb_190:
  s_waitcnt lgkmcnt(10)
  v_mfma_f32_16x16x32_bf16 v[38:41], v[50:53], v[26:29], v[38:41]
  v_mfma_f32_16x16x32_bf16 v[42:45], v[54:57], v[26:29], v[42:45]
  s_waitcnt lgkmcnt(5)
  v_mfma_f32_16x16x32_bf16 v[38:41], v[58:61], v[30:33], v[38:41]
  v_mfma_f32_16x16x32_bf16 v[42:45], v[62:65], v[30:33], v[42:45]
  s_waitcnt lgkmcnt(0)
  v_mfma_f32_16x16x32_bf16 v[38:41], v[66:69], v[34:37], v[38:41]
  v_mfma_f32_16x16x32_bf16 v[42:45], v[70:73], v[34:37], v[42:45]
  s_nop 7
  v_cndmask_b32 v26, v38, v42, vcc
  v_cndmask_b32 v27, v39, v43, vcc
  v_cndmask_b32 v28, v40, v44, vcc
  v_cndmask_b32 v29, v41, v45, vcc
  s_mov_b32 exec_lo, s91
  s_mov_b32 exec_hi, s92
  v_and_or_b32 v26, v26, v49, s68
  v_and_or_b32 v27, v27, v49, s69
  v_and_or_b32 v28, v28, v49, s70
  v_and_or_b32 v29, v29, v49, s90
  buffer_store_dwordx4 v[26:29], v74, s[64:67], s76 offen sc1
  s_mov_b64 exec, -1
.balignl 8, 0xBF800000
  v_and_b32_dpp v46, v22, v2 quad_perm:[2,2,2,2] row_mask:0xf bank_mask:0xf
  v_and_b32_dpp v47, v22, v3 quad_perm:[2,2,2,2] row_mask:0xf bank_mask:0xf
  v_and_b32_dpp v48, v22, v4 quad_perm:[1,1,1,1] row_mask:0xf bank_mask:0xf
  v_and_b32_dpp v49, v22, v5 quad_perm:[1,1,1,1] row_mask:0xf bank_mask:0xf
  s_cmp_lt_u32 s16, s17
  s_cbranch_scc0 L_tg_191
  s_swappc_b64 s[28:29], s[0:1]
L_tb_192:
.balignl 8, 0xBF800000
  v_mfma_f32_16x16x32_bf16 v[8:11], v[46:49], a[216:219], v[8:11]
  v_and_b32_dpp v50, v22, v2 quad_perm:[3,3,3,3] row_mask:0xf bank_mask:0xf
  v_and_b32_dpp v51, v22, v3 quad_perm:[3,3,3,3] row_mask:0xf bank_mask:0xf
  v_mfma_f32_16x16x32_bf16 v[12:15], v[46:49], a[220:223], v[12:15]
  v_and_b32_dpp v52, v22, v4 quad_perm:[0,0,0,0] row_mask:0xf bank_mask:0xf
  v_and_b32_dpp v53, v22, v5 quad_perm:[0,0,0,0] row_mask:0xf bank_mask:0xf
  v_mfma_f32_16x16x32_bf16 v[16:19], v[46:49], a[224:227], v[16:19]
  v_nop_e64
  v_mfma_f32_16x16x32_bf16 v[8:11], v[50:53], a[228:231], v[8:11]
  v_and_b32_dpp v46, v23, v2 quad_perm:[0,0,0,0] row_mask:0xf bank_mask:0xf
  v_and_b32_dpp v47, v23, v3 quad_perm:[0,0,0,0] row_mask:0xf bank_mask:0xf
  v_mfma_f32_16x16x32_bf16 v[12:15], v[50:53], a[232:235], v[12:15]
  v_and_b32_dpp v48, v23, v4 quad_perm:[3,3,3,3] row_mask:0xf bank_mask:0xf
  v_and_b32_dpp v49, v23, v5 quad_perm:[3,3,3,3] row_mask:0xf bank_mask:0xf
  v_mfma_f32_16x16x32_bf16 v[16:19], v[50:53], a[236:239], v[16:19]
  v_nop_e64
  v_mfma_f32_16x16x32_bf16 v[8:11], v[46:49], a[240:243], v[8:11]
  v_and_b32_dpp v50, v23, v2 quad_perm:[1,1,1,1] row_mask:0xf bank_mask:0xf
  v_and_b32_dpp v51, v23, v3 quad_perm:[1,1,1,1] row_mask:0xf bank_mask:0xf
  v_mfma_f32_16x16x32_bf16 v[12:15], v[46:49], a[244:247], v[12:15]
  v_and_b32_dpp v52, v23, v4 quad_perm:[2,2,2,2] row_mask:0xf bank_mask:0xf
  v_and_b32_dpp v53, v23, v5 quad_perm:[2,2,2,2] row_mask:0xf bank_mask:0xf
  v_mfma_f32_16x16x32_bf16 v[16:19], v[46:49], a[248:251], v[16:19]
  ds_read_b128 v[56:59], v6 offset:0
  ds_read_b128 v[60:63], v6 offset:4096
  s_waitcnt lgkmcnt(0)
  v_mfma_f32_16x16x32_bf16 v[8:11], v[50:53], a[252:255], v[8:11]
  v_and_b32_dpp v46, v23, v2 quad_perm:[2,2,2,2] row_mask:0xf bank_mask:0xf
  v_and_b32_dpp v47, v23, v3 quad_perm:[2,2,2,2] row_mask:0xf bank_mask:0xf
  v_mfma_f32_16x16x32_bf16 v[12:15], v[50:53], v[56:59], v[12:15]
  v_and_b32_dpp v48, v23, v4 quad_perm:[1,1,1,1] row_mask:0xf bank_mask:0xf
  v_and_b32_dpp v49, v23, v5 quad_perm:[1,1,1,1] row_mask:0xf bank_mask:0xf
  v_mfma_f32_16x16x32_bf16 v[16:19], v[50:53], v[60:63], v[16:19]
  ds_read_b128 v[56:59], v6 offset:8192
  ds_read_b128 v[60:63], v6 offset:12288
  ds_read_b128 v[64:67], v6 offset:16384
  s_waitcnt lgkmcnt(0)
  v_mfma_f32_16x16x32_bf16 v[8:11], v[46:49], v[56:59], v[8:11]
  v_and_b32_dpp v50, v23, v2 quad_perm:[3,3,3,3] row_mask:0xf bank_mask:0xf
  v_and_b32_dpp v51, v23, v3 quad_perm:[3,3,3,3] row_mask:0xf bank_mask:0xf
  v_mfma_f32_16x16x32_bf16 v[12:15], v[46:49], v[60:63], v[12:15]
  v_and_b32_dpp v52, v23, v4 quad_perm:[0,0,0,0] row_mask:0xf bank_mask:0xf
  v_and_b32_dpp v53, v23, v5 quad_perm:[0,0,0,0] row_mask:0xf bank_mask:0xf
  v_mfma_f32_16x16x32_bf16 v[16:19], v[46:49], v[64:67], v[16:19]
  ds_read_b128 v[56:59], v6 offset:20480
  ds_read_b128 v[60:63], v6 offset:24576
  ds_read_b128 v[64:67], v6 offset:28672
  s_waitcnt lgkmcnt(0)
  v_mfma_f32_16x16x32_bf16 v[8:11], v[50:53], v[56:59], v[8:11]
  v_and_b32_dpp v46, v20, v2 quad_perm:[0,0,0,0] row_mask:0xf bank_mask:0xf
  v_and_b32_dpp v47, v20, v3 quad_perm:[0,0,0,0] row_mask:0xf bank_mask:0xf
  v_mfma_f32_16x16x32_bf16 v[12:15], v[50:53], v[60:63], v[12:15]
  v_and_b32_dpp v48, v20, v4 quad_perm:[3,3,3,3] row_mask:0xf bank_mask:0xf
  v_and_b32_dpp v49, v20, v5 quad_perm:[3,3,3,3] row_mask:0xf bank_mask:0xf
  v_mfma_f32_16x16x32_bf16 v[16:19], v[50:53], v[64:67], v[16:19]
  s_cmp_lt_u32 s16, s17
  s_cbranch_scc0 L_tg_193
  s_waitcnt vmcnt(10)
  s_swappc_b64 s[28:29], s[0:1]
L_tb_194:
.balignl 8, 0xBF800000
  v_mfma_f32_16x16x32_bf16 v[8:11], v[46:49], v[172:175], v[8:11]
  v_and_b32_dpp v50, v20, v2 quad_perm:[1,1,1,1] row_mask:0xf bank_mask:0xf
  v_and_b32_dpp v51, v20, v3 quad_perm:[1,1,1,1] row_mask:0xf bank_mask:0xf
  v_mfma_f32_16x16x32_bf16 v[12:15], v[46:49], v[176:179], v[12:15]
  v_and_b32_dpp v52, v20, v4 quad_perm:[2,2,2,2] row_mask:0xf bank_mask:0xf
  v_and_b32_dpp v53, v20, v5 quad_perm:[2,2,2,2] row_mask:0xf bank_mask:0xf
  v_mfma_f32_16x16x32_bf16 v[16:19], v[46:49], v[180:183], v[16:19]
  v_nop_e64
  v_mfma_f32_16x16x32_bf16 v[8:11], v[50:53], v[184:187], v[8:11]
  v_and_b32_dpp v46, v20, v2 quad_perm:[2,2,2,2] row_mask:0xf bank_mask:0xf
  v_and_b32_dpp v47, v20, v3 quad_perm:[2,2,2,2] row_mask:0xf bank_mask:0xf
  v_mfma_f32_16x16x32_bf16 v[12:15], v[50:53], v[188:191], v[12:15]
  v_and_b32_dpp v48, v20, v4 quad_perm:[1,1,1,1] row_mask:0xf bank_mask:0xf
  v_and_b32_dpp v49, v20, v5 quad_perm:[1,1,1,1] row_mask:0xf bank_mask:0xf
  v_mfma_f32_16x16x32_bf16 v[16:19], v[50:53], v[192:195], v[16:19]
  v_nop_e64
  v_mfma_f32_16x16x32_bf16 v[8:11], v[46:49], v[196:199], v[8:11]
  v_and_b32_dpp v50, v20, v2 quad_perm:[3,3,3,3] row_mask:0xf bank_mask:0xf
  v_and_b32_dpp v51, v20, v3 quad_perm:[3,3,3,3] row_mask:0xf bank_mask:0xf
  v_mfma_f32_16x16x32_bf16 v[12:15], v[46:49], v[200:203], v[12:15]
  v_and_b32_dpp v52, v20, v4 quad_perm:[0,0,0,0] row_mask:0xf bank_mask:0xf
  v_and_b32_dpp v53, v20, v5 quad_perm:[0,0,0,0] row_mask:0xf bank_mask:0xf
  v_mfma_f32_16x16x32_bf16 v[16:19], v[46:49], v[204:207], v[16:19]
  v_nop_e64
  v_mfma_f32_16x16x32_bf16 v[8:11], v[50:53], v[208:211], v[8:11]
  v_and_b32_dpp v46, v21, v2 quad_perm:[0,0,0,0] row_mask:0xf bank_mask:0xf
  v_and_b32_dpp v47, v21, v3 quad_perm:[0,0,0,0] row_mask:0xf bank_mask:0xf
  v_mfma_f32_16x16x32_bf16 v[12:15], v[50:53], v[212:215], v[12:15]
  v_and_b32_dpp v48, v21, v4 quad_perm:[3,3,3,3] row_mask:0xf bank_mask:0xf
  v_and_b32_dpp v49, v21, v5 quad_perm:[3,3,3,3] row_mask:0xf bank_mask:0xf
  v_mfma_f32_16x16x32_bf16 v[16:19], v[50:53], v[216:219], v[16:19]
  v_nop_e64
  v_mfma_f32_16x16x32_bf16 v[8:11], v[46:49], v[220:223], v[8:11]
  v_and_b32_dpp v50, v21, v2 quad_perm:[1,1,1,1] row_mask:0xf bank_mask:0xf
  v_and_b32_dpp v51, v21, v3 quad_perm:[1,1,1,1] row_mask:0xf bank_mask:0xf
  v_mfma_f32_16x16x32_bf16 v[12:15], v[46:49], v[224:227], v[12:15]
  v_and_b32_dpp v52, v21, v4 quad_perm:[2,2,2,2] row_mask:0xf bank_mask:0xf
  v_and_b32_dpp v53, v21, v5 quad_perm:[2,2,2,2] row_mask:0xf bank_mask:0xf
  v_mfma_f32_16x16x32_bf16 v[16:19], v[46:49], v[228:231], v[16:19]
  v_nop_e64
  v_mfma_f32_16x16x32_bf16 v[8:11], v[50:53], v[232:235], v[8:11]
  v_mfma_f32_16x16x32_bf16 v[12:15], v[50:53], v[236:239], v[12:15]
  v_mfma_f32_16x16x32_bf16 v[16:19], v[50:53], v[240:243], v[16:19]
  s_mov_b32 s19, 237
  s_min_u32 s17, s18, s19
  v_lshrrev_b32 v60, 4, v0
  v_and_b32 v59, 15, v0
  v_lshlrev_b32 v58, 10, v60
  v_lshl_add_u32 v58, v59, 4, v58
  s_lshl_b32 s91, s3, 8
  s_add_u32 s91, s91, 155648
  v_add_u32 v58, s91, v58
  v_add_u32 v59, 155648, v6
  v_mov_b32 v49, s94
  v_permlane32_swap_b32 v8, v9
  v_permlane32_swap_b32 v10, v11
  v_permlane32_swap_b32 v12, v13
  v_permlane32_swap_b32 v14, v15
  v_permlane32_swap_b32 v16, v17
  v_permlane32_swap_b32 v18, v19
  v_add_f32_dpp v46, v9, v8 row_ror:8 row_mask:0xf bank_mask:0x3
  v_add_f32_dpp v47, v13, v12 row_ror:8 row_mask:0xf bank_mask:0x3
  v_add_f32_dpp v48, v17, v16 row_ror:8 row_mask:0xf bank_mask:0x3
  v_add_f32_dpp v46, v10, v11 row_ror:8 row_mask:0xf bank_mask:0xc
  v_add_f32_dpp v47, v14, v15 row_ror:8 row_mask:0xf bank_mask:0xc
  v_add_f32_dpp v48, v18, v19 row_ror:8 row_mask:0xf bank_mask:0xc
  ds_write_b128 v59, v[46:49]
  v_lshlrev_b32 v60, 2, v60
  v_add_u32 v60, 161472, v60
  v_mov_b32 v62, 161472
  s_waitcnt lgkmcnt(0)
  s_barrier
  ds_read_b128 v[54:57], v62
  ds_read_b32 v62, v60
  ds_read_b128 v[50:53], v58
  s_add_u32 s73, s72, 3
  s_mul_i32 s91, s31, 240
  s_sub_u32 s91, 2048, s91
  v_lshlrev_b32 v59, 4, v0
  v_writelane_b32 v59, s91, 16
  v_mov_b32 v49, s73
  s_add_u32 s76, s78, 0
  s_cmp_lt_u32 s16, s17
  s_cbranch_scc0 L_tg_195
  s_waitcnt vmcnt(10)
  s_swappc_b64 s[28:29], s[0:1]
L_tb_196:
  s_waitcnt lgkmcnt(1)
  v_max3_f32 v54, v54, v55, v56
  v_max_f32 v54, v54, v57
  v_sub_f32 v62, v62, v54
  v_mul_f32 v62, 0x3dd53b95, v62
  v_exp_f32 v62, v62
  s_waitcnt lgkmcnt(0)
  v_pk_mul_f32 v[50:51], v[50:51], v[62:63] op_sel_hi:[1,0]
  v_pk_mul_f32 v[52:53], v[52:53], v[62:63] op_sel_hi:[1,0]
  s_nop 0
  v_permlane32_swap_b32 v50, v51
  v_permlane32_swap_b32 v52, v53
  v_add_f32 v50, v50, v51
  v_add_f32 v52, v52, v53
  s_nop 1
  v_permlane16_swap_b32 v50, v52
  v_add_f32 v46, v50, v52
  v_add_f32 v47, v50, v52
  s_nop 1
  v_permlane32_swap_b32 v46, v47
  v_mov_b32 v48, v46
  s_nop 1
  v_permlane16_swap_b32 v46, v48
  s_nop 1
  v_mov_b32_dpp v46, v54 quad_perm:[0,1,2,3] row_mask:0x2 bank_mask:0xf
  s_mov_b64 exec, 0x1ffff
  buffer_store_dwordx4 v[46:49], v59, s[64:67], s76 offen
  s_mov_b64 exec, -1
  s_getpc_b64 s[98:99]
L_pw_197:
  s_sub_u32 s98, s98, L_pw_197-interleave_layers__sliding_block_cached__gqa_block_cached__decode_kernel
  s_subb_u32 s99, s99, 0
  s_lshr_b32 s91, s2, 3
  s_lshl_b32 s91, s91, 2
  s_add_u32 s91, s91, s3
  s_lshl_b32 s91, s91, 9
  v_lshl_add_u32 v73, v0, 7, s91
  v_min_u32 v73, L_cold-interleave_layers__sliding_block_cached__gqa_block_cached__decode_kernel-4, v73
  s_mov_b64 exec, 0xf
  global_load_dword v56, v73, s[98:99]
  s_mov_b64 exec, -1
  s_cmp_lt_u32 s16, s17
  s_cbranch_scc0 L_tg_198
  s_waitcnt vmcnt(12)
  s_swappc_b64 s[28:29], s[0:1]
L_tb_199:
  s_mov_b32 s77, 0
  s_add_u32 s73, s72, 3
  v_lshrrev_b32 v45, 4, v0
  v_and_b32 v44, 1, v0
  v_lshl_add_u32 v45, v44, 2, v45
  s_add_u32 s91, s27, 2048
  v_lshl_add_u32 v45, v45, 4, s91
  s_add_u32 s97, s79, 0
  buffer_load_dwordx4 v[34:37], v45, s[64:67], s97 offen nt
  buffer_load_dwordx4 v[26:29], v6, s[64:67], s97 offen offset:0 nt
  buffer_load_dwordx4 v[30:33], v6, s[64:67], s97 offen offset:1024 nt
  s_cmp_lt_u32 s16, s17
  s_cbranch_scc0 L_tg_200
  s_waitcnt vmcnt(14)
  s_swappc_b64 s[28:29], s[0:1]
L_tb_201:
  s_cmp_lt_u32 s16, s17
  s_cbranch_scc0 L_tg_202
  s_waitcnt vmcnt(14)
  s_swappc_b64 s[28:29], s[0:1]
L_tb_203:
  v_lshrrev_b32 v46, 2, v0
  v_and_b32 v47, 3, v0
  v_mul_u32_u24 v46, 160, v46
  v_lshl_add_u32 v47, v47, 3, v46
  s_lshl_b32 s91, s3, 5
  s_add_u32 s91, s91, 124928
  v_add_u32 v46, s91, v47
  v_add_u32 v47, 125056, v47
  v_bfe_u32 v49, v0, 4, 1
  v_lshlrev_b32 v49, 8, v49
  v_lshrrev_b32 v48, 5, v0
  v_lshl_add_u32 v49, v48, 7, v49
  v_and_b32 v48, 7, v0
  v_lshl_add_u32 v49, v48, 4, v49
  v_bfe_u32 v48, v0, 3, 1
  v_lshl_add_u32 v49, v48, 2, v49
  s_and_b32 s91, s3, 1
  s_lshl_b32 s91, s91, 3
  s_and_b32 s92, s3, 2
  s_add_u32 s91, s91, s92
  s_add_u32 s91, s91, 159744
  v_add_u32 v49, s91, v49
  v_and_b32 v74, 0x30, v0
  s_lshl_b32 s91, s3, 4
  s_add_u32 s91, s91, 1
  v_writelane_b32 v74, 64, s91
  s_movk_i32 s91, 80
  v_writelane_b32 v74, s91, 2
  s_movk_i32 s91, 96
  v_writelane_b32 v74, s91, 3
  s_movk_i32 s91, 112
  v_writelane_b32 v74, s91, 4
  s_bfe_u32 s68, s73, 0x80000
  s_bfe_u32 s69, s73, 0x80008
  s_bfe_u32 s70, s73, 0x80010
  s_bfe_u32 s90, s73, 0x80018
  s_cmp_lg_u32 s77, 0
  s_cbranch_scc1 L_wz_204
  s_waitcnt vmcnt(6)
L_wb_205:
L_chk_206:
  v_bitop3_b32 v75, v37, v29, s73 bitop3:0x7e
  v_bitop3_b32 v75, v75, v33, s73 bitop3:0xf6
  v_cmp_ne_u32 vcc, 0, v75
  s_nop 0
  s_cbranch_vccnz L_retry_207
  v_max_f32_dpp v43, v34, v34 quad_perm:[1,0,3,2] row_mask:0xf bank_mask:0xf
  v_mov_b32 v42, v43
  ds_read_b64_tr_b16 v[50:51], v46 offset:0
  ds_read_b64_tr_b16 v[52:53], v46 offset:2560
  ds_read_b64_tr_b16 v[54:55], v47 offset:0
  ds_read_b64_tr_b16 v[56:57], v47 offset:2560
  v_permlane32_swap_b32 v43, v42
  v_max_f32 v43, v43, v42
  v_mov_b32 v42, v43
  ds_read_b64_tr_b16 v[58:59], v46 offset:5120
  ds_read_b64_tr_b16 v[60:61], v46 offset:7680
  ds_read_b64_tr_b16 v[62:63], v47 offset:5120
  ds_read_b64_tr_b16 v[64:65], v47 offset:7680
  v_permlane16_swap_b32 v43, v42
  v_max_f32 v43, v43, v42
  v_sub_f32 v43, v34, v43
  v_mul_f32 v43, 0x3dd53b95, v43
  v_exp_f32 v43, v43
  ds_read_b64_tr_b16 v[66:67], v46 offset:10240
  ds_read_b64_tr_b16 v[68:69], v46 offset:12800
  ds_read_b64_tr_b16 v[70:71], v47 offset:10240
  ds_read_b64_tr_b16 v[72:73], v47 offset:12800
  v_mul_f32 v35, v35, v43
  v_mul_f32_dpp v26, v43, v26 quad_perm:[0,0,2,2] row_mask:0xf bank_mask:0xf
  v_mul_f32_dpp v27, v43, v27 quad_perm:[0,0,2,2] row_mask:0xf bank_mask:0xf
  v_mul_f32_dpp v28, v43, v28 quad_perm:[0,0,2,2] row_mask:0xf bank_mask:0xf
  v_add_f32_dpp v29, v35, v35 quad_perm:[1,0,3,2] row_mask:0xf bank_mask:0xf
  v_fmac_f32_dpp v26, v43, v30 quad_perm:[1,1,3,3] row_mask:0xf bank_mask:0xf
  v_fmac_f32_dpp v27, v43, v31 quad_perm:[1,1,3,3] row_mask:0xf bank_mask:0xf
  v_fmac_f32_dpp v28, v43, v32 quad_perm:[1,1,3,3] row_mask:0xf bank_mask:0xf
  s_nop 0
  v_permlane32_swap_b32 v26, v27
  v_permlane32_swap_b32 v28, v29
  v_add_f32 v26, v26, v27
  v_add_f32 v28, v28, v29
  s_nop 1
  v_permlane16_swap_b32 v26, v28
  v_add_f32 v48, v26, v28
  v_lshrrev_b32 v45, 4, v0
  v_readlane_b32 s92, v48, 48
  v_lshlrev_b32 v45, 3, v45
  v_add_u32 v44, 159744, v45
  v_rcp_f32 v43, s92
  s_mov_b32 exec_hi, 0xffff
  v_mul_f32 v48, v48, v43
  v_cvt_pk_bf16_f32 v48, v48, v48
  ds_write_b16 v49, v48
  s_mov_b64 exec, -1
  s_waitcnt lgkmcnt(0)
  s_barrier
  ds_read2_b64 v[26:29], v44 offset0:0 offset1:4
  ds_read2_b64 v[30:33], v44 offset0:8 offset1:12
  ds_read2_b64 v[34:37], v44 offset0:16 offset1:20
  v_mov_b32 v48, v44
  s_add_u32 s76, s82, 786432
  s_lshl_b32 s91, s3, 4
  s_lshl_b64 vcc, 2, s91
  s_or_b32 s91, vcc_lo, 0x1001d
  s_or_b32 s92, vcc_hi, 0x10001
  v_mov_b32 v49, 0xffffff00
  s_waitcnt lgkmcnt(2)
  v_mfma_f32_16x16x32_bf16 v[38:41], v[50:53], v[26:29], 0
  v_mfma_f32_16x16x32_bf16 v[42:45], v[54:57], v[26:29], 0
  ds_read2_b64 v[26:29], v48 offset0:24 offset1:28
  ds_read_b64_tr_b16 v[50:51], v46 offset:15360
  ds_read_b64_tr_b16 v[52:53], v46 offset:17920
  ds_read_b64_tr_b16 v[54:55], v47 offset:15360
  ds_read_b64_tr_b16 v[56:57], v47 offset:17920
  s_waitcnt lgkmcnt(6)
  v_mfma_f32_16x16x32_bf16 v[38:41], v[58:61], v[30:33], v[38:41]
  v_mfma_f32_16x16x32_bf16 v[42:45], v[62:65], v[30:33], v[42:45]
  ds_read2_b64 v[30:33], v48 offset0:32 offset1:36
  ds_read_b64_tr_b16 v[58:59], v46 offset:20480
  ds_read_b64_tr_b16 v[60:61], v46 offset:23040
  ds_read_b64_tr_b16 v[62:63], v47 offset:20480
  ds_read_b64_tr_b16 v[64:65], v47 offset:23040
  s_waitcnt lgkmcnt(10)
  v_mfma_f32_16x16x32_bf16 v[38:41], v[66:69], v[34:37], v[38:41]
  v_mfma_f32_16x16x32_bf16 v[42:45], v[70:73], v[34:37], v[42:45]
  ds_read2_b64 v[34:37], v48 offset0:40 offset1:44
  ds_read_b64_tr_b16 v[66:67], v46 offset:25600
  ds_read_b64_tr_b16 v[68:69], v46 offset:28160
  ds_read_b64_tr_b16 v[70:71], v47 offset:25600
  ds_read_b64_tr_b16 v[72:73], v47 offset:28160
  s_cmp_lt_u32 s16, s17
  s_cbranch_scc0 L_tg_214
  s_swappc_b64 s[28:29], s[0:1]
L_tb_215:
  s_waitcnt lgkmcnt(10)
  v_mfma_f32_16x16x32_bf16 v[38:41], v[50:53], v[26:29], v[38:41]
  v_mfma_f32_16x16x32_bf16 v[42:45], v[54:57], v[26:29], v[42:45]
  s_waitcnt lgkmcnt(5)
  v_mfma_f32_16x16x32_bf16 v[38:41], v[58:61], v[30:33], v[38:41]
  v_mfma_f32_16x16x32_bf16 v[42:45], v[62:65], v[30:33], v[42:45]
  s_waitcnt lgkmcnt(0)
  v_mfma_f32_16x16x32_bf16 v[38:41], v[66:69], v[34:37], v[38:41]
  v_mfma_f32_16x16x32_bf16 v[42:45], v[70:73], v[34:37], v[42:45]
  s_nop 7
  v_cndmask_b32 v26, v38, v42, vcc
  v_cndmask_b32 v27, v39, v43, vcc
  v_cndmask_b32 v28, v40, v44, vcc
  v_cndmask_b32 v29, v41, v45, vcc
  s_mov_b32 exec_lo, s91
  s_mov_b32 exec_hi, s92
  v_and_or_b32 v26, v26, v49, s68
  v_and_or_b32 v27, v27, v49, s69
  v_and_or_b32 v28, v28, v49, s70
  v_and_or_b32 v29, v29, v49, s90
  buffer_store_dwordx4 v[26:29], v74, s[64:67], s76 offen sc1
  s_mov_b64 exec, -1
  s_mov_b32 s77, 0
  s_add_u32 s73, s72, 0
  v_lshrrev_b32 v74, 3, v0
  v_and_b32 v75, 7, v0
  v_mul_u32_u24 v74, 128, v74
  v_lshl_add_u32 v74, v75, 4, v74
  s_add_u32 s97, s83, 131072
  s_mov_b32 exec_lo, 0x1f1f1f1f
  s_mov_b32 exec_hi, 0x1f1f1f1f
  buffer_load_dwordx4 v[26:29], v74, s[64:67], s97 offen offset:0 sc1
  buffer_load_dwordx4 v[30:33], v74, s[64:67], s97 offen offset:1024 sc1
  buffer_load_dwordx4 v[34:37], v74, s[64:67], s97 offen offset:2048 sc1
  buffer_load_dwordx4 v[38:41], v74, s[64:67], s97 offen offset:3072 sc1
  s_mov_b64 exec, -1
  s_bfe_u32 s68, s73, 0x80000
  s_bfe_u32 s69, s73, 0x80008
  s_bfe_u32 s70, s73, 0x80010
  s_bfe_u32 s90, s73, 0x80018
  s_cmp_lt_u32 s16, s17
  s_cbranch_scc0 L_tg_216
  s_swappc_b64 s[28:29], s[0:1]
L_tb_217:
  s_cmp_lt_u32 s16, s17
  s_cbranch_scc0 L_tg_218
  s_waitcnt vmcnt(14)
  s_swappc_b64 s[28:29], s[0:1]
L_tb_219:
  s_cmp_lg_u32 s77, 0
  s_cbranch_scc1 L_wz_220
  s_waitcnt vmcnt(6)
L_wb_221:
  s_mov_b32 exec_lo, 0x1f1f1f1f
  s_mov_b32 exec_hi, 0x1f1f1f1f
L_chk_222:
  v_xor_b32 v26, s68, v26
  v_xor_b32 v30, s68, v30
  v_xor_b32 v34, s68, v34
  v_xor_b32 v38, s68, v38
  v_xor_b32 v27, s69, v27
  v_xor_b32 v31, s69, v31
  v_xor_b32 v35, s69, v35
  v_xor_b32 v39, s69, v39
  v_xor_b32 v28, s70, v28
  v_xor_b32 v32, s70, v32
  v_xor_b32 v36, s70, v36
  v_xor_b32 v40, s70, v40
  v_xor_b32 v29, s90, v29
  v_xor_b32 v33, s90, v33
  v_xor_b32 v37, s90, v37
  v_xor_b32 v41, s90, v41
  v_or3_b32 v75, v26, v30, v34
  v_or3_b32 v75, v75, v38, v27
  v_or3_b32 v75, v75, v31, v35
  v_or3_b32 v75, v75, v39, v28
  v_or3_b32 v75, v75, v32, v36
  v_or3_b32 v75, v75, v40, v29
  v_or3_b32 v75, v75, v33, v37
  v_or3_b32 v75, v75, v41, v41
  v_and_b32 v75, 0xff, v75
  v_cmp_ne_u32 vcc, 0, v75
  s_nop 0
  s_cbranch_vccnz L_retry_223
  v_pk_add_f32 v[26:27], v[26:27], v[30:31]
  v_pk_add_f32 v[28:29], v[28:29], v[32:33]
  v_pk_add_f32 v[34:35], v[34:35], v[38:39]
  v_pk_add_f32 v[36:37], v[36:37], v[40:41]
  v_pk_add_f32 v[26:27], v[26:27], v[34:35]
  v_pk_add_f32 v[28:29], v[28:29], v[36:37]
  v_add_u32 v33, 160288, v24
  v_add_f32_dpp v30, v26, v26 row_ror:8 row_mask:0xf bank_mask:0x3
  v_add_f32_dpp v31, v28, v28 row_ror:8 row_mask:0xf bank_mask:0x3
  s_nop 0
  v_add_f32_dpp v30, v27, v27 row_ror:8 row_mask:0xf bank_mask:0xc
  v_add_f32_dpp v31, v29, v29 row_ror:8 row_mask:0xf bank_mask:0xc
  s_nop 1
  v_permlane32_swap_b32 v30, v31
  v_add_f32 v30, v30, v31
  v_mov_b32 v31, v30
  s_nop 1
  v_permlane16_swap_b32 v30, v31
  v_add_f32 v30, v30, v31
  v_cvt_pk_bf16_f32 v30, v30, v30
  v_and_b32 v30, 0xffff0000, v30
  v_add_f32 v30, v30, v25
  v_cvt_pk_bf16_f32 v31, v30, v30
  ds_write_b16 v33, v31
  v_and_b32 v25, 0xffff0000, v31
  s_mov_b64 exec, -1
  v_bfe_u32 v72, v0, 2, 3
  v_lshrrev_b32 v71, 5, v0
  v_mul_u32_u24 v71, 3072, v71
  v_lshl_add_u32 v71, v72, 7, v71
  v_and_b32 v73, 3, v0
  v_lshl_add_u32 v71, v73, 3, v71
  v_lshrrev_b32 v72, 1, v72
  s_mul_i32 s91, s3, 3
  s_add_u32 s91, s91, 0
  s_and_b32 s92, s91, 3
  s_lshr_b32 s91, s91, 2
  v_xor_b32 v73, s92, v72
  s_lshl_b32 s91, s91, 10
  s_add_u32 s91, s91, 63488
  v_lshl_add_u32 v73, v73, 5, v71
  v_add_u32 v42, s91, v73
  ds_read_b64_tr_b16 v[44:45], v42 offset:0
  ds_read_b64_tr_b16 v[46:47], v42 offset:6144
  ds_read_b64_tr_b16 v[48:49], v42 offset:12288
  ds_read_b64_tr_b16 v[50:51], v42 offset:18432
  ds_read_b64_tr_b16 v[52:53], v42 offset:24576
  s_mul_i32 s91, s3, 3
  s_add_u32 s91, s91, 1
  s_and_b32 s92, s91, 3
  s_lshr_b32 s91, s91, 2
  v_xor_b32 v73, s92, v72
  s_lshl_b32 s91, s91, 10
  s_add_u32 s91, s91, 63488
  v_lshl_add_u32 v73, v73, 5, v71
  v_add_u32 v43, s91, v73
  ds_read_b64_tr_b16 v[54:55], v43 offset:0
  ds_read_b64_tr_b16 v[56:57], v43 offset:6144
  ds_read_b64_tr_b16 v[58:59], v43 offset:12288
  ds_read_b64_tr_b16 v[60:61], v43 offset:18432
  ds_read_b64_tr_b16 v[62:63], v43 offset:24576
  s_mul_i32 s91, s3, 3
  s_add_u32 s91, s91, 2
  s_and_b32 s92, s91, 3
  s_lshr_b32 s91, s91, 2
  v_xor_b32 v73, s92, v72
  s_lshl_b32 s91, s91, 10
  s_add_u32 s91, s91, 63488
  v_lshl_add_u32 v73, v73, 5, v71
  v_add_u32 v42, s91, v73
  ds_read_b64_tr_b16 v[64:65], v42 offset:0
  ds_read_b64_tr_b16 v[66:67], v42 offset:6144
  ds_read_b64_tr_b16 v[68:69], v42 offset:12288
  ds_read_b64_tr_b16 v[70:71], v42 offset:18432
  ds_read_b64_tr_b16 v[72:73], v42 offset:24576
  v_mov_b32 v75, 160288
  v_mov_b32 v32, 161216
  s_mov_b32 vcc_lo, 0x00f000f0
  s_mov_b32 vcc_hi, 0x00f000f0
  v_cndmask_b32 v75, v75, v32, vcc
  v_lshrrev_b32 v32, 4, v0
  v_lshl_add_u32 v75, v32, 3, v75
  s_waitcnt lgkmcnt(0)
  s_barrier
  ds_read2_b64 v[34:37], v75 offset0:0 offset1:4
  ds_read2_b64 v[38:41], v75 offset0:8 offset1:12
  ds_read_b64 v[42:43], v75 offset:128
  s_add_u32 s73, s72, 1
  s_add_u32 s76, s80, 3145728
  s_mul_i32 s91, s31, 240
  s_sub_u32 s91, 2048, s91
  v_lshlrev_b32 v74, 4, v0
  v_writelane_b32 v74, s91, 32
  s_cmp_lt_u32 s16, s17
  s_cbranch_scc0 L_tg_230
  s_swappc_b64 s[28:29], s[0:1]
L_tb_231:
  s_waitcnt lgkmcnt(0)
  v_mfma_f32_16x16x32_bf16 v[26:29], v[34:37], v[44:47], 0
  v_mfma_f32_16x16x32_bf16 v[30:33], v[34:37], v[54:57], 0
  v_mfma_f32_16x16x32_bf16 v[26:29], v[38:41], v[48:51], v[26:29]
  v_mfma_f32_16x16x32_bf16 v[30:33], v[38:41], v[58:61], v[30:33]
  v_mfma_f32_16x16x16_bf16 v[26:29], v[42:43], v[52:53], v[26:29]
  v_mfma_f32_16x16x16_bf16 v[30:33], v[42:43], v[62:63], v[30:33]
  v_mfma_f32_16x16x32_bf16 v[48:51], v[34:37], v[34:37], 0
  v_mfma_f32_16x16x32_bf16 v[44:47], v[34:37], v[64:67], 0
  v_mfma_f32_16x16x32_bf16 v[48:51], v[38:41], v[38:41], v[48:51]
  v_mfma_f32_16x16x32_bf16 v[44:47], v[38:41], v[68:71], v[44:47]
  v_mfma_f32_16x16x16_bf16 v[48:51], v[42:43], v[42:43], v[48:51]
  v_mfma_f32_16x16x16_bf16 v[44:47], v[42:43], v[72:73], v[44:47]
  s_nop 0
  v_mov_b32 v29, s73
  v_mov_b32 v27, v30
  s_nop 4
  v_mov_b32 v28, v44
  v_mov_b32_dpp v26, v48 quad_perm:[0,1,2,3] row_mask:0x4 bank_mask:0xf
  v_mov_b32_dpp v27, v48 row_ror:12 row_mask:0x4 bank_mask:0xf
  s_mov_b32 exec_lo, 0xffff
  s_mov_b32 exec_hi, 1
  buffer_store_dwordx4 v[26:29], v74, s[64:67], s76 offen
  s_mov_b64 exec, -1
  s_mov_b32 s77, 0
  s_add_u32 s73, s72, 1
  v_and_b32 v38, 7, v0
  s_add_u32 s91, s27, 2048
  v_lshl_add_u32 v38, v38, 4, s91
  s_add_u32 s97, s81, 3145728
  buffer_load_dwordx4 v[34:37], v38, s[64:67], s97 offen nt
  buffer_load_dwordx4 v[26:29], v6, s[64:67], s97 offen offset:0 nt
  buffer_load_dwordx4 v[30:33], v6, s[64:67], s97 offen offset:1024 nt
  s_cmp_lt_u32 s16, s17
  s_cbranch_scc0 L_tg_232
  s_swappc_b64 s[28:29], s[0:1]
L_tb_233:
  s_cmp_lt_u32 s16, s17
  s_cbranch_scc0 L_tg_234
  s_waitcnt vmcnt(13)
  s_swappc_b64 s[28:29], s[0:1]
L_tb_235:
  v_and_b32 v58, 15, v0
  v_bfe_u32 v60, v0, 4, 1
  v_lshl_add_u32 v58, v60, 5, v58
  v_lshrrev_b32 v60, 5, v0
  v_lshl_add_u32 v58, v60, 4, v58
  s_mul_i32 s91, s3, 96
  s_add_u32 s91, s91, 160832
  v_lshl_add_u32 v58, v58, 1, s91
  v_lshrrev_b32 v61, 2, v6
  v_add_u32 v61, 162528, v61
  ds_read_b32 v60, v61
  s_cmp_lg_u32 s77, 0
  s_cbranch_scc1 L_wz_236
  s_waitcnt vmcnt(6)
L_wb_237:
L_chk_238:
  v_bitop3_b32 v75, v37, v29, s73 bitop3:0x7e
  v_bitop3_b32 v75, v75, v33, s73 bitop3:0xf6
  v_cmp_ne_u32 vcc, 0, v75
  s_nop 0
  s_cbranch_vccnz L_retry_239
  v_pk_add_f32 v[26:27], v[26:27], v[30:31]
  v_add_f32 v28, v28, v32
  v_mov_b32 v29, v28
  v_add_f32_dpp v34, v34, v34 quad_perm:[1,0,3,2] row_mask:0xf bank_mask:0xf
  v_add_f32_dpp v35, v35, v35 quad_perm:[1,0,3,2] row_mask:0xf bank_mask:0xf
  v_permlane32_swap_b32 v26, v27
  v_permlane32_swap_b32 v28, v29
  v_add_f32_dpp v34, v34, v34 quad_perm:[2,3,0,1] row_mask:0xf bank_mask:0xf
  v_add_f32_dpp v35, v35, v35 quad_perm:[2,3,0,1] row_mask:0xf bank_mask:0xf
  v_add_f32 v26, v26, v27
  v_add_f32 v28, v28, v29
  v_add_f32_dpp v34, v34, v34 row_half_mirror row_mask:0xf bank_mask:0xf
  v_add_f32_dpp v35, v35, v35 row_half_mirror row_mask:0xf bank_mask:0xf
  v_permlane16_swap_b32 v26, v28
  v_mul_f32 v35, 0x3acccccd, v35
  v_mul_f32 v34, 0x3acccccd, v34
  v_add_f32 v62, v26, v28
  v_fma_f32 v34, -v35, v35, v34
  v_max_f32 v34, 0, v34
  v_add_f32 v34, 0x3727c5ac, v34
  v_rsq_f32 v34, v34
  s_waitcnt lgkmcnt(0)
  v_fma_f32 v62, -v35, v60, v62
  s_mov_b32 exec_hi, 0xffff
  v_mul_f32 v62, v62, v34
  v_cvt_pk_bf16_f32 v62, v62, v62
  ds_write_b16 v58, v62
  s_mov_b64 exec, -1
  s_waitcnt lgkmcnt(0)
  s_barrier
L_nw_246:
  s_cmp_ge_u32 s16, 198
  s_cbranch_scc1 L_nx_247
  s_cmp_lt_u32 s16, s17
  s_cbranch_scc0 L_nd_248
  s_waitcnt vmcnt(9)
  s_swappc_b64 s[28:29], s[0:1]
  s_branch L_nw_246
L_nx_247:
  s_waitcnt vmcnt(6)
L_nq_249:
  v_and_b32 v66, 7, v0
  v_lshlrev_b32 v66, 4, v66
  v_add_u32 v66, 160832, v66
  ds_read_b128 v[8:11], v66 offset:0
  ds_read_b128 v[12:15], v66 offset:128
  ds_read_b128 v[16:19], v66 offset:256
  s_waitcnt lgkmcnt(0)
.balignl 8, 0xBF800000
  v_mfma_f32_4x4x4_16b_bf16 v[44:47], v[8:9], v[112:113], 0
  v_mfma_f32_4x4x4_16b_bf16 v[48:51], v[8:9], v[124:125], 0
  v_nop_e64
  v_mfma_f32_4x4x4_16b_bf16 v[44:47], v[10:11], v[114:115], v[44:47]
  v_mfma_f32_4x4x4_16b_bf16 v[48:51], v[10:11], v[126:127], v[48:51]
  v_nop_e64
  v_mfma_f32_4x4x4_16b_bf16 v[44:47], v[12:13], v[116:117], v[44:47]
  v_mfma_f32_4x4x4_16b_bf16 v[48:51], v[12:13], v[128:129], v[48:51]
  v_nop_e64
  v_mfma_f32_4x4x4_16b_bf16 v[44:47], v[14:15], v[118:119], v[44:47]
  v_mfma_f32_4x4x4_16b_bf16 v[48:51], v[14:15], v[130:131], v[48:51]
  v_nop_e64
  v_mfma_f32_4x4x4_16b_bf16 v[44:47], v[16:17], v[120:121], v[44:47]
  v_mfma_f32_4x4x4_16b_bf16 v[48:51], v[16:17], v[132:133], v[48:51]
  v_nop_e64
  v_mfma_f32_4x4x4_16b_bf16 v[44:47], v[18:19], v[122:123], v[44:47]
  v_mfma_f32_4x4x4_16b_bf16 v[48:51], v[18:19], v[134:135], v[48:51]
  v_mfma_f32_4x4x4_16b_bf16 v[52:55], v[8:9], v[136:137], 0
  v_mfma_f32_4x4x4_16b_bf16 v[56:59], v[8:9], v[148:149], 0
  v_nop_e64
  v_mfma_f32_4x4x4_16b_bf16 v[52:55], v[10:11], v[138:139], v[52:55]
  v_mov_b32_dpp v60, v44 quad_perm:[0,0,0,0] row_mask:0xf bank_mask:0xf
  v_mfma_f32_4x4x4_16b_bf16 v[56:59], v[10:11], v[150:151], v[56:59]
  v_mov_b32_dpp v61, v48 quad_perm:[0,0,0,0] row_mask:0xf bank_mask:0xf
  v_mfma_f32_4x4x4_16b_bf16 v[52:55], v[12:13], v[140:141], v[52:55]
  v_add_f32_dpp v60, v45, v60 quad_perm:[1,1,1,1] row_mask:0xf bank_mask:0xf
  v_mfma_f32_4x4x4_16b_bf16 v[56:59], v[12:13], v[152:153], v[56:59]
  v_add_f32_dpp v61, v49, v61 quad_perm:[1,1,1,1] row_mask:0xf bank_mask:0xf
  v_mfma_f32_4x4x4_16b_bf16 v[52:55], v[14:15], v[142:143], v[52:55]
  v_add_f32_dpp v60, v46, v60 quad_perm:[2,2,2,2] row_mask:0xf bank_mask:0xf
  v_mfma_f32_4x4x4_16b_bf16 v[56:59], v[14:15], v[154:155], v[56:59]
  v_add_f32_dpp v61, v50, v61 quad_perm:[2,2,2,2] row_mask:0xf bank_mask:0xf
  v_mfma_f32_4x4x4_16b_bf16 v[52:55], v[16:17], v[144:145], v[52:55]
  v_add_f32_dpp v20, v47, v60 quad_perm:[3,3,3,3] row_mask:0xf bank_mask:0xf
  v_mfma_f32_4x4x4_16b_bf16 v[56:59], v[16:17], v[156:157], v[56:59]
  v_add_f32_dpp v61, v51, v61 quad_perm:[3,3,3,3] row_mask:0xf bank_mask:0xf
  v_mfma_f32_4x4x4_16b_bf16 v[52:55], v[18:19], v[146:147], v[52:55]
  v_mfma_f32_4x4x4_16b_bf16 v[56:59], v[18:19], v[158:159], v[56:59]
  v_mfma_f32_4x4x4_16b_bf16 v[44:47], v[8:9], v[160:161], 0
  v_cndmask_b32 v20, v20, v61, s[84:85]
  v_mfma_f32_4x4x4_16b_bf16 v[48:51], v[8:9], v[244:245], 0
  v_mfma_f32_4x4x4_16b_bf16 v[44:47], v[10:11], v[162:163], v[44:47]
  v_mov_b32_dpp v62, v52 quad_perm:[0,0,0,0] row_mask:0xf bank_mask:0xf
  v_mfma_f32_4x4x4_16b_bf16 v[48:51], v[10:11], v[246:247], v[48:51]
  v_mov_b32_dpp v63, v56 quad_perm:[0,0,0,0] row_mask:0xf bank_mask:0xf
  v_mfma_f32_4x4x4_16b_bf16 v[44:47], v[12:13], v[164:165], v[44:47]
  v_add_f32_dpp v62, v53, v62 quad_perm:[1,1,1,1] row_mask:0xf bank_mask:0xf
  v_mfma_f32_4x4x4_16b_bf16 v[48:51], v[12:13], v[248:249], v[48:51]
  v_add_f32_dpp v63, v57, v63 quad_perm:[1,1,1,1] row_mask:0xf bank_mask:0xf
  v_mfma_f32_4x4x4_16b_bf16 v[44:47], v[14:15], v[166:167], v[44:47]
  v_add_f32_dpp v62, v54, v62 quad_perm:[2,2,2,2] row_mask:0xf bank_mask:0xf
  v_mfma_f32_4x4x4_16b_bf16 v[48:51], v[14:15], v[250:251], v[48:51]
  v_add_f32_dpp v63, v58, v63 quad_perm:[2,2,2,2] row_mask:0xf bank_mask:0xf
  v_mfma_f32_4x4x4_16b_bf16 v[44:47], v[16:17], v[168:169], v[44:47]
  v_add_f32_dpp v62, v55, v62 quad_perm:[3,3,3,3] row_mask:0xf bank_mask:0xf
  v_mfma_f32_4x4x4_16b_bf16 v[48:51], v[16:17], v[252:253], v[48:51]
  v_add_f32_dpp v63, v59, v63 quad_perm:[3,3,3,3] row_mask:0xf bank_mask:0xf
  v_mfma_f32_4x4x4_16b_bf16 v[44:47], v[18:19], v[170:171], v[44:47]
  v_mfma_f32_4x4x4_16b_bf16 v[48:51], v[18:19], v[254:255], v[48:51]
  v_mfma_f32_4x4x4_16b_bf16 v[52:55], v[8:9], a[0:1], 0
  v_cndmask_b32 v20, v20, v62, s[86:87]
  v_mfma_f32_4x4x4_16b_bf16 v[56:59], v[8:9], a[12:13], 0
  v_cndmask_b32 v20, v20, v63, s[88:89]
  v_mfma_f32_4x4x4_16b_bf16 v[52:55], v[10:11], a[2:3], v[52:55]
  v_mov_b32_dpp v60, v44 quad_perm:[0,0,0,0] row_mask:0xf bank_mask:0xf
  v_mfma_f32_4x4x4_16b_bf16 v[56:59], v[10:11], a[14:15], v[56:59]
  v_mov_b32_dpp v61, v48 quad_perm:[0,0,0,0] row_mask:0xf bank_mask:0xf
  v_mfma_f32_4x4x4_16b_bf16 v[52:55], v[12:13], a[4:5], v[52:55]
  v_add_f32_dpp v20, v20, v20 row_half_mirror row_mask:0xf bank_mask:0xf
  v_mfma_f32_4x4x4_16b_bf16 v[56:59], v[12:13], a[16:17], v[56:59]
  v_add_f32_dpp v60, v45, v60 quad_perm:[1,1,1,1] row_mask:0xf bank_mask:0xf
  v_mfma_f32_4x4x4_16b_bf16 v[52:55], v[14:15], a[6:7], v[52:55]
  v_add_f32_dpp v61, v49, v61 quad_perm:[1,1,1,1] row_mask:0xf bank_mask:0xf
  v_mfma_f32_4x4x4_16b_bf16 v[56:59], v[14:15], a[18:19], v[56:59]
  v_add_f32_dpp v60, v46, v60 quad_perm:[2,2,2,2] row_mask:0xf bank_mask:0xf
  v_mfma_f32_4x4x4_16b_bf16 v[52:55], v[16:17], a[8:9], v[52:55]
  v_add_f32_dpp v61, v50, v61 quad_perm:[2,2,2,2] row_mask:0xf bank_mask:0xf
  v_mfma_f32_4x4x4_16b_bf16 v[56:59], v[16:17], a[20:21], v[56:59]
  v_add_f32_dpp v21, v47, v60 quad_perm:[3,3,3,3] row_mask:0xf bank_mask:0xf
  v_mfma_f32_4x4x4_16b_bf16 v[52:55], v[18:19], a[10:11], v[52:55]
  v_add_f32_dpp v61, v51, v61 quad_perm:[3,3,3,3] row_mask:0xf bank_mask:0xf
  v_mfma_f32_4x4x4_16b_bf16 v[56:59], v[18:19], a[22:23], v[56:59]
  s_cmp_lt_u32 s16, s17
  s_cbranch_scc0 L_tg_250
  s_waitcnt vmcnt(9)
  s_swappc_b64 s[28:29], s[0:1]
L_tb_251:
.balignl 8, 0xBF800000
  v_mfma_f32_4x4x4_16b_bf16 v[44:47], v[8:9], a[24:25], 0
  v_cndmask_b32 v21, v21, v61, s[84:85]
  v_mfma_f32_4x4x4_16b_bf16 v[48:51], v[8:9], a[36:37], 0
  v_mfma_f32_4x4x4_16b_bf16 v[44:47], v[10:11], a[26:27], v[44:47]
  v_mov_b32_dpp v62, v52 quad_perm:[0,0,0,0] row_mask:0xf bank_mask:0xf
  v_mfma_f32_4x4x4_16b_bf16 v[48:51], v[10:11], a[38:39], v[48:51]
  v_mov_b32_dpp v63, v56 quad_perm:[0,0,0,0] row_mask:0xf bank_mask:0xf
  v_mfma_f32_4x4x4_16b_bf16 v[44:47], v[12:13], a[28:29], v[44:47]
  v_add_f32_dpp v62, v53, v62 quad_perm:[1,1,1,1] row_mask:0xf bank_mask:0xf
  v_mfma_f32_4x4x4_16b_bf16 v[48:51], v[12:13], a[40:41], v[48:51]
  v_add_f32_dpp v63, v57, v63 quad_perm:[1,1,1,1] row_mask:0xf bank_mask:0xf
  v_mfma_f32_4x4x4_16b_bf16 v[44:47], v[14:15], a[30:31], v[44:47]
  v_add_f32_dpp v62, v54, v62 quad_perm:[2,2,2,2] row_mask:0xf bank_mask:0xf
  v_mfma_f32_4x4x4_16b_bf16 v[48:51], v[14:15], a[42:43], v[48:51]
  v_add_f32_dpp v63, v58, v63 quad_perm:[2,2,2,2] row_mask:0xf bank_mask:0xf
  v_mfma_f32_4x4x4_16b_bf16 v[44:47], v[16:17], a[32:33], v[44:47]
  v_add_f32_dpp v62, v55, v62 quad_perm:[3,3,3,3] row_mask:0xf bank_mask:0xf
  v_mfma_f32_4x4x4_16b_bf16 v[48:51], v[16:17], a[44:45], v[48:51]
  v_add_f32_dpp v63, v59, v63 quad_perm:[3,3,3,3] row_mask:0xf bank_mask:0xf
  v_mfma_f32_4x4x4_16b_bf16 v[44:47], v[18:19], a[34:35], v[44:47]
  v_mfma_f32_4x4x4_16b_bf16 v[48:51], v[18:19], a[46:47], v[48:51]
  v_mfma_f32_4x4x4_16b_bf16 v[52:55], v[8:9], a[48:49], 0
  v_cndmask_b32 v21, v21, v62, s[86:87]
  v_mfma_f32_4x4x4_16b_bf16 v[56:59], v[8:9], a[60:61], 0
  v_cndmask_b32 v21, v21, v63, s[88:89]
  v_mfma_f32_4x4x4_16b_bf16 v[52:55], v[10:11], a[50:51], v[52:55]
  v_mov_b32_dpp v60, v44 quad_perm:[0,0,0,0] row_mask:0xf bank_mask:0xf
  v_mfma_f32_4x4x4_16b_bf16 v[56:59], v[10:11], a[62:63], v[56:59]
  v_mov_b32_dpp v61, v48 quad_perm:[0,0,0,0] row_mask:0xf bank_mask:0xf
  v_mfma_f32_4x4x4_16b_bf16 v[52:55], v[12:13], a[52:53], v[52:55]
  v_add_f32_dpp v21, v21, v21 row_half_mirror row_mask:0xf bank_mask:0xf
  v_mfma_f32_4x4x4_16b_bf16 v[56:59], v[12:13], a[64:65], v[56:59]
  v_add_f32_dpp v60, v45, v60 quad_perm:[1,1,1,1] row_mask:0xf bank_mask:0xf
  v_mfma_f32_4x4x4_16b_bf16 v[52:55], v[14:15], a[54:55], v[52:55]
  v_add_f32_dpp v61, v49, v61 quad_perm:[1,1,1,1] row_mask:0xf bank_mask:0xf
  v_mfma_f32_4x4x4_16b_bf16 v[56:59], v[14:15], a[66:67], v[56:59]
  v_add_f32_dpp v60, v46, v60 quad_perm:[2,2,2,2] row_mask:0xf bank_mask:0xf
  v_mfma_f32_4x4x4_16b_bf16 v[52:55], v[16:17], a[56:57], v[52:55]
  v_add_f32_dpp v61, v50, v61 quad_perm:[2,2,2,2] row_mask:0xf bank_mask:0xf
  v_mfma_f32_4x4x4_16b_bf16 v[56:59], v[16:17], a[68:69], v[56:59]
  v_add_f32_dpp v22, v47, v60 quad_perm:[3,3,3,3] row_mask:0xf bank_mask:0xf
  v_mfma_f32_4x4x4_16b_bf16 v[52:55], v[18:19], a[58:59], v[52:55]
  v_add_f32_dpp v61, v51, v61 quad_perm:[3,3,3,3] row_mask:0xf bank_mask:0xf
  v_mfma_f32_4x4x4_16b_bf16 v[56:59], v[18:19], a[70:71], v[56:59]
  v_mfma_f32_4x4x4_16b_bf16 v[44:47], v[8:9], a[72:73], 0
  v_cndmask_b32 v22, v22, v61, s[84:85]
  v_mfma_f32_4x4x4_16b_bf16 v[48:51], v[8:9], a[84:85], 0
  v_mfma_f32_4x4x4_16b_bf16 v[44:47], v[10:11], a[74:75], v[44:47]
  v_mov_b32_dpp v62, v52 quad_perm:[0,0,0,0] row_mask:0xf bank_mask:0xf
  v_mfma_f32_4x4x4_16b_bf16 v[48:51], v[10:11], a[86:87], v[48:51]
  v_mov_b32_dpp v63, v56 quad_perm:[0,0,0,0] row_mask:0xf bank_mask:0xf
  v_mfma_f32_4x4x4_16b_bf16 v[44:47], v[12:13], a[76:77], v[44:47]
  v_add_f32_dpp v62, v53, v62 quad_perm:[1,1,1,1] row_mask:0xf bank_mask:0xf
  v_mfma_f32_4x4x4_16b_bf16 v[48:51], v[12:13], a[88:89], v[48:51]
  v_add_f32_dpp v63, v57, v63 quad_perm:[1,1,1,1] row_mask:0xf bank_mask:0xf
  v_mfma_f32_4x4x4_16b_bf16 v[44:47], v[14:15], a[78:79], v[44:47]
  v_add_f32_dpp v62, v54, v62 quad_perm:[2,2,2,2] row_mask:0xf bank_mask:0xf
  v_mfma_f32_4x4x4_16b_bf16 v[48:51], v[14:15], a[90:91], v[48:51]
  v_add_f32_dpp v63, v58, v63 quad_perm:[2,2,2,2] row_mask:0xf bank_mask:0xf
  v_mfma_f32_4x4x4_16b_bf16 v[44:47], v[16:17], a[80:81], v[44:47]
  v_add_f32_dpp v62, v55, v62 quad_perm:[3,3,3,3] row_mask:0xf bank_mask:0xf
  v_mfma_f32_4x4x4_16b_bf16 v[48:51], v[16:17], a[92:93], v[48:51]
  v_add_f32_dpp v63, v59, v63 quad_perm:[3,3,3,3] row_mask:0xf bank_mask:0xf
  v_mfma_f32_4x4x4_16b_bf16 v[44:47], v[18:19], a[82:83], v[44:47]
  v_mfma_f32_4x4x4_16b_bf16 v[48:51], v[18:19], a[94:95], v[48:51]
  v_mfma_f32_4x4x4_16b_bf16 v[52:55], v[8:9], a[96:97], 0
  v_cndmask_b32 v22, v22, v62, s[86:87]
  v_mfma_f32_4x4x4_16b_bf16 v[56:59], v[8:9], a[168:169], 0
  v_cndmask_b32 v22, v22, v63, s[88:89]
  v_mfma_f32_4x4x4_16b_bf16 v[52:55], v[10:11], a[98:99], v[52:55]
  v_mov_b32_dpp v60, v44 quad_perm:[0,0,0,0] row_mask:0xf bank_mask:0xf
  v_mfma_f32_4x4x4_16b_bf16 v[56:59], v[10:11], a[170:171], v[56:59]
  v_mov_b32_dpp v61, v48 quad_perm:[0,0,0,0] row_mask:0xf bank_mask:0xf
  v_mfma_f32_4x4x4_16b_bf16 v[52:55], v[12:13], a[100:101], v[52:55]
  v_add_f32_dpp v22, v22, v22 row_half_mirror row_mask:0xf bank_mask:0xf
  v_mfma_f32_4x4x4_16b_bf16 v[56:59], v[12:13], a[172:173], v[56:59]
  v_add_f32_dpp v60, v45, v60 quad_perm:[1,1,1,1] row_mask:0xf bank_mask:0xf
  v_mfma_f32_4x4x4_16b_bf16 v[52:55], v[14:15], a[102:103], v[52:55]
  v_add_f32_dpp v61, v49, v61 quad_perm:[1,1,1,1] row_mask:0xf bank_mask:0xf
  v_mfma_f32_4x4x4_16b_bf16 v[56:59], v[14:15], a[174:175], v[56:59]
  v_add_f32_dpp v60, v46, v60 quad_perm:[2,2,2,2] row_mask:0xf bank_mask:0xf
  v_mfma_f32_4x4x4_16b_bf16 v[52:55], v[16:17], a[104:105], v[52:55]
  v_add_f32_dpp v61, v50, v61 quad_perm:[2,2,2,2] row_mask:0xf bank_mask:0xf
  v_mfma_f32_4x4x4_16b_bf16 v[56:59], v[16:17], a[176:177], v[56:59]
  v_add_f32_dpp v23, v47, v60 quad_perm:[3,3,3,3] row_mask:0xf bank_mask:0xf
  v_mfma_f32_4x4x4_16b_bf16 v[52:55], v[18:19], a[106:107], v[52:55]
  v_add_f32_dpp v61, v51, v61 quad_perm:[3,3,3,3] row_mask:0xf bank_mask:0xf
  v_mfma_f32_4x4x4_16b_bf16 v[56:59], v[18:19], a[178:179], v[56:59]
  v_cndmask_b32 v23, v23, v61, s[84:85]
  s_nop 0
  s_nop 0
  v_mov_b32_dpp v62, v52 quad_perm:[0,0,0,0] row_mask:0xf bank_mask:0xf
  v_nop_e64
  v_mov_b32_dpp v63, v56 quad_perm:[0,0,0,0] row_mask:0xf bank_mask:0xf
  v_add_f32_dpp v62, v53, v62 quad_perm:[1,1,1,1] row_mask:0xf bank_mask:0xf
  v_nop_e64
  v_add_f32_dpp v63, v57, v63 quad_perm:[1,1,1,1] row_mask:0xf bank_mask:0xf
  v_add_f32_dpp v62, v54, v62 quad_perm:[2,2,2,2] row_mask:0xf bank_mask:0xf
  v_nop_e64
  v_add_f32_dpp v63, v58, v63 quad_perm:[2,2,2,2] row_mask:0xf bank_mask:0xf
  v_add_f32_dpp v62, v55, v62 quad_perm:[3,3,3,3] row_mask:0xf bank_mask:0xf
  v_nop_e64
  v_add_f32_dpp v63, v59, v63 quad_perm:[3,3,3,3] row_mask:0xf bank_mask:0xf
  v_cndmask_b32 v23, v23, v62, s[86:87]
  v_cndmask_b32 v23, v23, v63, s[88:89]
  s_nop 0
  s_nop 0
  v_add_f32_dpp v23, v23, v23 row_half_mirror row_mask:0xf bank_mask:0xf
  s_mov_b32 s19, 240
  s_min_u32 s17, s18, s19
  v_max3_f32 v66, v20, v21, v22
  v_max_f32 v66, v66, v23
  s_nop 1
  v_max_f32_dpp v66, v66, v66 quad_perm:[1,0,3,2] row_mask:0xf bank_mask:0xf
  s_nop 1
  v_max_f32_dpp v66, v66, v66 quad_perm:[2,3,0,1] row_mask:0xf bank_mask:0xf
  s_nop 1
  v_max_f32_dpp v66, v66, v66 row_ror:8 row_mask:0xf bank_mask:0xf
  s_nop 1
  v_max_f32_dpp v66, v66, v66 row_bcast:15 row_mask:0xa bank_mask:0xf
  s_nop 1
  v_max_f32_dpp v66, v66, v66 row_bcast:31 row_mask:0xc bank_mask:0xf
  s_nop 0
  v_readlane_b32 s93, v66, 63
  s_cmp_lt_u32 s16, s17
  s_cbranch_scc0 L_tg_252
  s_waitcnt vmcnt(9)
  s_swappc_b64 s[28:29], s[0:1]
L_tb_253:
  v_mov_b32 v67, s21
  v_subrev_f32 v20, s93, v20
  v_subrev_f32 v21, s93, v21
  v_subrev_f32 v22, s93, v22
  v_subrev_f32 v23, s93, v23
  v_mov_b32 v66, s93
  v_mul_f32 v20, 0x3dd53b95, v20
  v_mul_f32 v21, 0x3dd53b95, v21
  v_mul_f32 v22, 0x3dd53b95, v22
  v_mul_f32 v23, 0x3dd53b95, v23
  ds_write_b32 v67, v66 offset:48
  v_exp_f32 v20, v20
  v_exp_f32 v21, v21
  v_exp_f32 v22, v22
  v_exp_f32 v23, v23
  v_add_f32 v66, v20, v21
  v_add_f32 v68, v22, v23
  v_add_f32 v68, v68, v66
  v_cvt_pk_bf16_f32 v20, v20, v20
  v_cvt_pk_bf16_f32 v21, v21, v21
  v_cvt_pk_bf16_f32 v22, v22, v22
  v_cvt_pk_bf16_f32 v23, v23, v23
  v_add_f32_dpp v68, v68, v68 quad_perm:[1,0,3,2] row_mask:0xf bank_mask:0xf
  s_nop 1
  v_add_f32_dpp v68, v68, v68 quad_perm:[2,3,0,1] row_mask:0xf bank_mask:0xf
  s_nop 1
  v_add_f32_dpp v68, v68, v68 row_ror:8 row_mask:0xf bank_mask:0xf
  s_nop 1
  v_add_f32_dpp v68, v68, v68 row_bcast:15 row_mask:0xa bank_mask:0xf
  s_nop 1
  v_add_f32_dpp v68, v68, v68 row_bcast:31 row_mask:0xc bank_mask:0xf
  s_nop 0
  v_readlane_b32 s94, v68, 63
L_nw_254:
  s_cmp_ge_u32 s16, 222
  s_cbranch_scc1 L_nx_255
  s_cmp_lt_u32 s16, s17
  s_cbranch_scc0 L_nd_256
  s_waitcnt vmcnt(9)
  s_swappc_b64 s[28:29], s[0:1]
  s_branch L_nw_254
L_nx_255:
  s_waitcnt vmcnt(6)
L_nq_257:
.balignl 8, 0xBF800000
  v_and_b32_dpp v46, v20, v2 quad_perm:[0,0,0,0] row_mask:0xf bank_mask:0xf
  v_and_b32_dpp v47, v20, v3 quad_perm:[0,0,0,0] row_mask:0xf bank_mask:0xf
  v_and_b32_dpp v48, v20, v4 quad_perm:[3,3,3,3] row_mask:0xf bank_mask:0xf
  v_and_b32_dpp v49, v20, v5 quad_perm:[3,3,3,3] row_mask:0xf bank_mask:0xf
  s_nop 0
  s_nop 0
  v_mfma_f32_16x16x32_bf16 v[8:11], v[46:49], a[180:183], 0
  v_and_b32_dpp v50, v20, v2 quad_perm:[1,1,1,1] row_mask:0xf bank_mask:0xf
  v_and_b32_dpp v51, v20, v3 quad_perm:[1,1,1,1] row_mask:0xf bank_mask:0xf
  v_mfma_f32_16x16x32_bf16 v[12:15], v[46:49], a[184:187], 0
  v_and_b32_dpp v52, v20, v4 quad_perm:[2,2,2,2] row_mask:0xf bank_mask:0xf
  v_and_b32_dpp v53, v20, v5 quad_perm:[2,2,2,2] row_mask:0xf bank_mask:0xf
  v_mfma_f32_16x16x32_bf16 v[16:19], v[46:49], a[188:191], 0
  v_nop_e64
  v_mfma_f32_16x16x32_bf16 v[8:11], v[50:53], a[192:195], v[8:11]
  v_and_b32_dpp v46, v20, v2 quad_perm:[2,2,2,2] row_mask:0xf bank_mask:0xf
  v_and_b32_dpp v47, v20, v3 quad_perm:[2,2,2,2] row_mask:0xf bank_mask:0xf
  v_mfma_f32_16x16x32_bf16 v[12:15], v[50:53], a[196:199], v[12:15]
  v_and_b32_dpp v48, v20, v4 quad_perm:[1,1,1,1] row_mask:0xf bank_mask:0xf
  v_and_b32_dpp v49, v20, v5 quad_perm:[1,1,1,1] row_mask:0xf bank_mask:0xf
  v_mfma_f32_16x16x32_bf16 v[16:19], v[50:53], a[200:203], v[16:19]
  v_nop_e64
  v_mfma_f32_16x16x32_bf16 v[8:11], v[46:49], a[204:207], v[8:11]
  v_and_b32_dpp v50, v20, v2 quad_perm:[3,3,3,3] row_mask:0xf bank_mask:0xf
  v_and_b32_dpp v51, v20, v3 quad_perm:[3,3,3,3] row_mask:0xf bank_mask:0xf
  v_mfma_f32_16x16x32_bf16 v[12:15], v[46:49], a[208:211], v[12:15]
  v_and_b32_dpp v52, v20, v4 quad_perm:[0,0,0,0] row_mask:0xf bank_mask:0xf
  v_and_b32_dpp v53, v20, v5 quad_perm:[0,0,0,0] row_mask:0xf bank_mask:0xf
  v_mfma_f32_16x16x32_bf16 v[16:19], v[46:49], a[212:215], v[16:19]
  v_nop_e64
  v_mfma_f32_16x16x32_bf16 v[8:11], v[50:53], a[216:219], v[8:11]
  v_and_b32_dpp v46, v21, v2 quad_perm:[0,0,0,0] row_mask:0xf bank_mask:0xf
  v_and_b32_dpp v47, v21, v3 quad_perm:[0,0,0,0] row_mask:0xf bank_mask:0xf
  v_mfma_f32_16x16x32_bf16 v[12:15], v[50:53], a[220:223], v[12:15]
  v_and_b32_dpp v48, v21, v4 quad_perm:[3,3,3,3] row_mask:0xf bank_mask:0xf
  v_and_b32_dpp v49, v21, v5 quad_perm:[3,3,3,3] row_mask:0xf bank_mask:0xf
  v_mfma_f32_16x16x32_bf16 v[16:19], v[50:53], a[224:227], v[16:19]
  v_nop_e64
  v_mfma_f32_16x16x32_bf16 v[8:11], v[46:49], a[228:231], v[8:11]
  v_and_b32_dpp v50, v21, v2 quad_perm:[1,1,1,1] row_mask:0xf bank_mask:0xf
  v_and_b32_dpp v51, v21, v3 quad_perm:[1,1,1,1] row_mask:0xf bank_mask:0xf
  v_mfma_f32_16x16x32_bf16 v[12:15], v[46:49], a[232:235], v[12:15]
  v_and_b32_dpp v52, v21, v4 quad_perm:[2,2,2,2] row_mask:0xf bank_mask:0xf
  v_and_b32_dpp v53, v21, v5 quad_perm:[2,2,2,2] row_mask:0xf bank_mask:0xf
  v_mfma_f32_16x16x32_bf16 v[16:19], v[46:49], a[236:239], v[16:19]
  v_nop_e64
  v_mfma_f32_16x16x32_bf16 v[8:11], v[50:53], a[240:243], v[8:11]
  v_and_b32_dpp v46, v21, v2 quad_perm:[2,2,2,2] row_mask:0xf bank_mask:0xf
  v_and_b32_dpp v47, v21, v3 quad_perm:[2,2,2,2] row_mask:0xf bank_mask:0xf
  v_mfma_f32_16x16x32_bf16 v[12:15], v[50:53], a[244:247], v[12:15]
  v_and_b32_dpp v48, v21, v4 quad_perm:[1,1,1,1] row_mask:0xf bank_mask:0xf
  v_and_b32_dpp v49, v21, v5 quad_perm:[1,1,1,1] row_mask:0xf bank_mask:0xf
  v_mfma_f32_16x16x32_bf16 v[16:19], v[50:53], a[248:251], v[16:19]
  v_nop_e64
  v_mfma_f32_16x16x32_bf16 v[8:11], v[46:49], v[172:175], v[8:11]
  v_and_b32_dpp v50, v21, v2 quad_perm:[3,3,3,3] row_mask:0xf bank_mask:0xf
  v_and_b32_dpp v51, v21, v3 quad_perm:[3,3,3,3] row_mask:0xf bank_mask:0xf
  v_mfma_f32_16x16x32_bf16 v[12:15], v[46:49], v[176:179], v[12:15]
  v_and_b32_dpp v52, v21, v4 quad_perm:[0,0,0,0] row_mask:0xf bank_mask:0xf
  v_and_b32_dpp v53, v21, v5 quad_perm:[0,0,0,0] row_mask:0xf bank_mask:0xf
  v_mfma_f32_16x16x32_bf16 v[16:19], v[46:49], v[180:183], v[16:19]
  v_nop_e64
  v_mfma_f32_16x16x32_bf16 v[8:11], v[50:53], v[184:187], v[8:11]
  v_mfma_f32_16x16x32_bf16 v[12:15], v[50:53], v[188:191], v[12:15]
  v_mfma_f32_16x16x32_bf16 v[16:19], v[50:53], v[192:195], v[16:19]
  s_mov_b32 s20, 234
  s_cmp_eq_u32 s20, -1
  s_cbranch_scc1 L_ux_259
L_uw_258:
  s_cmp_lt_u32 s16, s17
  s_cbranch_scc0 L_ud_261
  s_waitcnt vmcnt(12)
  s_swappc_b64 s[28:29], s[0:1]
  s_cmp_ge_u32 s16, s20
  s_cbranch_scc0 L_uw_258
L_uc_260:
  s_swappc_b64 s[28:29], s[14:15]
  s_cmp_ge_u32 s16, s20
  s_cbranch_scc0 L_ut_262
  s_swappc_b64 s[28:29], s[14:15]
  s_cmp_ge_u32 s16, s20
  s_cbranch_scc0 L_ut_262
  s_swappc_b64 s[28:29], s[14:15]
L_ut_262:
  s_cmp_eq_u32 s20, -1
  s_cbranch_scc0 L_uw_258
L_ux_259:
  v_lshrrev_b32 v60, 4, v0
  v_and_b32 v59, 15, v0
  v_lshlrev_b32 v58, 10, v60
  v_lshl_add_u32 v58, v59, 4, v58
  s_lshl_b32 s91, s3, 8
  s_add_u32 s91, s91, 155648
  v_add_u32 v58, s91, v58
  v_add_u32 v59, 155648, v6
  v_mov_b32 v49, s94
  v_permlane32_swap_b32 v8, v9
  v_permlane32_swap_b32 v10, v11
  v_permlane32_swap_b32 v12, v13
  v_permlane32_swap_b32 v14, v15
  v_permlane32_swap_b32 v16, v17
  v_permlane32_swap_b32 v18, v19
  v_add_f32_dpp v46, v9, v8 row_ror:8 row_mask:0xf bank_mask:0x3
  v_add_f32_dpp v47, v13, v12 row_ror:8 row_mask:0xf bank_mask:0x3
  v_add_f32_dpp v48, v17, v16 row_ror:8 row_mask:0xf bank_mask:0x3
  v_add_f32_dpp v46, v10, v11 row_ror:8 row_mask:0xf bank_mask:0xc
  v_add_f32_dpp v47, v14, v15 row_ror:8 row_mask:0xf bank_mask:0xc
  v_add_f32_dpp v48, v18, v19 row_ror:8 row_mask:0xf bank_mask:0xc
  ds_write_b128 v59, v[46:49]
  v_lshlrev_b32 v60, 2, v60
  v_add_u32 v60, 161424, v60
  v_mov_b32 v62, 161424
  s_waitcnt lgkmcnt(0)
  s_barrier
  ds_read_b128 v[54:57], v62
  ds_read_b32 v62, v60
  ds_read_b128 v[50:53], v58
  s_add_u32 s73, s72, 1
  s_mul_i32 s91, s31, 240
  s_sub_u32 s91, 2048, s91
  v_lshlrev_b32 v59, 4, v0
  v_writelane_b32 v59, s91, 16
  v_mov_b32 v49, s73
  s_add_u32 s76, s78, 524288
  s_waitcnt lgkmcnt(1)
  v_max3_f32 v54, v54, v55, v56
  v_max_f32 v54, v54, v57
  v_sub_f32 v62, v62, v54
  v_mul_f32 v62, 0x3dd53b95, v62
  v_exp_f32 v62, v62
  s_waitcnt lgkmcnt(0)
  v_pk_mul_f32 v[50:51], v[50:51], v[62:63] op_sel_hi:[1,0]
  v_pk_mul_f32 v[52:53], v[52:53], v[62:63] op_sel_hi:[1,0]
  s_nop 0
  v_permlane32_swap_b32 v50, v51
  v_permlane32_swap_b32 v52, v53
  v_add_f32 v50, v50, v51
  v_add_f32 v52, v52, v53
  s_nop 1
  v_permlane16_swap_b32 v50, v52
  v_add_f32 v46, v50, v52
  v_add_f32 v47, v50, v52
  s_nop 1
  v_permlane32_swap_b32 v46, v47
  v_mov_b32 v48, v46
  s_nop 1
  v_permlane16_swap_b32 v46, v48
  s_nop 1
  v_mov_b32_dpp v46, v54 quad_perm:[0,1,2,3] row_mask:0x2 bank_mask:0xf
  s_mov_b64 exec, 0x1ffff
  buffer_store_dwordx4 v[46:49], v59, s[64:67], s76 offen
  s_mov_b64 exec, -1
  s_add_u32 s73, s72, 1
  v_lshrrev_b32 v45, 4, v0
  v_and_b32 v44, 1, v0
  v_lshl_add_u32 v45, v44, 2, v45
  s_add_u32 s91, s27, 2048
  v_lshl_add_u32 v45, v45, 4, s91
  s_add_u32 s97, s79, 524288
  buffer_load_dwordx4 v[34:37], v45, s[64:67], s97 offen nt
  buffer_load_dwordx4 v[26:29], v6, s[64:67], s97 offen offset:0 nt
  buffer_load_dwordx4 v[30:33], v6, s[64:67], s97 offen offset:1024 nt
  v_lshrrev_b32 v46, 2, v0
  v_and_b32 v47, 3, v0
  v_mul_u32_u24 v46, 160, v46
  v_lshl_add_u32 v47, v47, 3, v46
  s_lshl_b32 s91, s3, 5
  s_add_u32 s91, s91, 124928
  v_add_u32 v46, s91, v47
  v_add_u32 v47, 125056, v47
  v_bfe_u32 v49, v0, 4, 1
  v_lshlrev_b32 v49, 8, v49
  v_lshrrev_b32 v48, 5, v0
  v_lshl_add_u32 v49, v48, 7, v49
  v_and_b32 v48, 7, v0
  v_lshl_add_u32 v49, v48, 4, v49
  v_bfe_u32 v48, v0, 3, 1
  v_lshl_add_u32 v49, v48, 2, v49
  s_and_b32 s91, s3, 1
  s_lshl_b32 s91, s91, 3
  s_and_b32 s92, s3, 2
  s_add_u32 s91, s91, s92
  s_add_u32 s91, s91, 159744
  v_add_u32 v49, s91, v49
  v_and_b32 v74, 0x30, v0
  s_lshl_b32 s91, s3, 4
  s_add_u32 s91, s91, 1
  v_writelane_b32 v74, 64, s91
  s_movk_i32 s91, 80
  v_writelane_b32 v74, s91, 2
  s_movk_i32 s91, 96
  v_writelane_b32 v74, s91, 3
  s_movk_i32 s91, 112
  v_writelane_b32 v74, s91, 4
  s_bfe_u32 s68, s73, 0x80000
  s_bfe_u32 s69, s73, 0x80008
  s_bfe_u32 s70, s73, 0x80010
  s_bfe_u32 s90, s73, 0x80018
  ds_read_b64_tr_b16 v[50:51], v46 offset:0
  ds_read_b64_tr_b16 v[52:53], v46 offset:2560
  ds_read_b64_tr_b16 v[54:55], v47 offset:0
  ds_read_b64_tr_b16 v[56:57], v47 offset:2560
  ds_read_b64_tr_b16 v[58:59], v46 offset:5120
  ds_read_b64_tr_b16 v[60:61], v46 offset:7680
  ds_read_b64_tr_b16 v[62:63], v47 offset:5120
  ds_read_b64_tr_b16 v[64:65], v47 offset:7680
  ds_read_b64_tr_b16 v[66:67], v46 offset:10240
  ds_read_b64_tr_b16 v[68:69], v46 offset:12800
  ds_read_b64_tr_b16 v[70:71], v47 offset:10240
  ds_read_b64_tr_b16 v[72:73], v47 offset:12800
  s_waitcnt vmcnt(0)
L_chk_263:
  v_bitop3_b32 v75, v37, v29, s73 bitop3:0x7e
  v_bitop3_b32 v75, v75, v33, s73 bitop3:0xf6
  v_cmp_ne_u32 vcc, 0, v75
  s_nop 0
  s_cbranch_vccz L_retry_264
  buffer_load_dwordx4 v[34:37], v45, s[64:67], s97 offen nt
  buffer_load_dwordx4 v[26:29], v6, s[64:67], s97 offen offset:0 nt
  buffer_load_dwordx4 v[30:33], v6, s[64:67], s97 offen offset:1024 nt
  s_sub_u32 s75, s75, 1
  s_cbranch_scc1 L_end
  s_waitcnt vmcnt(0)
  s_branch L_chk_263
L_retry_264:
  v_max_f32_dpp v43, v34, v34 quad_perm:[1,0,3,2] row_mask:0xf bank_mask:0xf
  v_mov_b32 v42, v43
  s_nop 1
  v_permlane32_swap_b32 v43, v42
  v_max_f32 v43, v43, v42
  v_mov_b32 v42, v43
  s_nop 1
  v_permlane16_swap_b32 v43, v42
  v_max_f32 v43, v43, v42
  v_sub_f32 v43, v34, v43
  v_mul_f32 v43, 0x3dd53b95, v43
  v_exp_f32 v43, v43
  s_nop 0
  v_mul_f32 v35, v35, v43
  v_mul_f32_dpp v26, v43, v26 quad_perm:[0,0,2,2] row_mask:0xf bank_mask:0xf
  v_mul_f32_dpp v27, v43, v27 quad_perm:[0,0,2,2] row_mask:0xf bank_mask:0xf
  v_mul_f32_dpp v28, v43, v28 quad_perm:[0,0,2,2] row_mask:0xf bank_mask:0xf
  v_add_f32_dpp v29, v35, v35 quad_perm:[1,0,3,2] row_mask:0xf bank_mask:0xf
  v_fmac_f32_dpp v26, v43, v30 quad_perm:[1,1,3,3] row_mask:0xf bank_mask:0xf
  v_fmac_f32_dpp v27, v43, v31 quad_perm:[1,1,3,3] row_mask:0xf bank_mask:0xf
  v_fmac_f32_dpp v28, v43, v32 quad_perm:[1,1,3,3] row_mask:0xf bank_mask:0xf
  s_nop 0
  v_permlane32_swap_b32 v26, v27
  v_permlane32_swap_b32 v28, v29
  v_add_f32 v26, v26, v27
  v_add_f32 v28, v28, v29
  s_nop 1
  v_permlane16_swap_b32 v26, v28
  v_add_f32 v48, v26, v28
  v_lshrrev_b32 v45, 4, v0
  v_readlane_b32 s92, v48, 48
  v_lshlrev_b32 v45, 3, v45
  v_add_u32 v44, 159744, v45
  v_rcp_f32 v43, s92
  s_mov_b32 exec_hi, 0xffff
  v_mul_f32 v48, v48, v43
  v_cvt_pk_bf16_f32 v48, v48, v48
  ds_write_b16 v49, v48
  s_mov_b64 exec, -1
  s_waitcnt lgkmcnt(0)
  s_barrier
  ds_read2_b64 v[26:29], v44 offset0:0 offset1:4
  ds_read2_b64 v[30:33], v44 offset0:8 offset1:12
  ds_read2_b64 v[34:37], v44 offset0:16 offset1:20
  v_mov_b32 v48, v44
  s_add_u32 s76, s82, 393216
  s_lshl_b32 s91, s3, 4
  s_lshl_b64 vcc, 2, s91
  s_or_b32 s91, vcc_lo, 0x1001d
  s_or_b32 s92, vcc_hi, 0x10001
  v_mov_b32 v49, 0xffffff00
  s_waitcnt lgkmcnt(2)
  v_mfma_f32_16x16x32_bf16 v[38:41], v[50:53], v[26:29], 0
  v_mfma_f32_16x16x32_bf16 v[42:45], v[54:57], v[26:29], 0
  ds_read2_b64 v[26:29], v48 offset0:24 offset1:28
  ds_read_b64_tr_b16 v[50:51], v46 offset:15360
  ds_read_b64_tr_b16 v[52:53], v46 offset:17920
  ds_read_b64_tr_b16 v[54:55], v47 offset:15360
  ds_read_b64_tr_b16 v[56:57], v47 offset:17920
  s_waitcnt lgkmcnt(6)
  v_mfma_f32_16x16x32_bf16 v[38:41], v[58:61], v[30:33], v[38:41]
  v_mfma_f32_16x16x32_bf16 v[42:45], v[62:65], v[30:33], v[42:45]
  ds_read2_b64 v[30:33], v48 offset0:32 offset1:36
  ds_read_b64_tr_b16 v[58:59], v46 offset:20480
  ds_read_b64_tr_b16 v[60:61], v46 offset:23040
  ds_read_b64_tr_b16 v[62:63], v47 offset:20480
  ds_read_b64_tr_b16 v[64:65], v47 offset:23040
  s_waitcnt lgkmcnt(10)
  v_mfma_f32_16x16x32_bf16 v[38:41], v[66:69], v[34:37], v[38:41]
  v_mfma_f32_16x16x32_bf16 v[42:45], v[70:73], v[34:37], v[42:45]
  ds_read2_b64 v[34:37], v48 offset0:40 offset1:44
  ds_read_b64_tr_b16 v[66:67], v46 offset:25600
  ds_read_b64_tr_b16 v[68:69], v46 offset:28160
  ds_read_b64_tr_b16 v[70:71], v47 offset:25600
  ds_read_b64_tr_b16 v[72:73], v47 offset:28160
  s_waitcnt lgkmcnt(10)
  v_mfma_f32_16x16x32_bf16 v[38:41], v[50:53], v[26:29], v[38:41]
  v_mfma_f32_16x16x32_bf16 v[42:45], v[54:57], v[26:29], v[42:45]
  s_waitcnt lgkmcnt(5)
  v_mfma_f32_16x16x32_bf16 v[38:41], v[58:61], v[30:33], v[38:41]
  v_mfma_f32_16x16x32_bf16 v[42:45], v[62:65], v[30:33], v[42:45]
  s_waitcnt lgkmcnt(0)
  v_mfma_f32_16x16x32_bf16 v[38:41], v[66:69], v[34:37], v[38:41]
  v_mfma_f32_16x16x32_bf16 v[42:45], v[70:73], v[34:37], v[42:45]
  s_nop 7
  v_cndmask_b32 v26, v38, v42, vcc
  v_cndmask_b32 v27, v39, v43, vcc
  v_cndmask_b32 v28, v40, v44, vcc
  v_cndmask_b32 v29, v41, v45, vcc
  s_mov_b32 exec_lo, s91
  s_mov_b32 exec_hi, s92
  v_and_or_b32 v26, v26, v49, s68
  v_and_or_b32 v27, v27, v49, s69
  v_and_or_b32 v28, v28, v49, s70
  v_and_or_b32 v29, v29, v49, s90
  buffer_store_dwordx4 v[26:29], v74, s[64:67], s76 offen sc1
  s_mov_b64 exec, -1
  s_waitcnt vmcnt(0)
  v_bfe_u32 v72, v0, 2, 3
  v_lshrrev_b32 v71, 5, v0
  v_mul_u32_u24 v71, 3072, v71
  v_lshl_add_u32 v71, v72, 7, v71
  v_and_b32 v73, 3, v0
  v_lshl_add_u32 v71, v73, 3, v71
  v_lshrrev_b32 v72, 1, v72
  s_mul_i32 s91, s3, 3
  s_add_u32 s91, s91, 0
  s_and_b32 s92, s91, 3
  s_lshr_b32 s91, s91, 2
  v_xor_b32 v73, s92, v72
  s_lshl_b32 s91, s91, 10
  s_add_u32 s91, s91, 32768
  v_lshl_add_u32 v73, v73, 5, v71
  v_add_u32 v42, s91, v73
  ds_read_b64_tr_b16 v[44:45], v42 offset:0
  ds_read_b64_tr_b16 v[46:47], v42 offset:6144
  ds_read_b64_tr_b16 v[48:49], v42 offset:12288
  ds_read_b64_tr_b16 v[50:51], v42 offset:18432
  ds_read_b64_tr_b16 v[52:53], v42 offset:24576
  s_mul_i32 s91, s3, 3
  s_add_u32 s91, s91, 1
  s_and_b32 s92, s91, 3
  s_lshr_b32 s91, s91, 2
  v_xor_b32 v73, s92, v72
  s_lshl_b32 s91, s91, 10
  s_add_u32 s91, s91, 32768
  v_lshl_add_u32 v73, v73, 5, v71
  v_add_u32 v43, s91, v73
  ds_read_b64_tr_b16 v[54:55], v43 offset:0
  ds_read_b64_tr_b16 v[56:57], v43 offset:6144
  ds_read_b64_tr_b16 v[58:59], v43 offset:12288
  ds_read_b64_tr_b16 v[60:61], v43 offset:18432
  ds_read_b64_tr_b16 v[62:63], v43 offset:24576
  s_mul_i32 s91, s3, 3
  s_add_u32 s91, s91, 2
  s_and_b32 s92, s91, 3
  s_lshr_b32 s91, s91, 2
  v_xor_b32 v73, s92, v72
  s_lshl_b32 s91, s91, 10
  s_add_u32 s91, s91, 32768
  v_lshl_add_u32 v73, v73, 5, v71
  v_add_u32 v42, s91, v73
  ds_read_b64_tr_b16 v[64:65], v42 offset:0
  ds_read_b64_tr_b16 v[66:67], v42 offset:6144
  ds_read_b64_tr_b16 v[68:69], v42 offset:12288
  ds_read_b64_tr_b16 v[70:71], v42 offset:18432
  ds_read_b64_tr_b16 v[72:73], v42 offset:24576
  s_add_u32 s73, s72, 1
  v_lshrrev_b32 v74, 3, v0
  v_and_b32 v75, 7, v0
  v_mul_u32_u24 v74, 128, v74
  v_lshl_add_u32 v74, v75, 4, v74
  s_add_u32 s97, s83, 393216
  s_mov_b32 exec_lo, 0x1f1f1f1f
  s_mov_b32 exec_hi, 0x1f1f1f1f
  buffer_load_dwordx4 v[26:29], v74, s[64:67], s97 offen offset:0 sc1
  buffer_load_dwordx4 v[30:33], v74, s[64:67], s97 offen offset:1024 sc1
  buffer_load_dwordx4 v[34:37], v74, s[64:67], s97 offen offset:2048 sc1
  buffer_load_dwordx4 v[38:41], v74, s[64:67], s97 offen offset:3072 sc1
  s_mov_b64 exec, -1
  s_bfe_u32 s68, s73, 0x80000
  s_bfe_u32 s69, s73, 0x80008
  s_bfe_u32 s70, s73, 0x80010
  s_bfe_u32 s90, s73, 0x80018
  s_waitcnt vmcnt(0)
  s_mov_b32 exec_lo, 0x1f1f1f1f
  s_mov_b32 exec_hi, 0x1f1f1f1f
L_chk_265:
  v_xor_b32 v26, s68, v26
  v_xor_b32 v30, s68, v30
  v_xor_b32 v34, s68, v34
  v_xor_b32 v38, s68, v38
  v_xor_b32 v27, s69, v27
  v_xor_b32 v31, s69, v31
  v_xor_b32 v35, s69, v35
  v_xor_b32 v39, s69, v39
  v_xor_b32 v28, s70, v28
  v_xor_b32 v32, s70, v32
  v_xor_b32 v36, s70, v36
  v_xor_b32 v40, s70, v40
  v_xor_b32 v29, s90, v29
  v_xor_b32 v33, s90, v33
  v_xor_b32 v37, s90, v37
  v_xor_b32 v41, s90, v41
  v_or3_b32 v75, v26, v30, v34
  v_or3_b32 v75, v75, v38, v27
  v_or3_b32 v75, v75, v31, v35
  v_or3_b32 v75, v75, v39, v28
  v_or3_b32 v75, v75, v32, v36
  v_or3_b32 v75, v75, v40, v29
  v_or3_b32 v75, v75, v33, v37
  v_or3_b32 v75, v75, v41, v41
  v_and_b32 v75, 0xff, v75
  v_cmp_ne_u32 vcc, 0, v75
  s_nop 0
  s_cbranch_vccz L_retry_266
  buffer_load_dwordx4 v[26:29], v74, s[64:67], s97 offen offset:0 sc1
  buffer_load_dwordx4 v[30:33], v74, s[64:67], s97 offen offset:1024 sc1
  buffer_load_dwordx4 v[34:37], v74, s[64:67], s97 offen offset:2048 sc1
  buffer_load_dwordx4 v[38:41], v74, s[64:67], s97 offen offset:3072 sc1
  s_sub_u32 s75, s75, 1
  s_cbranch_scc1 L_end
  s_waitcnt vmcnt(0)
  s_branch L_chk_265
L_retry_266:
  v_pk_add_f32 v[26:27], v[26:27], v[30:31]
  v_pk_add_f32 v[28:29], v[28:29], v[32:33]
  v_pk_add_f32 v[34:35], v[34:35], v[38:39]
  v_pk_add_f32 v[36:37], v[36:37], v[40:41]
  v_pk_add_f32 v[26:27], v[26:27], v[34:35]
  v_pk_add_f32 v[28:29], v[28:29], v[36:37]
  v_add_u32 v33, 160288, v24
  v_add_f32_dpp v30, v26, v26 row_ror:8 row_mask:0xf bank_mask:0x3
  v_add_f32_dpp v31, v28, v28 row_ror:8 row_mask:0xf bank_mask:0x3
  s_nop 0
  v_add_f32_dpp v30, v27, v27 row_ror:8 row_mask:0xf bank_mask:0xc
  v_add_f32_dpp v31, v29, v29 row_ror:8 row_mask:0xf bank_mask:0xc
  s_nop 1
  v_permlane32_swap_b32 v30, v31
  v_add_f32 v30, v30, v31
  v_mov_b32 v31, v30
  s_nop 1
  v_permlane16_swap_b32 v30, v31
  v_add_f32 v30, v30, v31
  v_cvt_pk_bf16_f32 v30, v30, v30
  v_and_b32 v30, 0xffff0000, v30
  v_add_f32 v30, v30, v25
  v_cvt_pk_bf16_f32 v31, v30, v30
  ds_write_b16 v33, v31
  v_and_b32 v25, 0xffff0000, v31
  s_mov_b64 exec, -1
  v_mov_b32 v75, 160288
  v_mov_b32 v32, 161216
  s_mov_b32 vcc_lo, 0x00f000f0
  s_mov_b32 vcc_hi, 0x00f000f0
  v_cndmask_b32 v75, v75, v32, vcc
  v_lshrrev_b32 v32, 4, v0
  v_lshl_add_u32 v75, v32, 3, v75
  s_waitcnt lgkmcnt(0)
  s_barrier
  ds_read2_b64 v[34:37], v75 offset0:0 offset1:4
  ds_read2_b64 v[38:41], v75 offset0:8 offset1:12
  ds_read_b64 v[42:43], v75 offset:128
  s_add_u32 s73, s72, 2
  s_add_u32 s76, s80, 3145728
  s_mul_i32 s91, s31, 240
  s_sub_u32 s91, 2048, s91
  v_lshlrev_b32 v74, 4, v0
  v_writelane_b32 v74, s91, 32
  s_waitcnt lgkmcnt(0)
  v_mfma_f32_16x16x32_bf16 v[26:29], v[34:37], v[44:47], 0
  v_mfma_f32_16x16x32_bf16 v[30:33], v[34:37], v[54:57], 0
  v_mfma_f32_16x16x32_bf16 v[26:29], v[38:41], v[48:51], v[26:29]
  v_mfma_f32_16x16x32_bf16 v[30:33], v[38:41], v[58:61], v[30:33]
  v_mfma_f32_16x16x16_bf16 v[26:29], v[42:43], v[52:53], v[26:29]
  v_mfma_f32_16x16x16_bf16 v[30:33], v[42:43], v[62:63], v[30:33]
  v_mfma_f32_16x16x32_bf16 v[48:51], v[34:37], v[34:37], 0
  v_mfma_f32_16x16x32_bf16 v[44:47], v[34:37], v[64:67], 0
  v_mfma_f32_16x16x32_bf16 v[48:51], v[38:41], v[38:41], v[48:51]
  v_mfma_f32_16x16x32_bf16 v[44:47], v[38:41], v[68:71], v[44:47]
  v_mfma_f32_16x16x16_bf16 v[48:51], v[42:43], v[42:43], v[48:51]
  v_mfma_f32_16x16x16_bf16 v[44:47], v[42:43], v[72:73], v[44:47]
  s_nop 0
  v_mov_b32 v29, s73
  v_mov_b32 v27, v30
  s_nop 4
  v_mov_b32 v28, v44
  v_mov_b32_dpp v26, v48 quad_perm:[0,1,2,3] row_mask:0x4 bank_mask:0xf
  v_mov_b32_dpp v27, v48 row_ror:12 row_mask:0x4 bank_mask:0xf
  s_mov_b32 exec_lo, 0xffff
  s_mov_b32 exec_hi, 1
  buffer_store_dwordx4 v[26:29], v74, s[64:67], s76 offen
  s_mov_b64 exec, -1
  s_add_u32 s73, s72, 2
  v_and_b32 v38, 7, v0
  s_add_u32 s91, s27, 2048
  v_lshl_add_u32 v38, v38, 4, s91
  s_add_u32 s97, s81, 3145728
  buffer_load_dwordx4 v[34:37], v38, s[64:67], s97 offen nt
  buffer_load_dwordx4 v[26:29], v6, s[64:67], s97 offen offset:0 nt
  buffer_load_dwordx4 v[30:33], v6, s[64:67], s97 offen offset:1024 nt
  v_and_b32 v58, 15, v0
  v_bfe_u32 v60, v0, 4, 1
  v_lshl_add_u32 v58, v60, 5, v58
  v_lshrrev_b32 v60, 5, v0
  v_lshl_add_u32 v58, v60, 4, v58
  s_mul_i32 s91, s3, 96
  s_add_u32 s91, s91, 160832
  v_lshl_add_u32 v58, v58, 1, s91
  v_lshrrev_b32 v61, 2, v6
  v_add_u32 v61, 161504, v61
  ds_read_b32 v60, v61
  s_waitcnt vmcnt(0)
L_chk_267:
  v_bitop3_b32 v75, v37, v29, s73 bitop3:0x7e
  v_bitop3_b32 v75, v75, v33, s73 bitop3:0xf6
  v_cmp_ne_u32 vcc, 0, v75
  s_nop 0
  s_cbranch_vccz L_retry_268
  buffer_load_dwordx4 v[34:37], v38, s[64:67], s97 offen nt
  buffer_load_dwordx4 v[26:29], v6, s[64:67], s97 offen offset:0 nt
  buffer_load_dwordx4 v[30:33], v6, s[64:67], s97 offen offset:1024 nt
  s_sub_u32 s75, s75, 1
  s_cbranch_scc1 L_end
  s_waitcnt vmcnt(0)
  s_branch L_chk_267
L_retry_268:
  v_pk_add_f32 v[26:27], v[26:27], v[30:31]
  v_add_f32 v28, v28, v32
  v_mov_b32 v29, v28
  v_add_f32_dpp v34, v34, v34 quad_perm:[1,0,3,2] row_mask:0xf bank_mask:0xf
  v_add_f32_dpp v35, v35, v35 quad_perm:[1,0,3,2] row_mask:0xf bank_mask:0xf
  v_permlane32_swap_b32 v26, v27
  v_permlane32_swap_b32 v28, v29
  v_add_f32_dpp v34, v34, v34 quad_perm:[2,3,0,1] row_mask:0xf bank_mask:0xf
  v_add_f32_dpp v35, v35, v35 quad_perm:[2,3,0,1] row_mask:0xf bank_mask:0xf
  v_add_f32 v26, v26, v27
  v_add_f32 v28, v28, v29
  v_add_f32_dpp v34, v34, v34 row_half_mirror row_mask:0xf bank_mask:0xf
  v_add_f32_dpp v35, v35, v35 row_half_mirror row_mask:0xf bank_mask:0xf
  v_permlane16_swap_b32 v26, v28
  v_mul_f32 v35, 0x3acccccd, v35
  v_mul_f32 v34, 0x3acccccd, v34
  v_add_f32 v62, v26, v28
  v_fma_f32 v34, -v35, v35, v34
  v_max_f32 v34, 0, v34
  v_add_f32 v34, 0x3727c5ac, v34
  v_rsq_f32 v34, v34
  s_waitcnt lgkmcnt(0)
  v_fma_f32 v62, -v35, v60, v62
  s_mov_b32 exec_hi, 0xffff
  v_mul_f32 v62, v62, v34
  v_cvt_pk_bf16_f32 v62, v62, v62
  ds_write_b16 v58, v62
  s_mov_b64 exec, -1
  s_waitcnt lgkmcnt(0)
  s_barrier
  v_and_b32 v66, 7, v0
  v_lshlrev_b32 v66, 4, v66
  v_add_u32 v66, 160832, v66
  ds_read_b128 v[26:29], v66 offset:0
  ds_read_b128 v[30:33], v66 offset:128
  ds_read_b128 v[34:37], v66 offset:256
  s_waitcnt lgkmcnt(0)
.balignl 8, 0xBF800000
  v_mfma_f32_4x4x4_16b_bf16 v[44:47], v[26:27], a[120:121], 0
  v_mfma_f32_4x4x4_16b_bf16 v[48:51], v[26:27], a[132:133], 0
  v_nop_e64
  v_mfma_f32_4x4x4_16b_bf16 v[44:47], v[28:29], a[122:123], v[44:47]
  v_mfma_f32_4x4x4_16b_bf16 v[48:51], v[28:29], a[134:135], v[48:51]
  v_nop_e64
  v_mfma_f32_4x4x4_16b_bf16 v[44:47], v[30:31], a[124:125], v[44:47]
  v_mfma_f32_4x4x4_16b_bf16 v[48:51], v[30:31], a[136:137], v[48:51]
  v_nop_e64
  v_mfma_f32_4x4x4_16b_bf16 v[44:47], v[32:33], a[126:127], v[44:47]
  v_mfma_f32_4x4x4_16b_bf16 v[48:51], v[32:33], a[138:139], v[48:51]
  v_nop_e64
  v_mfma_f32_4x4x4_16b_bf16 v[44:47], v[34:35], a[128:129], v[44:47]
  v_mfma_f32_4x4x4_16b_bf16 v[48:51], v[34:35], a[140:141], v[48:51]
  v_nop_e64
  v_mfma_f32_4x4x4_16b_bf16 v[44:47], v[36:37], a[130:131], v[44:47]
  v_mfma_f32_4x4x4_16b_bf16 v[48:51], v[36:37], a[142:143], v[48:51]
  v_mfma_f32_4x4x4_16b_bf16 v[52:55], v[26:27], a[144:145], 0
  v_mfma_f32_4x4x4_16b_bf16 v[56:59], v[26:27], a[156:157], 0
  v_nop_e64
  v_mfma_f32_4x4x4_16b_bf16 v[52:55], v[28:29], a[146:147], v[52:55]
  v_mov_b32_dpp v60, v44 quad_perm:[0,0,0,0] row_mask:0xf bank_mask:0xf
  v_mfma_f32_4x4x4_16b_bf16 v[56:59], v[28:29], a[158:159], v[56:59]
  v_mov_b32_dpp v61, v48 quad_perm:[0,0,0,0] row_mask:0xf bank_mask:0xf
  v_mfma_f32_4x4x4_16b_bf16 v[52:55], v[30:31], a[148:149], v[52:55]
  v_add_f32_dpp v60, v45, v60 quad_perm:[1,1,1,1] row_mask:0xf bank_mask:0xf
  v_mfma_f32_4x4x4_16b_bf16 v[56:59], v[30:31], a[160:161], v[56:59]
  v_add_f32_dpp v61, v49, v61 quad_perm:[1,1,1,1] row_mask:0xf bank_mask:0xf
  v_mfma_f32_4x4x4_16b_bf16 v[52:55], v[32:33], a[150:151], v[52:55]
  v_add_f32_dpp v60, v46, v60 quad_perm:[2,2,2,2] row_mask:0xf bank_mask:0xf
  v_mfma_f32_4x4x4_16b_bf16 v[56:59], v[32:33], a[162:163], v[56:59]
  v_add_f32_dpp v61, v50, v61 quad_perm:[2,2,2,2] row_mask:0xf bank_mask:0xf
  v_mfma_f32_4x4x4_16b_bf16 v[52:55], v[34:35], a[152:153], v[52:55]
  v_add_f32_dpp v38, v47, v60 quad_perm:[3,3,3,3] row_mask:0xf bank_mask:0xf
  v_mfma_f32_4x4x4_16b_bf16 v[56:59], v[34:35], a[164:165], v[56:59]
  v_add_f32_dpp v61, v51, v61 quad_perm:[3,3,3,3] row_mask:0xf bank_mask:0xf
  v_mfma_f32_4x4x4_16b_bf16 v[52:55], v[36:37], a[154:155], v[52:55]
  v_mfma_f32_4x4x4_16b_bf16 v[56:59], v[36:37], a[166:167], v[56:59]
  v_cndmask_b32 v38, v38, v61, s[84:85]
  s_nop 0
  s_nop 1
  v_mov_b32_dpp v62, v52 quad_perm:[0,0,0,0] row_mask:0xf bank_mask:0xf
  v_mov_b32_dpp v63, v56 quad_perm:[0,0,0,0] row_mask:0xf bank_mask:0xf
  v_nop_e64
  v_add_f32_dpp v62, v53, v62 quad_perm:[1,1,1,1] row_mask:0xf bank_mask:0xf
  v_add_f32_dpp v63, v57, v63 quad_perm:[1,1,1,1] row_mask:0xf bank_mask:0xf
  v_nop_e64
  v_add_f32_dpp v62, v54, v62 quad_perm:[2,2,2,2] row_mask:0xf bank_mask:0xf
  v_add_f32_dpp v63, v58, v63 quad_perm:[2,2,2,2] row_mask:0xf bank_mask:0xf
  v_nop_e64
  v_add_f32_dpp v62, v55, v62 quad_perm:[3,3,3,3] row_mask:0xf bank_mask:0xf
  v_add_f32_dpp v63, v59, v63 quad_perm:[3,3,3,3] row_mask:0xf bank_mask:0xf
  v_cndmask_b32 v38, v38, v62, s[86:87]
  v_cndmask_b32 v38, v38, v63, s[88:89]
  s_nop 0
  s_nop 0
  v_add_f32_dpp v38, v38, v38 row_half_mirror row_mask:0xf bank_mask:0xf
  s_mov_b32 s22, 50331648
  buffer_load_dwordx4 a[156:159], v1, s[40:43], s22 offen offset:0 nt
  buffer_load_dwordx4 a[160:163], v1, s[40:43], s22 offen offset:128 nt
  buffer_load_dwordx4 a[164:167], v1, s[40:43], s22 offen offset:256 nt
  v_max_f32_dpp v66, v38, v38 quad_perm:[1,0,3,2] row_mask:0xf bank_mask:0xf
  s_nop 1
  v_max_f32_dpp v66, v66, v66 quad_perm:[2,3,0,1] row_mask:0xf bank_mask:0xf
  s_nop 1
  v_max_f32_dpp v66, v66, v66 row_ror:8 row_mask:0xf bank_mask:0xf
  s_nop 1
  v_max_f32_dpp v66, v66, v66 row_bcast:15 row_mask:0xa bank_mask:0xf
  s_nop 1
  v_max_f32_dpp v66, v66, v66 row_bcast:31 row_mask:0xc bank_mask:0xf
  s_nop 0
  v_readlane_b32 s95, v66, 63
  v_mov_b32 v67, s21
  s_nop 0
  v_subrev_f32 v38, s95, v38
  v_mov_b32 v66, s95
  v_mul_f32 v38, 0x3dd53b95, v38
  ds_write_b32 v67, v66 offset:80
  v_exp_f32 v38, v38
  s_nop 1
  v_add_f32_dpp v68, v38, v38 quad_perm:[1,0,3,2] row_mask:0xf bank_mask:0xf
  v_cvt_pk_bf16_f32 v38, v38, v38
.balignl 8, 0xBF800000
  s_nop 0
  s_nop 0
  v_and_b32_dpp v46, v38, v2 quad_perm:[0,0,0,0] row_mask:0xf bank_mask:0xf
  v_and_b32_dpp v47, v38, v3 quad_perm:[0,0,0,0] row_mask:0xf bank_mask:0xf
  v_and_b32_dpp v48, v38, v4 quad_perm:[3,3,3,3] row_mask:0xf bank_mask:0xf
  v_and_b32_dpp v49, v38, v5 quad_perm:[3,3,3,3] row_mask:0xf bank_mask:0xf
  s_nop 0
  s_nop 0
  v_mfma_f32_16x16x32_bf16 v[26:29], v[46:49], a[108:111], 0
  v_and_b32_dpp v50, v38, v2 quad_perm:[1,1,1,1] row_mask:0xf bank_mask:0xf
  v_and_b32_dpp v51, v38, v3 quad_perm:[1,1,1,1] row_mask:0xf bank_mask:0xf
  v_mfma_f32_16x16x32_bf16 v[30:33], v[46:49], a[112:115], 0
  v_and_b32_dpp v52, v38, v4 quad_perm:[2,2,2,2] row_mask:0xf bank_mask:0xf
  v_and_b32_dpp v53, v38, v5 quad_perm:[2,2,2,2] row_mask:0xf bank_mask:0xf
  v_mfma_f32_16x16x32_bf16 v[34:37], v[46:49], a[116:119], 0
  v_add_f32_dpp v68, v68, v68 quad_perm:[2,3,0,1] row_mask:0xf bank_mask:0xf
  v_mfma_f32_16x16x32_bf16 v[26:29], v[50:53], v[76:79], v[26:29]
  v_and_b32_dpp v46, v38, v2 quad_perm:[2,2,2,2] row_mask:0xf bank_mask:0xf
  v_and_b32_dpp v47, v38, v3 quad_perm:[2,2,2,2] row_mask:0xf bank_mask:0xf
  v_mfma_f32_16x16x32_bf16 v[30:33], v[50:53], v[80:83], v[30:33]
  v_and_b32_dpp v48, v38, v4 quad_perm:[1,1,1,1] row_mask:0xf bank_mask:0xf
  v_and_b32_dpp v49, v38, v5 quad_perm:[1,1,1,1] row_mask:0xf bank_mask:0xf
  v_mfma_f32_16x16x32_bf16 v[34:37], v[50:53], v[84:87], v[34:37]
  v_add_f32_dpp v68, v68, v68 row_ror:8 row_mask:0xf bank_mask:0xf
  v_mfma_f32_16x16x32_bf16 v[26:29], v[46:49], v[88:91], v[26:29]
  v_and_b32_dpp v50, v38, v2 quad_perm:[3,3,3,3] row_mask:0xf bank_mask:0xf
  v_and_b32_dpp v51, v38, v3 quad_perm:[3,3,3,3] row_mask:0xf bank_mask:0xf
  v_mfma_f32_16x16x32_bf16 v[30:33], v[46:49], v[92:95], v[30:33]
  v_and_b32_dpp v52, v38, v4 quad_perm:[0,0,0,0] row_mask:0xf bank_mask:0xf
  v_and_b32_dpp v53, v38, v5 quad_perm:[0,0,0,0] row_mask:0xf bank_mask:0xf
  v_mfma_f32_16x16x32_bf16 v[34:37], v[46:49], v[96:99], v[34:37]
  v_add_f32_dpp v68, v68, v68 row_bcast:15 row_mask:0xa bank_mask:0xf
  v_mfma_f32_16x16x32_bf16 v[26:29], v[50:53], v[100:103], v[26:29]
  v_mfma_f32_16x16x32_bf16 v[30:33], v[50:53], v[104:107], v[30:33]
  v_mfma_f32_16x16x32_bf16 v[34:37], v[50:53], v[108:111], v[34:37]
  v_add_f32_dpp v68, v68, v68 row_bcast:31 row_mask:0xc bank_mask:0xf
  s_nop 0
  v_readlane_b32 s96, v68, 63
  v_lshrrev_b32 v60, 4, v0
  v_and_b32 v59, 15, v0
  v_lshlrev_b32 v58, 10, v60
  v_lshl_add_u32 v58, v59, 4, v58
  s_lshl_b32 s91, s3, 8
  s_add_u32 s91, s91, 155648
  v_add_u32 v58, s91, v58
  v_add_u32 v59, 155648, v6
  v_mov_b32 v49, s96
  v_permlane32_swap_b32 v26, v27
  v_permlane32_swap_b32 v28, v29
  v_permlane32_swap_b32 v30, v31
  v_permlane32_swap_b32 v32, v33
  v_permlane32_swap_b32 v34, v35
  v_permlane32_swap_b32 v36, v37
  v_add_f32_dpp v46, v27, v26 row_ror:8 row_mask:0xf bank_mask:0x3
  v_add_f32_dpp v47, v31, v30 row_ror:8 row_mask:0xf bank_mask:0x3
  v_add_f32_dpp v48, v35, v34 row_ror:8 row_mask:0xf bank_mask:0x3
  v_add_f32_dpp v46, v28, v29 row_ror:8 row_mask:0xf bank_mask:0xc
  v_add_f32_dpp v47, v32, v33 row_ror:8 row_mask:0xf bank_mask:0xc
  v_add_f32_dpp v48, v36, v37 row_ror:8 row_mask:0xf bank_mask:0xc
  ds_write_b128 v59, v[46:49]
  v_lshlrev_b32 v60, 2, v60
  v_add_u32 v60, 161456, v60
  v_mov_b32 v62, 161456
  s_waitcnt lgkmcnt(0)
  s_barrier
  ds_read_b128 v[54:57], v62
  ds_read_b32 v62, v60
  ds_read_b128 v[50:53], v58
  s_add_u32 s73, s72, 2
  s_mul_i32 s91, s31, 240
  s_sub_u32 s91, 2048, s91
  v_lshlrev_b32 v59, 4, v0
  v_writelane_b32 v59, s91, 16
  v_mov_b32 v49, s73
  s_add_u32 s76, s78, 524288
  s_waitcnt lgkmcnt(1)
  v_max3_f32 v54, v54, v55, v56
  v_max_f32 v54, v54, v57
  v_sub_f32 v62, v62, v54
  v_mul_f32 v62, 0x3dd53b95, v62
  v_exp_f32 v62, v62
  s_waitcnt lgkmcnt(0)
  v_pk_mul_f32 v[50:51], v[50:51], v[62:63] op_sel_hi:[1,0]
  v_pk_mul_f32 v[52:53], v[52:53], v[62:63] op_sel_hi:[1,0]
  s_nop 0
  v_permlane32_swap_b32 v50, v51
  v_permlane32_swap_b32 v52, v53
  v_add_f32 v50, v50, v51
  v_add_f32 v52, v52, v53
  s_nop 1
  v_permlane16_swap_b32 v50, v52
  v_add_f32 v46, v50, v52
  v_add_f32 v47, v50, v52
  s_nop 1
  v_permlane32_swap_b32 v46, v47
  v_mov_b32 v48, v46
  s_nop 1
  v_permlane16_swap_b32 v46, v48
  s_nop 1
  v_mov_b32_dpp v46, v54 quad_perm:[0,1,2,3] row_mask:0x2 bank_mask:0xf
  s_mov_b64 exec, 0x1ffff
  buffer_store_dwordx4 v[46:49], v59, s[64:67], s76 offen
  s_mov_b64 exec, -1
  s_add_u32 s73, s72, 2
  v_lshrrev_b32 v45, 4, v0
  v_and_b32 v44, 1, v0
  v_lshl_add_u32 v45, v44, 2, v45
  s_add_u32 s91, s27, 2048
  v_lshl_add_u32 v45, v45, 4, s91
  s_add_u32 s97, s79, 524288
  buffer_load_dwordx4 v[34:37], v45, s[64:67], s97 offen nt
  buffer_load_dwordx4 v[26:29], v6, s[64:67], s97 offen offset:0 nt
  buffer_load_dwordx4 v[30:33], v6, s[64:67], s97 offen offset:1024 nt
  v_lshrrev_b32 v46, 2, v0
  v_and_b32 v47, 3, v0
  v_mul_u32_u24 v46, 160, v46
  v_lshl_add_u32 v47, v47, 3, v46
  s_lshl_b32 s91, s3, 5
  s_add_u32 s91, s91, 94208
  v_add_u32 v46, s91, v47
  v_add_u32 v47, 94336, v47
  v_bfe_u32 v49, v0, 4, 1
  v_lshlrev_b32 v49, 8, v49
  v_lshrrev_b32 v48, 5, v0
  v_lshl_add_u32 v49, v48, 7, v49
  v_and_b32 v48, 7, v0
  v_lshl_add_u32 v49, v48, 4, v49
  v_bfe_u32 v48, v0, 3, 1
  v_lshl_add_u32 v49, v48, 2, v49
  s_and_b32 s91, s3, 1
  s_lshl_b32 s91, s91, 3
  s_and_b32 s92, s3, 2
  s_add_u32 s91, s91, s92
  s_add_u32 s91, s91, 159744
  v_add_u32 v49, s91, v49
  v_and_b32 v74, 0x30, v0
  s_lshl_b32 s91, s3, 4
  s_add_u32 s91, s91, 1
  v_writelane_b32 v74, 64, s91
  s_movk_i32 s91, 80
  v_writelane_b32 v74, s91, 2
  s_movk_i32 s91, 96
  v_writelane_b32 v74, s91, 3
  s_movk_i32 s91, 112
  v_writelane_b32 v74, s91, 4
  s_bfe_u32 s68, s73, 0x80000
  s_bfe_u32 s69, s73, 0x80008
  s_bfe_u32 s70, s73, 0x80010
  s_bfe_u32 s90, s73, 0x80018
  ds_read_b64_tr_b16 v[50:51], v46 offset:0
  ds_read_b64_tr_b16 v[52:53], v46 offset:2560
  ds_read_b64_tr_b16 v[54:55], v47 offset:0
  ds_read_b64_tr_b16 v[56:57], v47 offset:2560
  ds_read_b64_tr_b16 v[58:59], v46 offset:5120
  ds_read_b64_tr_b16 v[60:61], v46 offset:7680
  ds_read_b64_tr_b16 v[62:63], v47 offset:5120
  ds_read_b64_tr_b16 v[64:65], v47 offset:7680
  ds_read_b64_tr_b16 v[66:67], v46 offset:10240
  ds_read_b64_tr_b16 v[68:69], v46 offset:12800
  ds_read_b64_tr_b16 v[70:71], v47 offset:10240
  ds_read_b64_tr_b16 v[72:73], v47 offset:12800
  s_waitcnt vmcnt(0)
L_chk_269:
  v_bitop3_b32 v75, v37, v29, s73 bitop3:0x7e
  v_bitop3_b32 v75, v75, v33, s73 bitop3:0xf6
  v_cmp_ne_u32 vcc, 0, v75
  s_nop 0
  s_cbranch_vccz L_retry_270
  buffer_load_dwordx4 v[34:37], v45, s[64:67], s97 offen nt
  buffer_load_dwordx4 v[26:29], v6, s[64:67], s97 offen offset:0 nt
  buffer_load_dwordx4 v[30:33], v6, s[64:67], s97 offen offset:1024 nt
  s_sub_u32 s75, s75, 1
  s_cbranch_scc1 L_end
  s_waitcnt vmcnt(0)
  s_branch L_chk_269
L_retry_270:
  v_max_f32_dpp v43, v34, v34 quad_perm:[1,0,3,2] row_mask:0xf bank_mask:0xf
  v_mov_b32 v42, v43
  s_nop 1
  v_permlane32_swap_b32 v43, v42
  v_max_f32 v43, v43, v42
  v_mov_b32 v42, v43
  s_nop 1
  v_permlane16_swap_b32 v43, v42
  v_max_f32 v43, v43, v42
  v_sub_f32 v43, v34, v43
  v_mul_f32 v43, 0x3dd53b95, v43
  v_exp_f32 v43, v43
  s_nop 0
  v_mul_f32 v35, v35, v43
  v_mul_f32_dpp v26, v43, v26 quad_perm:[0,0,2,2] row_mask:0xf bank_mask:0xf
  v_mul_f32_dpp v27, v43, v27 quad_perm:[0,0,2,2] row_mask:0xf bank_mask:0xf
  v_mul_f32_dpp v28, v43, v28 quad_perm:[0,0,2,2] row_mask:0xf bank_mask:0xf
  v_add_f32_dpp v29, v35, v35 quad_perm:[1,0,3,2] row_mask:0xf bank_mask:0xf
  v_fmac_f32_dpp v26, v43, v30 quad_perm:[1,1,3,3] row_mask:0xf bank_mask:0xf
  v_fmac_f32_dpp v27, v43, v31 quad_perm:[1,1,3,3] row_mask:0xf bank_mask:0xf
  v_fmac_f32_dpp v28, v43, v32 quad_perm:[1,1,3,3] row_mask:0xf bank_mask:0xf
  s_nop 0
  v_permlane32_swap_b32 v26, v27
  v_permlane32_swap_b32 v28, v29
  v_add_f32 v26, v26, v27
  v_add_f32 v28, v28, v29
  s_nop 1
  v_permlane16_swap_b32 v26, v28
  v_add_f32 v48, v26, v28
  v_lshrrev_b32 v45, 4, v0
  v_readlane_b32 s92, v48, 48
  v_lshlrev_b32 v45, 3, v45
  v_add_u32 v44, 159744, v45
  v_rcp_f32 v43, s92
  s_mov_b32 exec_hi, 0xffff
  v_mul_f32 v48, v48, v43
  v_cvt_pk_bf16_f32 v48, v48, v48
  ds_write_b16 v49, v48
  s_mov_b64 exec, -1
  s_waitcnt lgkmcnt(0)
  s_barrier
  ds_read2_b64 v[26:29], v44 offset0:0 offset1:4
  ds_read2_b64 v[30:33], v44 offset0:8 offset1:12
  ds_read2_b64 v[34:37], v44 offset0:16 offset1:20
  v_mov_b32 v48, v44
  s_add_u32 s76, s82, 655360
  s_lshl_b32 s91, s3, 4
  s_lshl_b64 vcc, 2, s91
  s_or_b32 s91, vcc_lo, 0x1001d
  s_or_b32 s92, vcc_hi, 0x10001
  v_mov_b32 v49, 0xffffff00
  s_waitcnt lgkmcnt(2)
  v_mfma_f32_16x16x32_bf16 v[38:41], v[50:53], v[26:29], 0
  v_mfma_f32_16x16x32_bf16 v[42:45], v[54:57], v[26:29], 0
  ds_read2_b64 v[26:29], v48 offset0:24 offset1:28
  ds_read_b64_tr_b16 v[50:51], v46 offset:15360
  ds_read_b64_tr_b16 v[52:53], v46 offset:17920
  ds_read_b64_tr_b16 v[54:55], v47 offset:15360
  ds_read_b64_tr_b16 v[56:57], v47 offset:17920
  s_waitcnt lgkmcnt(6)
  v_mfma_f32_16x16x32_bf16 v[38:41], v[58:61], v[30:33], v[38:41]
  v_mfma_f32_16x16x32_bf16 v[42:45], v[62:65], v[30:33], v[42:45]
  ds_read2_b64 v[30:33], v48 offset0:32 offset1:36
  ds_read_b64_tr_b16 v[58:59], v46 offset:20480
  ds_read_b64_tr_b16 v[60:61], v46 offset:23040
  ds_read_b64_tr_b16 v[62:63], v47 offset:20480
  ds_read_b64_tr_b16 v[64:65], v47 offset:23040
  s_waitcnt lgkmcnt(10)
  v_mfma_f32_16x16x32_bf16 v[38:41], v[66:69], v[34:37], v[38:41]
  v_mfma_f32_16x16x32_bf16 v[42:45], v[70:73], v[34:37], v[42:45]
  ds_read2_b64 v[34:37], v48 offset0:40 offset1:44
  ds_read_b64_tr_b16 v[66:67], v46 offset:25600
  ds_read_b64_tr_b16 v[68:69], v46 offset:28160
  ds_read_b64_tr_b16 v[70:71], v47 offset:25600
  ds_read_b64_tr_b16 v[72:73], v47 offset:28160
  s_waitcnt lgkmcnt(10)
  v_mfma_f32_16x16x32_bf16 v[38:41], v[50:53], v[26:29], v[38:41]
  v_mfma_f32_16x16x32_bf16 v[42:45], v[54:57], v[26:29], v[42:45]
  s_waitcnt lgkmcnt(5)
  v_mfma_f32_16x16x32_bf16 v[38:41], v[58:61], v[30:33], v[38:41]
  v_mfma_f32_16x16x32_bf16 v[42:45], v[62:65], v[30:33], v[42:45]
  s_waitcnt lgkmcnt(0)
  v_mfma_f32_16x16x32_bf16 v[38:41], v[66:69], v[34:37], v[38:41]
  v_mfma_f32_16x16x32_bf16 v[42:45], v[70:73], v[34:37], v[42:45]
  s_nop 7
  v_cndmask_b32 v26, v38, v42, vcc
  v_cndmask_b32 v27, v39, v43, vcc
  v_cndmask_b32 v28, v40, v44, vcc
  v_cndmask_b32 v29, v41, v45, vcc
  s_mov_b32 exec_lo, s91
  s_mov_b32 exec_hi, s92
  v_and_or_b32 v26, v26, v49, s68
  v_and_or_b32 v27, v27, v49, s69
  v_and_or_b32 v28, v28, v49, s70
  v_and_or_b32 v29, v29, v49, s90
  buffer_store_dwordx4 v[26:29], v74, s[64:67], s76 offen sc1
  s_mov_b64 exec, -1
  s_waitcnt vmcnt(0)
  v_bfe_u32 v72, v0, 2, 3
  v_lshrrev_b32 v71, 5, v0
  v_mul_u32_u24 v71, 3072, v71
  v_lshl_add_u32 v71, v72, 7, v71
  v_and_b32 v73, 3, v0
  v_lshl_add_u32 v71, v73, 3, v71
  v_lshrrev_b32 v72, 1, v72
  s_mul_i32 s91, s3, 3
  s_add_u32 s91, s91, 0
  s_and_b32 s92, s91, 3
  s_lshr_b32 s91, s91, 2
  v_xor_b32 v73, s92, v72
  s_lshl_b32 s91, s91, 10
  s_add_u32 s91, s91, 63488
  v_lshl_add_u32 v73, v73, 5, v71
  v_add_u32 v42, s91, v73
  ds_read_b64_tr_b16 v[44:45], v42 offset:0
  ds_read_b64_tr_b16 v[46:47], v42 offset:6144
  ds_read_b64_tr_b16 v[48:49], v42 offset:12288
  ds_read_b64_tr_b16 v[50:51], v42 offset:18432
  ds_read_b64_tr_b16 v[52:53], v42 offset:24576
  s_mul_i32 s91, s3, 3
  s_add_u32 s91, s91, 1
  s_and_b32 s92, s91, 3
  s_lshr_b32 s91, s91, 2
  v_xor_b32 v73, s92, v72
  s_lshl_b32 s91, s91, 10
  s_add_u32 s91, s91, 63488
  v_lshl_add_u32 v73, v73, 5, v71
  v_add_u32 v43, s91, v73
  ds_read_b64_tr_b16 v[54:55], v43 offset:0
  ds_read_b64_tr_b16 v[56:57], v43 offset:6144
  ds_read_b64_tr_b16 v[58:59], v43 offset:12288
  ds_read_b64_tr_b16 v[60:61], v43 offset:18432
  ds_read_b64_tr_b16 v[62:63], v43 offset:24576
  s_mul_i32 s91, s3, 3
  s_add_u32 s91, s91, 2
  s_and_b32 s92, s91, 3
  s_lshr_b32 s91, s91, 2
  v_xor_b32 v73, s92, v72
  s_lshl_b32 s91, s91, 10
  s_add_u32 s91, s91, 63488
  v_lshl_add_u32 v73, v73, 5, v71
  v_add_u32 v42, s91, v73
  ds_read_b64_tr_b16 v[64:65], v42 offset:0
  ds_read_b64_tr_b16 v[66:67], v42 offset:6144
  ds_read_b64_tr_b16 v[68:69], v42 offset:12288
  ds_read_b64_tr_b16 v[70:71], v42 offset:18432
  ds_read_b64_tr_b16 v[72:73], v42 offset:24576
  s_add_u32 s73, s72, 2
  v_lshrrev_b32 v74, 3, v0
  v_and_b32 v75, 7, v0
  v_mul_u32_u24 v74, 128, v74
  v_lshl_add_u32 v74, v75, 4, v74
  s_add_u32 s97, s83, 655360
  s_mov_b32 exec_lo, 0x1f1f1f1f
  s_mov_b32 exec_hi, 0x1f1f1f1f
  buffer_load_dwordx4 v[26:29], v74, s[64:67], s97 offen offset:0 sc1
  buffer_load_dwordx4 v[30:33], v74, s[64:67], s97 offen offset:1024 sc1
  buffer_load_dwordx4 v[34:37], v74, s[64:67], s97 offen offset:2048 sc1
  buffer_load_dwordx4 v[38:41], v74, s[64:67], s97 offen offset:3072 sc1
  s_mov_b64 exec, -1
  s_bfe_u32 s68, s73, 0x80000
  s_bfe_u32 s69, s73, 0x80008
  s_bfe_u32 s70, s73, 0x80010
  s_bfe_u32 s90, s73, 0x80018
  s_waitcnt vmcnt(0)
  s_mov_b32 exec_lo, 0x1f1f1f1f
  s_mov_b32 exec_hi, 0x1f1f1f1f
L_chk_271:
  v_xor_b32 v26, s68, v26
  v_xor_b32 v30, s68, v30
  v_xor_b32 v34, s68, v34
  v_xor_b32 v38, s68, v38
  v_xor_b32 v27, s69, v27
  v_xor_b32 v31, s69, v31
  v_xor_b32 v35, s69, v35
  v_xor_b32 v39, s69, v39
  v_xor_b32 v28, s70, v28
  v_xor_b32 v32, s70, v32
  v_xor_b32 v36, s70, v36
  v_xor_b32 v40, s70, v40
  v_xor_b32 v29, s90, v29
  v_xor_b32 v33, s90, v33
  v_xor_b32 v37, s90, v37
  v_xor_b32 v41, s90, v41
  v_or3_b32 v75, v26, v30, v34
  v_or3_b32 v75, v75, v38, v27
  v_or3_b32 v75, v75, v31, v35
  v_or3_b32 v75, v75, v39, v28
  v_or3_b32 v75, v75, v32, v36
  v_or3_b32 v75, v75, v40, v29
  v_or3_b32 v75, v75, v33, v37
  v_or3_b32 v75, v75, v41, v41
  v_and_b32 v75, 0xff, v75
  v_cmp_ne_u32 vcc, 0, v75
  s_nop 0
  s_cbranch_vccz L_retry_272
  buffer_load_dwordx4 v[26:29], v74, s[64:67], s97 offen offset:0 sc1
  buffer_load_dwordx4 v[30:33], v74, s[64:67], s97 offen offset:1024 sc1
  buffer_load_dwordx4 v[34:37], v74, s[64:67], s97 offen offset:2048 sc1
  buffer_load_dwordx4 v[38:41], v74, s[64:67], s97 offen offset:3072 sc1
  s_sub_u32 s75, s75, 1
  s_cbranch_scc1 L_end
  s_waitcnt vmcnt(0)
  s_branch L_chk_271
L_retry_272:
  v_pk_add_f32 v[26:27], v[26:27], v[30:31]
  v_pk_add_f32 v[28:29], v[28:29], v[32:33]
  v_pk_add_f32 v[34:35], v[34:35], v[38:39]
  v_pk_add_f32 v[36:37], v[36:37], v[40:41]
  v_pk_add_f32 v[26:27], v[26:27], v[34:35]
  v_pk_add_f32 v[28:29], v[28:29], v[36:37]
  v_add_u32 v33, 160288, v24
  v_add_f32_dpp v30, v26, v26 row_ror:8 row_mask:0xf bank_mask:0x3
  v_add_f32_dpp v31, v28, v28 row_ror:8 row_mask:0xf bank_mask:0x3
  s_nop 0
  v_add_f32_dpp v30, v27, v27 row_ror:8 row_mask:0xf bank_mask:0xc
  v_add_f32_dpp v31, v29, v29 row_ror:8 row_mask:0xf bank_mask:0xc
  s_nop 1
  v_permlane32_swap_b32 v30, v31
  v_add_f32 v30, v30, v31
  v_mov_b32 v31, v30
  s_nop 1
  v_permlane16_swap_b32 v30, v31
  v_add_f32 v30, v30, v31
  v_cvt_pk_bf16_f32 v30, v30, v30
  v_and_b32 v30, 0xffff0000, v30
  v_add_f32 v30, v30, v25
  v_cvt_pk_bf16_f32 v31, v30, v30
  ds_write_b16 v33, v31
  v_and_b32 v25, 0xffff0000, v31
  s_mov_b64 exec, -1
  v_mov_b32 v75, 160288
  v_mov_b32 v32, 161216
  s_mov_b32 vcc_lo, 0x00f000f0
  s_mov_b32 vcc_hi, 0x00f000f0
  v_cndmask_b32 v75, v75, v32, vcc
  v_lshrrev_b32 v32, 4, v0
  v_lshl_add_u32 v75, v32, 3, v75
  s_waitcnt lgkmcnt(0)
  s_barrier
  ds_read2_b64 v[34:37], v75 offset0:0 offset1:4
  ds_read2_b64 v[38:41], v75 offset0:8 offset1:12
  ds_read_b64 v[42:43], v75 offset:128
  s_add_u32 s73, s72, 3
  s_add_u32 s76, s80, 3145728
  s_mul_i32 s91, s31, 240
  s_sub_u32 s91, 2048, s91
  v_lshlrev_b32 v74, 4, v0
  v_writelane_b32 v74, s91, 32
  s_waitcnt lgkmcnt(0)
  v_mfma_f32_16x16x32_bf16 v[26:29], v[34:37], v[44:47], 0
  v_mfma_f32_16x16x32_bf16 v[30:33], v[34:37], v[54:57], 0
  v_mfma_f32_16x16x32_bf16 v[26:29], v[38:41], v[48:51], v[26:29]
  v_mfma_f32_16x16x32_bf16 v[30:33], v[38:41], v[58:61], v[30:33]
  v_mfma_f32_16x16x16_bf16 v[26:29], v[42:43], v[52:53], v[26:29]
  v_mfma_f32_16x16x16_bf16 v[30:33], v[42:43], v[62:63], v[30:33]
  v_mfma_f32_16x16x32_bf16 v[48:51], v[34:37], v[34:37], 0
  v_mfma_f32_16x16x32_bf16 v[44:47], v[34:37], v[64:67], 0
  v_mfma_f32_16x16x32_bf16 v[48:51], v[38:41], v[38:41], v[48:51]
  v_mfma_f32_16x16x32_bf16 v[44:47], v[38:41], v[68:71], v[44:47]
  v_mfma_f32_16x16x16_bf16 v[48:51], v[42:43], v[42:43], v[48:51]
  v_mfma_f32_16x16x16_bf16 v[44:47], v[42:43], v[72:73], v[44:47]
  s_nop 0
  v_mov_b32 v29, s73
  v_mov_b32 v27, v30
  s_nop 4
  v_mov_b32 v28, v44
  v_mov_b32_dpp v26, v48 quad_perm:[0,1,2,3] row_mask:0x4 bank_mask:0xf
  v_mov_b32_dpp v27, v48 row_ror:12 row_mask:0x4 bank_mask:0xf
  s_mov_b32 exec_lo, 0xffff
  s_mov_b32 exec_hi, 1
  buffer_store_dwordx4 v[26:29], v74, s[64:67], s76 offen
  s_mov_b64 exec, -1
  s_add_u32 s73, s72, 3
  v_and_b32 v38, 7, v0
  s_add_u32 s91, s27, 2048
  v_lshl_add_u32 v38, v38, 4, s91
  s_add_u32 s97, s81, 3145728
  buffer_load_dwordx4 v[34:37], v38, s[64:67], s97 offen nt
  buffer_load_dwordx4 v[26:29], v6, s[64:67], s97 offen offset:0 nt
  buffer_load_dwordx4 v[30:33], v6, s[64:67], s97 offen offset:1024 nt
  v_and_b32 v58, 15, v0
  v_bfe_u32 v60, v0, 4, 1
  v_lshl_add_u32 v58, v60, 5, v58
  v_lshrrev_b32 v60, 5, v0
  v_lshl_add_u32 v58, v60, 4, v58
  s_mul_i32 s91, s3, 96
  s_add_u32 s91, s91, 160832
  v_lshl_add_u32 v58, v58, 1, s91
  v_lshrrev_b32 v61, 2, v6
  v_add_u32 v61, 162528, v61
  ds_read_b32 v60, v61
  s_waitcnt vmcnt(0)
L_chk_273:
  v_bitop3_b32 v75, v37, v29, s73 bitop3:0x7e
  v_bitop3_b32 v75, v75, v33, s73 bitop3:0xf6
  v_cmp_ne_u32 vcc, 0, v75
  s_nop 0
  s_cbranch_vccz L_retry_274
  buffer_load_dwordx4 v[34:37], v38, s[64:67], s97 offen nt
  buffer_load_dwordx4 v[26:29], v6, s[64:67], s97 offen offset:0 nt
  buffer_load_dwordx4 v[30:33], v6, s[64:67], s97 offen offset:1024 nt
  s_sub_u32 s75, s75, 1
  s_cbranch_scc1 L_end
  s_waitcnt vmcnt(0)
  s_branch L_chk_273
L_retry_274:
  v_pk_add_f32 v[26:27], v[26:27], v[30:31]
  v_add_f32 v28, v28, v32
  v_mov_b32 v29, v28
  v_add_f32_dpp v34, v34, v34 quad_perm:[1,0,3,2] row_mask:0xf bank_mask:0xf
  v_add_f32_dpp v35, v35, v35 quad_perm:[1,0,3,2] row_mask:0xf bank_mask:0xf
  v_permlane32_swap_b32 v26, v27
  v_permlane32_swap_b32 v28, v29
  v_add_f32_dpp v34, v34, v34 quad_perm:[2,3,0,1] row_mask:0xf bank_mask:0xf
  v_add_f32_dpp v35, v35, v35 quad_perm:[2,3,0,1] row_mask:0xf bank_mask:0xf
  v_add_f32 v26, v26, v27
  v_add_f32 v28, v28, v29
  v_add_f32_dpp v34, v34, v34 row_half_mirror row_mask:0xf bank_mask:0xf
  v_add_f32_dpp v35, v35, v35 row_half_mirror row_mask:0xf bank_mask:0xf
  v_permlane16_swap_b32 v26, v28
  v_mul_f32 v35, 0x3acccccd, v35
  v_mul_f32 v34, 0x3acccccd, v34
  v_add_f32 v62, v26, v28
  v_fma_f32 v34, -v35, v35, v34
  v_max_f32 v34, 0, v34
  v_add_f32 v34, 0x3727c5ac, v34
  v_rsq_f32 v34, v34
  s_waitcnt lgkmcnt(0)
  v_fma_f32 v62, -v35, v60, v62
  s_mov_b32 exec_hi, 0xffff
  v_mul_f32 v62, v62, v34
  v_cvt_pk_bf16_f32 v62, v62, v62
  ds_write_b16 v58, v62
  s_mov_b64 exec, -1
  s_waitcnt lgkmcnt(0)
  s_barrier
  v_and_b32 v66, 7, v0
  v_lshlrev_b32 v66, 4, v66
  v_add_u32 v66, 160832, v66
  ds_read_b128 v[26:29], v66 offset:0
  ds_read_b128 v[30:33], v66 offset:128
  ds_read_b128 v[34:37], v66 offset:256
  s_waitcnt lgkmcnt(0)
.balignl 8, 0xBF800000
  v_mfma_f32_4x4x4_16b_bf16 v[44:47], v[26:27], a[156:157], 0
  v_mfma_f32_4x4x4_16b_bf16 v[48:51], v[26:27], v[124:125], 0
  v_nop_e64
  v_mfma_f32_4x4x4_16b_bf16 v[44:47], v[28:29], a[158:159], v[44:47]
  v_mfma_f32_4x4x4_16b_bf16 v[48:51], v[28:29], v[126:127], v[48:51]
  v_nop_e64
  v_mfma_f32_4x4x4_16b_bf16 v[44:47], v[30:31], a[160:161], v[44:47]
  v_mfma_f32_4x4x4_16b_bf16 v[48:51], v[30:31], v[128:129], v[48:51]
  v_nop_e64
  v_mfma_f32_4x4x4_16b_bf16 v[44:47], v[32:33], a[162:163], v[44:47]
  v_mfma_f32_4x4x4_16b_bf16 v[48:51], v[32:33], v[130:131], v[48:51]
  v_nop_e64
  v_mfma_f32_4x4x4_16b_bf16 v[44:47], v[34:35], a[164:165], v[44:47]
  v_mfma_f32_4x4x4_16b_bf16 v[48:51], v[34:35], v[132:133], v[48:51]
  v_nop_e64
  v_mfma_f32_4x4x4_16b_bf16 v[44:47], v[36:37], a[166:167], v[44:47]
  v_mfma_f32_4x4x4_16b_bf16 v[48:51], v[36:37], v[134:135], v[48:51]
  v_mfma_f32_4x4x4_16b_bf16 v[52:55], v[26:27], v[136:137], 0
  v_mfma_f32_4x4x4_16b_bf16 v[56:59], v[26:27], v[148:149], 0
  v_nop_e64
  v_mfma_f32_4x4x4_16b_bf16 v[52:55], v[28:29], v[138:139], v[52:55]
  v_mov_b32_dpp v60, v44 quad_perm:[0,0,0,0] row_mask:0xf bank_mask:0xf
  v_mfma_f32_4x4x4_16b_bf16 v[56:59], v[28:29], v[150:151], v[56:59]
  v_mov_b32_dpp v61, v48 quad_perm:[0,0,0,0] row_mask:0xf bank_mask:0xf
  v_mfma_f32_4x4x4_16b_bf16 v[52:55], v[30:31], v[140:141], v[52:55]
  v_add_f32_dpp v60, v45, v60 quad_perm:[1,1,1,1] row_mask:0xf bank_mask:0xf
  v_mfma_f32_4x4x4_16b_bf16 v[56:59], v[30:31], v[152:153], v[56:59]
  v_add_f32_dpp v61, v49, v61 quad_perm:[1,1,1,1] row_mask:0xf bank_mask:0xf
  v_mfma_f32_4x4x4_16b_bf16 v[52:55], v[32:33], v[142:143], v[52:55]
  v_add_f32_dpp v60, v46, v60 quad_perm:[2,2,2,2] row_mask:0xf bank_mask:0xf
  v_mfma_f32_4x4x4_16b_bf16 v[56:59], v[32:33], v[154:155], v[56:59]
  v_add_f32_dpp v61, v50, v61 quad_perm:[2,2,2,2] row_mask:0xf bank_mask:0xf
  v_mfma_f32_4x4x4_16b_bf16 v[52:55], v[34:35], v[144:145], v[52:55]
  v_add_f32_dpp v38, v47, v60 quad_perm:[3,3,3,3] row_mask:0xf bank_mask:0xf
  v_mfma_f32_4x4x4_16b_bf16 v[56:59], v[34:35], v[156:157], v[56:59]
  v_add_f32_dpp v61, v51, v61 quad_perm:[3,3,3,3] row_mask:0xf bank_mask:0xf
  v_mfma_f32_4x4x4_16b_bf16 v[52:55], v[36:37], v[146:147], v[52:55]
  v_mfma_f32_4x4x4_16b_bf16 v[56:59], v[36:37], v[158:159], v[56:59]
  v_mfma_f32_4x4x4_16b_bf16 v[44:47], v[26:27], v[160:161], 0
  v_cndmask_b32 v38, v38, v61, s[84:85]
  v_mfma_f32_4x4x4_16b_bf16 v[48:51], v[26:27], v[244:245], 0
  v_mfma_f32_4x4x4_16b_bf16 v[44:47], v[28:29], v[162:163], v[44:47]
  v_mov_b32_dpp v62, v52 quad_perm:[0,0,0,0] row_mask:0xf bank_mask:0xf
  v_mfma_f32_4x4x4_16b_bf16 v[48:51], v[28:29], v[246:247], v[48:51]
  v_mov_b32_dpp v63, v56 quad_perm:[0,0,0,0] row_mask:0xf bank_mask:0xf
  v_mfma_f32_4x4x4_16b_bf16 v[44:47], v[30:31], v[164:165], v[44:47]
  v_add_f32_dpp v62, v53, v62 quad_perm:[1,1,1,1] row_mask:0xf bank_mask:0xf
  v_mfma_f32_4x4x4_16b_bf16 v[48:51], v[30:31], v[248:249], v[48:51]
  v_add_f32_dpp v63, v57, v63 quad_perm:[1,1,1,1] row_mask:0xf bank_mask:0xf
  v_mfma_f32_4x4x4_16b_bf16 v[44:47], v[32:33], v[166:167], v[44:47]
  v_add_f32_dpp v62, v54, v62 quad_perm:[2,2,2,2] row_mask:0xf bank_mask:0xf
  v_mfma_f32_4x4x4_16b_bf16 v[48:51], v[32:33], v[250:251], v[48:51]
  v_add_f32_dpp v63, v58, v63 quad_perm:[2,2,2,2] row_mask:0xf bank_mask:0xf
  v_mfma_f32_4x4x4_16b_bf16 v[44:47], v[34:35], v[168:169], v[44:47]
  v_add_f32_dpp v62, v55, v62 quad_perm:[3,3,3,3] row_mask:0xf bank_mask:0xf
  v_mfma_f32_4x4x4_16b_bf16 v[48:51], v[34:35], v[252:253], v[48:51]
  v_add_f32_dpp v63, v59, v63 quad_perm:[3,3,3,3] row_mask:0xf bank_mask:0xf
  v_mfma_f32_4x4x4_16b_bf16 v[44:47], v[36:37], v[170:171], v[44:47]
  v_mfma_f32_4x4x4_16b_bf16 v[48:51], v[36:37], v[254:255], v[48:51]
  v_mfma_f32_4x4x4_16b_bf16 v[52:55], v[26:27], a[0:1], 0
  v_cndmask_b32 v38, v38, v62, s[86:87]
  v_mfma_f32_4x4x4_16b_bf16 v[56:59], v[26:27], a[12:13], 0
  v_cndmask_b32 v38, v38, v63, s[88:89]
  v_mfma_f32_4x4x4_16b_bf16 v[52:55], v[28:29], a[2:3], v[52:55]
  v_mov_b32_dpp v60, v44 quad_perm:[0,0,0,0] row_mask:0xf bank_mask:0xf
  v_mfma_f32_4x4x4_16b_bf16 v[56:59], v[28:29], a[14:15], v[56:59]
  v_mov_b32_dpp v61, v48 quad_perm:[0,0,0,0] row_mask:0xf bank_mask:0xf
  v_mfma_f32_4x4x4_16b_bf16 v[52:55], v[30:31], a[4:5], v[52:55]
  v_add_f32_dpp v38, v38, v38 row_half_mirror row_mask:0xf bank_mask:0xf
  v_mfma_f32_4x4x4_16b_bf16 v[56:59], v[30:31], a[16:17], v[56:59]
  v_add_f32_dpp v60, v45, v60 quad_perm:[1,1,1,1] row_mask:0xf bank_mask:0xf
  v_mfma_f32_4x4x4_16b_bf16 v[52:55], v[32:33], a[6:7], v[52:55]
  v_add_f32_dpp v61, v49, v61 quad_perm:[1,1,1,1] row_mask:0xf bank_mask:0xf
  v_mfma_f32_4x4x4_16b_bf16 v[56:59], v[32:33], a[18:19], v[56:59]
  v_add_f32_dpp v60, v46, v60 quad_perm:[2,2,2,2] row_mask:0xf bank_mask:0xf
  v_mfma_f32_4x4x4_16b_bf16 v[52:55], v[34:35], a[8:9], v[52:55]
  v_add_f32_dpp v61, v50, v61 quad_perm:[2,2,2,2] row_mask:0xf bank_mask:0xf
  v_mfma_f32_4x4x4_16b_bf16 v[56:59], v[34:35], a[20:21], v[56:59]
  v_add_f32_dpp v39, v47, v60 quad_perm:[3,3,3,3] row_mask:0xf bank_mask:0xf
  v_mfma_f32_4x4x4_16b_bf16 v[52:55], v[36:37], a[10:11], v[52:55]
  v_add_f32_dpp v61, v51, v61 quad_perm:[3,3,3,3] row_mask:0xf bank_mask:0xf
  v_mfma_f32_4x4x4_16b_bf16 v[56:59], v[36:37], a[22:23], v[56:59]
  v_mfma_f32_4x4x4_16b_bf16 v[44:47], v[26:27], a[24:25], 0
  v_cndmask_b32 v39, v39, v61, s[84:85]
  v_mfma_f32_4x4x4_16b_bf16 v[48:51], v[26:27], a[36:37], 0
  v_mfma_f32_4x4x4_16b_bf16 v[44:47], v[28:29], a[26:27], v[44:47]
  v_mov_b32_dpp v62, v52 quad_perm:[0,0,0,0] row_mask:0xf bank_mask:0xf
  v_mfma_f32_4x4x4_16b_bf16 v[48:51], v[28:29], a[38:39], v[48:51]
  v_mov_b32_dpp v63, v56 quad_perm:[0,0,0,0] row_mask:0xf bank_mask:0xf
  v_mfma_f32_4x4x4_16b_bf16 v[44:47], v[30:31], a[28:29], v[44:47]
  v_add_f32_dpp v62, v53, v62 quad_perm:[1,1,1,1] row_mask:0xf bank_mask:0xf
  v_mfma_f32_4x4x4_16b_bf16 v[48:51], v[30:31], a[40:41], v[48:51]
  v_add_f32_dpp v63, v57, v63 quad_perm:[1,1,1,1] row_mask:0xf bank_mask:0xf
  v_mfma_f32_4x4x4_16b_bf16 v[44:47], v[32:33], a[30:31], v[44:47]
  v_add_f32_dpp v62, v54, v62 quad_perm:[2,2,2,2] row_mask:0xf bank_mask:0xf
  v_mfma_f32_4x4x4_16b_bf16 v[48:51], v[32:33], a[42:43], v[48:51]
  v_add_f32_dpp v63, v58, v63 quad_perm:[2,2,2,2] row_mask:0xf bank_mask:0xf
  v_mfma_f32_4x4x4_16b_bf16 v[44:47], v[34:35], a[32:33], v[44:47]
  v_add_f32_dpp v62, v55, v62 quad_perm:[3,3,3,3] row_mask:0xf bank_mask:0xf
  v_mfma_f32_4x4x4_16b_bf16 v[48:51], v[34:35], a[44:45], v[48:51]
  v_add_f32_dpp v63, v59, v63 quad_perm:[3,3,3,3] row_mask:0xf bank_mask:0xf
  v_mfma_f32_4x4x4_16b_bf16 v[44:47], v[36:37], a[34:35], v[44:47]
  v_mfma_f32_4x4x4_16b_bf16 v[48:51], v[36:37], a[46:47], v[48:51]
  v_mfma_f32_4x4x4_16b_bf16 v[52:55], v[26:27], a[48:49], 0
  v_cndmask_b32 v39, v39, v62, s[86:87]
  v_mfma_f32_4x4x4_16b_bf16 v[56:59], v[26:27], a[60:61], 0
  v_cndmask_b32 v39, v39, v63, s[88:89]
  v_mfma_f32_4x4x4_16b_bf16 v[52:55], v[28:29], a[50:51], v[52:55]
  v_mov_b32_dpp v60, v44 quad_perm:[0,0,0,0] row_mask:0xf bank_mask:0xf
  v_mfma_f32_4x4x4_16b_bf16 v[56:59], v[28:29], a[62:63], v[56:59]
  v_mov_b32_dpp v61, v48 quad_perm:[0,0,0,0] row_mask:0xf bank_mask:0xf
  v_mfma_f32_4x4x4_16b_bf16 v[52:55], v[30:31], a[52:53], v[52:55]
  v_add_f32_dpp v39, v39, v39 row_half_mirror row_mask:0xf bank_mask:0xf
  v_mfma_f32_4x4x4_16b_bf16 v[56:59], v[30:31], a[64:65], v[56:59]
  v_add_f32_dpp v60, v45, v60 quad_perm:[1,1,1,1] row_mask:0xf bank_mask:0xf
  v_mfma_f32_4x4x4_16b_bf16 v[52:55], v[32:33], a[54:55], v[52:55]
  v_add_f32_dpp v61, v49, v61 quad_perm:[1,1,1,1] row_mask:0xf bank_mask:0xf
  v_mfma_f32_4x4x4_16b_bf16 v[56:59], v[32:33], a[66:67], v[56:59]
  v_add_f32_dpp v60, v46, v60 quad_perm:[2,2,2,2] row_mask:0xf bank_mask:0xf
  v_mfma_f32_4x4x4_16b_bf16 v[52:55], v[34:35], a[56:57], v[52:55]
  v_add_f32_dpp v61, v50, v61 quad_perm:[2,2,2,2] row_mask:0xf bank_mask:0xf
  v_mfma_f32_4x4x4_16b_bf16 v[56:59], v[34:35], a[68:69], v[56:59]
  v_add_f32_dpp v40, v47, v60 quad_perm:[3,3,3,3] row_mask:0xf bank_mask:0xf
  v_mfma_f32_4x4x4_16b_bf16 v[52:55], v[36:37], a[58:59], v[52:55]
  v_add_f32_dpp v61, v51, v61 quad_perm:[3,3,3,3] row_mask:0xf bank_mask:0xf
  v_mfma_f32_4x4x4_16b_bf16 v[56:59], v[36:37], a[70:71], v[56:59]
  v_mfma_f32_4x4x4_16b_bf16 v[44:47], v[26:27], a[72:73], 0
  v_cndmask_b32 v40, v40, v61, s[84:85]
  v_mfma_f32_4x4x4_16b_bf16 v[48:51], v[26:27], a[84:85], 0
  v_mfma_f32_4x4x4_16b_bf16 v[44:47], v[28:29], a[74:75], v[44:47]
  v_mov_b32_dpp v62, v52 quad_perm:[0,0,0,0] row_mask:0xf bank_mask:0xf
  v_mfma_f32_4x4x4_16b_bf16 v[48:51], v[28:29], a[86:87], v[48:51]
  v_mov_b32_dpp v63, v56 quad_perm:[0,0,0,0] row_mask:0xf bank_mask:0xf
  v_mfma_f32_4x4x4_16b_bf16 v[44:47], v[30:31], a[76:77], v[44:47]
  v_add_f32_dpp v62, v53, v62 quad_perm:[1,1,1,1] row_mask:0xf bank_mask:0xf
  v_mfma_f32_4x4x4_16b_bf16 v[48:51], v[30:31], a[88:89], v[48:51]
  v_add_f32_dpp v63, v57, v63 quad_perm:[1,1,1,1] row_mask:0xf bank_mask:0xf
  v_mfma_f32_4x4x4_16b_bf16 v[44:47], v[32:33], a[78:79], v[44:47]
  v_add_f32_dpp v62, v54, v62 quad_perm:[2,2,2,2] row_mask:0xf bank_mask:0xf
  v_mfma_f32_4x4x4_16b_bf16 v[48:51], v[32:33], a[90:91], v[48:51]
  v_add_f32_dpp v63, v58, v63 quad_perm:[2,2,2,2] row_mask:0xf bank_mask:0xf
  v_mfma_f32_4x4x4_16b_bf16 v[44:47], v[34:35], a[80:81], v[44:47]
  v_add_f32_dpp v62, v55, v62 quad_perm:[3,3,3,3] row_mask:0xf bank_mask:0xf
  v_mfma_f32_4x4x4_16b_bf16 v[48:51], v[34:35], a[92:93], v[48:51]
  v_add_f32_dpp v63, v59, v63 quad_perm:[3,3,3,3] row_mask:0xf bank_mask:0xf
  v_mfma_f32_4x4x4_16b_bf16 v[44:47], v[36:37], a[82:83], v[44:47]
  v_mfma_f32_4x4x4_16b_bf16 v[48:51], v[36:37], a[94:95], v[48:51]
  v_mfma_f32_4x4x4_16b_bf16 v[52:55], v[26:27], a[96:97], 0
  v_cndmask_b32 v40, v40, v62, s[86:87]
  v_mfma_f32_4x4x4_16b_bf16 v[56:59], v[26:27], a[168:169], 0
  v_cndmask_b32 v40, v40, v63, s[88:89]
  v_mfma_f32_4x4x4_16b_bf16 v[52:55], v[28:29], a[98:99], v[52:55]
  v_mov_b32_dpp v60, v44 quad_perm:[0,0,0,0] row_mask:0xf bank_mask:0xf
  v_mfma_f32_4x4x4_16b_bf16 v[56:59], v[28:29], a[170:171], v[56:59]
  v_mov_b32_dpp v61, v48 quad_perm:[0,0,0,0] row_mask:0xf bank_mask:0xf
  v_mfma_f32_4x4x4_16b_bf16 v[52:55], v[30:31], a[100:101], v[52:55]
  v_add_f32_dpp v40, v40, v40 row_half_mirror row_mask:0xf bank_mask:0xf
  v_mfma_f32_4x4x4_16b_bf16 v[56:59], v[30:31], a[172:173], v[56:59]
  v_add_f32_dpp v60, v45, v60 quad_perm:[1,1,1,1] row_mask:0xf bank_mask:0xf
  v_mfma_f32_4x4x4_16b_bf16 v[52:55], v[32:33], a[102:103], v[52:55]
  v_add_f32_dpp v61, v49, v61 quad_perm:[1,1,1,1] row_mask:0xf bank_mask:0xf
  v_mfma_f32_4x4x4_16b_bf16 v[56:59], v[32:33], a[174:175], v[56:59]
  v_add_f32_dpp v60, v46, v60 quad_perm:[2,2,2,2] row_mask:0xf bank_mask:0xf
  v_mfma_f32_4x4x4_16b_bf16 v[52:55], v[34:35], a[104:105], v[52:55]
  v_add_f32_dpp v61, v50, v61 quad_perm:[2,2,2,2] row_mask:0xf bank_mask:0xf
  v_mfma_f32_4x4x4_16b_bf16 v[56:59], v[34:35], a[176:177], v[56:59]
  v_add_f32_dpp v41, v47, v60 quad_perm:[3,3,3,3] row_mask:0xf bank_mask:0xf
  v_mfma_f32_4x4x4_16b_bf16 v[52:55], v[36:37], a[106:107], v[52:55]
  v_add_f32_dpp v61, v51, v61 quad_perm:[3,3,3,3] row_mask:0xf bank_mask:0xf
  v_mfma_f32_4x4x4_16b_bf16 v[56:59], v[36:37], a[178:179], v[56:59]
  v_cndmask_b32 v41, v41, v61, s[84:85]
  s_nop 0
  s_nop 0
  v_mov_b32_dpp v62, v52 quad_perm:[0,0,0,0] row_mask:0xf bank_mask:0xf
  v_nop_e64
  v_mov_b32_dpp v63, v56 quad_perm:[0,0,0,0] row_mask:0xf bank_mask:0xf
  v_add_f32_dpp v62, v53, v62 quad_perm:[1,1,1,1] row_mask:0xf bank_mask:0xf
  v_nop_e64
  v_add_f32_dpp v63, v57, v63 quad_perm:[1,1,1,1] row_mask:0xf bank_mask:0xf
  v_add_f32_dpp v62, v54, v62 quad_perm:[2,2,2,2] row_mask:0xf bank_mask:0xf
  v_nop_e64
  v_add_f32_dpp v63, v58, v63 quad_perm:[2,2,2,2] row_mask:0xf bank_mask:0xf
  v_add_f32_dpp v62, v55, v62 quad_perm:[3,3,3,3] row_mask:0xf bank_mask:0xf
  v_nop_e64
  v_add_f32_dpp v63, v59, v63 quad_perm:[3,3,3,3] row_mask:0xf bank_mask:0xf
  v_cndmask_b32 v41, v41, v62, s[86:87]
  v_cndmask_b32 v41, v41, v63, s[88:89]
  s_nop 0
  s_nop 0
  v_add_f32_dpp v41, v41, v41 row_half_mirror row_mask:0xf bank_mask:0xf
  ds_read_b128 a[156:159], v6 offset:0
  ds_read_b128 a[160:163], v6 offset:4096
  ds_read_b128 a[164:167], v6 offset:8192
  ds_read_b128 v[124:127], v6 offset:12288
  ds_read_b128 v[128:131], v6 offset:16384
  ds_read_b128 v[132:135], v6 offset:20480
  ds_read_b128 v[136:139], v6 offset:24576
  ds_read_b128 v[140:143], v6 offset:28672
  v_max3_f32 v66, v38, v39, v40
  v_max_f32 v66, v66, v41
  s_nop 1
  v_max_f32_dpp v66, v66, v66 quad_perm:[1,0,3,2] row_mask:0xf bank_mask:0xf
  s_nop 1
  v_max_f32_dpp v66, v66, v66 quad_perm:[2,3,0,1] row_mask:0xf bank_mask:0xf
  s_nop 1
  v_max_f32_dpp v66, v66, v66 row_ror:8 row_mask:0xf bank_mask:0xf
  s_nop 1
  v_max_f32_dpp v66, v66, v66 row_bcast:15 row_mask:0xa bank_mask:0xf
  s_nop 1
  v_max_f32_dpp v66, v66, v66 row_bcast:31 row_mask:0xc bank_mask:0xf
  s_nop 0
  v_readlane_b32 s95, v66, 63
  v_mov_b32 v67, s21
  s_nop 0
  v_subrev_f32 v38, s95, v38
  v_subrev_f32 v39, s95, v39
  v_subrev_f32 v40, s95, v40
  v_subrev_f32 v41, s95, v41
  v_mov_b32 v66, s95
  v_mul_f32 v38, 0x3dd53b95, v38
  v_mul_f32 v39, 0x3dd53b95, v39
  v_mul_f32 v40, 0x3dd53b95, v40
  v_mul_f32 v41, 0x3dd53b95, v41
  ds_write_b32 v67, v66 offset:112
  v_exp_f32 v38, v38
  v_exp_f32 v39, v39
  v_exp_f32 v40, v40
  v_exp_f32 v41, v41
  v_add_f32 v66, v38, v39
  v_add_f32 v68, v40, v41
  v_add_f32 v68, v68, v66
  v_cvt_pk_bf16_f32 v38, v38, v38
  v_cvt_pk_bf16_f32 v39, v39, v39
  v_cvt_pk_bf16_f32 v40, v40, v40
  v_cvt_pk_bf16_f32 v41, v41, v41
  s_waitcnt lgkmcnt(0)
.balignl 8, 0xBF800000
  v_and_b32_dpp v46, v38, v2 quad_perm:[0,0,0,0] row_mask:0xf bank_mask:0xf
  v_and_b32_dpp v47, v38, v3 quad_perm:[0,0,0,0] row_mask:0xf bank_mask:0xf
  v_and_b32_dpp v48, v38, v4 quad_perm:[3,3,3,3] row_mask:0xf bank_mask:0xf
  v_and_b32_dpp v49, v38, v5 quad_perm:[3,3,3,3] row_mask:0xf bank_mask:0xf
  s_nop 0
  s_nop 0
  v_mfma_f32_16x16x32_bf16 v[26:29], v[46:49], a[180:183], 0
  v_and_b32_dpp v50, v38, v2 quad_perm:[1,1,1,1] row_mask:0xf bank_mask:0xf
  v_and_b32_dpp v51, v38, v3 quad_perm:[1,1,1,1] row_mask:0xf bank_mask:0xf
  v_mfma_f32_16x16x32_bf16 v[30:33], v[46:49], a[184:187], 0
  v_and_b32_dpp v52, v38, v4 quad_perm:[2,2,2,2] row_mask:0xf bank_mask:0xf
  v_and_b32_dpp v53, v38, v5 quad_perm:[2,2,2,2] row_mask:0xf bank_mask:0xf
  v_mfma_f32_16x16x32_bf16 v[34:37], v[46:49], a[188:191], 0
  v_add_f32_dpp v68, v68, v68 quad_perm:[1,0,3,2] row_mask:0xf bank_mask:0xf
  v_mfma_f32_16x16x32_bf16 v[26:29], v[50:53], a[192:195], v[26:29]
  v_and_b32_dpp v46, v38, v2 quad_perm:[2,2,2,2] row_mask:0xf bank_mask:0xf
  v_and_b32_dpp v47, v38, v3 quad_perm:[2,2,2,2] row_mask:0xf bank_mask:0xf
  v_mfma_f32_16x16x32_bf16 v[30:33], v[50:53], a[196:199], v[30:33]
  v_and_b32_dpp v48, v38, v4 quad_perm:[1,1,1,1] row_mask:0xf bank_mask:0xf
  v_and_b32_dpp v49, v38, v5 quad_perm:[1,1,1,1] row_mask:0xf bank_mask:0xf
  v_mfma_f32_16x16x32_bf16 v[34:37], v[50:53], a[200:203], v[34:37]
  v_add_f32_dpp v68, v68, v68 quad_perm:[2,3,0,1] row_mask:0xf bank_mask:0xf
  v_mfma_f32_16x16x32_bf16 v[26:29], v[46:49], a[204:207], v[26:29]
  v_and_b32_dpp v50, v38, v2 quad_perm:[3,3,3,3] row_mask:0xf bank_mask:0xf
  v_and_b32_dpp v51, v38, v3 quad_perm:[3,3,3,3] row_mask:0xf bank_mask:0xf
  v_mfma_f32_16x16x32_bf16 v[30:33], v[46:49], a[208:211], v[30:33]
  v_and_b32_dpp v52, v38, v4 quad_perm:[0,0,0,0] row_mask:0xf bank_mask:0xf
  v_and_b32_dpp v53, v38, v5 quad_perm:[0,0,0,0] row_mask:0xf bank_mask:0xf
  v_mfma_f32_16x16x32_bf16 v[34:37], v[46:49], a[212:215], v[34:37]
  v_add_f32_dpp v68, v68, v68 row_ror:8 row_mask:0xf bank_mask:0xf
  v_mfma_f32_16x16x32_bf16 v[26:29], v[50:53], a[216:219], v[26:29]
  v_and_b32_dpp v46, v39, v2 quad_perm:[0,0,0,0] row_mask:0xf bank_mask:0xf
  v_and_b32_dpp v47, v39, v3 quad_perm:[0,0,0,0] row_mask:0xf bank_mask:0xf
  v_mfma_f32_16x16x32_bf16 v[30:33], v[50:53], a[220:223], v[30:33]
  v_and_b32_dpp v48, v39, v4 quad_perm:[3,3,3,3] row_mask:0xf bank_mask:0xf
  v_and_b32_dpp v49, v39, v5 quad_perm:[3,3,3,3] row_mask:0xf bank_mask:0xf
  v_mfma_f32_16x16x32_bf16 v[34:37], v[50:53], a[224:227], v[34:37]
  v_add_f32_dpp v68, v68, v68 row_bcast:15 row_mask:0xa bank_mask:0xf
  v_mfma_f32_16x16x32_bf16 v[26:29], v[46:49], a[228:231], v[26:29]
  v_and_b32_dpp v50, v39, v2 quad_perm:[1,1,1,1] row_mask:0xf bank_mask:0xf
  v_and_b32_dpp v51, v39, v3 quad_perm:[1,1,1,1] row_mask:0xf bank_mask:0xf
  v_mfma_f32_16x16x32_bf16 v[30:33], v[46:49], a[232:235], v[30:33]
  v_and_b32_dpp v52, v39, v4 quad_perm:[2,2,2,2] row_mask:0xf bank_mask:0xf
  v_and_b32_dpp v53, v39, v5 quad_perm:[2,2,2,2] row_mask:0xf bank_mask:0xf
  v_mfma_f32_16x16x32_bf16 v[34:37], v[46:49], a[236:239], v[34:37]
  v_add_f32_dpp v68, v68, v68 row_bcast:31 row_mask:0xc bank_mask:0xf
  v_mfma_f32_16x16x32_bf16 v[26:29], v[50:53], a[240:243], v[26:29]
  v_and_b32_dpp v46, v39, v2 quad_perm:[2,2,2,2] row_mask:0xf bank_mask:0xf
  v_and_b32_dpp v47, v39, v3 quad_perm:[2,2,2,2] row_mask:0xf bank_mask:0xf
  v_mfma_f32_16x16x32_bf16 v[30:33], v[50:53], a[244:247], v[30:33]
  v_and_b32_dpp v48, v39, v4 quad_perm:[1,1,1,1] row_mask:0xf bank_mask:0xf
  v_and_b32_dpp v49, v39, v5 quad_perm:[1,1,1,1] row_mask:0xf bank_mask:0xf
  v_mfma_f32_16x16x32_bf16 v[34:37], v[50:53], a[248:251], v[34:37]
  v_readlane_b32 s96, v68, 63
  v_mfma_f32_16x16x32_bf16 v[26:29], v[46:49], v[172:175], v[26:29]
  v_and_b32_dpp v50, v39, v2 quad_perm:[3,3,3,3] row_mask:0xf bank_mask:0xf
  v_and_b32_dpp v51, v39, v3 quad_perm:[3,3,3,3] row_mask:0xf bank_mask:0xf
  v_mfma_f32_16x16x32_bf16 v[30:33], v[46:49], v[176:179], v[30:33]
  v_and_b32_dpp v52, v39, v4 quad_perm:[0,0,0,0] row_mask:0xf bank_mask:0xf
  v_and_b32_dpp v53, v39, v5 quad_perm:[0,0,0,0] row_mask:0xf bank_mask:0xf
  v_mfma_f32_16x16x32_bf16 v[34:37], v[46:49], v[180:183], v[34:37]
  v_nop_e64
  v_mfma_f32_16x16x32_bf16 v[26:29], v[50:53], v[184:187], v[26:29]
  v_and_b32_dpp v46, v40, v2 quad_perm:[0,0,0,0] row_mask:0xf bank_mask:0xf
  v_and_b32_dpp v47, v40, v3 quad_perm:[0,0,0,0] row_mask:0xf bank_mask:0xf
  v_mfma_f32_16x16x32_bf16 v[30:33], v[50:53], v[188:191], v[30:33]
  v_and_b32_dpp v48, v40, v4 quad_perm:[3,3,3,3] row_mask:0xf bank_mask:0xf
  v_and_b32_dpp v49, v40, v5 quad_perm:[3,3,3,3] row_mask:0xf bank_mask:0xf
  v_mfma_f32_16x16x32_bf16 v[34:37], v[50:53], v[192:195], v[34:37]
  v_nop_e64
  v_mfma_f32_16x16x32_bf16 v[26:29], v[46:49], v[196:199], v[26:29]
  v_and_b32_dpp v50, v40, v2 quad_perm:[1,1,1,1] row_mask:0xf bank_mask:0xf
  v_and_b32_dpp v51, v40, v3 quad_perm:[1,1,1,1] row_mask:0xf bank_mask:0xf
  v_mfma_f32_16x16x32_bf16 v[30:33], v[46:49], v[200:203], v[30:33]
  v_and_b32_dpp v52, v40, v4 quad_perm:[2,2,2,2] row_mask:0xf bank_mask:0xf
  v_and_b32_dpp v53, v40, v5 quad_perm:[2,2,2,2] row_mask:0xf bank_mask:0xf
  v_mfma_f32_16x16x32_bf16 v[34:37], v[46:49], v[204:207], v[34:37]
  v_nop_e64
  v_mfma_f32_16x16x32_bf16 v[26:29], v[50:53], v[208:211], v[26:29]
  v_and_b32_dpp v46, v40, v2 quad_perm:[2,2,2,2] row_mask:0xf bank_mask:0xf
  v_and_b32_dpp v47, v40, v3 quad_perm:[2,2,2,2] row_mask:0xf bank_mask:0xf
  v_mfma_f32_16x16x32_bf16 v[30:33], v[50:53], v[212:215], v[30:33]
  v_and_b32_dpp v48, v40, v4 quad_perm:[1,1,1,1] row_mask:0xf bank_mask:0xf
  v_and_b32_dpp v49, v40, v5 quad_perm:[1,1,1,1] row_mask:0xf bank_mask:0xf
  v_mfma_f32_16x16x32_bf16 v[34:37], v[50:53], v[216:219], v[34:37]
  v_nop_e64
  v_mfma_f32_16x16x32_bf16 v[26:29], v[46:49], v[220:223], v[26:29]
  v_and_b32_dpp v50, v40, v2 quad_perm:[3,3,3,3] row_mask:0xf bank_mask:0xf
  v_and_b32_dpp v51, v40, v3 quad_perm:[3,3,3,3] row_mask:0xf bank_mask:0xf
  v_mfma_f32_16x16x32_bf16 v[30:33], v[46:49], v[224:227], v[30:33]
  v_and_b32_dpp v52, v40, v4 quad_perm:[0,0,0,0] row_mask:0xf bank_mask:0xf
  v_and_b32_dpp v53, v40, v5 quad_perm:[0,0,0,0] row_mask:0xf bank_mask:0xf
  v_mfma_f32_16x16x32_bf16 v[34:37], v[46:49], v[228:231], v[34:37]
  v_nop_e64
  v_mfma_f32_16x16x32_bf16 v[26:29], v[50:53], v[232:235], v[26:29]
  v_and_b32_dpp v46, v41, v2 quad_perm:[0,0,0,0] row_mask:0xf bank_mask:0xf
  v_and_b32_dpp v47, v41, v3 quad_perm:[0,0,0,0] row_mask:0xf bank_mask:0xf
  v_mfma_f32_16x16x32_bf16 v[30:33], v[50:53], v[236:239], v[30:33]
  v_and_b32_dpp v48, v41, v4 quad_perm:[3,3,3,3] row_mask:0xf bank_mask:0xf
  v_and_b32_dpp v49, v41, v5 quad_perm:[3,3,3,3] row_mask:0xf bank_mask:0xf
  v_mfma_f32_16x16x32_bf16 v[34:37], v[50:53], v[240:243], v[34:37]
  v_nop_e64
  v_mfma_f32_16x16x32_bf16 v[26:29], v[46:49], a[252:255], v[26:29]
  v_and_b32_dpp v50, v41, v2 quad_perm:[1,1,1,1] row_mask:0xf bank_mask:0xf
  v_and_b32_dpp v51, v41, v3 quad_perm:[1,1,1,1] row_mask:0xf bank_mask:0xf
  v_mfma_f32_16x16x32_bf16 v[30:33], v[46:49], a[156:159], v[30:33]
  v_and_b32_dpp v52, v41, v4 quad_perm:[2,2,2,2] row_mask:0xf bank_mask:0xf
  v_and_b32_dpp v53, v41, v5 quad_perm:[2,2,2,2] row_mask:0xf bank_mask:0xf
  v_mfma_f32_16x16x32_bf16 v[34:37], v[46:49], a[160:163], v[34:37]
  v_nop_e64
  v_mfma_f32_16x16x32_bf16 v[26:29], v[50:53], a[164:167], v[26:29]
  v_and_b32_dpp v46, v41, v2 quad_perm:[2,2,2,2] row_mask:0xf bank_mask:0xf
  v_and_b32_dpp v47, v41, v3 quad_perm:[2,2,2,2] row_mask:0xf bank_mask:0xf
  v_mfma_f32_16x16x32_bf16 v[30:33], v[50:53], v[124:127], v[30:33]
  v_and_b32_dpp v48, v41, v4 quad_perm:[1,1,1,1] row_mask:0xf bank_mask:0xf
  v_and_b32_dpp v49, v41, v5 quad_perm:[1,1,1,1] row_mask:0xf bank_mask:0xf
  v_mfma_f32_16x16x32_bf16 v[34:37], v[50:53], v[128:131], v[34:37]
  v_nop_e64
  v_mfma_f32_16x16x32_bf16 v[26:29], v[46:49], v[132:135], v[26:29]
  v_and_b32_dpp v50, v41, v2 quad_perm:[3,3,3,3] row_mask:0xf bank_mask:0xf
  v_and_b32_dpp v51, v41, v3 quad_perm:[3,3,3,3] row_mask:0xf bank_mask:0xf
  v_mfma_f32_16x16x32_bf16 v[30:33], v[46:49], v[136:139], v[30:33]
  v_and_b32_dpp v52, v41, v4 quad_perm:[0,0,0,0] row_mask:0xf bank_mask:0xf
  v_and_b32_dpp v53, v41, v5 quad_perm:[0,0,0,0] row_mask:0xf bank_mask:0xf
  v_mfma_f32_16x16x32_bf16 v[34:37], v[46:49], v[140:143], v[34:37]
  v_nop_e64
  v_mfma_f32_16x16x32_bf16 v[26:29], v[50:53], v[112:115], v[26:29]
  v_mfma_f32_16x16x32_bf16 v[30:33], v[50:53], v[116:119], v[30:33]
  v_mfma_f32_16x16x32_bf16 v[34:37], v[50:53], v[120:123], v[34:37]
  v_lshrrev_b32 v60, 4, v0
  v_and_b32 v59, 15, v0
  v_lshlrev_b32 v58, 10, v60
  v_lshl_add_u32 v58, v59, 4, v58
  s_lshl_b32 s91, s3, 8
  s_add_u32 s91, s91, 155648
  v_add_u32 v58, s91, v58
  v_add_u32 v59, 155648, v6
  v_mov_b32 v49, s96
  v_permlane32_swap_b32 v26, v27
  v_permlane32_swap_b32 v28, v29
  v_permlane32_swap_b32 v30, v31
  v_permlane32_swap_b32 v32, v33
  v_permlane32_swap_b32 v34, v35
  v_permlane32_swap_b32 v36, v37
  v_add_f32_dpp v46, v27, v26 row_ror:8 row_mask:0xf bank_mask:0x3
  v_add_f32_dpp v47, v31, v30 row_ror:8 row_mask:0xf bank_mask:0x3
  v_add_f32_dpp v48, v35, v34 row_ror:8 row_mask:0xf bank_mask:0x3
  v_add_f32_dpp v46, v28, v29 row_ror:8 row_mask:0xf bank_mask:0xc
  v_add_f32_dpp v47, v32, v33 row_ror:8 row_mask:0xf bank_mask:0xc
  v_add_f32_dpp v48, v36, v37 row_ror:8 row_mask:0xf bank_mask:0xc
  ds_write_b128 v59, v[46:49]
  v_lshlrev_b32 v60, 2, v60
  v_add_u32 v60, 161488, v60
  v_mov_b32 v62, 161488
  s_waitcnt lgkmcnt(0)
  s_barrier
  ds_read_b128 v[54:57], v62
  ds_read_b32 v62, v60
  ds_read_b128 v[50:53], v58
  s_add_u32 s73, s72, 3
  s_mul_i32 s91, s31, 240
  s_sub_u32 s91, 2048, s91
  v_lshlrev_b32 v59, 4, v0
  v_writelane_b32 v59, s91, 16
  v_mov_b32 v49, s73
  s_add_u32 s76, s78, 524288
  s_waitcnt lgkmcnt(1)
  v_max3_f32 v54, v54, v55, v56
  v_max_f32 v54, v54, v57
  v_sub_f32 v62, v62, v54
  v_mul_f32 v62, 0x3dd53b95, v62
  v_exp_f32 v62, v62
  s_waitcnt lgkmcnt(0)
  v_pk_mul_f32 v[50:51], v[50:51], v[62:63] op_sel_hi:[1,0]
  v_pk_mul_f32 v[52:53], v[52:53], v[62:63] op_sel_hi:[1,0]
  s_nop 0
  v_permlane32_swap_b32 v50, v51
  v_permlane32_swap_b32 v52, v53
  v_add_f32 v50, v50, v51
  v_add_f32 v52, v52, v53
  s_nop 1
  v_permlane16_swap_b32 v50, v52
  v_add_f32 v46, v50, v52
  v_add_f32 v47, v50, v52
  s_nop 1
  v_permlane32_swap_b32 v46, v47
  v_mov_b32 v48, v46
  s_nop 1
  v_permlane16_swap_b32 v46, v48
  s_nop 1
  v_mov_b32_dpp v46, v54 quad_perm:[0,1,2,3] row_mask:0x2 bank_mask:0xf
  s_mov_b64 exec, 0x1ffff
  buffer_store_dwordx4 v[46:49], v59, s[64:67], s76 offen
  s_mov_b64 exec, -1
  s_add_u32 s73, s72, 3
  v_lshrrev_b32 v45, 4, v0
  v_and_b32 v44, 1, v0
  v_lshl_add_u32 v45, v44, 2, v45
  s_add_u32 s91, s27, 2048
  v_lshl_add_u32 v45, v45, 4, s91
  s_add_u32 s97, s79, 524288
  buffer_load_dwordx4 v[34:37], v45, s[64:67], s97 offen nt
  buffer_load_dwordx4 v[26:29], v6, s[64:67], s97 offen offset:0 nt
  buffer_load_dwordx4 v[30:33], v6, s[64:67], s97 offen offset:1024 nt
  v_lshrrev_b32 v46, 2, v0
  v_and_b32 v47, 3, v0
  v_mul_u32_u24 v46, 160, v46
  v_lshl_add_u32 v47, v47, 3, v46
  s_lshl_b32 s91, s3, 5
  s_add_u32 s91, s91, 124928
  v_add_u32 v46, s91, v47
  v_add_u32 v47, 125056, v47
  v_bfe_u32 v49, v0, 4, 1
  v_lshlrev_b32 v49, 8, v49
  v_lshrrev_b32 v48, 5, v0
  v_lshl_add_u32 v49, v48, 7, v49
  v_and_b32 v48, 7, v0
  v_lshl_add_u32 v49, v48, 4, v49
  v_bfe_u32 v48, v0, 3, 1
  v_lshl_add_u32 v49, v48, 2, v49
  s_and_b32 s91, s3, 1
  s_lshl_b32 s91, s91, 3
  s_and_b32 s92, s3, 2
  s_add_u32 s91, s91, s92
  s_add_u32 s91, s91, 159744
  v_add_u32 v49, s91, v49
  v_and_b32 v74, 0x30, v0
  s_lshl_b32 s91, s3, 4
  s_add_u32 s91, s91, 1
  v_writelane_b32 v74, 64, s91
  s_movk_i32 s91, 80
  v_writelane_b32 v74, s91, 2
  s_movk_i32 s91, 96
  v_writelane_b32 v74, s91, 3
  s_movk_i32 s91, 112
  v_writelane_b32 v74, s91, 4
  s_bfe_u32 s68, s73, 0x80000
  s_bfe_u32 s69, s73, 0x80008
  s_bfe_u32 s70, s73, 0x80010
  s_bfe_u32 s90, s73, 0x80018
  ds_read_b64_tr_b16 v[50:51], v46 offset:0
  ds_read_b64_tr_b16 v[52:53], v46 offset:2560
  ds_read_b64_tr_b16 v[54:55], v47 offset:0
  ds_read_b64_tr_b16 v[56:57], v47 offset:2560
  ds_read_b64_tr_b16 v[58:59], v46 offset:5120
  ds_read_b64_tr_b16 v[60:61], v46 offset:7680
  ds_read_b64_tr_b16 v[62:63], v47 offset:5120
  ds_read_b64_tr_b16 v[64:65], v47 offset:7680
  ds_read_b64_tr_b16 v[66:67], v46 offset:10240
  ds_read_b64_tr_b16 v[68:69], v46 offset:12800
  ds_read_b64_tr_b16 v[70:71], v47 offset:10240
  ds_read_b64_tr_b16 v[72:73], v47 offset:12800
  s_waitcnt vmcnt(0)
L_chk_275:
  v_bitop3_b32 v75, v37, v29, s73 bitop3:0x7e
  v_bitop3_b32 v75, v75, v33, s73 bitop3:0xf6
  v_cmp_ne_u32 vcc, 0, v75
  s_nop 0
  s_cbranch_vccz L_retry_276
  buffer_load_dwordx4 v[34:37], v45, s[64:67], s97 offen nt
  buffer_load_dwordx4 v[26:29], v6, s[64:67], s97 offen offset:0 nt
  buffer_load_dwordx4 v[30:33], v6, s[64:67], s97 offen offset:1024 nt
  s_sub_u32 s75, s75, 1
  s_cbranch_scc1 L_end
  s_waitcnt vmcnt(0)
  s_branch L_chk_275
L_retry_276:
  v_max_f32_dpp v43, v34, v34 quad_perm:[1,0,3,2] row_mask:0xf bank_mask:0xf
  v_mov_b32 v42, v43
  s_nop 1
  v_permlane32_swap_b32 v43, v42
  v_max_f32 v43, v43, v42
  v_mov_b32 v42, v43
  s_nop 1
  v_permlane16_swap_b32 v43, v42
  v_max_f32 v43, v43, v42
  v_sub_f32 v43, v34, v43
  v_mul_f32 v43, 0x3dd53b95, v43
  v_exp_f32 v43, v43
  s_nop 0
  v_mul_f32 v35, v35, v43
  v_mul_f32_dpp v26, v43, v26 quad_perm:[0,0,2,2] row_mask:0xf bank_mask:0xf
  v_mul_f32_dpp v27, v43, v27 quad_perm:[0,0,2,2] row_mask:0xf bank_mask:0xf
  v_mul_f32_dpp v28, v43, v28 quad_perm:[0,0,2,2] row_mask:0xf bank_mask:0xf
  v_add_f32_dpp v29, v35, v35 quad_perm:[1,0,3,2] row_mask:0xf bank_mask:0xf
  v_fmac_f32_dpp v26, v43, v30 quad_perm:[1,1,3,3] row_mask:0xf bank_mask:0xf
  v_fmac_f32_dpp v27, v43, v31 quad_perm:[1,1,3,3] row_mask:0xf bank_mask:0xf
  v_fmac_f32_dpp v28, v43, v32 quad_perm:[1,1,3,3] row_mask:0xf bank_mask:0xf
  s_nop 0
  v_permlane32_swap_b32 v26, v27
  v_permlane32_swap_b32 v28, v29
  v_add_f32 v26, v26, v27
  v_add_f32 v28, v28, v29
  s_nop 1
  v_permlane16_swap_b32 v26, v28
  v_add_f32 v48, v26, v28
  v_lshrrev_b32 v45, 4, v0
  v_readlane_b32 s92, v48, 48
  v_lshlrev_b32 v45, 3, v45
  v_add_u32 v44, 159744, v45
  v_rcp_f32 v43, s92
  s_mov_b32 exec_hi, 0xffff
  v_mul_f32 v48, v48, v43
  v_cvt_pk_bf16_f32 v48, v48, v48
  ds_write_b16 v49, v48
  s_mov_b64 exec, -1
  s_waitcnt lgkmcnt(0)
  s_barrier
  ds_read2_b64 v[26:29], v44 offset0:0 offset1:4
  ds_read2_b64 v[30:33], v44 offset0:8 offset1:12
  ds_read2_b64 v[34:37], v44 offset0:16 offset1:20
  v_mov_b32 v48, v44
  s_add_u32 s76, s82, 917504
  s_lshl_b32 s91, s3, 4
  s_lshl_b64 vcc, 2, s91
  s_or_b32 s91, vcc_lo, 0x1001d
  s_or_b32 s92, vcc_hi, 0x10001
  v_mov_b32 v49, 0xffffff00
  s_waitcnt lgkmcnt(2)
  v_mfma_f32_16x16x32_bf16 v[38:41], v[50:53], v[26:29], 0
  v_mfma_f32_16x16x32_bf16 v[42:45], v[54:57], v[26:29], 0
  ds_read2_b64 v[26:29], v48 offset0:24 offset1:28
  ds_read_b64_tr_b16 v[50:51], v46 offset:15360
  ds_read_b64_tr_b16 v[52:53], v46 offset:17920
  ds_read_b64_tr_b16 v[54:55], v47 offset:15360
  ds_read_b64_tr_b16 v[56:57], v47 offset:17920
  s_waitcnt lgkmcnt(6)
  v_mfma_f32_16x16x32_bf16 v[38:41], v[58:61], v[30:33], v[38:41]
  v_mfma_f32_16x16x32_bf16 v[42:45], v[62:65], v[30:33], v[42:45]
  ds_read2_b64 v[30:33], v48 offset0:32 offset1:36
  ds_read_b64_tr_b16 v[58:59], v46 offset:20480
  ds_read_b64_tr_b16 v[60:61], v46 offset:23040
  ds_read_b64_tr_b16 v[62:63], v47 offset:20480
  ds_read_b64_tr_b16 v[64:65], v47 offset:23040
  s_waitcnt lgkmcnt(10)
  v_mfma_f32_16x16x32_bf16 v[38:41], v[66:69], v[34:37], v[38:41]
  v_mfma_f32_16x16x32_bf16 v[42:45], v[70:73], v[34:37], v[42:45]
  ds_read2_b64 v[34:37], v48 offset0:40 offset1:44
  ds_read_b64_tr_b16 v[66:67], v46 offset:25600
  ds_read_b64_tr_b16 v[68:69], v46 offset:28160
  ds_read_b64_tr_b16 v[70:71], v47 offset:25600
  ds_read_b64_tr_b16 v[72:73], v47 offset:28160
  s_waitcnt lgkmcnt(10)
  v_mfma_f32_16x16x32_bf16 v[38:41], v[50:53], v[26:29], v[38:41]
  v_mfma_f32_16x16x32_bf16 v[42:45], v[54:57], v[26:29], v[42:45]
  s_waitcnt lgkmcnt(5)
  v_mfma_f32_16x16x32_bf16 v[38:41], v[58:61], v[30:33], v[38:41]
  v_mfma_f32_16x16x32_bf16 v[42:45], v[62:65], v[30:33], v[42:45]
  s_waitcnt lgkmcnt(0)
  v_mfma_f32_16x16x32_bf16 v[38:41], v[66:69], v[34:37], v[38:41]
  v_mfma_f32_16x16x32_bf16 v[42:45], v[70:73], v[34:37], v[42:45]
  s_nop 7
  v_cndmask_b32 v26, v38, v42, vcc
  v_cndmask_b32 v27, v39, v43, vcc
  v_cndmask_b32 v28, v40, v44, vcc
  v_cndmask_b32 v29, v41, v45, vcc
  s_mov_b32 exec_lo, s91
  s_mov_b32 exec_hi, s92
  v_and_or_b32 v26, v26, v49, s68
  v_and_or_b32 v27, v27, v49, s69
  v_and_or_b32 v28, v28, v49, s70
  v_and_or_b32 v29, v29, v49, s90
  buffer_store_dwordx4 v[26:29], v74, s[64:67], s76 offen sc1
  s_mov_b64 exec, -1
  s_waitcnt vmcnt(0)
  s_cmp_ge_u32 s30, 2
  s_cbranch_scc1 L_done
  s_cmp_eq_u32 s30, 0
  s_cselect_b64 vcc, -1, 0
  v_cndmask_b32 v74, v7, v25, vcc
  s_cselect_b32 s101, 917504, 0
  s_max_u32 s101, s101, 786432
  s_add_u32 s73, s72, 3
  v_lshrrev_b32 v58, 3, v0
  v_and_b32 v75, 7, v0
  v_mul_u32_u24 v58, 128, v58
  v_lshl_add_u32 v58, v75, 4, v58
  s_add_u32 s97, s83, s101
  s_mov_b32 exec_lo, 0x1f1f1f1f
  s_mov_b32 exec_hi, 0x1f1f1f1f
  buffer_load_dwordx4 v[26:29], v58, s[64:67], s97 offen offset:0 sc1
  buffer_load_dwordx4 v[30:33], v58, s[64:67], s97 offen offset:1024 sc1
  buffer_load_dwordx4 v[34:37], v58, s[64:67], s97 offen offset:2048 sc1
  buffer_load_dwordx4 v[38:41], v58, s[64:67], s97 offen offset:3072 sc1
  s_mov_b64 exec, -1
  s_bfe_u32 s68, s73, 0x80000
  s_bfe_u32 s69, s73, 0x80008
  s_bfe_u32 s70, s73, 0x80010
  s_bfe_u32 s90, s73, 0x80018
  s_xor_b32 s91, s30, 1
  s_mul_i32 s91, s91, 1280
  s_mul_i32 s92, s31, 160
  s_add_u32 s101, s91, s92
  s_mov_b32 s48, s24
  s_mov_b32 s49, s25
  s_mov_b32 s50, 2560
  s_waitcnt vmcnt(0)
  s_mov_b32 exec_lo, 0x1f1f1f1f
  s_mov_b32 exec_hi, 0x1f1f1f1f
L_chk_277:
  v_xor_b32 v26, s68, v26
  v_xor_b32 v30, s68, v30
  v_xor_b32 v34, s68, v34
  v_xor_b32 v38, s68, v38
  v_xor_b32 v27, s69, v27
  v_xor_b32 v31, s69, v31
  v_xor_b32 v35, s69, v35
  v_xor_b32 v39, s69, v39
  v_xor_b32 v28, s70, v28
  v_xor_b32 v32, s70, v32
  v_xor_b32 v36, s70, v36
  v_xor_b32 v40, s70, v40
  v_xor_b32 v29, s90, v29
  v_xor_b32 v33, s90, v33
  v_xor_b32 v37, s90, v37
  v_xor_b32 v41, s90, v41
  v_or3_b32 v75, v26, v30, v34
  v_or3_b32 v75, v75, v38, v27
  v_or3_b32 v75, v75, v31, v35
  v_or3_b32 v75, v75, v39, v28
  v_or3_b32 v75, v75, v32, v36
  v_or3_b32 v75, v75, v40, v29
  v_or3_b32 v75, v75, v33, v37
  v_or3_b32 v75, v75, v41, v41
  v_and_b32 v75, 0xff, v75
  v_cmp_ne_u32 vcc, 0, v75
  s_nop 0
  s_cbranch_vccz L_retry_278
  buffer_load_dwordx4 v[26:29], v58, s[64:67], s97 offen offset:0 sc1
  buffer_load_dwordx4 v[30:33], v58, s[64:67], s97 offen offset:1024 sc1
  buffer_load_dwordx4 v[34:37], v58, s[64:67], s97 offen offset:2048 sc1
  buffer_load_dwordx4 v[38:41], v58, s[64:67], s97 offen offset:3072 sc1
  s_sub_u32 s75, s75, 1
  s_cbranch_scc1 L_end
  s_waitcnt vmcnt(0)
  s_branch L_chk_277
L_retry_278:
  v_pk_add_f32 v[26:27], v[26:27], v[30:31]
  v_pk_add_f32 v[28:29], v[28:29], v[32:33]
  v_pk_add_f32 v[34:35], v[34:35], v[38:39]
  v_pk_add_f32 v[36:37], v[36:37], v[40:41]
  v_pk_add_f32 v[26:27], v[26:27], v[34:35]
  v_pk_add_f32 v[28:29], v[28:29], v[36:37]
  v_add_u32 v33, 160128, v24
  v_add_f32_dpp v30, v26, v26 row_ror:8 row_mask:0xf bank_mask:0x3
  v_add_f32_dpp v31, v28, v28 row_ror:8 row_mask:0xf bank_mask:0x3
  s_nop 0
  v_add_f32_dpp v30, v27, v27 row_ror:8 row_mask:0xf bank_mask:0xc
  v_add_f32_dpp v31, v29, v29 row_ror:8 row_mask:0xf bank_mask:0xc
  s_nop 1
  v_permlane32_swap_b32 v30, v31
  v_add_f32 v30, v30, v31
  v_mov_b32 v31, v30
  s_nop 1
  v_permlane16_swap_b32 v30, v31
  v_add_f32 v30, v30, v31
  v_cvt_pk_bf16_f32 v30, v30, v30
  v_and_b32 v30, 0xffff0000, v30
  v_add_f32 v30, v30, v74
  v_cvt_pk_bf16_f32 v31, v30, v30
  s_mov_b32 exec_lo, 0x1f1f
  s_mov_b32 exec_hi, 0x1f1f
  buffer_store_short v31, v24, s[48:51], s101 offen
  s_or_b32 s91, s2, s3
  s_cmp_lg_u32 s91, 0
  s_cbranch_scc1 L_done
  s_mov_b32 exec_lo, -1
  s_mov_b32 exec_hi, 0
  v_mov_b32 v27, s72
  v_lshlrev_b32 v28, 2, v0
  buffer_store_dword v27, v28, s[64:67], 0 offen
L_done:
  s_mov_b64 exec, -1
  s_endpgm
L_tg_4:
  s_mov_b32 s77, 1
  s_branch L_tb_5
L_wz_6:
  s_waitcnt vmcnt(5)
  s_branch L_wb_7
L_wz_8:
  s_waitcnt vmcnt(0)
  s_branch L_wb_9
L_tg_10:
  s_mov_b32 s77, 1
  s_branch L_tb_11
L_tg_12:
  s_mov_b32 s77, 1
  s_branch L_tb_13
L_wz_14:
  s_waitcnt vmcnt(0)
  s_branch L_wb_15
L_tg_20:
  s_mov_b32 s77, 1
  s_branch L_tb_21
L_tg_22:
  s_mov_b32 s77, 1
  s_branch L_tb_23
L_retry_17:
s_sub_u32 s75, s75, 1
s_cbranch_scc1 L_end
buffer_load_dwordx2 v[30:31], v32, s[64:67], s97 offen sc1
s_mov_b64 exec, -1
s_mov_b32 s77, 0
s_cmp_lt_u32 s16, s17
s_cbranch_scc0 L_tg_20
s_waitcnt vmcnt(10)
s_swappc_b64 s[28:29], s[0:1]
L_tb_21:
s_cmp_lt_u32 s16, s17
s_cbranch_scc0 L_tg_22
s_waitcnt vmcnt(10)
s_swappc_b64 s[28:29], s[0:1]
L_tb_23:
s_cmp_lg_u32 s77, 0
s_cbranch_scc1 L_rz_18
s_waitcnt vmcnt(6)
s_branch L_chk_16
L_rz_18:
s_waitcnt vmcnt(0)
s_branch L_chk_16
L_tg_24:
  s_mov_b32 s77, 1
  s_branch L_tb_25
L_tg_26:
  s_mov_b32 s77, 1
  s_branch L_tb_27
L_tg_28:
  s_mov_b32 s77, 1
  s_branch L_tb_29
L_tg_30:
  s_mov_b32 s77, 1
  s_branch L_tb_31
L_tg_32:
  s_mov_b32 s77, 1
  s_branch L_tb_33
L_wz_34:
  s_waitcnt vmcnt(0)
  s_branch L_wb_35
L_tg_40:
  s_mov_b32 s77, 1
  s_branch L_tb_41
L_tg_42:
  s_mov_b32 s77, 1
  s_branch L_tb_43
L_retry_37:
s_sub_u32 s75, s75, 1
s_cbranch_scc1 L_end
buffer_load_dwordx4 v[34:37], v59, s[64:67], s97 offen nt
buffer_load_dwordx4 v[26:29], v6, s[64:67], s97 offen offset:0 nt
buffer_load_dwordx4 v[30:33], v6, s[64:67], s97 offen offset:1024 nt
buffer_load_dwordx4 v[38:41], v6, s[64:67], s100 offen offset:0 nt
buffer_load_dwordx4 v[42:45], v6, s[64:67], s100 offen offset:1024 nt
s_mov_b64 exec, -1
s_mov_b32 s77, 0
s_cmp_lt_u32 s16, s17
s_cbranch_scc0 L_tg_40
s_waitcnt vmcnt(14)
s_swappc_b64 s[28:29], s[0:1]
L_tb_41:
s_cmp_lt_u32 s16, s17
s_cbranch_scc0 L_tg_42
s_waitcnt vmcnt(14)
s_swappc_b64 s[28:29], s[0:1]
L_tb_43:
s_cmp_lg_u32 s77, 0
s_cbranch_scc1 L_rz_38
s_waitcnt vmcnt(6)
s_branch L_chk_36
L_rz_38:
s_waitcnt vmcnt(0)
s_branch L_chk_36
L_nd_46:
  s_waitcnt vmcnt(0)
  s_cmp_ge_u32 s16, 24
  s_cbranch_scc1 L_nq_47
  s_branch L_end
L_tg_48:
  s_mov_b32 s77, 1
  s_branch L_tb_49
L_tg_50:
  s_mov_b32 s77, 1
  s_branch L_tb_51
L_tg_53:
  s_mov_b32 s77, 1
  s_branch L_tb_54
L_tg_55:
  s_mov_b32 s77, 1
  s_branch L_tb_56
L_tg_57:
  s_mov_b32 s77, 1
  s_branch L_tb_58
L_wz_59:
  s_waitcnt vmcnt(0)
  s_branch L_wb_60
L_tg_65:
  s_mov_b32 s77, 1
  s_branch L_tb_66
L_tg_67:
  s_mov_b32 s77, 1
  s_branch L_tb_68
L_retry_62:
s_sub_u32 s75, s75, 1
s_cbranch_scc1 L_end
buffer_load_dwordx4 v[34:37], v45, s[64:67], s97 offen nt
buffer_load_dwordx4 v[26:29], v6, s[64:67], s97 offen offset:0 nt
buffer_load_dwordx4 v[30:33], v6, s[64:67], s97 offen offset:1024 nt
s_mov_b64 exec, -1
s_mov_b32 s77, 0
s_cmp_lt_u32 s16, s17
s_cbranch_scc0 L_tg_65
s_waitcnt vmcnt(12)
s_swappc_b64 s[28:29], s[0:1]
L_tb_66:
s_cmp_lt_u32 s16, s17
s_cbranch_scc0 L_tg_67
s_waitcnt vmcnt(12)
s_swappc_b64 s[28:29], s[0:1]
L_tb_68:
s_cmp_lg_u32 s77, 0
s_cbranch_scc1 L_rz_63
s_waitcnt vmcnt(6)
s_branch L_chk_61
L_rz_63:
s_waitcnt vmcnt(0)
s_branch L_chk_61
L_tg_69:
  s_mov_b32 s77, 1
  s_branch L_tb_70
L_tg_71:
  s_mov_b32 s77, 1
  s_branch L_tb_72
L_tg_73:
  s_mov_b32 s77, 1
  s_branch L_tb_74
L_tg_75:
  s_mov_b32 s77, 1
  s_branch L_tb_76
L_tg_77:
  s_mov_b32 s77, 1
  s_branch L_tb_78
L_tg_79:
  s_mov_b32 s77, 1
  s_branch L_tb_80
L_tg_81:
  s_mov_b32 s77, 1
  s_branch L_tb_82
L_tg_83:
  s_mov_b32 s77, 1
  s_branch L_tb_84
L_tg_85:
  s_mov_b32 s77, 1
  s_branch L_tb_86
L_tg_87:
  s_mov_b32 s77, 1
  s_branch L_tb_88
L_wz_89:
  s_waitcnt vmcnt(0)
  s_branch L_wb_90
L_tg_95:
  s_mov_b32 s77, 1
  s_branch L_tb_96
L_tg_97:
  s_mov_b32 s77, 1
  s_branch L_tb_98
L_retry_92:
s_sub_u32 s75, s75, 1
s_cbranch_scc1 L_end
buffer_load_dwordx4 v[26:29], v74, s[64:67], s97 offen offset:0 sc1
buffer_load_dwordx4 v[30:33], v74, s[64:67], s97 offen offset:1024 sc1
buffer_load_dwordx4 v[34:37], v74, s[64:67], s97 offen offset:2048 sc1
buffer_load_dwordx4 v[38:41], v74, s[64:67], s97 offen offset:3072 sc1
s_mov_b64 exec, -1
s_mov_b32 s77, 0
s_cmp_lt_u32 s16, s17
s_cbranch_scc0 L_tg_95
s_waitcnt vmcnt(13)
s_swappc_b64 s[28:29], s[0:1]
L_tb_96:
s_cmp_lt_u32 s16, s17
s_cbranch_scc0 L_tg_97
s_waitcnt vmcnt(13)
s_swappc_b64 s[28:29], s[0:1]
L_tb_98:
  s_mov_b32 exec_lo, 0x1f1f1f1f
  s_mov_b32 exec_hi, 0x1f1f1f1f
s_cmp_lg_u32 s77, 0
s_cbranch_scc1 L_rz_93
s_waitcnt vmcnt(6)
s_branch L_chk_91
L_rz_93:
s_waitcnt vmcnt(0)
s_branch L_chk_91
L_tg_99:
  s_mov_b32 s77, 1
  s_branch L_tb_100
L_tg_101:
  s_mov_b32 s77, 1
  s_branch L_tb_102
L_tg_103:
  s_mov_b32 s77, 1
  s_branch L_tb_104
L_tg_105:
  s_mov_b32 s77, 1
  s_branch L_tb_106
L_tg_107:
  s_mov_b32 s77, 1
  s_branch L_tb_108
L_wz_109:
  s_waitcnt vmcnt(0)
  s_branch L_wb_110
L_tg_115:
  s_mov_b32 s77, 1
  s_branch L_tb_116
L_tg_117:
  s_mov_b32 s77, 1
  s_branch L_tb_118
L_retry_112:
s_sub_u32 s75, s75, 1
s_cbranch_scc1 L_end
buffer_load_dwordx4 v[34:37], v59, s[64:67], s97 offen nt
buffer_load_dwordx4 v[26:29], v6, s[64:67], s97 offen offset:0 nt
buffer_load_dwordx4 v[30:33], v6, s[64:67], s97 offen offset:1024 nt
buffer_load_dwordx4 v[38:41], v6, s[64:67], s100 offen offset:0 nt
buffer_load_dwordx4 v[42:45], v6, s[64:67], s100 offen offset:1024 nt
s_mov_b64 exec, -1
s_mov_b32 s77, 0
s_cmp_lt_u32 s16, s17
s_cbranch_scc0 L_tg_115
s_waitcnt vmcnt(14)
s_swappc_b64 s[28:29], s[0:1]
L_tb_116:
s_cmp_lt_u32 s16, s17
s_cbranch_scc0 L_tg_117
s_waitcnt vmcnt(14)
s_swappc_b64 s[28:29], s[0:1]
L_tb_118:
s_cmp_lg_u32 s77, 0
s_cbranch_scc1 L_rz_113
s_waitcnt vmcnt(6)
s_branch L_chk_111
L_rz_113:
s_waitcnt vmcnt(0)
s_branch L_chk_111
L_ud_122:
  s_cmp_ge_u32 s16, s20
  s_cbranch_scc1 L_uc_121
  s_waitcnt vmcnt(0)
  s_branch L_uc_121
L_tg_135:
  s_mov_b32 s77, 1
  s_branch L_tb_136
L_tg_137:
  s_mov_b32 s77, 1
  s_branch L_tb_138
L_wz_139:
  s_waitcnt vmcnt(0)
  s_branch L_wb_140
L_tg_145:
  s_mov_b32 s77, 1
  s_branch L_tb_146
L_retry_142:
s_sub_u32 s75, s75, 1
s_cbranch_scc1 L_end
buffer_load_dwordx4 v[34:37], v38, s[64:67], s97 offen nt
buffer_load_dwordx4 v[26:29], v6, s[64:67], s97 offen offset:0 nt
buffer_load_dwordx4 v[30:33], v6, s[64:67], s97 offen offset:1024 nt
s_mov_b64 exec, -1
s_mov_b32 s77, 0
s_cmp_lt_u32 s16, s17
s_cbranch_scc0 L_tg_145
s_waitcnt vmcnt(6)
s_swappc_b64 s[28:29], s[0:1]
L_tb_146:
s_cmp_lg_u32 s77, 0
s_cbranch_scc1 L_rz_143
s_waitcnt vmcnt(3)
s_branch L_chk_141
L_rz_143:
s_waitcnt vmcnt(0)
s_branch L_chk_141
L_tg_147:
  s_mov_b32 s77, 1
  s_branch L_tb_148
L_tg_149:
  s_mov_b32 s77, 1
  s_branch L_tb_150
L_tg_151:
  s_mov_b32 s77, 1
  s_branch L_tb_152
L_tg_153:
  s_mov_b32 s77, 1
  s_branch L_tb_154
L_wz_155:
  s_waitcnt vmcnt(18)
  s_branch L_wb_156
L_tg_161:
  s_mov_b32 s77, 1
  s_branch L_tb_162
L_tg_163:
  s_mov_b32 s77, 1
  s_branch L_tb_164
L_retry_158:
s_sub_u32 s75, s75, 1
s_cbranch_scc1 L_end
buffer_load_dwordx4 v[34:37], v38, s[64:67], s97 offen nt
buffer_load_dwordx4 v[26:29], v6, s[64:67], s97 offen offset:0 nt
buffer_load_dwordx4 v[30:33], v6, s[64:67], s97 offen offset:1024 nt
s_mov_b64 exec, -1
s_mov_b32 s77, 0
s_cmp_lt_u32 s16, s17
s_cbranch_scc0 L_tg_161
s_waitcnt vmcnt(12)
s_swappc_b64 s[28:29], s[0:1]
L_tb_162:
s_cmp_lt_u32 s16, s17
s_cbranch_scc0 L_tg_163
s_waitcnt vmcnt(12)
s_swappc_b64 s[28:29], s[0:1]
L_tb_164:
s_cmp_lg_u32 s77, 0
s_cbranch_scc1 L_rz_159
s_waitcnt vmcnt(6)
s_branch L_chk_157
L_rz_159:
s_waitcnt vmcnt(0)
s_branch L_chk_157
L_nd_167:
  s_waitcnt vmcnt(0)
  s_cmp_ge_u32 s16, 144
  s_cbranch_scc1 L_nq_168
  s_branch L_end
L_tg_169:
  s_mov_b32 s77, 1
  s_branch L_tb_170
L_tg_171:
  s_mov_b32 s77, 1
  s_branch L_tb_172
L_tg_173:
  s_mov_b32 s77, 1
  s_branch L_tb_174
L_tg_175:
  s_mov_b32 s77, 1
  s_branch L_tb_176
L_tg_177:
  s_mov_b32 s77, 1
  s_branch L_tb_178
L_wz_179:
  s_waitcnt vmcnt(0)
  s_branch L_wb_180
L_tg_185:
  s_mov_b32 s77, 1
  s_branch L_tb_186
L_tg_187:
  s_mov_b32 s77, 1
  s_branch L_tb_188
L_retry_182:
s_sub_u32 s75, s75, 1
s_cbranch_scc1 L_end
buffer_load_dwordx4 v[34:37], v45, s[64:67], s97 offen nt
buffer_load_dwordx4 v[26:29], v6, s[64:67], s97 offen offset:0 nt
buffer_load_dwordx4 v[30:33], v6, s[64:67], s97 offen offset:1024 nt
s_mov_b64 exec, -1
s_mov_b32 s77, 0
s_cmp_lt_u32 s16, s17
s_cbranch_scc0 L_tg_185
s_waitcnt vmcnt(12)
s_swappc_b64 s[28:29], s[0:1]
L_tb_186:
s_cmp_lt_u32 s16, s17
s_cbranch_scc0 L_tg_187
s_waitcnt vmcnt(12)
s_swappc_b64 s[28:29], s[0:1]
L_tb_188:
s_cmp_lg_u32 s77, 0
s_cbranch_scc1 L_rz_183
s_waitcnt vmcnt(6)
s_branch L_chk_181
L_rz_183:
s_waitcnt vmcnt(0)
s_branch L_chk_181
L_tg_189:
  s_mov_b32 s77, 1
  s_branch L_tb_190
L_tg_191:
  s_mov_b32 s77, 1
  s_branch L_tb_192
L_tg_193:
  s_mov_b32 s77, 1
  s_branch L_tb_194
L_tg_195:
  s_mov_b32 s77, 1
  s_branch L_tb_196
L_tg_198:
  s_mov_b32 s77, 1
  s_branch L_tb_199
L_tg_200:
  s_mov_b32 s77, 1
  s_branch L_tb_201
L_tg_202:
  s_mov_b32 s77, 1
  s_branch L_tb_203
L_wz_204:
  s_waitcnt vmcnt(0)
  s_branch L_wb_205
L_tg_210:
  s_mov_b32 s77, 1
  s_branch L_tb_211
L_tg_212:
  s_mov_b32 s77, 1
  s_branch L_tb_213
L_retry_207:
s_sub_u32 s75, s75, 1
s_cbranch_scc1 L_end
buffer_load_dwordx4 v[34:37], v45, s[64:67], s97 offen nt
buffer_load_dwordx4 v[26:29], v6, s[64:67], s97 offen offset:0 nt
buffer_load_dwordx4 v[30:33], v6, s[64:67], s97 offen offset:1024 nt
s_mov_b64 exec, -1
s_mov_b32 s77, 0
s_cmp_lt_u32 s16, s17
s_cbranch_scc0 L_tg_210
s_waitcnt vmcnt(12)
s_swappc_b64 s[28:29], s[0:1]
L_tb_211:
s_cmp_lt_u32 s16, s17
s_cbranch_scc0 L_tg_212
s_waitcnt vmcnt(12)
s_swappc_b64 s[28:29], s[0:1]
L_tb_213:
s_cmp_lg_u32 s77, 0
s_cbranch_scc1 L_rz_208
s_waitcnt vmcnt(6)
s_branch L_chk_206
L_rz_208:
s_waitcnt vmcnt(0)
s_branch L_chk_206
L_tg_214:
  s_mov_b32 s77, 1
  s_branch L_tb_215
L_tg_216:
  s_mov_b32 s77, 1
  s_branch L_tb_217
L_tg_218:
  s_mov_b32 s77, 1
  s_branch L_tb_219
L_wz_220:
  s_waitcnt vmcnt(0)
  s_branch L_wb_221
L_tg_226:
  s_mov_b32 s77, 1
  s_branch L_tb_227
L_tg_228:
  s_mov_b32 s77, 1
  s_branch L_tb_229
L_retry_223:
s_sub_u32 s75, s75, 1
s_cbranch_scc1 L_end
buffer_load_dwordx4 v[26:29], v74, s[64:67], s97 offen offset:0 sc1
buffer_load_dwordx4 v[30:33], v74, s[64:67], s97 offen offset:1024 sc1
buffer_load_dwordx4 v[34:37], v74, s[64:67], s97 offen offset:2048 sc1
buffer_load_dwordx4 v[38:41], v74, s[64:67], s97 offen offset:3072 sc1
s_mov_b64 exec, -1
s_mov_b32 s77, 0
s_cmp_lt_u32 s16, s17
s_cbranch_scc0 L_tg_226
s_waitcnt vmcnt(13)
s_swappc_b64 s[28:29], s[0:1]
L_tb_227:
s_cmp_lt_u32 s16, s17
s_cbranch_scc0 L_tg_228
s_waitcnt vmcnt(13)
s_swappc_b64 s[28:29], s[0:1]
L_tb_229:
  s_mov_b32 exec_lo, 0x1f1f1f1f
  s_mov_b32 exec_hi, 0x1f1f1f1f
s_cmp_lg_u32 s77, 0
s_cbranch_scc1 L_rz_224
s_waitcnt vmcnt(6)
s_branch L_chk_222
L_rz_224:
s_waitcnt vmcnt(0)
s_branch L_chk_222
L_tg_230:
  s_mov_b32 s77, 1
  s_branch L_tb_231
L_tg_232:
  s_mov_b32 s77, 1
  s_branch L_tb_233
L_tg_234:
  s_mov_b32 s77, 1
  s_branch L_tb_235
L_wz_236:
  s_waitcnt vmcnt(0)
  s_branch L_wb_237
L_tg_242:
  s_mov_b32 s77, 1
  s_branch L_tb_243
L_tg_244:
  s_mov_b32 s77, 1
  s_branch L_tb_245
L_retry_239:
s_sub_u32 s75, s75, 1
s_cbranch_scc1 L_end
buffer_load_dwordx4 v[34:37], v38, s[64:67], s97 offen nt
buffer_load_dwordx4 v[26:29], v6, s[64:67], s97 offen offset:0 nt
buffer_load_dwordx4 v[30:33], v6, s[64:67], s97 offen offset:1024 nt
s_mov_b64 exec, -1
s_mov_b32 s77, 0
s_cmp_lt_u32 s16, s17
s_cbranch_scc0 L_tg_242
s_waitcnt vmcnt(12)
s_swappc_b64 s[28:29], s[0:1]
L_tb_243:
s_cmp_lt_u32 s16, s17
s_cbranch_scc0 L_tg_244
s_waitcnt vmcnt(12)
s_swappc_b64 s[28:29], s[0:1]
L_tb_245:
s_cmp_lg_u32 s77, 0
s_cbranch_scc1 L_rz_240
s_waitcnt vmcnt(6)
s_branch L_chk_238
L_rz_240:
s_waitcnt vmcnt(0)
s_branch L_chk_238
L_nd_248:
  s_waitcnt vmcnt(0)
  s_cmp_ge_u32 s16, 192
  s_cbranch_scc1 L_nq_249
  s_branch L_end
L_tg_250:
  s_mov_b32 s77, 1
  s_branch L_tb_251
L_tg_252:
  s_mov_b32 s77, 1
  s_branch L_tb_253
L_nd_256:
  s_waitcnt vmcnt(0)
  s_cmp_ge_u32 s16, 216
  s_cbranch_scc1 L_nq_257
  s_branch L_end
L_ud_261:
  s_cmp_ge_u32 s16, s20
  s_cbranch_scc1 L_uc_260
  s_waitcnt vmcnt(0)
  s_branch L_uc_260
L_stream:
  s_mov_b32 s22, 0
  buffer_load_dwordx4 v[76:79], v1, s[32:35], s22 offen offset:0 nt
  buffer_load_dwordx4 v[80:83], v1, s[32:35], s22 offen offset:128 nt
  buffer_load_dwordx4 v[84:87], v1, s[32:35], s22 offen offset:256 nt
  s_add_u32 s16, s16, 3
  s_add_u32 s0, s0, L_S3-L_stream
  s_addc_u32 s1, s1, 0
  s_setpc_b64 s[28:29]
L_S3:
  s_mov_b32 s22, 98304
  buffer_load_dwordx4 v[88:91], v1, s[32:35], s22 offen offset:0 nt
  buffer_load_dwordx4 v[92:95], v1, s[32:35], s22 offen offset:128 nt
  buffer_load_dwordx4 v[96:99], v1, s[32:35], s22 offen offset:256 nt
  s_add_u32 s16, s16, 3
  s_add_u32 s0, s0, L_S6-L_S3
  s_addc_u32 s1, s1, 0
  s_setpc_b64 s[28:29]
L_S6:
  s_mov_b32 s22, 196608
  buffer_load_dwordx4 v[100:103], v1, s[32:35], s22 offen offset:0 nt
  buffer_load_dwordx4 v[104:107], v1, s[32:35], s22 offen offset:128 nt
  buffer_load_dwordx4 v[108:111], v1, s[32:35], s22 offen offset:256 nt
  s_add_u32 s16, s16, 3
  s_add_u32 s0, s0, L_S9-L_S6
  s_addc_u32 s1, s1, 0
  s_setpc_b64 s[28:29]
L_S9:
  s_mov_b32 s22, 294912
  buffer_load_dwordx4 v[112:115], v1, s[32:35], s22 offen offset:0 nt
  buffer_load_dwordx4 v[116:119], v1, s[32:35], s22 offen offset:128 nt
  buffer_load_dwordx4 v[120:123], v1, s[32:35], s22 offen offset:256 nt
  s_add_u32 s16, s16, 3
  s_add_u32 s0, s0, L_S12-L_S9
  s_addc_u32 s1, s1, 0
  s_setpc_b64 s[28:29]
L_S12:
  s_mov_b32 s22, 0
  buffer_load_dwordx4 v[124:127], v1, s[36:39], s22 offen offset:0 nt
  buffer_load_dwordx4 v[128:131], v1, s[36:39], s22 offen offset:128 nt
  buffer_load_dwordx4 v[132:135], v1, s[36:39], s22 offen offset:256 nt
  s_add_u32 s16, s16, 3
  s_add_u32 s0, s0, L_S15-L_S12
  s_addc_u32 s1, s1, 0
  s_setpc_b64 s[28:29]
L_S15:
  s_mov_b32 s22, 98304
  buffer_load_dwordx4 v[136:139], v1, s[36:39], s22 offen offset:0 nt
  buffer_load_dwordx4 v[140:143], v1, s[36:39], s22 offen offset:128 nt
  buffer_load_dwordx4 v[144:147], v1, s[36:39], s22 offen offset:256 nt
  s_add_u32 s16, s16, 3
  s_add_u32 s0, s0, L_S18-L_S15
  s_addc_u32 s1, s1, 0
  s_setpc_b64 s[28:29]
L_S18:
  s_mov_b32 s22, 196608
  buffer_load_dwordx4 v[148:151], v1, s[36:39], s22 offen offset:0 nt
  buffer_load_dwordx4 v[152:155], v1, s[36:39], s22 offen offset:128 nt
  buffer_load_dwordx4 v[156:159], v1, s[36:39], s22 offen offset:256 nt
  s_add_u32 s16, s16, 3
  s_add_u32 s0, s0, L_S21-L_S18
  s_addc_u32 s1, s1, 0
  s_setpc_b64 s[28:29]
L_S21:
  s_mov_b32 s22, 294912
  buffer_load_dwordx4 v[160:163], v1, s[36:39], s22 offen offset:0 nt
  buffer_load_dwordx4 v[164:167], v1, s[36:39], s22 offen offset:128 nt
  buffer_load_dwordx4 v[168:171], v1, s[36:39], s22 offen offset:256 nt
  s_add_u32 s16, s16, 3
  s_add_u32 s0, s0, L_S24-L_S21
  s_addc_u32 s1, s1, 0
  s_setpc_b64 s[28:29]
L_S24:
  s_mov_b32 s22, 0
  buffer_load_dwordx4 v[172:175], v1, s[40:43], s22 offen offset:0 nt
  buffer_load_dwordx4 v[176:179], v1, s[40:43], s22 offen offset:128 nt
  buffer_load_dwordx4 v[180:183], v1, s[40:43], s22 offen offset:256 nt
  s_add_u32 s16, s16, 3
  s_add_u32 s0, s0, L_S27-L_S24
  s_addc_u32 s1, s1, 0
  s_setpc_b64 s[28:29]
L_S27:
  s_mov_b32 s22, 98304
  buffer_load_dwordx4 v[184:187], v1, s[40:43], s22 offen offset:0 nt
  buffer_load_dwordx4 v[188:191], v1, s[40:43], s22 offen offset:128 nt
  buffer_load_dwordx4 v[192:195], v1, s[40:43], s22 offen offset:256 nt
  s_add_u32 s16, s16, 3
  s_add_u32 s0, s0, L_S30-L_S27
  s_addc_u32 s1, s1, 0
  s_setpc_b64 s[28:29]
L_S30:
  s_mov_b32 s22, 196608
  buffer_load_dwordx4 v[196:199], v1, s[40:43], s22 offen offset:0 nt
  buffer_load_dwordx4 v[200:203], v1, s[40:43], s22 offen offset:128 nt
  buffer_load_dwordx4 v[204:207], v1, s[40:43], s22 offen offset:256 nt
  s_add_u32 s16, s16, 3
  s_add_u32 s0, s0, L_S33-L_S30
  s_addc_u32 s1, s1, 0
  s_setpc_b64 s[28:29]
L_S33:
  s_mov_b32 s22, 294912
  buffer_load_dwordx4 v[208:211], v1, s[40:43], s22 offen offset:0 nt
  buffer_load_dwordx4 v[212:215], v1, s[40:43], s22 offen offset:128 nt
  buffer_load_dwordx4 v[216:219], v1, s[40:43], s22 offen offset:256 nt
  s_add_u32 s16, s16, 3
  s_add_u32 s0, s0, L_S36-L_S33
  s_addc_u32 s1, s1, 0
  s_setpc_b64 s[28:29]
L_S36:
  s_mov_b32 s22, 393216
  buffer_load_dwordx4 v[220:223], v1, s[40:43], s22 offen offset:0 nt
  buffer_load_dwordx4 v[224:227], v1, s[40:43], s22 offen offset:128 nt
  buffer_load_dwordx4 v[228:231], v1, s[40:43], s22 offen offset:256 nt
  s_add_u32 s16, s16, 3
  s_add_u32 s0, s0, L_S39-L_S36
  s_addc_u32 s1, s1, 0
  s_setpc_b64 s[28:29]
L_S39:
  s_mov_b32 s22, 491520
  buffer_load_dwordx4 v[232:235], v1, s[40:43], s22 offen offset:0 nt
  buffer_load_dwordx4 v[236:239], v1, s[40:43], s22 offen offset:128 nt
  buffer_load_dwordx4 v[240:243], v1, s[40:43], s22 offen offset:256 nt
  s_add_u32 s16, s16, 3
  s_add_u32 s0, s0, L_S42-L_S39
  s_addc_u32 s1, s1, 0
  s_setpc_b64 s[28:29]
L_S42:
  s_mov_b32 s22, 589824
  buffer_load_dwordx4 v[244:247], v1, s[40:43], s22 offen offset:0 nt
  buffer_load_dwordx4 v[248:251], v1, s[40:43], s22 offen offset:128 nt
  buffer_load_dwordx4 v[252:255], v1, s[40:43], s22 offen offset:256 nt
  s_add_u32 s16, s16, 3
  s_add_u32 s0, s0, L_S45-L_S42
  s_addc_u32 s1, s1, 0
  s_setpc_b64 s[28:29]
L_S45:
  s_mov_b32 s22, 688128
  buffer_load_dwordx4 a[0:3], v1, s[40:43], s22 offen offset:0 nt
  buffer_load_dwordx4 a[4:7], v1, s[40:43], s22 offen offset:128 nt
  buffer_load_dwordx4 a[8:11], v1, s[40:43], s22 offen offset:256 nt
  s_add_u32 s16, s16, 3
  s_add_u32 s0, s0, L_S48-L_S45
  s_addc_u32 s1, s1, 0
  s_setpc_b64 s[28:29]
L_S48:
  s_mov_b32 s22, 786432
  buffer_load_dwordx4 a[12:15], v1, s[40:43], s22 offen offset:0 nt
  buffer_load_dwordx4 a[16:19], v1, s[40:43], s22 offen offset:128 nt
  buffer_load_dwordx4 a[20:23], v1, s[40:43], s22 offen offset:256 nt
  s_add_u32 s16, s16, 3
  s_add_u32 s0, s0, L_S51-L_S48
  s_addc_u32 s1, s1, 0
  s_setpc_b64 s[28:29]
L_S51:
  s_mov_b32 s22, 884736
  buffer_load_dwordx4 a[24:27], v1, s[40:43], s22 offen offset:0 nt
  buffer_load_dwordx4 a[28:31], v1, s[40:43], s22 offen offset:128 nt
  buffer_load_dwordx4 a[32:35], v1, s[40:43], s22 offen offset:256 nt
  s_add_u32 s16, s16, 3
  s_add_u32 s0, s0, L_S54-L_S51
  s_addc_u32 s1, s1, 0
  s_setpc_b64 s[28:29]
L_S54:
  s_mov_b32 s22, 983040
  buffer_load_dwordx4 a[36:39], v1, s[40:43], s22 offen offset:0 nt
  buffer_load_dwordx4 a[40:43], v1, s[40:43], s22 offen offset:128 nt
  buffer_load_dwordx4 a[44:47], v1, s[40:43], s22 offen offset:256 nt
  s_add_u32 s16, s16, 3
  s_add_u32 s0, s0, L_S57-L_S54
  s_addc_u32 s1, s1, 0
  s_setpc_b64 s[28:29]
L_S57:
  s_mov_b32 s22, 1081344
  buffer_load_dwordx4 a[48:51], v1, s[40:43], s22 offen offset:0 nt
  buffer_load_dwordx4 a[52:55], v1, s[40:43], s22 offen offset:128 nt
  buffer_load_dwordx4 a[56:59], v1, s[40:43], s22 offen offset:256 nt
  s_add_u32 s16, s16, 3
  s_add_u32 s0, s0, L_S60-L_S57
  s_addc_u32 s1, s1, 0
  s_setpc_b64 s[28:29]
L_S60:
  s_mov_b32 s22, 1179648
  buffer_load_dwordx4 a[60:63], v1, s[40:43], s22 offen offset:0 nt
  buffer_load_dwordx4 a[64:67], v1, s[40:43], s22 offen offset:128 nt
  buffer_load_dwordx4 a[68:71], v1, s[40:43], s22 offen offset:256 nt
  s_add_u32 s16, s16, 3
  s_add_u32 s0, s0, L_S63-L_S60
  s_addc_u32 s1, s1, 0
  s_setpc_b64 s[28:29]
L_S63:
  s_mov_b32 s22, 1277952
  buffer_load_dwordx4 a[72:75], v1, s[40:43], s22 offen offset:0 nt
  buffer_load_dwordx4 a[76:79], v1, s[40:43], s22 offen offset:128 nt
  buffer_load_dwordx4 a[80:83], v1, s[40:43], s22 offen offset:256 nt
  s_add_u32 s16, s16, 3
  s_add_u32 s0, s0, L_S66-L_S63
  s_addc_u32 s1, s1, 0
  s_setpc_b64 s[28:29]
L_S66:
  s_mov_b32 s22, 1376256
  buffer_load_dwordx4 a[84:87], v1, s[40:43], s22 offen offset:0 nt
  buffer_load_dwordx4 a[88:91], v1, s[40:43], s22 offen offset:128 nt
  buffer_load_dwordx4 a[92:95], v1, s[40:43], s22 offen offset:256 nt
  s_add_u32 s16, s16, 3
  s_add_u32 s0, s0, L_S69-L_S66
  s_addc_u32 s1, s1, 0
  s_setpc_b64 s[28:29]
L_S69:
  s_mov_b32 s22, 1474560
  buffer_load_dwordx4 a[96:99], v1, s[40:43], s22 offen offset:0 nt
  buffer_load_dwordx4 a[100:103], v1, s[40:43], s22 offen offset:128 nt
  buffer_load_dwordx4 a[104:107], v1, s[40:43], s22 offen offset:256 nt
  s_add_u32 s16, s16, 3
  s_add_u32 s0, s0, L_S72-L_S69
  s_addc_u32 s1, s1, 0
  s_setpc_b64 s[28:29]
L_S72:
  s_mov_b32 s22, 0
  buffer_load_dwordx4 a[108:111], v1, s[44:47], s22 offen offset:0
  buffer_load_dwordx4 a[112:115], v1, s[44:47], s22 offen offset:128
  buffer_load_dwordx4 a[116:119], v1, s[44:47], s22 offen offset:256
  s_add_u32 s16, s16, 3
  s_add_u32 s0, s0, L_S75-L_S72
  s_addc_u32 s1, s1, 0
  s_setpc_b64 s[28:29]
L_S75:
  s_mov_b32 s22, 98304
  buffer_load_dwordx4 a[120:123], v1, s[44:47], s22 offen offset:0
  buffer_load_dwordx4 a[124:127], v1, s[44:47], s22 offen offset:128
  buffer_load_dwordx4 a[128:131], v1, s[44:47], s22 offen offset:256
  s_add_u32 s16, s16, 3
  s_add_u32 s0, s0, L_S78-L_S75
  s_addc_u32 s1, s1, 0
  s_setpc_b64 s[28:29]
L_S78:
  s_mov_b32 s22, 196608
  buffer_load_dwordx4 a[132:135], v1, s[44:47], s22 offen offset:0
  buffer_load_dwordx4 a[136:139], v1, s[44:47], s22 offen offset:128
  buffer_load_dwordx4 a[140:143], v1, s[44:47], s22 offen offset:256
  s_add_u32 s16, s16, 3
  s_add_u32 s0, s0, L_S81-L_S78
  s_addc_u32 s1, s1, 0
  s_setpc_b64 s[28:29]
L_S81:
  s_mov_b32 s22, 294912
  buffer_load_dwordx4 a[144:147], v1, s[44:47], s22 offen offset:0
  buffer_load_dwordx4 a[148:151], v1, s[44:47], s22 offen offset:128
  buffer_load_dwordx4 a[152:155], v1, s[44:47], s22 offen offset:256
  s_add_u32 s16, s16, 3
  s_add_u32 s0, s0, L_S84-L_S81
  s_addc_u32 s1, s1, 0
  s_setpc_b64 s[28:29]
L_S84:
  s_mov_b32 s22, 393216
  buffer_load_dwordx4 a[156:159], v1, s[44:47], s22 offen offset:0
  buffer_load_dwordx4 a[160:163], v1, s[44:47], s22 offen offset:128
  buffer_load_dwordx4 a[164:167], v1, s[44:47], s22 offen offset:256
  s_add_u32 s16, s16, 3
  s_add_u32 s0, s0, L_S87-L_S84
  s_addc_u32 s1, s1, 0
  s_setpc_b64 s[28:29]
L_S87:
  s_mov_b32 s22, 589824
  buffer_load_dwordx4 a[168:171], v1, s[44:47], s22 offen offset:0 nt
  buffer_load_dwordx4 a[172:175], v1, s[44:47], s22 offen offset:128 nt
  buffer_load_dwordx4 a[176:179], v1, s[44:47], s22 offen offset:256 nt
  s_add_u32 s16, s16, 3
  s_add_u32 s0, s0, L_S90-L_S87
  s_addc_u32 s1, s1, 0
  s_setpc_b64 s[28:29]
L_S90:
  s_mov_b32 s22, 688128
  buffer_load_dwordx4 a[180:183], v1, s[44:47], s22 offen offset:0 nt
  buffer_load_dwordx4 a[184:187], v1, s[44:47], s22 offen offset:128 nt
  buffer_load_dwordx4 a[188:191], v1, s[44:47], s22 offen offset:256 nt
  s_add_u32 s16, s16, 3
  s_add_u32 s0, s0, L_S93-L_S90
  s_addc_u32 s1, s1, 0
  s_setpc_b64 s[28:29]
L_S93:
  s_mov_b32 s22, 786432
  buffer_load_dwordx4 a[192:195], v1, s[44:47], s22 offen offset:0 nt
  buffer_load_dwordx4 a[196:199], v1, s[44:47], s22 offen offset:128 nt
  buffer_load_dwordx4 a[200:203], v1, s[44:47], s22 offen offset:256 nt
  s_add_u32 s16, s16, 3
  s_add_u32 s0, s0, L_S96-L_S93
  s_addc_u32 s1, s1, 0
  s_setpc_b64 s[28:29]
L_S96:
  s_mov_b32 s22, 884736
  buffer_load_dwordx4 a[204:207], v1, s[44:47], s22 offen offset:0 nt
  buffer_load_dwordx4 a[208:211], v1, s[44:47], s22 offen offset:128 nt
  buffer_load_dwordx4 a[212:215], v1, s[44:47], s22 offen offset:256 nt
  s_add_u32 s16, s16, 3
  s_add_u32 s0, s0, L_S99-L_S96
  s_addc_u32 s1, s1, 0
  s_setpc_b64 s[28:29]
L_S99:
  s_mov_b32 s22, 983040
  buffer_load_dwordx4 a[216:219], v1, s[44:47], s22 offen offset:0 nt
  buffer_load_dwordx4 a[220:223], v1, s[44:47], s22 offen offset:128 nt
  buffer_load_dwordx4 a[224:227], v1, s[44:47], s22 offen offset:256 nt
  s_add_u32 s16, s16, 3
  s_add_u32 s0, s0, L_S102-L_S99
  s_addc_u32 s1, s1, 0
  s_setpc_b64 s[28:29]
L_S102:
  s_mov_b32 s22, 1081344
  buffer_load_dwordx4 a[228:231], v1, s[44:47], s22 offen offset:0 nt
  buffer_load_dwordx4 a[232:235], v1, s[44:47], s22 offen offset:128 nt
  buffer_load_dwordx4 a[236:239], v1, s[44:47], s22 offen offset:256 nt
  s_add_u32 s16, s16, 3
  s_add_u32 s0, s0, L_S105-L_S102
  s_addc_u32 s1, s1, 0
  s_setpc_b64 s[28:29]
L_S105:
  s_mov_b32 s22, 1179648
  buffer_load_dwordx4 a[240:243], v1, s[44:47], s22 offen offset:0 nt
  buffer_load_dwordx4 a[244:247], v1, s[44:47], s22 offen offset:128 nt
  buffer_load_dwordx4 a[248:251], v1, s[44:47], s22 offen offset:256 nt
  s_add_u32 s16, s16, 3
  s_add_u32 s0, s0, L_S108-L_S105
  s_addc_u32 s1, s1, 0
  s_setpc_b64 s[28:29]
L_S108:
  s_mov_b32 s22, 1277952
  buffer_load_dwordx4 a[252:255], v1, s[44:47], s22 offen offset:0 nt
  s_add_u32 m0, s27, 0
  s_add_u32 s23, s22, 128
  buffer_load_dwordx4 v1, s[44:47], s23 offen nt lds
  s_add_u32 m0, s27, 4096
  s_add_u32 s23, s22, 256
  buffer_load_dwordx4 v1, s[44:47], s23 offen nt lds
  s_add_u32 s16, s16, 3
  s_add_u32 s0, s0, L_S111-L_S108
  s_addc_u32 s1, s1, 0
  s_setpc_b64 s[28:29]
L_S111:
  s_mov_b32 s22, 1376256
  s_add_u32 m0, s27, 8192
  s_add_u32 s23, s22, 0
  buffer_load_dwordx4 v1, s[44:47], s23 offen nt lds
  s_add_u32 m0, s27, 12288
  s_add_u32 s23, s22, 128
  buffer_load_dwordx4 v1, s[44:47], s23 offen nt lds
  s_add_u32 m0, s27, 16384
  s_add_u32 s23, s22, 256
  buffer_load_dwordx4 v1, s[44:47], s23 offen nt lds
  s_add_u32 s16, s16, 3
  s_add_u32 s0, s0, L_S114-L_S111
  s_addc_u32 s1, s1, 0
  s_setpc_b64 s[28:29]
L_S114:
  s_mov_b32 s22, 1474560
  s_add_u32 m0, s27, 20480
  s_add_u32 s23, s22, 0
  buffer_load_dwordx4 v1, s[44:47], s23 offen nt lds
  s_add_u32 m0, s27, 24576
  s_add_u32 s23, s22, 128
  buffer_load_dwordx4 v1, s[44:47], s23 offen nt lds
  s_add_u32 m0, s27, 28672
  s_add_u32 s23, s22, 256
  buffer_load_dwordx4 v1, s[44:47], s23 offen nt lds
  s_add_u32 s16, s16, 3
  s_add_u32 s0, s0, L_S117-L_S114
  s_addc_u32 s1, s1, 0
  s_setpc_b64 s[28:29]
L_S117:
  s_mov_b32 s22, 491520
  buffer_load_dwordx4 a[108:111], v1, s[44:47], s22 offen offset:0
  buffer_load_dwordx4 a[112:115], v1, s[44:47], s22 offen offset:128
  buffer_load_dwordx4 a[116:119], v1, s[44:47], s22 offen offset:256
  s_add_u32 s16, s16, 3
  s_add_u32 s0, s0, L_S120-L_S117
  s_addc_u32 s1, s1, 0
  s_setpc_b64 s[28:29]
L_S120:
  s_mov_b32 s22, 50331648
  buffer_load_dwordx4 a[120:123], v1, s[32:35], s22 offen offset:0 nt
  buffer_load_dwordx4 a[124:127], v1, s[32:35], s22 offen offset:128 nt
  buffer_load_dwordx4 a[128:131], v1, s[32:35], s22 offen offset:256 nt
  s_add_u32 s16, s16, 3
  s_add_u32 s0, s0, L_S123-L_S120
  s_addc_u32 s1, s1, 0
  s_setpc_b64 s[28:29]
L_S123:
  s_mov_b32 s22, 50429952
  buffer_load_dwordx4 a[132:135], v1, s[32:35], s22 offen offset:0 nt
  buffer_load_dwordx4 a[136:139], v1, s[32:35], s22 offen offset:128 nt
  buffer_load_dwordx4 a[140:143], v1, s[32:35], s22 offen offset:256 nt
  s_add_u32 s16, s16, 3
  s_add_u32 s0, s0, L_S126-L_S123
  s_addc_u32 s1, s1, 0
  s_setpc_b64 s[28:29]
L_S126:
  s_mov_b32 s22, 50528256
  buffer_load_dwordx4 a[144:147], v1, s[32:35], s22 offen offset:0 nt
  buffer_load_dwordx4 a[148:151], v1, s[32:35], s22 offen offset:128 nt
  buffer_load_dwordx4 a[152:155], v1, s[32:35], s22 offen offset:256 nt
  s_add_u32 s16, s16, 3
  s_add_u32 s0, s0, L_S129-L_S126
  s_addc_u32 s1, s1, 0
  s_setpc_b64 s[28:29]
L_S129:
  s_mov_b32 s22, 50626560
  buffer_load_dwordx4 a[156:159], v1, s[32:35], s22 offen offset:0 nt
  buffer_load_dwordx4 a[160:163], v1, s[32:35], s22 offen offset:128 nt
  buffer_load_dwordx4 a[164:167], v1, s[32:35], s22 offen offset:256 nt
  s_add_u32 s16, s16, 3
  s_add_u32 s0, s0, L_S132-L_S129
  s_addc_u32 s1, s1, 0
  s_setpc_b64 s[28:29]
L_S132:
  s_mov_b32 s22, 50331648
  buffer_load_dwordx4 a[108:111], v1, s[36:39], s22 offen offset:0 nt
  buffer_load_dwordx4 a[112:115], v1, s[36:39], s22 offen offset:128 nt
  buffer_load_dwordx4 a[116:119], v1, s[36:39], s22 offen offset:256 nt
  s_add_u32 s16, s16, 3
  s_add_u32 s0, s0, L_S135-L_S132
  s_addc_u32 s1, s1, 0
  s_setpc_b64 s[28:29]
L_S135:
  s_mov_b32 s22, 50429952
  buffer_load_dwordx4 v[76:79], v1, s[36:39], s22 offen offset:0 nt
  buffer_load_dwordx4 v[80:83], v1, s[36:39], s22 offen offset:128 nt
  buffer_load_dwordx4 v[84:87], v1, s[36:39], s22 offen offset:256 nt
  s_add_u32 s16, s16, 3
  s_add_u32 s0, s0, L_S138-L_S135
  s_addc_u32 s1, s1, 0
  s_setpc_b64 s[28:29]
L_S138:
  s_mov_b32 s22, 50528256
  buffer_load_dwordx4 v[88:91], v1, s[36:39], s22 offen offset:0 nt
  buffer_load_dwordx4 v[92:95], v1, s[36:39], s22 offen offset:128 nt
  buffer_load_dwordx4 v[96:99], v1, s[36:39], s22 offen offset:256 nt
  s_add_u32 s16, s16, 3
  s_add_u32 s0, s0, L_S141-L_S138
  s_addc_u32 s1, s1, 0
  s_setpc_b64 s[28:29]
L_S141:
  s_mov_b32 s22, 50626560
  buffer_load_dwordx4 v[100:103], v1, s[36:39], s22 offen offset:0 nt
  buffer_load_dwordx4 v[104:107], v1, s[36:39], s22 offen offset:128 nt
  buffer_load_dwordx4 v[108:111], v1, s[36:39], s22 offen offset:256 nt
  s_add_u32 s16, s16, 3
  s_add_u32 s0, s0, L_S144-L_S141
  s_addc_u32 s1, s1, 0
  s_setpc_b64 s[28:29]
L_S144:
  s_mov_b32 s22, 50331648
  buffer_load_dwordx4 v[112:115], v1, s[40:43], s22 offen offset:0
  buffer_load_dwordx4 v[116:119], v1, s[40:43], s22 offen offset:128
  buffer_load_dwordx4 v[120:123], v1, s[40:43], s22 offen offset:256
  s_add_u32 s16, s16, 3
  s_add_u32 s0, s0, L_S147-L_S144
  s_addc_u32 s1, s1, 0
  s_setpc_b64 s[28:29]
L_S147:
  s_mov_b32 s22, 50429952
  buffer_load_dwordx4 v[124:127], v1, s[40:43], s22 offen offset:0 nt
  buffer_load_dwordx4 v[128:131], v1, s[40:43], s22 offen offset:128 nt
  buffer_load_dwordx4 v[132:135], v1, s[40:43], s22 offen offset:256 nt
  s_add_u32 s16, s16, 3
  s_add_u32 s0, s0, L_S150-L_S147
  s_addc_u32 s1, s1, 0
  s_setpc_b64 s[28:29]
L_S150:
  s_mov_b32 s22, 50528256
  buffer_load_dwordx4 v[136:139], v1, s[40:43], s22 offen offset:0 nt
  buffer_load_dwordx4 v[140:143], v1, s[40:43], s22 offen offset:128 nt
  buffer_load_dwordx4 v[144:147], v1, s[40:43], s22 offen offset:256 nt
  s_add_u32 s16, s16, 3
  s_add_u32 s0, s0, L_S153-L_S150
  s_addc_u32 s1, s1, 0
  s_setpc_b64 s[28:29]
L_S153:
  s_mov_b32 s22, 50626560
  buffer_load_dwordx4 v[148:151], v1, s[40:43], s22 offen offset:0 nt
  buffer_load_dwordx4 v[152:155], v1, s[40:43], s22 offen offset:128 nt
  buffer_load_dwordx4 v[156:159], v1, s[40:43], s22 offen offset:256 nt
  s_add_u32 s16, s16, 3
  s_add_u32 s0, s0, L_S156-L_S153
  s_addc_u32 s1, s1, 0
  s_setpc_b64 s[28:29]
L_S156:
  s_mov_b32 s22, 50724864
  buffer_load_dwordx4 v[160:163], v1, s[40:43], s22 offen offset:0 nt
  buffer_load_dwordx4 v[164:167], v1, s[40:43], s22 offen offset:128 nt
  buffer_load_dwordx4 v[168:171], v1, s[40:43], s22 offen offset:256 nt
  s_add_u32 s16, s16, 3
  s_add_u32 s0, s0, L_S159-L_S156
  s_addc_u32 s1, s1, 0
  s_setpc_b64 s[28:29]
L_S159:
  s_mov_b32 s22, 50823168
  buffer_load_dwordx4 v[244:247], v1, s[40:43], s22 offen offset:0 nt
  buffer_load_dwordx4 v[248:251], v1, s[40:43], s22 offen offset:128 nt
  buffer_load_dwordx4 v[252:255], v1, s[40:43], s22 offen offset:256 nt
  s_add_u32 s16, s16, 3
  s_add_u32 s0, s0, L_S162-L_S159
  s_addc_u32 s1, s1, 0
  s_setpc_b64 s[28:29]
L_S162:
  s_mov_b32 s22, 50921472
  buffer_load_dwordx4 a[0:3], v1, s[40:43], s22 offen offset:0 nt
  buffer_load_dwordx4 a[4:7], v1, s[40:43], s22 offen offset:128 nt
  buffer_load_dwordx4 a[8:11], v1, s[40:43], s22 offen offset:256 nt
  s_add_u32 s16, s16, 3
  s_add_u32 s0, s0, L_S165-L_S162
  s_addc_u32 s1, s1, 0
  s_setpc_b64 s[28:29]
L_S165:
  s_mov_b32 s22, 51019776
  buffer_load_dwordx4 a[12:15], v1, s[40:43], s22 offen offset:0 nt
  buffer_load_dwordx4 a[16:19], v1, s[40:43], s22 offen offset:128 nt
  buffer_load_dwordx4 a[20:23], v1, s[40:43], s22 offen offset:256 nt
  s_add_u32 s16, s16, 3
  s_add_u32 s0, s0, L_S168-L_S165
  s_addc_u32 s1, s1, 0
  s_setpc_b64 s[28:29]
L_S168:
  s_mov_b32 s22, 51118080
  buffer_load_dwordx4 a[24:27], v1, s[40:43], s22 offen offset:0 nt
  buffer_load_dwordx4 a[28:31], v1, s[40:43], s22 offen offset:128 nt
  buffer_load_dwordx4 a[32:35], v1, s[40:43], s22 offen offset:256 nt
  s_add_u32 s16, s16, 3
  s_add_u32 s0, s0, L_S171-L_S168
  s_addc_u32 s1, s1, 0
  s_setpc_b64 s[28:29]
L_S171:
  s_mov_b32 s22, 51216384
  buffer_load_dwordx4 a[36:39], v1, s[40:43], s22 offen offset:0 nt
  buffer_load_dwordx4 a[40:43], v1, s[40:43], s22 offen offset:128 nt
  buffer_load_dwordx4 a[44:47], v1, s[40:43], s22 offen offset:256 nt
  s_add_u32 s16, s16, 3
  s_add_u32 s0, s0, L_S174-L_S171
  s_addc_u32 s1, s1, 0
  s_setpc_b64 s[28:29]
L_S174:
  s_mov_b32 s22, 51314688
  buffer_load_dwordx4 a[48:51], v1, s[40:43], s22 offen offset:0 nt
  buffer_load_dwordx4 a[52:55], v1, s[40:43], s22 offen offset:128 nt
  buffer_load_dwordx4 a[56:59], v1, s[40:43], s22 offen offset:256 nt
  s_add_u32 s16, s16, 3
  s_add_u32 s0, s0, L_S177-L_S174
  s_addc_u32 s1, s1, 0
  s_setpc_b64 s[28:29]
L_S177:
  s_mov_b32 s22, 51412992
  buffer_load_dwordx4 a[60:63], v1, s[40:43], s22 offen offset:0 nt
  buffer_load_dwordx4 a[64:67], v1, s[40:43], s22 offen offset:128 nt
  buffer_load_dwordx4 a[68:71], v1, s[40:43], s22 offen offset:256 nt
  s_add_u32 s16, s16, 3
  s_add_u32 s0, s0, L_S180-L_S177
  s_addc_u32 s1, s1, 0
  s_setpc_b64 s[28:29]
L_S180:
  s_mov_b32 s22, 51511296
  buffer_load_dwordx4 a[72:75], v1, s[40:43], s22 offen offset:0 nt
  buffer_load_dwordx4 a[76:79], v1, s[40:43], s22 offen offset:128 nt
  buffer_load_dwordx4 a[80:83], v1, s[40:43], s22 offen offset:256 nt
  s_add_u32 s16, s16, 3
  s_add_u32 s0, s0, L_S183-L_S180
  s_addc_u32 s1, s1, 0
  s_setpc_b64 s[28:29]
L_S183:
  s_mov_b32 s22, 51609600
  buffer_load_dwordx4 a[84:87], v1, s[40:43], s22 offen offset:0 nt
  buffer_load_dwordx4 a[88:91], v1, s[40:43], s22 offen offset:128 nt
  buffer_load_dwordx4 a[92:95], v1, s[40:43], s22 offen offset:256 nt
  s_add_u32 s16, s16, 3
  s_add_u32 s0, s0, L_S186-L_S183
  s_addc_u32 s1, s1, 0
  s_setpc_b64 s[28:29]
L_S186:
  s_mov_b32 s22, 51707904
  buffer_load_dwordx4 a[96:99], v1, s[40:43], s22 offen offset:0 nt
  buffer_load_dwordx4 a[100:103], v1, s[40:43], s22 offen offset:128 nt
  buffer_load_dwordx4 a[104:107], v1, s[40:43], s22 offen offset:256 nt
  s_add_u32 s16, s16, 3
  s_add_u32 s0, s0, L_S189-L_S186
  s_addc_u32 s1, s1, 0
  s_setpc_b64 s[28:29]
L_S189:
  s_mov_b32 s22, 51806208
  buffer_load_dwordx4 a[168:171], v1, s[40:43], s22 offen offset:0 nt
  buffer_load_dwordx4 a[172:175], v1, s[40:43], s22 offen offset:128 nt
  buffer_load_dwordx4 a[176:179], v1, s[40:43], s22 offen offset:256 nt
  s_add_u32 s16, s16, 3
  s_add_u32 s0, s0, L_S192-L_S189
  s_addc_u32 s1, s1, 0
  s_setpc_b64 s[28:29]
L_S192:
  s_mov_b32 s22, 50331648
  buffer_load_dwordx4 a[180:183], v1, s[44:47], s22 offen offset:0 nt
  buffer_load_dwordx4 a[184:187], v1, s[44:47], s22 offen offset:128 nt
  buffer_load_dwordx4 a[188:191], v1, s[44:47], s22 offen offset:256 nt
  s_add_u32 s16, s16, 3
  s_add_u32 s0, s0, L_S195-L_S192
  s_addc_u32 s1, s1, 0
  s_setpc_b64 s[28:29]
L_S195:
  s_mov_b32 s22, 50429952
  buffer_load_dwordx4 a[192:195], v1, s[44:47], s22 offen offset:0 nt
  buffer_load_dwordx4 a[196:199], v1, s[44:47], s22 offen offset:128 nt
  buffer_load_dwordx4 a[200:203], v1, s[44:47], s22 offen offset:256 nt
  s_add_u32 s16, s16, 3
  s_add_u32 s0, s0, L_S198-L_S195
  s_addc_u32 s1, s1, 0
  s_setpc_b64 s[28:29]
L_S198:
  s_mov_b32 s22, 50528256
  buffer_load_dwordx4 a[204:207], v1, s[44:47], s22 offen offset:0 nt
  buffer_load_dwordx4 a[208:211], v1, s[44:47], s22 offen offset:128 nt
  buffer_load_dwordx4 a[212:215], v1, s[44:47], s22 offen offset:256 nt
  s_add_u32 s16, s16, 3
  s_add_u32 s0, s0, L_S201-L_S198
  s_addc_u32 s1, s1, 0
  s_setpc_b64 s[28:29]
L_S201:
  s_mov_b32 s22, 50626560
  buffer_load_dwordx4 a[216:219], v1, s[44:47], s22 offen offset:0 nt
  buffer_load_dwordx4 a[220:223], v1, s[44:47], s22 offen offset:128 nt
  buffer_load_dwordx4 a[224:227], v1, s[44:47], s22 offen offset:256 nt
  s_add_u32 s16, s16, 3
  s_add_u32 s0, s0, L_S204-L_S201
  s_addc_u32 s1, s1, 0
  s_setpc_b64 s[28:29]
L_S204:
  s_mov_b32 s22, 50724864
  buffer_load_dwordx4 a[228:231], v1, s[44:47], s22 offen offset:0 nt
  buffer_load_dwordx4 a[232:235], v1, s[44:47], s22 offen offset:128 nt
  buffer_load_dwordx4 a[236:239], v1, s[44:47], s22 offen offset:256 nt
  s_add_u32 s16, s16, 3
  s_add_u32 s0, s0, L_S207-L_S204
  s_addc_u32 s1, s1, 0
  s_setpc_b64 s[28:29]
L_S207:
  s_mov_b32 s22, 50823168
  buffer_load_dwordx4 a[240:243], v1, s[44:47], s22 offen offset:0 nt
  buffer_load_dwordx4 a[244:247], v1, s[44:47], s22 offen offset:128 nt
  buffer_load_dwordx4 a[248:251], v1, s[44:47], s22 offen offset:256 nt
  s_add_u32 s16, s16, 3
  s_add_u32 s0, s0, L_S210-L_S207
  s_addc_u32 s1, s1, 0
  s_setpc_b64 s[28:29]
L_S210:
  s_mov_b32 s22, 50921472
  buffer_load_dwordx4 v[172:175], v1, s[44:47], s22 offen offset:0 nt
  buffer_load_dwordx4 v[176:179], v1, s[44:47], s22 offen offset:128 nt
  buffer_load_dwordx4 v[180:183], v1, s[44:47], s22 offen offset:256 nt
  s_add_u32 s16, s16, 3
  s_add_u32 s0, s0, L_S213-L_S210
  s_addc_u32 s1, s1, 0
  s_setpc_b64 s[28:29]
L_S213:
  s_mov_b32 s22, 51019776
  buffer_load_dwordx4 v[184:187], v1, s[44:47], s22 offen offset:0 nt
  buffer_load_dwordx4 v[188:191], v1, s[44:47], s22 offen offset:128 nt
  buffer_load_dwordx4 v[192:195], v1, s[44:47], s22 offen offset:256 nt
  s_add_u32 s16, s16, 3
  s_add_u32 s0, s0, L_S216-L_S213
  s_addc_u32 s1, s1, 0
  s_setpc_b64 s[28:29]
L_S216:
  s_mov_b32 s22, 51118080
  buffer_load_dwordx4 v[196:199], v1, s[44:47], s22 offen offset:0 nt
  buffer_load_dwordx4 v[200:203], v1, s[44:47], s22 offen offset:128 nt
  buffer_load_dwordx4 v[204:207], v1, s[44:47], s22 offen offset:256 nt
  s_add_u32 s16, s16, 3
  s_add_u32 s0, s0, L_S219-L_S216
  s_addc_u32 s1, s1, 0
  s_setpc_b64 s[28:29]
L_S219:
  s_mov_b32 s22, 51216384
  buffer_load_dwordx4 v[208:211], v1, s[44:47], s22 offen offset:0 nt
  buffer_load_dwordx4 v[212:215], v1, s[44:47], s22 offen offset:128 nt
  buffer_load_dwordx4 v[216:219], v1, s[44:47], s22 offen offset:256 nt
  s_add_u32 s16, s16, 3
  s_add_u32 s0, s0, L_S222-L_S219
  s_addc_u32 s1, s1, 0
  s_setpc_b64 s[28:29]
L_S222:
  s_mov_b32 s22, 51314688
  buffer_load_dwordx4 v[220:223], v1, s[44:47], s22 offen offset:0 nt
  buffer_load_dwordx4 v[224:227], v1, s[44:47], s22 offen offset:128 nt
  buffer_load_dwordx4 v[228:231], v1, s[44:47], s22 offen offset:256 nt
  s_add_u32 s16, s16, 3
  s_add_u32 s0, s0, L_S225-L_S222
  s_addc_u32 s1, s1, 0
  s_setpc_b64 s[28:29]
L_S225:
  s_mov_b32 s22, 51412992
  buffer_load_dwordx4 v[232:235], v1, s[44:47], s22 offen offset:0 nt
  buffer_load_dwordx4 v[236:239], v1, s[44:47], s22 offen offset:128 nt
  buffer_load_dwordx4 v[240:243], v1, s[44:47], s22 offen offset:256 nt
  s_add_u32 s16, s16, 3
  s_add_u32 s0, s0, L_S228-L_S225
  s_addc_u32 s1, s1, 0
  s_setpc_b64 s[28:29]
L_S228:
  s_mov_b32 s22, 51511296
  buffer_load_dwordx4 a[252:255], v1, s[44:47], s22 offen offset:0 nt
  s_add_u32 m0, s27, 0
  s_add_u32 s23, s22, 128
  buffer_load_dwordx4 v1, s[44:47], s23 offen nt lds
  s_add_u32 m0, s27, 4096
  s_add_u32 s23, s22, 256
  buffer_load_dwordx4 v1, s[44:47], s23 offen nt lds
  s_add_u32 s16, s16, 3
  s_add_u32 s0, s0, L_S231-L_S228
  s_addc_u32 s1, s1, 0
  s_setpc_b64 s[28:29]
L_S231:
  s_mov_b32 s22, 51609600
  s_add_u32 m0, s27, 8192
  s_add_u32 s23, s22, 0
  buffer_load_dwordx4 v1, s[44:47], s23 offen nt lds
  s_add_u32 m0, s27, 12288
  s_add_u32 s23, s22, 128
  buffer_load_dwordx4 v1, s[44:47], s23 offen nt lds
  s_add_u32 m0, s27, 16384
  s_add_u32 s23, s22, 256
  buffer_load_dwordx4 v1, s[44:47], s23 offen nt lds
  s_add_u32 s16, s16, 3
  s_add_u32 s0, s0, L_S234-L_S231
  s_addc_u32 s1, s1, 0
  s_setpc_b64 s[28:29]
L_S234:
  s_mov_b32 s22, 51707904
  s_add_u32 m0, s27, 20480
  s_add_u32 s23, s22, 0
  buffer_load_dwordx4 v1, s[44:47], s23 offen nt lds
  s_add_u32 m0, s27, 24576
  s_add_u32 s23, s22, 128
  buffer_load_dwordx4 v1, s[44:47], s23 offen nt lds
  s_add_u32 m0, s27, 28672
  s_add_u32 s23, s22, 256
  buffer_load_dwordx4 v1, s[44:47], s23 offen nt lds
  s_add_u32 s16, s16, 3
  s_add_u32 s0, s0, L_S237-L_S234
  s_addc_u32 s1, s1, 0
  s_setpc_b64 s[28:29]
L_S237:
  s_mov_b32 s22, 51806208
  buffer_load_dwordx4 v[112:115], v1, s[44:47], s22 offen offset:0 nt
  buffer_load_dwordx4 v[116:119], v1, s[44:47], s22 offen offset:128 nt
  buffer_load_dwordx4 v[120:123], v1, s[44:47], s22 offen offset:256 nt
  s_add_u32 s16, s16, 3
  s_add_u32 s0, s0, L_S240-L_S237
  s_addc_u32 s1, s1, 0
  s_setpc_b64 s[28:29]
L_S240:
  s_mov_b32 s22, 50331648
  buffer_load_dwordx4 a[156:159], v1, s[40:43], s22 offen offset:0 nt
  buffer_load_dwordx4 a[160:163], v1, s[40:43], s22 offen offset:128 nt
  buffer_load_dwordx4 a[164:167], v1, s[40:43], s22 offen offset:256 nt
  s_add_u32 s16, s16, 3
  s_add_u32 s0, s0, L_S243-L_S240
  s_addc_u32 s1, s1, 0
  s_setpc_b64 s[28:29]
L_S243:
  s_endpgm
L_consume:
  v_and_b32 v66, 7, v0
  v_lshlrev_b32 v66, 4, v66
  v_add_u32 v66, 160448, v66
  ds_read_b128 v[8:11], v66 offset:0
  ds_read_b128 v[12:15], v66 offset:128
  ds_read_b128 v[16:19], v66 offset:256
  s_waitcnt lgkmcnt(0)
  v_mfma_f32_4x4x4_16b_bf16 v[66:69], v[8:9], v[172:173], 0
  s_nop 1
  v_mfma_f32_4x4x4_16b_bf16 v[66:69], v[10:11], v[174:175], v[66:69]
  s_nop 1
  v_mfma_f32_4x4x4_16b_bf16 v[66:69], v[12:13], v[176:177], v[66:69]
  s_nop 1
  v_mfma_f32_4x4x4_16b_bf16 v[66:69], v[14:15], v[178:179], v[66:69]
  s_nop 1
  v_mfma_f32_4x4x4_16b_bf16 v[66:69], v[16:17], v[180:181], v[66:69]
  s_nop 1
  v_mfma_f32_4x4x4_16b_bf16 v[66:69], v[18:19], v[182:183], v[66:69]
  s_nop 4
  v_mov_b32_dpp v70, v66 quad_perm:[0,0,0,0] row_mask:0xf bank_mask:0xf
  s_nop 1
  v_add_f32_dpp v70, v67, v70 quad_perm:[1,1,1,1] row_mask:0xf bank_mask:0xf
  s_nop 1
  v_add_f32_dpp v70, v68, v70 quad_perm:[2,2,2,2] row_mask:0xf bank_mask:0xf
  s_nop 1
  v_add_f32_dpp v20, v69, v70 quad_perm:[3,3,3,3] row_mask:0xf bank_mask:0xf
  s_mov_b32 s20, 45
  s_add_u32 s14, s14, L_c_200001-L_consume
  s_addc_u32 s15, s15, 0
  s_setpc_b64 s[28:29]
L_c_200001:
  v_mfma_f32_4x4x4_16b_bf16 v[66:69], v[8:9], v[184:185], 0
  s_nop 1
  v_mfma_f32_4x4x4_16b_bf16 v[66:69], v[10:11], v[186:187], v[66:69]
  s_nop 1
  v_mfma_f32_4x4x4_16b_bf16 v[66:69], v[12:13], v[188:189], v[66:69]
  s_nop 1
  v_mfma_f32_4x4x4_16b_bf16 v[66:69], v[14:15], v[190:191], v[66:69]
  s_nop 1
  v_mfma_f32_4x4x4_16b_bf16 v[66:69], v[16:17], v[192:193], v[66:69]
  s_nop 1
  v_mfma_f32_4x4x4_16b_bf16 v[66:69], v[18:19], v[194:195], v[66:69]
  s_nop 4
  v_mov_b32_dpp v70, v66 quad_perm:[0,0,0,0] row_mask:0xf bank_mask:0xf
  s_nop 1
  v_add_f32_dpp v70, v67, v70 quad_perm:[1,1,1,1] row_mask:0xf bank_mask:0xf
  s_nop 1
  v_add_f32_dpp v70, v68, v70 quad_perm:[2,2,2,2] row_mask:0xf bank_mask:0xf
  s_nop 1
  v_add_f32_dpp v70, v69, v70 quad_perm:[3,3,3,3] row_mask:0xf bank_mask:0xf
  v_cndmask_b32 v20, v20, v70, s[84:85]
  s_mov_b32 s20, 48
  s_add_u32 s14, s14, L_c_200002-L_c_200001
  s_addc_u32 s15, s15, 0
  s_setpc_b64 s[28:29]
L_c_200002:
  v_mfma_f32_4x4x4_16b_bf16 v[66:69], v[8:9], v[196:197], 0
  s_nop 1
  v_mfma_f32_4x4x4_16b_bf16 v[66:69], v[10:11], v[198:199], v[66:69]
  s_nop 1
  v_mfma_f32_4x4x4_16b_bf16 v[66:69], v[12:13], v[200:201], v[66:69]
  s_nop 1
  v_mfma_f32_4x4x4_16b_bf16 v[66:69], v[14:15], v[202:203], v[66:69]
  s_nop 1
  v_mfma_f32_4x4x4_16b_bf16 v[66:69], v[16:17], v[204:205], v[66:69]
  s_nop 1
  v_mfma_f32_4x4x4_16b_bf16 v[66:69], v[18:19], v[206:207], v[66:69]
  s_nop 4
  v_mov_b32_dpp v70, v66 quad_perm:[0,0,0,0] row_mask:0xf bank_mask:0xf
  s_nop 1
  v_add_f32_dpp v70, v67, v70 quad_perm:[1,1,1,1] row_mask:0xf bank_mask:0xf
  s_nop 1
  v_add_f32_dpp v70, v68, v70 quad_perm:[2,2,2,2] row_mask:0xf bank_mask:0xf
  s_nop 1
  v_add_f32_dpp v70, v69, v70 quad_perm:[3,3,3,3] row_mask:0xf bank_mask:0xf
  v_cndmask_b32 v20, v20, v70, s[86:87]
  s_mov_b32 s20, 51
  s_add_u32 s14, s14, L_c_200003-L_c_200002
  s_addc_u32 s15, s15, 0
  s_setpc_b64 s[28:29]
L_c_200003:
  v_mfma_f32_4x4x4_16b_bf16 v[66:69], v[8:9], v[208:209], 0
  s_nop 1
  v_mfma_f32_4x4x4_16b_bf16 v[66:69], v[10:11], v[210:211], v[66:69]
  s_nop 1
  v_mfma_f32_4x4x4_16b_bf16 v[66:69], v[12:13], v[212:213], v[66:69]
  s_nop 1
  v_mfma_f32_4x4x4_16b_bf16 v[66:69], v[14:15], v[214:215], v[66:69]
  s_nop 1
  v_mfma_f32_4x4x4_16b_bf16 v[66:69], v[16:17], v[216:217], v[66:69]
  s_nop 1
  v_mfma_f32_4x4x4_16b_bf16 v[66:69], v[18:19], v[218:219], v[66:69]
  s_nop 4
  v_mov_b32_dpp v70, v66 quad_perm:[0,0,0,0] row_mask:0xf bank_mask:0xf
  s_nop 1
  v_add_f32_dpp v70, v67, v70 quad_perm:[1,1,1,1] row_mask:0xf bank_mask:0xf
  s_nop 1
  v_add_f32_dpp v70, v68, v70 quad_perm:[2,2,2,2] row_mask:0xf bank_mask:0xf
  s_nop 1
  v_add_f32_dpp v70, v69, v70 quad_perm:[3,3,3,3] row_mask:0xf bank_mask:0xf
  v_cndmask_b32 v20, v20, v70, s[88:89]
  s_nop 1
  v_add_f32_dpp v20, v20, v20 row_half_mirror row_mask:0xf bank_mask:0xf
  s_mov_b32 s20, 54
  s_add_u32 s14, s14, L_c_200004-L_c_200003
  s_addc_u32 s15, s15, 0
  s_setpc_b64 s[28:29]
L_c_200004:
  v_mfma_f32_4x4x4_16b_bf16 v[66:69], v[8:9], v[220:221], 0
  s_nop 1
  v_mfma_f32_4x4x4_16b_bf16 v[66:69], v[10:11], v[222:223], v[66:69]
  s_nop 1
  v_mfma_f32_4x4x4_16b_bf16 v[66:69], v[12:13], v[224:225], v[66:69]
  s_nop 1
  v_mfma_f32_4x4x4_16b_bf16 v[66:69], v[14:15], v[226:227], v[66:69]
  s_nop 1
  v_mfma_f32_4x4x4_16b_bf16 v[66:69], v[16:17], v[228:229], v[66:69]
  s_nop 1
  v_mfma_f32_4x4x4_16b_bf16 v[66:69], v[18:19], v[230:231], v[66:69]
  s_nop 4
  v_mov_b32_dpp v70, v66 quad_perm:[0,0,0,0] row_mask:0xf bank_mask:0xf
  s_nop 1
  v_add_f32_dpp v70, v67, v70 quad_perm:[1,1,1,1] row_mask:0xf bank_mask:0xf
  s_nop 1
  v_add_f32_dpp v70, v68, v70 quad_perm:[2,2,2,2] row_mask:0xf bank_mask:0xf
  s_nop 1
  v_add_f32_dpp v21, v69, v70 quad_perm:[3,3,3,3] row_mask:0xf bank_mask:0xf
  s_mov_b32 s20, 57
  s_add_u32 s14, s14, L_c_200005-L_c_200004
  s_addc_u32 s15, s15, 0
  s_setpc_b64 s[28:29]
L_c_200005:
  v_mfma_f32_4x4x4_16b_bf16 v[66:69], v[8:9], v[232:233], 0
  s_nop 1
  v_mfma_f32_4x4x4_16b_bf16 v[66:69], v[10:11], v[234:235], v[66:69]
  s_nop 1
  v_mfma_f32_4x4x4_16b_bf16 v[66:69], v[12:13], v[236:237], v[66:69]
  s_nop 1
  v_mfma_f32_4x4x4_16b_bf16 v[66:69], v[14:15], v[238:239], v[66:69]
  s_nop 1
  v_mfma_f32_4x4x4_16b_bf16 v[66:69], v[16:17], v[240:241], v[66:69]
  s_nop 1
  v_mfma_f32_4x4x4_16b_bf16 v[66:69], v[18:19], v[242:243], v[66:69]
  s_nop 4
  v_mov_b32_dpp v70, v66 quad_perm:[0,0,0,0] row_mask:0xf bank_mask:0xf
  s_nop 1
  v_add_f32_dpp v70, v67, v70 quad_perm:[1,1,1,1] row_mask:0xf bank_mask:0xf
  s_nop 1
  v_add_f32_dpp v70, v68, v70 quad_perm:[2,2,2,2] row_mask:0xf bank_mask:0xf
  s_nop 1
  v_add_f32_dpp v70, v69, v70 quad_perm:[3,3,3,3] row_mask:0xf bank_mask:0xf
  v_cndmask_b32 v21, v21, v70, s[84:85]
  s_mov_b32 s20, 60
  s_add_u32 s14, s14, L_c_200006-L_c_200005
  s_addc_u32 s15, s15, 0
  s_setpc_b64 s[28:29]
L_c_200006:
  v_mfma_f32_4x4x4_16b_bf16 v[66:69], v[8:9], v[244:245], 0
  s_nop 1
  v_mfma_f32_4x4x4_16b_bf16 v[66:69], v[10:11], v[246:247], v[66:69]
  s_nop 1
  v_mfma_f32_4x4x4_16b_bf16 v[66:69], v[12:13], v[248:249], v[66:69]
  s_nop 1
  v_mfma_f32_4x4x4_16b_bf16 v[66:69], v[14:15], v[250:251], v[66:69]
  s_nop 1
  v_mfma_f32_4x4x4_16b_bf16 v[66:69], v[16:17], v[252:253], v[66:69]
  s_nop 1
  v_mfma_f32_4x4x4_16b_bf16 v[66:69], v[18:19], v[254:255], v[66:69]
  s_nop 4
  v_mov_b32_dpp v70, v66 quad_perm:[0,0,0,0] row_mask:0xf bank_mask:0xf
  s_nop 1
  v_add_f32_dpp v70, v67, v70 quad_perm:[1,1,1,1] row_mask:0xf bank_mask:0xf
  s_nop 1
  v_add_f32_dpp v70, v68, v70 quad_perm:[2,2,2,2] row_mask:0xf bank_mask:0xf
  s_nop 1
  v_add_f32_dpp v70, v69, v70 quad_perm:[3,3,3,3] row_mask:0xf bank_mask:0xf
  v_cndmask_b32 v21, v21, v70, s[86:87]
  s_mov_b32 s20, 63
  s_add_u32 s14, s14, L_c_200007-L_c_200006
  s_addc_u32 s15, s15, 0
  s_setpc_b64 s[28:29]
L_c_200007:
  v_mfma_f32_4x4x4_16b_bf16 v[66:69], v[8:9], a[0:1], 0
  s_nop 1
  v_mfma_f32_4x4x4_16b_bf16 v[66:69], v[10:11], a[2:3], v[66:69]
  s_nop 1
  v_mfma_f32_4x4x4_16b_bf16 v[66:69], v[12:13], a[4:5], v[66:69]
  s_nop 1
  v_mfma_f32_4x4x4_16b_bf16 v[66:69], v[14:15], a[6:7], v[66:69]
  s_nop 1
  v_mfma_f32_4x4x4_16b_bf16 v[66:69], v[16:17], a[8:9], v[66:69]
  s_nop 1
  v_mfma_f32_4x4x4_16b_bf16 v[66:69], v[18:19], a[10:11], v[66:69]
  s_nop 4
  v_mov_b32_dpp v70, v66 quad_perm:[0,0,0,0] row_mask:0xf bank_mask:0xf
  s_nop 1
  v_add_f32_dpp v70, v67, v70 quad_perm:[1,1,1,1] row_mask:0xf bank_mask:0xf
  s_nop 1
  v_add_f32_dpp v70, v68, v70 quad_perm:[2,2,2,2] row_mask:0xf bank_mask:0xf
  s_nop 1
  v_add_f32_dpp v70, v69, v70 quad_perm:[3,3,3,3] row_mask:0xf bank_mask:0xf
  v_cndmask_b32 v21, v21, v70, s[88:89]
  s_nop 1
  v_add_f32_dpp v21, v21, v21 row_half_mirror row_mask:0xf bank_mask:0xf
  s_mov_b32 s20, 66
  s_add_u32 s14, s14, L_c_200008-L_c_200007
  s_addc_u32 s15, s15, 0
  s_setpc_b64 s[28:29]
L_c_200008:
  v_mfma_f32_4x4x4_16b_bf16 v[66:69], v[8:9], a[12:13], 0
  s_nop 1
  v_mfma_f32_4x4x4_16b_bf16 v[66:69], v[10:11], a[14:15], v[66:69]
  s_nop 1
  v_mfma_f32_4x4x4_16b_bf16 v[66:69], v[12:13], a[16:17], v[66:69]
  s_nop 1
  v_mfma_f32_4x4x4_16b_bf16 v[66:69], v[14:15], a[18:19], v[66:69]
  s_nop 1
  v_mfma_f32_4x4x4_16b_bf16 v[66:69], v[16:17], a[20:21], v[66:69]
  s_nop 1
  v_mfma_f32_4x4x4_16b_bf16 v[66:69], v[18:19], a[22:23], v[66:69]
  s_nop 4
  v_mov_b32_dpp v70, v66 quad_perm:[0,0,0,0] row_mask:0xf bank_mask:0xf
  s_nop 1
  v_add_f32_dpp v70, v67, v70 quad_perm:[1,1,1,1] row_mask:0xf bank_mask:0xf
  s_nop 1
  v_add_f32_dpp v70, v68, v70 quad_perm:[2,2,2,2] row_mask:0xf bank_mask:0xf
  s_nop 1
  v_add_f32_dpp v22, v69, v70 quad_perm:[3,3,3,3] row_mask:0xf bank_mask:0xf
  s_mov_b32 s20, 69
  s_add_u32 s14, s14, L_c_200009-L_c_200008
  s_addc_u32 s15, s15, 0
  s_setpc_b64 s[28:29]
L_c_200009:
  v_mfma_f32_4x4x4_16b_bf16 v[66:69], v[8:9], a[24:25], 0
  s_nop 1
  v_mfma_f32_4x4x4_16b_bf16 v[66:69], v[10:11], a[26:27], v[66:69]
  s_nop 1
  v_mfma_f32_4x4x4_16b_bf16 v[66:69], v[12:13], a[28:29], v[66:69]
  s_nop 1
  v_mfma_f32_4x4x4_16b_bf16 v[66:69], v[14:15], a[30:31], v[66:69]
  s_nop 1
  v_mfma_f32_4x4x4_16b_bf16 v[66:69], v[16:17], a[32:33], v[66:69]
  s_nop 1
  v_mfma_f32_4x4x4_16b_bf16 v[66:69], v[18:19], a[34:35], v[66:69]
  s_nop 4
  v_mov_b32_dpp v70, v66 quad_perm:[0,0,0,0] row_mask:0xf bank_mask:0xf
  s_nop 1
  v_add_f32_dpp v70, v67, v70 quad_perm:[1,1,1,1] row_mask:0xf bank_mask:0xf
  s_nop 1
  v_add_f32_dpp v70, v68, v70 quad_perm:[2,2,2,2] row_mask:0xf bank_mask:0xf
  s_nop 1
  v_add_f32_dpp v70, v69, v70 quad_perm:[3,3,3,3] row_mask:0xf bank_mask:0xf
  v_cndmask_b32 v22, v22, v70, s[84:85]
  s_mov_b32 s20, 72
  s_add_u32 s14, s14, L_c_200010-L_c_200009
  s_addc_u32 s15, s15, 0
  s_setpc_b64 s[28:29]
L_c_200010:
  v_mfma_f32_4x4x4_16b_bf16 v[66:69], v[8:9], a[36:37], 0
  s_nop 1
  v_mfma_f32_4x4x4_16b_bf16 v[66:69], v[10:11], a[38:39], v[66:69]
  s_nop 1
  v_mfma_f32_4x4x4_16b_bf16 v[66:69], v[12:13], a[40:41], v[66:69]
  s_nop 1
  v_mfma_f32_4x4x4_16b_bf16 v[66:69], v[14:15], a[42:43], v[66:69]
  s_nop 1
  v_mfma_f32_4x4x4_16b_bf16 v[66:69], v[16:17], a[44:45], v[66:69]
  s_nop 1
  v_mfma_f32_4x4x4_16b_bf16 v[66:69], v[18:19], a[46:47], v[66:69]
  s_nop 4
  v_mov_b32_dpp v70, v66 quad_perm:[0,0,0,0] row_mask:0xf bank_mask:0xf
  s_nop 1
  v_add_f32_dpp v70, v67, v70 quad_perm:[1,1,1,1] row_mask:0xf bank_mask:0xf
  s_nop 1
  v_add_f32_dpp v70, v68, v70 quad_perm:[2,2,2,2] row_mask:0xf bank_mask:0xf
  s_nop 1
  v_add_f32_dpp v70, v69, v70 quad_perm:[3,3,3,3] row_mask:0xf bank_mask:0xf
  v_cndmask_b32 v22, v22, v70, s[86:87]
  s_mov_b32 s20, 75
  s_add_u32 s14, s14, L_c_200011-L_c_200010
  s_addc_u32 s15, s15, 0
  s_setpc_b64 s[28:29]
L_c_200011:
  v_mfma_f32_4x4x4_16b_bf16 v[66:69], v[8:9], a[48:49], 0
  s_nop 1
  v_mfma_f32_4x4x4_16b_bf16 v[66:69], v[10:11], a[50:51], v[66:69]
  s_nop 1
  v_mfma_f32_4x4x4_16b_bf16 v[66:69], v[12:13], a[52:53], v[66:69]
  s_nop 1
  v_mfma_f32_4x4x4_16b_bf16 v[66:69], v[14:15], a[54:55], v[66:69]
  s_nop 1
  v_mfma_f32_4x4x4_16b_bf16 v[66:69], v[16:17], a[56:57], v[66:69]
  s_nop 1
  v_mfma_f32_4x4x4_16b_bf16 v[66:69], v[18:19], a[58:59], v[66:69]
  s_nop 4
  v_mov_b32_dpp v70, v66 quad_perm:[0,0,0,0] row_mask:0xf bank_mask:0xf
  s_nop 1
  v_add_f32_dpp v70, v67, v70 quad_perm:[1,1,1,1] row_mask:0xf bank_mask:0xf
  s_nop 1
  v_add_f32_dpp v70, v68, v70 quad_perm:[2,2,2,2] row_mask:0xf bank_mask:0xf
  s_nop 1
  v_add_f32_dpp v70, v69, v70 quad_perm:[3,3,3,3] row_mask:0xf bank_mask:0xf
  v_cndmask_b32 v22, v22, v70, s[88:89]
  s_nop 1
  v_add_f32_dpp v22, v22, v22 row_half_mirror row_mask:0xf bank_mask:0xf
  s_mov_b32 s20, 78
  s_add_u32 s14, s14, L_c_200012-L_c_200011
  s_addc_u32 s15, s15, 0
  s_setpc_b64 s[28:29]
L_c_200012:
  v_mfma_f32_4x4x4_16b_bf16 v[66:69], v[8:9], a[60:61], 0
  s_nop 1
  v_mfma_f32_4x4x4_16b_bf16 v[66:69], v[10:11], a[62:63], v[66:69]
  s_nop 1
  v_mfma_f32_4x4x4_16b_bf16 v[66:69], v[12:13], a[64:65], v[66:69]
  s_nop 1
  v_mfma_f32_4x4x4_16b_bf16 v[66:69], v[14:15], a[66:67], v[66:69]
  s_nop 1
  v_mfma_f32_4x4x4_16b_bf16 v[66:69], v[16:17], a[68:69], v[66:69]
  s_nop 1
  v_mfma_f32_4x4x4_16b_bf16 v[66:69], v[18:19], a[70:71], v[66:69]
  s_nop 4
  v_mov_b32_dpp v70, v66 quad_perm:[0,0,0,0] row_mask:0xf bank_mask:0xf
  s_nop 1
  v_add_f32_dpp v70, v67, v70 quad_perm:[1,1,1,1] row_mask:0xf bank_mask:0xf
  s_nop 1
  v_add_f32_dpp v70, v68, v70 quad_perm:[2,2,2,2] row_mask:0xf bank_mask:0xf
  s_nop 1
  v_add_f32_dpp v23, v69, v70 quad_perm:[3,3,3,3] row_mask:0xf bank_mask:0xf
  s_mov_b32 s20, 81
  s_add_u32 s14, s14, L_c_200013-L_c_200012
  s_addc_u32 s15, s15, 0
  s_setpc_b64 s[28:29]
L_c_200013:
  v_mfma_f32_4x4x4_16b_bf16 v[66:69], v[8:9], a[72:73], 0
  s_nop 1
  v_mfma_f32_4x4x4_16b_bf16 v[66:69], v[10:11], a[74:75], v[66:69]
  s_nop 1
  v_mfma_f32_4x4x4_16b_bf16 v[66:69], v[12:13], a[76:77], v[66:69]
  s_nop 1
  v_mfma_f32_4x4x4_16b_bf16 v[66:69], v[14:15], a[78:79], v[66:69]
  s_nop 1
  v_mfma_f32_4x4x4_16b_bf16 v[66:69], v[16:17], a[80:81], v[66:69]
  s_nop 1
  v_mfma_f32_4x4x4_16b_bf16 v[66:69], v[18:19], a[82:83], v[66:69]
  s_nop 4
  v_mov_b32_dpp v70, v66 quad_perm:[0,0,0,0] row_mask:0xf bank_mask:0xf
  s_nop 1
  v_add_f32_dpp v70, v67, v70 quad_perm:[1,1,1,1] row_mask:0xf bank_mask:0xf
  s_nop 1
  v_add_f32_dpp v70, v68, v70 quad_perm:[2,2,2,2] row_mask:0xf bank_mask:0xf
  s_nop 1
  v_add_f32_dpp v70, v69, v70 quad_perm:[3,3,3,3] row_mask:0xf bank_mask:0xf
  v_cndmask_b32 v23, v23, v70, s[84:85]
  s_mov_b32 s20, 84
  s_add_u32 s14, s14, L_c_200014-L_c_200013
  s_addc_u32 s15, s15, 0
  s_setpc_b64 s[28:29]
L_c_200014:
  v_mfma_f32_4x4x4_16b_bf16 v[66:69], v[8:9], a[84:85], 0
  s_nop 1
  v_mfma_f32_4x4x4_16b_bf16 v[66:69], v[10:11], a[86:87], v[66:69]
  s_nop 1
  v_mfma_f32_4x4x4_16b_bf16 v[66:69], v[12:13], a[88:89], v[66:69]
  s_nop 1
  v_mfma_f32_4x4x4_16b_bf16 v[66:69], v[14:15], a[90:91], v[66:69]
  s_nop 1
  v_mfma_f32_4x4x4_16b_bf16 v[66:69], v[16:17], a[92:93], v[66:69]
  s_nop 1
  v_mfma_f32_4x4x4_16b_bf16 v[66:69], v[18:19], a[94:95], v[66:69]
  s_nop 4
  v_mov_b32_dpp v70, v66 quad_perm:[0,0,0,0] row_mask:0xf bank_mask:0xf
  s_nop 1
  v_add_f32_dpp v70, v67, v70 quad_perm:[1,1,1,1] row_mask:0xf bank_mask:0xf
  s_nop 1
  v_add_f32_dpp v70, v68, v70 quad_perm:[2,2,2,2] row_mask:0xf bank_mask:0xf
  s_nop 1
  v_add_f32_dpp v70, v69, v70 quad_perm:[3,3,3,3] row_mask:0xf bank_mask:0xf
  v_cndmask_b32 v23, v23, v70, s[86:87]
  s_mov_b32 s20, 87
  s_add_u32 s14, s14, L_c_200015-L_c_200014
  s_addc_u32 s15, s15, 0
  s_setpc_b64 s[28:29]
L_c_200015:
  v_mfma_f32_4x4x4_16b_bf16 v[66:69], v[8:9], a[96:97], 0
  s_nop 1
  v_mfma_f32_4x4x4_16b_bf16 v[66:69], v[10:11], a[98:99], v[66:69]
  s_nop 1
  v_mfma_f32_4x4x4_16b_bf16 v[66:69], v[12:13], a[100:101], v[66:69]
  s_nop 1
  v_mfma_f32_4x4x4_16b_bf16 v[66:69], v[14:15], a[102:103], v[66:69]
  s_nop 1
  v_mfma_f32_4x4x4_16b_bf16 v[66:69], v[16:17], a[104:105], v[66:69]
  s_nop 1
  v_mfma_f32_4x4x4_16b_bf16 v[66:69], v[18:19], a[106:107], v[66:69]
  s_nop 4
  v_mov_b32_dpp v70, v66 quad_perm:[0,0,0,0] row_mask:0xf bank_mask:0xf
  s_nop 1
  v_add_f32_dpp v70, v67, v70 quad_perm:[1,1,1,1] row_mask:0xf bank_mask:0xf
  s_nop 1
  v_add_f32_dpp v70, v68, v70 quad_perm:[2,2,2,2] row_mask:0xf bank_mask:0xf
  s_nop 1
  v_add_f32_dpp v70, v69, v70 quad_perm:[3,3,3,3] row_mask:0xf bank_mask:0xf
  v_cndmask_b32 v23, v23, v70, s[88:89]
  s_nop 1
  v_add_f32_dpp v23, v23, v23 row_half_mirror row_mask:0xf bank_mask:0xf
  v_max3_f32 v66, v20, v21, v22
  v_max_f32 v66, v66, v23
  s_nop 1
  v_max_f32_dpp v66, v66, v66 quad_perm:[1,0,3,2] row_mask:0xf bank_mask:0xf
  s_nop 1
  v_max_f32_dpp v66, v66, v66 quad_perm:[2,3,0,1] row_mask:0xf bank_mask:0xf
  s_nop 1
  v_max_f32_dpp v66, v66, v66 row_ror:8 row_mask:0xf bank_mask:0xf
  s_nop 1
  v_max_f32_dpp v66, v66, v66 row_bcast:15 row_mask:0xa bank_mask:0xf
  s_nop 1
  v_max_f32_dpp v66, v66, v66 row_bcast:31 row_mask:0xc bank_mask:0xf
  s_nop 0
  v_readlane_b32 s93, v66, 63
  v_mov_b32 v67, s21
  s_nop 0
  v_subrev_f32 v20, s93, v20
  v_subrev_f32 v21, s93, v21
  v_subrev_f32 v22, s93, v22
  v_subrev_f32 v23, s93, v23
  v_mov_b32 v66, s93
  v_mul_f32 v20, 0x3dd53b95, v20
  v_mul_f32 v21, 0x3dd53b95, v21
  v_mul_f32 v22, 0x3dd53b95, v22
  v_mul_f32 v23, 0x3dd53b95, v23
  ds_write_b32 v67, v66 offset:32
  v_exp_f32 v20, v20
  v_exp_f32 v21, v21
  v_exp_f32 v22, v22
  v_exp_f32 v23, v23
  v_add_f32 v66, v20, v21
  v_add_f32 v68, v22, v23
  v_add_f32 v68, v68, v66
  v_cvt_pk_bf16_f32 v20, v20, v20
  v_cvt_pk_bf16_f32 v21, v21, v21
  v_cvt_pk_bf16_f32 v22, v22, v22
  v_cvt_pk_bf16_f32 v23, v23, v23
  v_add_f32_dpp v68, v68, v68 quad_perm:[1,0,3,2] row_mask:0xf bank_mask:0xf
  s_nop 1
  v_add_f32_dpp v68, v68, v68 quad_perm:[2,3,0,1] row_mask:0xf bank_mask:0xf
  s_nop 1
  v_add_f32_dpp v68, v68, v68 row_ror:8 row_mask:0xf bank_mask:0xf
  s_nop 1
  v_add_f32_dpp v68, v68, v68 row_bcast:15 row_mask:0xa bank_mask:0xf
  s_nop 1
  v_add_f32_dpp v68, v68, v68 row_bcast:31 row_mask:0xc bank_mask:0xf
  s_nop 0
  v_readlane_b32 s94, v68, 63
  s_mov_b32 s20, 90
  s_add_u32 s14, s14, L_c_200016-L_c_200015
  s_addc_u32 s15, s15, 0
  s_setpc_b64 s[28:29]
L_c_200016:
  v_and_b32_dpp v66, v20, v2 quad_perm:[0,0,0,0] row_mask:0xf bank_mask:0xf
  v_and_b32_dpp v67, v20, v3 quad_perm:[0,0,0,0] row_mask:0xf bank_mask:0xf
  v_and_b32_dpp v68, v20, v4 quad_perm:[3,3,3,3] row_mask:0xf bank_mask:0xf
  v_and_b32_dpp v69, v20, v5 quad_perm:[3,3,3,3] row_mask:0xf bank_mask:0xf
  s_nop 1
  v_mfma_f32_16x16x32_bf16 v[8:11], v[66:69], a[108:111], 0
  v_mfma_f32_16x16x32_bf16 v[12:15], v[66:69], a[112:115], 0
  v_mfma_f32_16x16x32_bf16 v[16:19], v[66:69], a[116:119], 0
  s_mov_b32 s18, 120
  s_min_u32 s17, s18, s19
  s_mov_b32 s20, 93
  s_add_u32 s14, s14, L_c_200017-L_c_200016
  s_addc_u32 s15, s15, 0
  s_setpc_b64 s[28:29]
L_c_200017:
  v_and_b32_dpp v66, v20, v2 quad_perm:[1,1,1,1] row_mask:0xf bank_mask:0xf
  v_and_b32_dpp v67, v20, v3 quad_perm:[1,1,1,1] row_mask:0xf bank_mask:0xf
  v_and_b32_dpp v68, v20, v4 quad_perm:[2,2,2,2] row_mask:0xf bank_mask:0xf
  v_and_b32_dpp v69, v20, v5 quad_perm:[2,2,2,2] row_mask:0xf bank_mask:0xf
  s_nop 1
  v_mfma_f32_16x16x32_bf16 v[8:11], v[66:69], a[120:123], v[8:11]
  v_mfma_f32_16x16x32_bf16 v[12:15], v[66:69], a[124:127], v[12:15]
  v_mfma_f32_16x16x32_bf16 v[16:19], v[66:69], a[128:131], v[16:19]
  s_mov_b32 s18, 123
  s_min_u32 s17, s18, s19
  s_mov_b32 s20, 96
  s_add_u32 s14, s14, L_c_200018-L_c_200017
  s_addc_u32 s15, s15, 0
  s_setpc_b64 s[28:29]
L_c_200018:
  v_and_b32_dpp v66, v20, v2 quad_perm:[2,2,2,2] row_mask:0xf bank_mask:0xf
  v_and_b32_dpp v67, v20, v3 quad_perm:[2,2,2,2] row_mask:0xf bank_mask:0xf
  v_and_b32_dpp v68, v20, v4 quad_perm:[1,1,1,1] row_mask:0xf bank_mask:0xf
  v_and_b32_dpp v69, v20, v5 quad_perm:[1,1,1,1] row_mask:0xf bank_mask:0xf
  s_nop 1
  v_mfma_f32_16x16x32_bf16 v[8:11], v[66:69], a[132:135], v[8:11]
  v_mfma_f32_16x16x32_bf16 v[12:15], v[66:69], a[136:139], v[12:15]
  v_mfma_f32_16x16x32_bf16 v[16:19], v[66:69], a[140:143], v[16:19]
  s_mov_b32 s18, 126
  s_min_u32 s17, s18, s19
  s_mov_b32 s20, 99
  s_add_u32 s14, s14, L_c_200019-L_c_200018
  s_addc_u32 s15, s15, 0
  s_setpc_b64 s[28:29]
L_c_200019:
  v_and_b32_dpp v66, v20, v2 quad_perm:[3,3,3,3] row_mask:0xf bank_mask:0xf
  v_and_b32_dpp v67, v20, v3 quad_perm:[3,3,3,3] row_mask:0xf bank_mask:0xf
  v_and_b32_dpp v68, v20, v4 quad_perm:[0,0,0,0] row_mask:0xf bank_mask:0xf
  v_and_b32_dpp v69, v20, v5 quad_perm:[0,0,0,0] row_mask:0xf bank_mask:0xf
  s_nop 1
  v_mfma_f32_16x16x32_bf16 v[8:11], v[66:69], a[144:147], v[8:11]
  v_mfma_f32_16x16x32_bf16 v[12:15], v[66:69], a[148:151], v[12:15]
  v_mfma_f32_16x16x32_bf16 v[16:19], v[66:69], a[152:155], v[16:19]
  s_mov_b32 s18, 129
  s_min_u32 s17, s18, s19
  s_mov_b32 s20, 102
  s_add_u32 s14, s14, L_c_200020-L_c_200019
  s_addc_u32 s15, s15, 0
  s_setpc_b64 s[28:29]
L_c_200020:
  v_and_b32_dpp v66, v21, v2 quad_perm:[0,0,0,0] row_mask:0xf bank_mask:0xf
  v_and_b32_dpp v67, v21, v3 quad_perm:[0,0,0,0] row_mask:0xf bank_mask:0xf
  v_and_b32_dpp v68, v21, v4 quad_perm:[3,3,3,3] row_mask:0xf bank_mask:0xf
  v_and_b32_dpp v69, v21, v5 quad_perm:[3,3,3,3] row_mask:0xf bank_mask:0xf
  s_nop 1
  v_mfma_f32_16x16x32_bf16 v[8:11], v[66:69], a[156:159], v[8:11]
  v_mfma_f32_16x16x32_bf16 v[12:15], v[66:69], a[160:163], v[12:15]
  v_mfma_f32_16x16x32_bf16 v[16:19], v[66:69], a[164:167], v[16:19]
  s_mov_b32 s18, 132
  s_min_u32 s17, s18, s19
  s_mov_b32 s20, 105
  s_add_u32 s14, s14, L_c_200021-L_c_200020
  s_addc_u32 s15, s15, 0
  s_setpc_b64 s[28:29]
L_c_200021:
  v_and_b32_dpp v66, v21, v2 quad_perm:[2,2,2,2] row_mask:0xf bank_mask:0xf
  v_and_b32_dpp v67, v21, v3 quad_perm:[2,2,2,2] row_mask:0xf bank_mask:0xf
  v_and_b32_dpp v68, v21, v4 quad_perm:[1,1,1,1] row_mask:0xf bank_mask:0xf
  v_and_b32_dpp v69, v21, v5 quad_perm:[1,1,1,1] row_mask:0xf bank_mask:0xf
  s_nop 1
  v_mfma_f32_16x16x32_bf16 v[8:11], v[66:69], a[168:171], v[8:11]
  v_mfma_f32_16x16x32_bf16 v[12:15], v[66:69], a[172:175], v[12:15]
  v_mfma_f32_16x16x32_bf16 v[16:19], v[66:69], a[176:179], v[16:19]
  s_mov_b32 s20, 108
  s_add_u32 s14, s14, L_c_200022-L_c_200021
  s_addc_u32 s15, s15, 0
  s_setpc_b64 s[28:29]
L_c_200022:
  v_and_b32_dpp v66, v21, v2 quad_perm:[3,3,3,3] row_mask:0xf bank_mask:0xf
  v_and_b32_dpp v67, v21, v3 quad_perm:[3,3,3,3] row_mask:0xf bank_mask:0xf
  v_and_b32_dpp v68, v21, v4 quad_perm:[0,0,0,0] row_mask:0xf bank_mask:0xf
  v_and_b32_dpp v69, v21, v5 quad_perm:[0,0,0,0] row_mask:0xf bank_mask:0xf
  s_nop 1
  v_mfma_f32_16x16x32_bf16 v[8:11], v[66:69], a[180:183], v[8:11]
  v_mfma_f32_16x16x32_bf16 v[12:15], v[66:69], a[184:187], v[12:15]
  v_mfma_f32_16x16x32_bf16 v[16:19], v[66:69], a[188:191], v[16:19]
  s_mov_b32 s20, 111
  s_add_u32 s14, s14, L_c_200023-L_c_200022
  s_addc_u32 s15, s15, 0
  s_setpc_b64 s[28:29]
L_c_200023:
  v_and_b32_dpp v66, v22, v2 quad_perm:[0,0,0,0] row_mask:0xf bank_mask:0xf
  v_and_b32_dpp v67, v22, v3 quad_perm:[0,0,0,0] row_mask:0xf bank_mask:0xf
  v_and_b32_dpp v68, v22, v4 quad_perm:[3,3,3,3] row_mask:0xf bank_mask:0xf
  v_and_b32_dpp v69, v22, v5 quad_perm:[3,3,3,3] row_mask:0xf bank_mask:0xf
  s_nop 1
  v_mfma_f32_16x16x32_bf16 v[8:11], v[66:69], a[192:195], v[8:11]
  v_mfma_f32_16x16x32_bf16 v[12:15], v[66:69], a[196:199], v[12:15]
  v_mfma_f32_16x16x32_bf16 v[16:19], v[66:69], a[200:203], v[16:19]
  s_mov_b32 s20, 114
  s_add_u32 s14, s14, L_c_200024-L_c_200023
  s_addc_u32 s15, s15, 0
  s_setpc_b64 s[28:29]
L_c_200024:
  v_and_b32_dpp v66, v22, v2 quad_perm:[1,1,1,1] row_mask:0xf bank_mask:0xf
  v_and_b32_dpp v67, v22, v3 quad_perm:[1,1,1,1] row_mask:0xf bank_mask:0xf
  v_and_b32_dpp v68, v22, v4 quad_perm:[2,2,2,2] row_mask:0xf bank_mask:0xf
  v_and_b32_dpp v69, v22, v5 quad_perm:[2,2,2,2] row_mask:0xf bank_mask:0xf
  s_nop 1
  v_mfma_f32_16x16x32_bf16 v[8:11], v[66:69], a[204:207], v[8:11]
  v_mfma_f32_16x16x32_bf16 v[12:15], v[66:69], a[208:211], v[12:15]
  v_mfma_f32_16x16x32_bf16 v[16:19], v[66:69], a[212:215], v[16:19]
  s_mov_b32 s20, 117
  s_add_u32 s14, s14, L_c_200025-L_c_200024
  s_addc_u32 s15, s15, 0
  s_setpc_b64 s[28:29]
L_c_200025:
  v_and_b32_dpp v66, v22, v2 quad_perm:[2,2,2,2] row_mask:0xf bank_mask:0xf
  v_and_b32_dpp v67, v22, v3 quad_perm:[2,2,2,2] row_mask:0xf bank_mask:0xf
  v_and_b32_dpp v68, v22, v4 quad_perm:[1,1,1,1] row_mask:0xf bank_mask:0xf
  v_and_b32_dpp v69, v22, v5 quad_perm:[1,1,1,1] row_mask:0xf bank_mask:0xf
  s_nop 1
  v_mfma_f32_16x16x32_bf16 v[8:11], v[66:69], a[216:219], v[8:11]
  v_mfma_f32_16x16x32_bf16 v[12:15], v[66:69], a[220:223], v[12:15]
  v_mfma_f32_16x16x32_bf16 v[16:19], v[66:69], a[224:227], v[16:19]
  s_mov_b32 s20, 120
  s_add_u32 s14, s14, L_c_200026-L_c_200025
  s_addc_u32 s15, s15, 0
  s_setpc_b64 s[28:29]
L_c_200026:
  v_and_b32_dpp v66, v22, v2 quad_perm:[3,3,3,3] row_mask:0xf bank_mask:0xf
  v_and_b32_dpp v67, v22, v3 quad_perm:[3,3,3,3] row_mask:0xf bank_mask:0xf
  v_and_b32_dpp v68, v22, v4 quad_perm:[0,0,0,0] row_mask:0xf bank_mask:0xf
  v_and_b32_dpp v69, v22, v5 quad_perm:[0,0,0,0] row_mask:0xf bank_mask:0xf
  s_nop 1
  v_mfma_f32_16x16x32_bf16 v[8:11], v[66:69], a[228:231], v[8:11]
  v_mfma_f32_16x16x32_bf16 v[12:15], v[66:69], a[232:235], v[12:15]
  v_mfma_f32_16x16x32_bf16 v[16:19], v[66:69], a[236:239], v[16:19]
  s_mov_b32 s20, 123
  s_add_u32 s14, s14, L_c_200027-L_c_200026
  s_addc_u32 s15, s15, 0
  s_setpc_b64 s[28:29]
L_c_200027:
  v_and_b32_dpp v66, v23, v2 quad_perm:[0,0,0,0] row_mask:0xf bank_mask:0xf
  v_and_b32_dpp v67, v23, v3 quad_perm:[0,0,0,0] row_mask:0xf bank_mask:0xf
  v_and_b32_dpp v68, v23, v4 quad_perm:[3,3,3,3] row_mask:0xf bank_mask:0xf
  v_and_b32_dpp v69, v23, v5 quad_perm:[3,3,3,3] row_mask:0xf bank_mask:0xf
  s_nop 1
  v_mfma_f32_16x16x32_bf16 v[8:11], v[66:69], a[240:243], v[8:11]
  v_mfma_f32_16x16x32_bf16 v[12:15], v[66:69], a[244:247], v[12:15]
  v_mfma_f32_16x16x32_bf16 v[16:19], v[66:69], a[248:251], v[16:19]
  s_mov_b32 s20, 126
  s_add_u32 s14, s14, L_c_200028-L_c_200027
  s_addc_u32 s15, s15, 0
  s_setpc_b64 s[28:29]
L_c_200028:
  v_and_b32_dpp v66, v23, v2 quad_perm:[1,1,1,1] row_mask:0xf bank_mask:0xf
  v_and_b32_dpp v67, v23, v3 quad_perm:[1,1,1,1] row_mask:0xf bank_mask:0xf
  v_and_b32_dpp v68, v23, v4 quad_perm:[2,2,2,2] row_mask:0xf bank_mask:0xf
  v_and_b32_dpp v69, v23, v5 quad_perm:[2,2,2,2] row_mask:0xf bank_mask:0xf
  s_nop 1
  v_mfma_f32_16x16x32_bf16 v[8:11], v[66:69], a[252:255], v[8:11]
  ds_read_b128 v[70:73], v6 offset:0
  s_waitcnt lgkmcnt(0)
  v_mfma_f32_16x16x32_bf16 v[12:15], v[66:69], v[70:73], v[12:15]
  ds_read_b128 v[70:73], v6 offset:4096
  s_waitcnt lgkmcnt(0)
  v_mfma_f32_16x16x32_bf16 v[16:19], v[66:69], v[70:73], v[16:19]
  s_mov_b32 s20, 126
  s_add_u32 s14, s14, L_c_200029-L_c_200028
  s_addc_u32 s15, s15, 0
  s_setpc_b64 s[28:29]
L_c_200029:
  s_waitcnt vmcnt(12)
  v_and_b32_dpp v66, v23, v2 quad_perm:[2,2,2,2] row_mask:0xf bank_mask:0xf
  v_and_b32_dpp v67, v23, v3 quad_perm:[2,2,2,2] row_mask:0xf bank_mask:0xf
  v_and_b32_dpp v68, v23, v4 quad_perm:[1,1,1,1] row_mask:0xf bank_mask:0xf
  v_and_b32_dpp v69, v23, v5 quad_perm:[1,1,1,1] row_mask:0xf bank_mask:0xf
  ds_read_b128 v[70:73], v6 offset:8192
  s_waitcnt lgkmcnt(0)
  v_mfma_f32_16x16x32_bf16 v[8:11], v[66:69], v[70:73], v[8:11]
  ds_read_b128 v[70:73], v6 offset:12288
  s_waitcnt lgkmcnt(0)
  v_mfma_f32_16x16x32_bf16 v[12:15], v[66:69], v[70:73], v[12:15]
  ds_read_b128 v[70:73], v6 offset:16384
  s_waitcnt lgkmcnt(0)
  v_mfma_f32_16x16x32_bf16 v[16:19], v[66:69], v[70:73], v[16:19]
  s_mov_b32 s20, 126
  s_add_u32 s14, s14, L_c_200030-L_c_200029
  s_addc_u32 s15, s15, 0
  s_setpc_b64 s[28:29]
L_c_200030:
  s_waitcnt vmcnt(9)
  v_and_b32_dpp v66, v23, v2 quad_perm:[3,3,3,3] row_mask:0xf bank_mask:0xf
  v_and_b32_dpp v67, v23, v3 quad_perm:[3,3,3,3] row_mask:0xf bank_mask:0xf
  v_and_b32_dpp v68, v23, v4 quad_perm:[0,0,0,0] row_mask:0xf bank_mask:0xf
  v_and_b32_dpp v69, v23, v5 quad_perm:[0,0,0,0] row_mask:0xf bank_mask:0xf
  ds_read_b128 v[70:73], v6 offset:20480
  s_waitcnt lgkmcnt(0)
  v_mfma_f32_16x16x32_bf16 v[8:11], v[66:69], v[70:73], v[8:11]
  ds_read_b128 v[70:73], v6 offset:24576
  s_waitcnt lgkmcnt(0)
  v_mfma_f32_16x16x32_bf16 v[12:15], v[66:69], v[70:73], v[12:15]
  ds_read_b128 v[70:73], v6 offset:28672
  s_waitcnt lgkmcnt(0)
  v_mfma_f32_16x16x32_bf16 v[16:19], v[66:69], v[70:73], v[16:19]
  s_mov_b32 s20, 126
  s_add_u32 s14, s14, L_c_200031-L_c_200030
  s_addc_u32 s15, s15, 0
  s_setpc_b64 s[28:29]
L_c_200031:
  s_waitcnt vmcnt(6)
  v_and_b32_dpp v66, v21, v2 quad_perm:[1,1,1,1] row_mask:0xf bank_mask:0xf
  v_and_b32_dpp v67, v21, v3 quad_perm:[1,1,1,1] row_mask:0xf bank_mask:0xf
  v_and_b32_dpp v68, v21, v4 quad_perm:[2,2,2,2] row_mask:0xf bank_mask:0xf
  v_and_b32_dpp v69, v21, v5 quad_perm:[2,2,2,2] row_mask:0xf bank_mask:0xf
  s_nop 1
  v_mfma_f32_16x16x32_bf16 v[8:11], v[66:69], a[108:111], v[8:11]
  v_mfma_f32_16x16x32_bf16 v[12:15], v[66:69], a[112:115], v[12:15]
  v_mfma_f32_16x16x32_bf16 v[16:19], v[66:69], a[116:119], v[16:19]
  s_mov_b32 s18, 243
  s_min_u32 s17, s18, s19
  s_mov_b32 s20, -1
  s_nop 7
  s_add_u32 s14, s14, L_c_200032-L_c_200031
  s_addc_u32 s15, s15, 0
  s_setpc_b64 s[28:29]
L_c_200032:
  v_and_b32_dpp v66, v22, v2 quad_perm:[0,0,0,0] row_mask:0xf bank_mask:0xf
  v_and_b32_dpp v67, v22, v3 quad_perm:[0,0,0,0] row_mask:0xf bank_mask:0xf
  v_and_b32_dpp v68, v22, v4 quad_perm:[3,3,3,3] row_mask:0xf bank_mask:0xf
  v_and_b32_dpp v69, v22, v5 quad_perm:[3,3,3,3] row_mask:0xf bank_mask:0xf
  s_nop 1
  v_mfma_f32_16x16x32_bf16 v[8:11], v[66:69], v[196:199], v[8:11]
  v_mfma_f32_16x16x32_bf16 v[12:15], v[66:69], v[200:203], v[12:15]
  v_mfma_f32_16x16x32_bf16 v[16:19], v[66:69], v[204:207], v[16:19]
  s_mov_b32 s20, 237
  s_add_u32 s14, s14, L_c_200033-L_c_200032
  s_addc_u32 s15, s15, 0
  s_setpc_b64 s[28:29]
L_c_200033:
  v_and_b32_dpp v66, v22, v2 quad_perm:[1,1,1,1] row_mask:0xf bank_mask:0xf
  v_and_b32_dpp v67, v22, v3 quad_perm:[1,1,1,1] row_mask:0xf bank_mask:0xf
  v_and_b32_dpp v68, v22, v4 quad_perm:[2,2,2,2] row_mask:0xf bank_mask:0xf
  v_and_b32_dpp v69, v22, v5 quad_perm:[2,2,2,2] row_mask:0xf bank_mask:0xf
  s_nop 1
  v_mfma_f32_16x16x32_bf16 v[8:11], v[66:69], v[208:211], v[8:11]
  v_mfma_f32_16x16x32_bf16 v[12:15], v[66:69], v[212:215], v[12:15]
  v_mfma_f32_16x16x32_bf16 v[16:19], v[66:69], v[216:219], v[16:19]
  s_mov_b32 s20, 240
  s_add_u32 s14, s14, L_c_200034-L_c_200033
  s_addc_u32 s15, s15, 0
  s_setpc_b64 s[28:29]
L_c_200034:
  v_and_b32_dpp v66, v22, v2 quad_perm:[2,2,2,2] row_mask:0xf bank_mask:0xf
  v_and_b32_dpp v67, v22, v3 quad_perm:[2,2,2,2] row_mask:0xf bank_mask:0xf
  v_and_b32_dpp v68, v22, v4 quad_perm:[1,1,1,1] row_mask:0xf bank_mask:0xf
  v_and_b32_dpp v69, v22, v5 quad_perm:[1,1,1,1] row_mask:0xf bank_mask:0xf
  s_nop 1
  v_mfma_f32_16x16x32_bf16 v[8:11], v[66:69], v[220:223], v[8:11]
  v_mfma_f32_16x16x32_bf16 v[12:15], v[66:69], v[224:227], v[12:15]
  v_mfma_f32_16x16x32_bf16 v[16:19], v[66:69], v[228:231], v[16:19]
  s_mov_b32 s20, 240
  s_add_u32 s14, s14, L_c_200035-L_c_200034
  s_addc_u32 s15, s15, 0
  s_setpc_b64 s[28:29]
L_c_200035:
  s_waitcnt vmcnt(12)
  v_and_b32_dpp v66, v22, v2 quad_perm:[3,3,3,3] row_mask:0xf bank_mask:0xf
  v_and_b32_dpp v67, v22, v3 quad_perm:[3,3,3,3] row_mask:0xf bank_mask:0xf
  v_and_b32_dpp v68, v22, v4 quad_perm:[0,0,0,0] row_mask:0xf bank_mask:0xf
  v_and_b32_dpp v69, v22, v5 quad_perm:[0,0,0,0] row_mask:0xf bank_mask:0xf
  s_nop 1
  v_mfma_f32_16x16x32_bf16 v[8:11], v[66:69], v[232:235], v[8:11]
  v_mfma_f32_16x16x32_bf16 v[12:15], v[66:69], v[236:239], v[12:15]
  v_mfma_f32_16x16x32_bf16 v[16:19], v[66:69], v[240:243], v[16:19]
  s_mov_b32 s20, 240
  s_add_u32 s14, s14, L_c_200036-L_c_200035
  s_addc_u32 s15, s15, 0
  s_setpc_b64 s[28:29]
L_c_200036:
  s_waitcnt vmcnt(9)
  v_and_b32_dpp v66, v23, v2 quad_perm:[0,0,0,0] row_mask:0xf bank_mask:0xf
  v_and_b32_dpp v67, v23, v3 quad_perm:[0,0,0,0] row_mask:0xf bank_mask:0xf
  v_and_b32_dpp v68, v23, v4 quad_perm:[3,3,3,3] row_mask:0xf bank_mask:0xf
  v_and_b32_dpp v69, v23, v5 quad_perm:[3,3,3,3] row_mask:0xf bank_mask:0xf
  s_nop 1
  v_mfma_f32_16x16x32_bf16 v[8:11], v[66:69], a[252:255], v[8:11]
  ds_read_b128 v[70:73], v6 offset:0
  s_waitcnt lgkmcnt(0)
  v_mfma_f32_16x16x32_bf16 v[12:15], v[66:69], v[70:73], v[12:15]
  ds_read_b128 v[70:73], v6 offset:4096
  s_waitcnt lgkmcnt(0)
  v_mfma_f32_16x16x32_bf16 v[16:19], v[66:69], v[70:73], v[16:19]
  s_mov_b32 s20, 240
  s_add_u32 s14, s14, L_c_200037-L_c_200036
  s_addc_u32 s15, s15, 0
  s_setpc_b64 s[28:29]
L_c_200037:
  s_waitcnt vmcnt(6)
  v_and_b32_dpp v66, v23, v2 quad_perm:[1,1,1,1] row_mask:0xf bank_mask:0xf
  v_and_b32_dpp v67, v23, v3 quad_perm:[1,1,1,1] row_mask:0xf bank_mask:0xf
  v_and_b32_dpp v68, v23, v4 quad_perm:[2,2,2,2] row_mask:0xf bank_mask:0xf
  v_and_b32_dpp v69, v23, v5 quad_perm:[2,2,2,2] row_mask:0xf bank_mask:0xf
  ds_read_b128 v[70:73], v6 offset:8192
  s_waitcnt lgkmcnt(0)
  v_mfma_f32_16x16x32_bf16 v[8:11], v[66:69], v[70:73], v[8:11]
  ds_read_b128 v[70:73], v6 offset:12288
  s_waitcnt lgkmcnt(0)
  v_mfma_f32_16x16x32_bf16 v[12:15], v[66:69], v[70:73], v[12:15]
  ds_read_b128 v[70:73], v6 offset:16384
  s_waitcnt lgkmcnt(0)
  v_mfma_f32_16x16x32_bf16 v[16:19], v[66:69], v[70:73], v[16:19]
  s_mov_b32 s20, 240
  s_add_u32 s14, s14, L_c_200038-L_c_200037
  s_addc_u32 s15, s15, 0
  s_setpc_b64 s[28:29]
L_c_200038:
  s_waitcnt vmcnt(3)
  v_and_b32_dpp v66, v23, v2 quad_perm:[2,2,2,2] row_mask:0xf bank_mask:0xf
  v_and_b32_dpp v67, v23, v3 quad_perm:[2,2,2,2] row_mask:0xf bank_mask:0xf
  v_and_b32_dpp v68, v23, v4 quad_perm:[1,1,1,1] row_mask:0xf bank_mask:0xf
  v_and_b32_dpp v69, v23, v5 quad_perm:[1,1,1,1] row_mask:0xf bank_mask:0xf
  ds_read_b128 v[70:73], v6 offset:20480
  s_waitcnt lgkmcnt(0)
  v_mfma_f32_16x16x32_bf16 v[8:11], v[66:69], v[70:73], v[8:11]
  ds_read_b128 v[70:73], v6 offset:24576
  s_waitcnt lgkmcnt(0)
  v_mfma_f32_16x16x32_bf16 v[12:15], v[66:69], v[70:73], v[12:15]
  ds_read_b128 v[70:73], v6 offset:28672
  s_waitcnt lgkmcnt(0)
  v_mfma_f32_16x16x32_bf16 v[16:19], v[66:69], v[70:73], v[16:19]
  s_mov_b32 s20, 240
  s_add_u32 s14, s14, L_c_200039-L_c_200038
  s_addc_u32 s15, s15, 0
  s_setpc_b64 s[28:29]
L_c_200039:
  s_waitcnt vmcnt(0)
  v_and_b32_dpp v66, v23, v2 quad_perm:[3,3,3,3] row_mask:0xf bank_mask:0xf
  v_and_b32_dpp v67, v23, v3 quad_perm:[3,3,3,3] row_mask:0xf bank_mask:0xf
  v_and_b32_dpp v68, v23, v4 quad_perm:[0,0,0,0] row_mask:0xf bank_mask:0xf
  v_and_b32_dpp v69, v23, v5 quad_perm:[0,0,0,0] row_mask:0xf bank_mask:0xf
  s_nop 1
  v_mfma_f32_16x16x32_bf16 v[8:11], v[66:69], v[112:115], v[8:11]
  v_mfma_f32_16x16x32_bf16 v[12:15], v[66:69], v[116:119], v[12:15]
  v_mfma_f32_16x16x32_bf16 v[16:19], v[66:69], v[120:123], v[16:19]
  s_mov_b32 s20, -1
  s_nop 7
  s_add_u32 s14, s14, L_c_200040-L_c_200039
  s_addc_u32 s15, s15, 0
  s_setpc_b64 s[28:29]
L_c_200040:
  s_endpgm
L_cold:
L_apart:
  v_bfe_u32 v72, v0, 2, 3
  v_lshrrev_b32 v71, 5, v0
  v_mul_u32_u24 v71, 3072, v71
  v_lshl_add_u32 v71, v72, 7, v71
  v_and_b32 v73, 3, v0
  v_lshl_add_u32 v71, v73, 3, v71
  v_lshrrev_b32 v72, 1, v72
  s_mul_i32 s91, s3, 3
  s_add_u32 s91, s91, 0
  s_and_b32 s92, s91, 3
  s_lshr_b32 s91, s91, 2
  v_xor_b32 v73, s92, v72
  s_lshl_b32 s91, s91, 10
  s_add_u32 s91, s91, 32768
  v_lshl_add_u32 v73, v73, 5, v71
  v_add_u32 v42, s91, v73
  ds_read_b64_tr_b16 v[44:45], v42 offset:0
  ds_read_b64_tr_b16 v[46:47], v42 offset:6144
  ds_read_b64_tr_b16 v[48:49], v42 offset:12288
  ds_read_b64_tr_b16 v[50:51], v42 offset:18432
  ds_read_b64_tr_b16 v[52:53], v42 offset:24576
  s_mul_i32 s91, s3, 3
  s_add_u32 s91, s91, 1
  s_and_b32 s92, s91, 3
  s_lshr_b32 s91, s91, 2
  v_xor_b32 v73, s92, v72
  s_lshl_b32 s91, s91, 10
  s_add_u32 s91, s91, 32768
  v_lshl_add_u32 v73, v73, 5, v71
  v_add_u32 v43, s91, v73
  ds_read_b64_tr_b16 v[54:55], v43 offset:0
  ds_read_b64_tr_b16 v[56:57], v43 offset:6144
  ds_read_b64_tr_b16 v[58:59], v43 offset:12288
  ds_read_b64_tr_b16 v[60:61], v43 offset:18432
  ds_read_b64_tr_b16 v[62:63], v43 offset:24576
  s_mul_i32 s91, s3, 3
  s_add_u32 s91, s91, 2
  s_and_b32 s92, s91, 3
  s_lshr_b32 s91, s91, 2
  v_xor_b32 v73, s92, v72
  s_lshl_b32 s91, s91, 10
  s_add_u32 s91, s91, 32768
  v_lshl_add_u32 v73, v73, 5, v71
  v_add_u32 v42, s91, v73
  ds_read_b64_tr_b16 v[64:65], v42 offset:0
  ds_read_b64_tr_b16 v[66:67], v42 offset:6144
  ds_read_b64_tr_b16 v[68:69], v42 offset:12288
  ds_read_b64_tr_b16 v[70:71], v42 offset:18432
  ds_read_b64_tr_b16 v[72:73], v42 offset:24576
  v_mov_b32 v75, 160128
  v_mov_b32 v32, 161216
  s_mov_b32 vcc_lo, 0x00f000f0
  s_mov_b32 vcc_hi, 0x00f000f0
  v_cndmask_b32 v75, v75, v32, vcc
  v_lshrrev_b32 v32, 4, v0
  v_lshl_add_u32 v75, v32, 3, v75
  ds_read2_b64 v[34:37], v75 offset0:0 offset1:4
  ds_read2_b64 v[38:41], v75 offset0:8 offset1:12
  ds_read_b64 v[42:43], v75 offset:128
  s_add_u32 s73, s72, 0
  s_add_u32 s76, s80, 0
  s_mul_i32 s91, s31, 240
  s_sub_u32 s91, 2048, s91
  v_lshlrev_b32 v74, 4, v0
  v_add_u32 v32, 3840, v74
  s_nop 1
  v_mov_b32_dpp v74, v32 quad_perm:[0,1,2,3] row_mask:0x2 bank_mask:0xf
  v_writelane_b32 v74, s91, 32
  s_waitcnt lgkmcnt(0)
  v_mfma_f32_16x16x32_bf16 v[26:29], v[34:37], v[44:47], 0
  v_mfma_f32_16x16x32_bf16 v[30:33], v[34:37], v[54:57], 0
  v_mfma_f32_16x16x32_bf16 v[26:29], v[38:41], v[48:51], v[26:29]
  v_mfma_f32_16x16x32_bf16 v[30:33], v[38:41], v[58:61], v[30:33]
  v_mfma_f32_16x16x16_bf16 v[26:29], v[42:43], v[52:53], v[26:29]
  v_mfma_f32_16x16x16_bf16 v[30:33], v[42:43], v[62:63], v[30:33]
  v_mfma_f32_16x16x32_bf16 v[48:51], v[34:37], v[34:37], 0
  v_mfma_f32_16x16x32_bf16 v[44:47], v[34:37], v[64:67], 0
  v_mfma_f32_16x16x32_bf16 v[48:51], v[38:41], v[38:41], v[48:51]
  v_mfma_f32_16x16x32_bf16 v[44:47], v[38:41], v[68:71], v[44:47]
  v_mfma_f32_16x16x16_bf16 v[48:51], v[42:43], v[42:43], v[48:51]
  v_mfma_f32_16x16x16_bf16 v[44:47], v[42:43], v[72:73], v[44:47]
  s_cmp_lt_u32 s16, s17
  s_cbranch_scc0 L_tg_50001
  s_swappc_b64 s[28:29], s[0:1]
L_tb_50002:
  v_mov_b32 v29, s73
  v_mov_b32 v27, v30
  s_nop 2
  v_mov_b32 v28, v44
  v_mov_b32_dpp v26, v48 quad_perm:[0,1,2,3] row_mask:0x4 bank_mask:0xf
  v_mov_b32_dpp v27, v48 row_ror:12 row_mask:0x4 bank_mask:0xf
  s_mov_b32 exec_lo, -1
  s_mov_b32 exec_hi, 1
  buffer_store_dwordx4 v[26:29], v74, s[64:67], s76 offen sc1
  s_mov_b64 exec, -1
  v_mul_u32_u24 v71, 26, v0
  v_lshrrev_b32 v71, 8, v71
  v_mul_u32_u24 v71, 1120, v71
  v_lshl_add_u32 v71, v0, 4, v71
  s_mul_i32 s76, s3, 7680
  s_mul_i32 s91, s3, 960
  s_mov_b32 exec_hi, 0xfffffff
  s_waitcnt vmcnt(10)
  s_add_u32 m0, s91, 94208
  s_nop 0
  buffer_load_dwordx4 v71, s[56:59], s76 offen nt lds
  s_waitcnt vmcnt(10)
  s_add_u32 m0, s91, 98048
  s_add_u32 s76, s76, 30720
  buffer_load_dwordx4 v71, s[56:59], s76 offen nt lds
  s_waitcnt vmcnt(10)
  s_add_u32 m0, s91, 101888
  s_add_u32 s76, s76, 30720
  buffer_load_dwordx4 v71, s[56:59], s76 offen nt lds
  s_waitcnt vmcnt(10)
  s_add_u32 m0, s91, 105728
  s_add_u32 s76, s76, 30720
  buffer_load_dwordx4 v71, s[56:59], s76 offen nt lds
  s_waitcnt vmcnt(10)
  s_add_u32 m0, s91, 109568
  s_add_u32 s76, s76, 30720
  buffer_load_dwordx4 v71, s[56:59], s76 offen nt lds
  s_waitcnt vmcnt(10)
  s_add_u32 m0, s91, 113408
  s_add_u32 s76, s76, 30720
  buffer_load_dwordx4 v71, s[56:59], s76 offen nt lds
  s_waitcnt vmcnt(10)
  s_add_u32 m0, s91, 117248
  s_add_u32 s76, s76, 30720
  buffer_load_dwordx4 v71, s[56:59], s76 offen nt lds
  s_waitcnt vmcnt(10)
  s_add_u32 m0, s91, 121088
  s_add_u32 s76, s76, 30720
  buffer_load_dwordx4 v71, s[56:59], s76 offen nt lds
  s_mov_b64 exec, -1
  s_cmp_lt_u32 s16, s17
  s_cbranch_scc0 L_tg_50003
  s_waitcnt vmcnt(10)
  s_swappc_b64 s[28:29], s[0:1]
L_tb_50004:
  s_mov_b32 s77, 0
  s_add_u32 s73, s72, 0
  v_and_b32 v59, 7, v0
  s_add_u32 s91, s27, 2048
  v_lshl_add_u32 v59, v59, 4, s91
  s_add_u32 s97, s81, 0
  s_add_u32 s100, s97, 4096
  buffer_load_dwordx4 v[34:37], v59, s[64:67], s97 offen sc1
  buffer_load_dwordx4 v[26:29], v6, s[64:67], s97 offen offset:0 sc1
  buffer_load_dwordx4 v[30:33], v6, s[64:67], s97 offen offset:1024 sc1
  buffer_load_dwordx4 v[38:41], v6, s[64:67], s100 offen offset:0 sc1
  buffer_load_dwordx4 v[42:45], v6, s[64:67], s100 offen offset:1024 sc1
  s_cmp_lt_u32 s16, s17
  s_cbranch_scc0 L_tg_50005
  s_waitcnt vmcnt(14)
  s_swappc_b64 s[28:29], s[0:1]
L_tb_50006:
  s_cmp_lt_u32 s16, s17
  s_cbranch_scc0 L_tg_50007
  s_waitcnt vmcnt(14)
  s_swappc_b64 s[28:29], s[0:1]
L_tb_50008:
  v_and_b32 v58, 15, v0
  v_bfe_u32 v60, v0, 4, 1
  v_lshl_add_u32 v58, v60, 5, v58
  v_lshrrev_b32 v60, 5, v0
  v_lshl_add_u32 v58, v60, 4, v58
  s_mul_i32 s91, s3, 96
  s_add_u32 s91, s91, 160448
  v_lshl_add_u32 v58, v58, 1, s91
  v_lshrrev_b32 v61, 2, v6
  v_add_u32 v61, 161504, v61
  s_cmp_lg_u32 s77, 0
  s_cbranch_scc1 L_wz_50009
  s_waitcnt vmcnt(6)
L_wb_50010:
L_chk_50011:
  v_bitop3_b32 v75, v37, v29, s73 bitop3:0x7e
  v_bitop3_b32 v75, v75, v33, s73 bitop3:0xf6
  v_bitop3_b32 v75, v75, v41, s73 bitop3:0xf6
  v_bitop3_b32 v75, v75, v45, s73 bitop3:0xf6
  v_cmp_ne_u32 vcc, 0, v75
  s_nop 0
  s_cbranch_vccnz L_retry_50012
  v_pk_add_f32 v[26:27], v[26:27], v[30:31]
  v_add_f32 v28, v28, v32
  v_mov_b32 v29, v28
  v_add_f32_dpp v34, v34, v34 quad_perm:[1,0,3,2] row_mask:0xf bank_mask:0xf
  v_add_f32_dpp v35, v35, v35 quad_perm:[1,0,3,2] row_mask:0xf bank_mask:0xf
  v_permlane32_swap_b32 v26, v27
  v_permlane32_swap_b32 v28, v29
  v_add_f32_dpp v34, v34, v34 quad_perm:[2,3,0,1] row_mask:0xf bank_mask:0xf
  v_add_f32_dpp v35, v35, v35 quad_perm:[2,3,0,1] row_mask:0xf bank_mask:0xf
  v_add_f32 v26, v26, v27
  v_add_f32 v28, v28, v29
  v_add_f32_dpp v34, v34, v34 row_half_mirror row_mask:0xf bank_mask:0xf
  v_add_f32_dpp v35, v35, v35 row_half_mirror row_mask:0xf bank_mask:0xf
  v_permlane16_swap_b32 v26, v28
  v_mul_f32 v35, 0x3acccccd, v35
  v_mul_f32 v34, 0x3acccccd, v34
  v_add_f32 v62, v26, v28
  v_fma_f32 v34, -v35, v35, v34
  v_max_f32 v34, 0, v34
  v_add_f32 v34, 0x3727c5ac, v34
  v_rsq_f32 v34, v34
  v_pk_add_f32 v[38:39], v[38:39], v[42:43]
  v_add_f32 v40, v40, v44
  v_mov_b32 v41, v40
  v_permlane32_swap_b32 v38, v39
  s_nop 0
  v_permlane32_swap_b32 v40, v41
  v_add_f32 v38, v38, v39
  v_add_f32 v40, v40, v41
  s_nop 1
  v_permlane16_swap_b32 v38, v40
  v_add_f32 v60, v38, v40
  ds_write_b32 v61, v60
  v_fma_f32 v62, -v35, v60, v62
  s_mov_b32 exec_hi, 0xffff
  v_mul_f32 v62, v62, v34
  v_cvt_pk_bf16_f32 v62, v62, v62
  ds_write_b16 v58, v62
  s_mov_b64 exec, -1
  s_waitcnt lgkmcnt(0)
  s_barrier
L_nw_50019:
  s_cmp_ge_u32 s16, 30
  s_cbranch_scc1 L_nx_50020
  s_cmp_lt_u32 s16, s17
  s_cbranch_scc0 L_nd_50021
  s_waitcnt vmcnt(9)
  s_swappc_b64 s[28:29], s[0:1]
  s_branch L_nw_50019
L_nx_50020:
  s_waitcnt vmcnt(6)
L_nq_50022:
  v_and_b32 v66, 7, v0
  v_lshlrev_b32 v66, 4, v66
  v_add_u32 v66, 160448, v66
  ds_read_b128 v[26:29], v66 offset:0
  ds_read_b128 v[30:33], v66 offset:128
  ds_read_b128 v[34:37], v66 offset:256
  s_waitcnt lgkmcnt(0)
.balignl 8, 0xBF800000
  v_mfma_f32_4x4x4_16b_bf16 v[44:47], v[26:27], v[76:77], 0
  v_mfma_f32_4x4x4_16b_bf16 v[48:51], v[26:27], v[88:89], 0
  v_nop_e64
  v_mfma_f32_4x4x4_16b_bf16 v[44:47], v[28:29], v[78:79], v[44:47]
  v_mfma_f32_4x4x4_16b_bf16 v[48:51], v[28:29], v[90:91], v[48:51]
  v_nop_e64
  v_mfma_f32_4x4x4_16b_bf16 v[44:47], v[30:31], v[80:81], v[44:47]
  v_mfma_f32_4x4x4_16b_bf16 v[48:51], v[30:31], v[92:93], v[48:51]
  v_nop_e64
  v_mfma_f32_4x4x4_16b_bf16 v[44:47], v[32:33], v[82:83], v[44:47]
  v_mfma_f32_4x4x4_16b_bf16 v[48:51], v[32:33], v[94:95], v[48:51]
  v_nop_e64
  v_mfma_f32_4x4x4_16b_bf16 v[44:47], v[34:35], v[84:85], v[44:47]
  v_mfma_f32_4x4x4_16b_bf16 v[48:51], v[34:35], v[96:97], v[48:51]
  v_nop_e64
  v_mfma_f32_4x4x4_16b_bf16 v[44:47], v[36:37], v[86:87], v[44:47]
  v_mfma_f32_4x4x4_16b_bf16 v[48:51], v[36:37], v[98:99], v[48:51]
  v_mfma_f32_4x4x4_16b_bf16 v[52:55], v[26:27], v[100:101], 0
  v_mfma_f32_4x4x4_16b_bf16 v[56:59], v[26:27], v[112:113], 0
  v_nop_e64
  v_mfma_f32_4x4x4_16b_bf16 v[52:55], v[28:29], v[102:103], v[52:55]
  v_mov_b32_dpp v60, v44 quad_perm:[0,0,0,0] row_mask:0xf bank_mask:0xf
  v_mfma_f32_4x4x4_16b_bf16 v[56:59], v[28:29], v[114:115], v[56:59]
  v_mov_b32_dpp v61, v48 quad_perm:[0,0,0,0] row_mask:0xf bank_mask:0xf
  v_mfma_f32_4x4x4_16b_bf16 v[52:55], v[30:31], v[104:105], v[52:55]
  v_add_f32_dpp v60, v45, v60 quad_perm:[1,1,1,1] row_mask:0xf bank_mask:0xf
  v_mfma_f32_4x4x4_16b_bf16 v[56:59], v[30:31], v[116:117], v[56:59]
  v_add_f32_dpp v61, v49, v61 quad_perm:[1,1,1,1] row_mask:0xf bank_mask:0xf
  v_mfma_f32_4x4x4_16b_bf16 v[52:55], v[32:33], v[106:107], v[52:55]
  v_add_f32_dpp v60, v46, v60 quad_perm:[2,2,2,2] row_mask:0xf bank_mask:0xf
  v_mfma_f32_4x4x4_16b_bf16 v[56:59], v[32:33], v[118:119], v[56:59]
  v_add_f32_dpp v61, v50, v61 quad_perm:[2,2,2,2] row_mask:0xf bank_mask:0xf
  v_mfma_f32_4x4x4_16b_bf16 v[52:55], v[34:35], v[108:109], v[52:55]
  v_add_f32_dpp v38, v47, v60 quad_perm:[3,3,3,3] row_mask:0xf bank_mask:0xf
  v_mfma_f32_4x4x4_16b_bf16 v[56:59], v[34:35], v[120:121], v[56:59]
  v_add_f32_dpp v61, v51, v61 quad_perm:[3,3,3,3] row_mask:0xf bank_mask:0xf
  v_mfma_f32_4x4x4_16b_bf16 v[52:55], v[36:37], v[110:111], v[52:55]
  v_mfma_f32_4x4x4_16b_bf16 v[56:59], v[36:37], v[122:123], v[56:59]
  v_cndmask_b32 v38, v38, v61, s[84:85]
  s_nop 0
  s_nop 1
  v_mov_b32_dpp v62, v52 quad_perm:[0,0,0,0] row_mask:0xf bank_mask:0xf
  v_mov_b32_dpp v63, v56 quad_perm:[0,0,0,0] row_mask:0xf bank_mask:0xf
  v_nop_e64
  v_add_f32_dpp v62, v53, v62 quad_perm:[1,1,1,1] row_mask:0xf bank_mask:0xf
  v_add_f32_dpp v63, v57, v63 quad_perm:[1,1,1,1] row_mask:0xf bank_mask:0xf
  v_nop_e64
  v_add_f32_dpp v62, v54, v62 quad_perm:[2,2,2,2] row_mask:0xf bank_mask:0xf
  v_add_f32_dpp v63, v58, v63 quad_perm:[2,2,2,2] row_mask:0xf bank_mask:0xf
  v_nop_e64
  v_add_f32_dpp v62, v55, v62 quad_perm:[3,3,3,3] row_mask:0xf bank_mask:0xf
  v_add_f32_dpp v63, v59, v63 quad_perm:[3,3,3,3] row_mask:0xf bank_mask:0xf
  v_cndmask_b32 v38, v38, v62, s[86:87]
  v_cndmask_b32 v38, v38, v63, s[88:89]
  s_nop 0
  s_nop 0
  v_add_f32_dpp v38, v38, v38 row_half_mirror row_mask:0xf bank_mask:0xf
  s_nop 1
  v_max_f32_dpp v66, v38, v38 quad_perm:[1,0,3,2] row_mask:0xf bank_mask:0xf
  s_nop 1
  v_max_f32_dpp v66, v66, v66 quad_perm:[2,3,0,1] row_mask:0xf bank_mask:0xf
  s_nop 1
  v_max_f32_dpp v66, v66, v66 row_ror:8 row_mask:0xf bank_mask:0xf
  s_nop 1
  v_max_f32_dpp v66, v66, v66 row_bcast:15 row_mask:0xa bank_mask:0xf
  s_nop 1
  v_max_f32_dpp v66, v66, v66 row_bcast:31 row_mask:0xc bank_mask:0xf
  s_nop 0
  v_readlane_b32 s95, v66, 63
  v_mov_b32 v67, s21
  s_nop 0
  v_subrev_f32 v38, s95, v38
  v_mov_b32 v66, s95
  v_mul_f32 v38, 0x3dd53b95, v38
  ds_write_b32 v67, v66 offset:0
  v_exp_f32 v38, v38
  s_nop 1
  v_add_f32_dpp v68, v38, v38 quad_perm:[1,0,3,2] row_mask:0xf bank_mask:0xf
  v_cvt_pk_bf16_f32 v38, v38, v38
.balignl 8, 0xBF800000
  s_nop 0
  s_nop 0
  v_and_b32_dpp v46, v38, v2 quad_perm:[0,0,0,0] row_mask:0xf bank_mask:0xf
  v_and_b32_dpp v47, v38, v3 quad_perm:[0,0,0,0] row_mask:0xf bank_mask:0xf
  v_and_b32_dpp v48, v38, v4 quad_perm:[3,3,3,3] row_mask:0xf bank_mask:0xf
  v_and_b32_dpp v49, v38, v5 quad_perm:[3,3,3,3] row_mask:0xf bank_mask:0xf
  s_cmp_lt_u32 s16, s17
  s_cbranch_scc0 L_tg_50023
  s_waitcnt vmcnt(9)
  s_swappc_b64 s[28:29], s[0:1]
L_tb_50024:
.balignl 8, 0xBF800000
  v_mfma_f32_16x16x32_bf16 v[26:29], v[46:49], v[124:127], 0
  v_and_b32_dpp v50, v38, v2 quad_perm:[1,1,1,1] row_mask:0xf bank_mask:0xf
  v_and_b32_dpp v51, v38, v3 quad_perm:[1,1,1,1] row_mask:0xf bank_mask:0xf
  v_mfma_f32_16x16x32_bf16 v[30:33], v[46:49], v[128:131], 0
  v_and_b32_dpp v52, v38, v4 quad_perm:[2,2,2,2] row_mask:0xf bank_mask:0xf
  v_and_b32_dpp v53, v38, v5 quad_perm:[2,2,2,2] row_mask:0xf bank_mask:0xf
  v_mfma_f32_16x16x32_bf16 v[34:37], v[46:49], v[132:135], 0
  v_add_f32_dpp v68, v68, v68 quad_perm:[2,3,0,1] row_mask:0xf bank_mask:0xf
  v_mfma_f32_16x16x32_bf16 v[26:29], v[50:53], v[136:139], v[26:29]
  v_and_b32_dpp v46, v38, v2 quad_perm:[2,2,2,2] row_mask:0xf bank_mask:0xf
  v_and_b32_dpp v47, v38, v3 quad_perm:[2,2,2,2] row_mask:0xf bank_mask:0xf
  v_mfma_f32_16x16x32_bf16 v[30:33], v[50:53], v[140:143], v[30:33]
  v_and_b32_dpp v48, v38, v4 quad_perm:[1,1,1,1] row_mask:0xf bank_mask:0xf
  v_and_b32_dpp v49, v38, v5 quad_perm:[1,1,1,1] row_mask:0xf bank_mask:0xf
  v_mfma_f32_16x16x32_bf16 v[34:37], v[50:53], v[144:147], v[34:37]
  v_add_f32_dpp v68, v68, v68 row_ror:8 row_mask:0xf bank_mask:0xf
  v_mfma_f32_16x16x32_bf16 v[26:29], v[46:49], v[148:151], v[26:29]
  v_and_b32_dpp v50, v38, v2 quad_perm:[3,3,3,3] row_mask:0xf bank_mask:0xf
  v_and_b32_dpp v51, v38, v3 quad_perm:[3,3,3,3] row_mask:0xf bank_mask:0xf
  v_mfma_f32_16x16x32_bf16 v[30:33], v[46:49], v[152:155], v[30:33]
  v_and_b32_dpp v52, v38, v4 quad_perm:[0,0,0,0] row_mask:0xf bank_mask:0xf
  v_and_b32_dpp v53, v38, v5 quad_perm:[0,0,0,0] row_mask:0xf bank_mask:0xf
  v_mfma_f32_16x16x32_bf16 v[34:37], v[46:49], v[156:159], v[34:37]
  v_add_f32_dpp v68, v68, v68 row_bcast:15 row_mask:0xa bank_mask:0xf
  v_mfma_f32_16x16x32_bf16 v[26:29], v[50:53], v[160:163], v[26:29]
  v_mfma_f32_16x16x32_bf16 v[30:33], v[50:53], v[164:167], v[30:33]
  v_mfma_f32_16x16x32_bf16 v[34:37], v[50:53], v[168:171], v[34:37]
  v_add_f32_dpp v68, v68, v68 row_bcast:31 row_mask:0xc bank_mask:0xf
  s_nop 0
  v_readlane_b32 s96, v68, 63
  v_lshrrev_b32 v60, 4, v0
  v_and_b32 v59, 15, v0
  v_lshlrev_b32 v58, 10, v60
  v_lshl_add_u32 v58, v59, 4, v58
  s_lshl_b32 s91, s3, 8
  s_add_u32 s91, s91, 155648
  v_add_u32 v58, s91, v58
  v_add_u32 v59, 155648, v6
  v_mov_b32 v49, s96
  v_permlane32_swap_b32 v26, v27
  v_permlane32_swap_b32 v28, v29
  v_permlane32_swap_b32 v30, v31
  v_permlane32_swap_b32 v32, v33
  v_permlane32_swap_b32 v34, v35
  v_permlane32_swap_b32 v36, v37
  v_add_f32_dpp v46, v27, v26 row_ror:8 row_mask:0xf bank_mask:0x3
  v_add_f32_dpp v47, v31, v30 row_ror:8 row_mask:0xf bank_mask:0x3
  v_add_f32_dpp v48, v35, v34 row_ror:8 row_mask:0xf bank_mask:0x3
  v_add_f32_dpp v46, v28, v29 row_ror:8 row_mask:0xf bank_mask:0xc
  v_add_f32_dpp v47, v32, v33 row_ror:8 row_mask:0xf bank_mask:0xc
  v_add_f32_dpp v48, v36, v37 row_ror:8 row_mask:0xf bank_mask:0xc
  ds_write_b128 v59, v[46:49]
  v_lshlrev_b32 v60, 2, v60
  v_add_u32 v60, 161376, v60
  v_mov_b32 v62, 161376
  s_waitcnt lgkmcnt(0)
  s_barrier
  ds_read_b128 v[54:57], v62
  ds_read_b32 v62, v60
  ds_read_b128 v[50:53], v58
  s_add_u32 s73, s72, 0
  s_mul_i32 s91, s31, 240
  s_sub_u32 s91, 2048, s91
  v_lshlrev_b32 v59, 4, v0
  v_writelane_b32 v59, s91, 16
  v_mov_b32 v49, s73
  s_add_u32 s76, s78, 0
  s_cmp_lt_u32 s16, s17
  s_cbranch_scc0 L_tg_50025
  s_waitcnt vmcnt(9)
  s_swappc_b64 s[28:29], s[0:1]
L_tb_50026:
  s_waitcnt lgkmcnt(1)
  v_max3_f32 v54, v54, v55, v56
  v_max_f32 v54, v54, v57
  v_sub_f32 v62, v62, v54
  v_mul_f32 v62, 0x3dd53b95, v62
  v_exp_f32 v62, v62
  s_waitcnt lgkmcnt(0)
  v_pk_mul_f32 v[50:51], v[50:51], v[62:63] op_sel_hi:[1,0]
  v_pk_mul_f32 v[52:53], v[52:53], v[62:63] op_sel_hi:[1,0]
  s_nop 0
  v_permlane32_swap_b32 v50, v51
  v_permlane32_swap_b32 v52, v53
  v_add_f32 v50, v50, v51
  v_add_f32 v52, v52, v53
  s_nop 1
  v_permlane16_swap_b32 v50, v52
  v_add_f32 v46, v50, v52
  v_add_f32 v47, v50, v52
  s_nop 1
  v_permlane32_swap_b32 v46, v47
  v_mov_b32 v48, v46
  s_nop 1
  v_permlane16_swap_b32 v46, v48
  s_nop 1
  v_mov_b32_dpp v46, v54 quad_perm:[0,1,2,3] row_mask:0x2 bank_mask:0xf
  s_mov_b64 exec, 0x1ffff
  buffer_store_dwordx4 v[46:49], v59, s[64:67], s76 offen sc1
  s_mov_b64 exec, -1
  v_lshrrev_b32 v71, 3, v0
  v_bfe_u32 v72, v0, 4, 2
  v_lshlrev_b32 v72, 1, v72
  v_and_b32 v73, 7, v0
  v_xor_b32 v72, v72, v73
  v_mul_u32_u24 v71, 12288, v71
  v_lshl_add_u32 v71, v72, 4, v71
  s_waitcnt vmcnt(10)
  s_add_u32 m0, s27, 63488
  s_add_u32 s91, s3, 0
  s_mul_i32 s92, s91, 11
  s_lshr_b32 s92, s92, 5
  s_mul_i32 s76, s92, 97920
  s_lshl_b32 s92, s91, 7
  s_add_u32 s76, s76, s92
  buffer_load_dwordx4 v71, s[52:55], s76 offen nt lds
  s_waitcnt vmcnt(10)
  s_add_u32 m0, s27, 67584
  s_add_u32 s91, s3, 4
  s_mul_i32 s92, s91, 11
  s_lshr_b32 s92, s92, 5
  s_mul_i32 s76, s92, 97920
  s_lshl_b32 s92, s91, 7
  s_add_u32 s76, s76, s92
  buffer_load_dwordx4 v71, s[52:55], s76 offen nt lds
  s_waitcnt vmcnt(10)
  s_add_u32 m0, s27, 71680
  s_add_u32 s91, s3, 8
  s_mul_i32 s92, s91, 11
  s_lshr_b32 s92, s92, 5
  s_mul_i32 s76, s92, 97920
  s_lshl_b32 s92, s91, 7
  s_add_u32 s76, s76, s92
  buffer_load_dwordx4 v71, s[52:55], s76 offen nt lds
  s_waitcnt vmcnt(10)
  s_add_u32 m0, s27, 75776
  s_add_u32 s91, s3, 12
  s_mul_i32 s92, s91, 11
  s_lshr_b32 s92, s92, 5
  s_mul_i32 s76, s92, 97920
  s_lshl_b32 s92, s91, 7
  s_add_u32 s76, s76, s92
  buffer_load_dwordx4 v71, s[52:55], s76 offen nt lds
  s_waitcnt vmcnt(10)
  s_add_u32 m0, s27, 79872
  s_add_u32 s91, s3, 16
  s_mul_i32 s92, s91, 11
  s_lshr_b32 s92, s92, 5
  s_mul_i32 s76, s92, 97920
  s_lshl_b32 s92, s91, 7
  s_add_u32 s76, s76, s92
  buffer_load_dwordx4 v71, s[52:55], s76 offen nt lds
  s_waitcnt vmcnt(10)
  s_add_u32 m0, s27, 83968
  s_add_u32 s91, s3, 20
  s_mul_i32 s92, s91, 11
  s_lshr_b32 s92, s92, 5
  s_mul_i32 s76, s92, 97920
  s_lshl_b32 s92, s91, 7
  s_add_u32 s76, s76, s92
  buffer_load_dwordx4 v71, s[52:55], s76 offen nt lds
  s_waitcnt vmcnt(10)
  s_add_u32 m0, s27, 88064
  s_add_u32 s91, s3, 24
  s_mul_i32 s92, s91, 11
  s_lshr_b32 s92, s92, 5
  s_mul_i32 s76, s92, 97920
  s_lshl_b32 s92, s91, 7
  s_add_u32 s76, s76, s92
  buffer_load_dwordx4 v71, s[52:55], s76 offen nt lds
  s_waitcnt vmcnt(10)
  s_cmp_ge_u32 s3, 2
  s_cbranch_scc1 L_wqskip_50027
  s_add_u32 m0, s27, 92160
  s_add_u32 s91, s3, 28
  s_mul_i32 s92, s91, 11
  s_lshr_b32 s92, s92, 5
  s_mul_i32 s76, s92, 97920
  s_lshl_b32 s92, s91, 7
  s_add_u32 s76, s76, s92
  buffer_load_dwordx4 v71, s[52:55], s76 offen nt lds
L_wqskip_50027:
  s_cmp_lt_u32 s16, s17
  s_cbranch_scc0 L_tg_50028
  s_waitcnt vmcnt(10)
  s_swappc_b64 s[28:29], s[0:1]
L_tb_50029:
  s_mov_b32 s77, 0
  s_add_u32 s73, s72, 0
  v_lshrrev_b32 v45, 4, v0
  v_and_b32 v44, 1, v0
  v_lshl_add_u32 v45, v44, 2, v45
  s_add_u32 s91, s27, 2048
  v_lshl_add_u32 v45, v45, 4, s91
  s_add_u32 s97, s79, 0
  buffer_load_dwordx4 v[34:37], v45, s[64:67], s97 offen sc1
  buffer_load_dwordx4 v[26:29], v6, s[64:67], s97 offen offset:0 sc1
  buffer_load_dwordx4 v[30:33], v6, s[64:67], s97 offen offset:1024 sc1
  s_cmp_lt_u32 s16, s17
  s_cbranch_scc0 L_tg_50030
  s_waitcnt vmcnt(12)
  s_swappc_b64 s[28:29], s[0:1]
L_tb_50031:
  s_cmp_lt_u32 s16, s17
  s_cbranch_scc0 L_tg_50032
  s_waitcnt vmcnt(12)
  s_swappc_b64 s[28:29], s[0:1]
L_tb_50033:
  v_lshrrev_b32 v46, 2, v0
  v_and_b32 v47, 3, v0
  v_mul_u32_u24 v46, 160, v46
  v_lshl_add_u32 v47, v47, 3, v46
  s_lshl_b32 s91, s3, 5
  s_add_u32 s91, s91, 94208
  v_add_u32 v46, s91, v47
  v_add_u32 v47, 94336, v47
  v_bfe_u32 v49, v0, 4, 1
  v_lshlrev_b32 v49, 8, v49
  v_lshrrev_b32 v48, 5, v0
  v_lshl_add_u32 v49, v48, 7, v49
  v_and_b32 v48, 7, v0
  v_lshl_add_u32 v49, v48, 4, v49
  v_bfe_u32 v48, v0, 3, 1
  v_lshl_add_u32 v49, v48, 2, v49
  s_and_b32 s91, s3, 1
  s_lshl_b32 s91, s91, 3
  s_and_b32 s92, s3, 2
  s_add_u32 s91, s91, s92
  s_add_u32 s91, s91, 159744
  v_add_u32 v49, s91, v49
  v_and_b32 v74, 0x30, v0
  s_lshl_b32 s91, s3, 4
  s_add_u32 s91, s91, 1
  v_writelane_b32 v74, 64, s91
  s_movk_i32 s91, 80
  v_writelane_b32 v74, s91, 2
  s_movk_i32 s91, 96
  v_writelane_b32 v74, s91, 3
  s_movk_i32 s91, 112
  v_writelane_b32 v74, s91, 4
  s_bfe_u32 s68, s73, 0x80000
  s_bfe_u32 s69, s73, 0x80008
  s_bfe_u32 s70, s73, 0x80010
  s_bfe_u32 s90, s73, 0x80018
  s_cmp_lg_u32 s77, 0
  s_cbranch_scc1 L_wz_50034
  s_waitcnt vmcnt(6)
L_wb_50035:
L_chk_50036:
  v_bitop3_b32 v75, v37, v29, s73 bitop3:0x7e
  v_bitop3_b32 v75, v75, v33, s73 bitop3:0xf6
  v_cmp_ne_u32 vcc, 0, v75
  s_nop 0
  s_cbranch_vccnz L_retry_50037
  v_max_f32_dpp v43, v34, v34 quad_perm:[1,0,3,2] row_mask:0xf bank_mask:0xf
  v_mov_b32 v42, v43
  ds_read_b64_tr_b16 v[50:51], v46 offset:0
  ds_read_b64_tr_b16 v[52:53], v46 offset:2560
  ds_read_b64_tr_b16 v[54:55], v47 offset:0
  ds_read_b64_tr_b16 v[56:57], v47 offset:2560
  v_permlane32_swap_b32 v43, v42
  v_max_f32 v43, v43, v42
  v_mov_b32 v42, v43
  ds_read_b64_tr_b16 v[58:59], v46 offset:5120
  ds_read_b64_tr_b16 v[60:61], v46 offset:7680
  ds_read_b64_tr_b16 v[62:63], v47 offset:5120
  ds_read_b64_tr_b16 v[64:65], v47 offset:7680
  v_permlane16_swap_b32 v43, v42
  v_max_f32 v43, v43, v42
  v_sub_f32 v43, v34, v43
  v_mul_f32 v43, 0x3dd53b95, v43
  v_exp_f32 v43, v43
  ds_read_b64_tr_b16 v[66:67], v46 offset:10240
  ds_read_b64_tr_b16 v[68:69], v46 offset:12800
  ds_read_b64_tr_b16 v[70:71], v47 offset:10240
  ds_read_b64_tr_b16 v[72:73], v47 offset:12800
  v_mul_f32 v35, v35, v43
  v_mul_f32_dpp v26, v43, v26 quad_perm:[0,0,2,2] row_mask:0xf bank_mask:0xf
  v_mul_f32_dpp v27, v43, v27 quad_perm:[0,0,2,2] row_mask:0xf bank_mask:0xf
  v_mul_f32_dpp v28, v43, v28 quad_perm:[0,0,2,2] row_mask:0xf bank_mask:0xf
  v_add_f32_dpp v29, v35, v35 quad_perm:[1,0,3,2] row_mask:0xf bank_mask:0xf
  v_fmac_f32_dpp v26, v43, v30 quad_perm:[1,1,3,3] row_mask:0xf bank_mask:0xf
  v_fmac_f32_dpp v27, v43, v31 quad_perm:[1,1,3,3] row_mask:0xf bank_mask:0xf
  v_fmac_f32_dpp v28, v43, v32 quad_perm:[1,1,3,3] row_mask:0xf bank_mask:0xf
  s_nop 0
  v_permlane32_swap_b32 v26, v27
  v_permlane32_swap_b32 v28, v29
  v_add_f32 v26, v26, v27
  v_add_f32 v28, v28, v29
  s_nop 1
  v_permlane16_swap_b32 v26, v28
  v_add_f32 v48, v26, v28
  v_lshrrev_b32 v45, 4, v0
  v_readlane_b32 s92, v48, 48
  v_lshlrev_b32 v45, 3, v45
  v_add_u32 v44, 159744, v45
  v_rcp_f32 v43, s92
  s_mov_b32 exec_hi, 0xffff
  v_mul_f32 v48, v48, v43
  v_cvt_pk_bf16_f32 v48, v48, v48
  ds_write_b16 v49, v48
  s_mov_b64 exec, -1
  s_waitcnt lgkmcnt(0)
  s_barrier
  ds_read2_b64 v[26:29], v44 offset0:0 offset1:4
  ds_read2_b64 v[30:33], v44 offset0:8 offset1:12
  ds_read2_b64 v[34:37], v44 offset0:16 offset1:20
  v_mov_b32 v48, v44
  s_add_u32 s76, s82, 0
  s_lshl_b32 s91, s3, 4
  s_lshl_b64 vcc, 2, s91
  s_or_b32 s91, vcc_lo, 0x1001d
  s_or_b32 s92, vcc_hi, 0x10001
  v_mov_b32 v49, 0xffffff00
  s_waitcnt lgkmcnt(2)
  v_mfma_f32_16x16x32_bf16 v[38:41], v[50:53], v[26:29], 0
  v_mfma_f32_16x16x32_bf16 v[42:45], v[54:57], v[26:29], 0
  ds_read2_b64 v[26:29], v48 offset0:24 offset1:28
  ds_read_b64_tr_b16 v[50:51], v46 offset:15360
  ds_read_b64_tr_b16 v[52:53], v46 offset:17920
  ds_read_b64_tr_b16 v[54:55], v47 offset:15360
  ds_read_b64_tr_b16 v[56:57], v47 offset:17920
  s_waitcnt lgkmcnt(6)
  v_mfma_f32_16x16x32_bf16 v[38:41], v[58:61], v[30:33], v[38:41]
  v_mfma_f32_16x16x32_bf16 v[42:45], v[62:65], v[30:33], v[42:45]
  ds_read2_b64 v[30:33], v48 offset0:32 offset1:36
  ds_read_b64_tr_b16 v[58:59], v46 offset:20480
  ds_read_b64_tr_b16 v[60:61], v46 offset:23040
  ds_read_b64_tr_b16 v[62:63], v47 offset:20480
  ds_read_b64_tr_b16 v[64:65], v47 offset:23040
  s_waitcnt lgkmcnt(10)
  v_mfma_f32_16x16x32_bf16 v[38:41], v[66:69], v[34:37], v[38:41]
  v_mfma_f32_16x16x32_bf16 v[42:45], v[70:73], v[34:37], v[42:45]
  ds_read2_b64 v[34:37], v48 offset0:40 offset1:44
  ds_read_b64_tr_b16 v[66:67], v46 offset:25600
  ds_read_b64_tr_b16 v[68:69], v46 offset:28160
  ds_read_b64_tr_b16 v[70:71], v47 offset:25600
  ds_read_b64_tr_b16 v[72:73], v47 offset:28160
  s_cmp_lt_u32 s16, s17
  s_cbranch_scc0 L_tg_50044
  s_swappc_b64 s[28:29], s[0:1]
L_tb_50045:
  s_waitcnt lgkmcnt(10)
  v_mfma_f32_16x16x32_bf16 v[38:41], v[50:53], v[26:29], v[38:41]
  v_mfma_f32_16x16x32_bf16 v[42:45], v[54:57], v[26:29], v[42:45]
  s_waitcnt lgkmcnt(5)
  v_mfma_f32_16x16x32_bf16 v[38:41], v[58:61], v[30:33], v[38:41]
  v_mfma_f32_16x16x32_bf16 v[42:45], v[62:65], v[30:33], v[42:45]
  s_waitcnt lgkmcnt(0)
  v_mfma_f32_16x16x32_bf16 v[38:41], v[66:69], v[34:37], v[38:41]
  v_mfma_f32_16x16x32_bf16 v[42:45], v[70:73], v[34:37], v[42:45]
  s_cmp_lt_u32 s16, s17
  s_cbranch_scc0 L_tg_50046
  s_swappc_b64 s[28:29], s[0:1]
L_tb_50047:
  s_nop 4
  v_cndmask_b32 v26, v38, v42, vcc
  v_cndmask_b32 v27, v39, v43, vcc
  v_cndmask_b32 v28, v40, v44, vcc
  v_cndmask_b32 v29, v41, v45, vcc
  s_mov_b32 exec_lo, s91
  s_mov_b32 exec_hi, s92
  v_and_or_b32 v26, v26, v49, s68
  v_and_or_b32 v27, v27, v49, s69
  v_and_or_b32 v28, v28, v49, s70
  v_and_or_b32 v29, v29, v49, s90
  buffer_store_dwordx4 v[26:29], v74, s[64:67], s76 offen sc1
  s_mov_b64 exec, -1
  v_mul_u32_u24 v71, 26, v0
  v_lshrrev_b32 v71, 8, v71
  v_mul_u32_u24 v71, 1120, v71
  v_lshl_add_u32 v71, v0, 4, v71
  s_mul_i32 s76, s3, 7680
  s_mul_i32 s91, s3, 960
  s_mov_b32 exec_hi, 0xfffffff
  s_waitcnt vmcnt(10)
  s_add_u32 m0, s91, 124928
  s_nop 0
  buffer_load_dwordx4 v71, s[60:63], s76 offen nt lds
  s_waitcnt vmcnt(10)
  s_add_u32 m0, s91, 128768
  s_add_u32 s76, s76, 30720
  buffer_load_dwordx4 v71, s[60:63], s76 offen nt lds
  s_waitcnt vmcnt(10)
  s_add_u32 m0, s91, 132608
  s_add_u32 s76, s76, 30720
  buffer_load_dwordx4 v71, s[60:63], s76 offen nt lds
  s_waitcnt vmcnt(10)
  s_add_u32 m0, s91, 136448
  s_add_u32 s76, s76, 30720
  buffer_load_dwordx4 v71, s[60:63], s76 offen nt lds
  s_waitcnt vmcnt(10)
  s_add_u32 m0, s91, 140288
  s_add_u32 s76, s76, 30720
  buffer_load_dwordx4 v71, s[60:63], s76 offen nt lds
  s_waitcnt vmcnt(10)
  s_add_u32 m0, s91, 144128
  s_add_u32 s76, s76, 30720
  buffer_load_dwordx4 v71, s[60:63], s76 offen nt lds
  s_waitcnt vmcnt(10)
  s_add_u32 m0, s91, 147968
  s_add_u32 s76, s76, 30720
  buffer_load_dwordx4 v71, s[60:63], s76 offen nt lds
  s_waitcnt vmcnt(10)
  s_add_u32 m0, s91, 151808
  s_add_u32 s76, s76, 30720
  buffer_load_dwordx4 v71, s[60:63], s76 offen nt lds
  s_mov_b64 exec, -1
  s_mov_b64 exec, 0x1
  s_mov_b32 s22, 50331648
  buffer_load_dword v50, off, s[32:35], s22 nt
  s_mov_b32 s22, 50331648
  buffer_load_dword v51, off, s[36:39], s22 nt
  s_mov_b32 s22, 50331648
  buffer_load_dword v52, off, s[40:43], s22 nt
  s_mov_b32 s22, 50331648
  buffer_load_dword v53, off, s[44:47], s22 nt
  s_mov_b32 s22, 51806208
  buffer_load_dword v54, off, s[40:43], s22 nt
  s_mov_b32 s22, 51806208
  buffer_load_dword v55, off, s[44:47], s22 nt
  s_mov_b64 exec, -1
  s_cmp_lt_u32 s16, s17
  s_cbranch_scc0 L_tg_50048
  s_waitcnt vmcnt(16)
  s_swappc_b64 s[28:29], s[0:1]
L_tb_50049:
  s_cmp_lt_u32 s16, s17
  s_cbranch_scc0 L_tg_50050
  s_waitcnt vmcnt(15)
  s_swappc_b64 s[28:29], s[0:1]
L_tb_50051:
  s_cmp_lt_u32 s16, s17
  s_cbranch_scc0 L_tg_50052
  s_waitcnt vmcnt(15)
  s_swappc_b64 s[28:29], s[0:1]
L_tb_50053:
  s_cmp_lt_u32 s16, s17
  s_cbranch_scc0 L_tg_50054
  s_waitcnt vmcnt(15)
  s_swappc_b64 s[28:29], s[0:1]
L_tb_50055:
  s_cmp_lt_u32 s16, s17
  s_cbranch_scc0 L_tg_50056
  s_waitcnt vmcnt(9)
  s_swappc_b64 s[28:29], s[0:1]
L_tb_50057:
  s_cmp_lt_u32 s16, s17
  s_cbranch_scc0 L_tg_50058
  s_waitcnt vmcnt(9)
  s_swappc_b64 s[28:29], s[0:1]
L_tb_50059:
  s_mov_b32 s77, 0
  s_add_u32 s73, s72, 0
  v_lshrrev_b32 v74, 3, v0
  v_and_b32 v75, 7, v0
  v_mul_u32_u24 v74, 128, v74
  v_lshl_add_u32 v74, v75, 4, v74
  s_add_u32 s97, s83, 0
  s_mov_b32 exec_lo, 0x1f1f1f1f
  s_mov_b32 exec_hi, 0x1f1f1f1f
  buffer_load_dwordx4 v[26:29], v74, s[64:67], s97 offen offset:0 sc1
  buffer_load_dwordx4 v[30:33], v74, s[64:67], s97 offen offset:1024 sc1
  buffer_load_dwordx4 v[34:37], v74, s[64:67], s97 offen offset:2048 sc1
  buffer_load_dwordx4 v[38:41], v74, s[64:67], s97 offen offset:3072 sc1
  s_mov_b64 exec, -1
  s_bfe_u32 s68, s73, 0x80000
  s_bfe_u32 s69, s73, 0x80008
  s_bfe_u32 s70, s73, 0x80010
  s_bfe_u32 s90, s73, 0x80018
  s_cmp_lt_u32 s16, s17
  s_cbranch_scc0 L_tg_50060
  s_waitcnt vmcnt(13)
  s_swappc_b64 s[28:29], s[0:1]
L_tb_50061:
  s_cmp_lt_u32 s16, s17
  s_cbranch_scc0 L_tg_50062
  s_waitcnt vmcnt(13)
  s_swappc_b64 s[28:29], s[0:1]
L_tb_50063:
  s_cmp_lg_u32 s77, 0
  s_cbranch_scc1 L_wz_50064
  s_waitcnt vmcnt(6)
L_wb_50065:
  s_mov_b32 exec_lo, 0x1f1f1f1f
  s_mov_b32 exec_hi, 0x1f1f1f1f
L_chk_50066:
  v_xor_b32 v26, s68, v26
  v_xor_b32 v30, s68, v30
  v_xor_b32 v34, s68, v34
  v_xor_b32 v38, s68, v38
  v_xor_b32 v27, s69, v27
  v_xor_b32 v31, s69, v31
  v_xor_b32 v35, s69, v35
  v_xor_b32 v39, s69, v39
  v_xor_b32 v28, s70, v28
  v_xor_b32 v32, s70, v32
  v_xor_b32 v36, s70, v36
  v_xor_b32 v40, s70, v40
  v_xor_b32 v29, s90, v29
  v_xor_b32 v33, s90, v33
  v_xor_b32 v37, s90, v37
  v_xor_b32 v41, s90, v41
  v_or3_b32 v75, v26, v30, v34
  v_or3_b32 v75, v75, v38, v27
  v_or3_b32 v75, v75, v31, v35
  v_or3_b32 v75, v75, v39, v28
  v_or3_b32 v75, v75, v32, v36
  v_or3_b32 v75, v75, v40, v29
  v_or3_b32 v75, v75, v33, v37
  v_or3_b32 v75, v75, v41, v41
  v_and_b32 v75, 0xff, v75
  v_cmp_ne_u32 vcc, 0, v75
  s_nop 0
  s_cbranch_vccnz L_retry_50067
  v_pk_add_f32 v[26:27], v[26:27], v[30:31]
  v_pk_add_f32 v[28:29], v[28:29], v[32:33]
  v_pk_add_f32 v[34:35], v[34:35], v[38:39]
  v_pk_add_f32 v[36:37], v[36:37], v[40:41]
  v_pk_add_f32 v[26:27], v[26:27], v[34:35]
  v_pk_add_f32 v[28:29], v[28:29], v[36:37]
  v_add_u32 v33, 160128, v24
  v_add_f32_dpp v30, v26, v26 row_ror:8 row_mask:0xf bank_mask:0x3
  v_add_f32_dpp v31, v28, v28 row_ror:8 row_mask:0xf bank_mask:0x3
  s_nop 0
  v_add_f32_dpp v30, v27, v27 row_ror:8 row_mask:0xf bank_mask:0xc
  v_add_f32_dpp v31, v29, v29 row_ror:8 row_mask:0xf bank_mask:0xc
  s_nop 1
  v_permlane32_swap_b32 v30, v31
  v_add_f32 v30, v30, v31
  v_mov_b32 v31, v30
  s_nop 1
  v_permlane16_swap_b32 v30, v31
  v_add_f32 v30, v30, v31
  v_cvt_pk_bf16_f32 v30, v30, v30
  v_and_b32 v30, 0xffff0000, v30
  v_add_f32 v30, v30, v7
  v_cvt_pk_bf16_f32 v31, v30, v30
  ds_write_b16 v33, v31
  v_and_b32 v7, 0xffff0000, v31
  s_mov_b64 exec, -1
  v_bfe_u32 v72, v0, 2, 3
  v_lshrrev_b32 v71, 5, v0
  v_mul_u32_u24 v71, 3072, v71
  v_lshl_add_u32 v71, v72, 7, v71
  v_and_b32 v73, 3, v0
  v_lshl_add_u32 v71, v73, 3, v71
  v_lshrrev_b32 v72, 1, v72
  s_mul_i32 s91, s3, 3
  s_add_u32 s91, s91, 0
  s_and_b32 s92, s91, 3
  s_lshr_b32 s91, s91, 2
  v_xor_b32 v73, s92, v72
  s_lshl_b32 s91, s91, 10
  s_add_u32 s91, s91, 63488
  v_lshl_add_u32 v73, v73, 5, v71
  v_add_u32 v42, s91, v73
  ds_read_b64_tr_b16 v[44:45], v42 offset:0
  ds_read_b64_tr_b16 v[46:47], v42 offset:6144
  ds_read_b64_tr_b16 v[48:49], v42 offset:12288
  ds_read_b64_tr_b16 v[50:51], v42 offset:18432
  ds_read_b64_tr_b16 v[52:53], v42 offset:24576
  s_mul_i32 s91, s3, 3
  s_add_u32 s91, s91, 1
  s_and_b32 s92, s91, 3
  s_lshr_b32 s91, s91, 2
  v_xor_b32 v73, s92, v72
  s_lshl_b32 s91, s91, 10
  s_add_u32 s91, s91, 63488
  v_lshl_add_u32 v73, v73, 5, v71
  v_add_u32 v43, s91, v73
  ds_read_b64_tr_b16 v[54:55], v43 offset:0
  ds_read_b64_tr_b16 v[56:57], v43 offset:6144
  ds_read_b64_tr_b16 v[58:59], v43 offset:12288
  ds_read_b64_tr_b16 v[60:61], v43 offset:18432
  ds_read_b64_tr_b16 v[62:63], v43 offset:24576
  s_mul_i32 s91, s3, 3
  s_add_u32 s91, s91, 2
  s_and_b32 s92, s91, 3
  s_lshr_b32 s91, s91, 2
  v_xor_b32 v73, s92, v72
  s_lshl_b32 s91, s91, 10
  s_add_u32 s91, s91, 63488
  v_lshl_add_u32 v73, v73, 5, v71
  v_add_u32 v42, s91, v73
  ds_read_b64_tr_b16 v[64:65], v42 offset:0
  ds_read_b64_tr_b16 v[66:67], v42 offset:6144
  ds_read_b64_tr_b16 v[68:69], v42 offset:12288
  ds_read_b64_tr_b16 v[70:71], v42 offset:18432
  ds_read_b64_tr_b16 v[72:73], v42 offset:24576
  v_mov_b32 v75, 160128
  v_mov_b32 v32, 161216
  s_mov_b32 vcc_lo, 0x00f000f0
  s_mov_b32 vcc_hi, 0x00f000f0
  v_cndmask_b32 v75, v75, v32, vcc
  v_lshrrev_b32 v32, 4, v0
  v_lshl_add_u32 v75, v32, 3, v75
  s_waitcnt lgkmcnt(0)
  s_barrier
  ds_read2_b64 v[34:37], v75 offset0:0 offset1:4
  ds_read2_b64 v[38:41], v75 offset0:8 offset1:12
  ds_read_b64 v[42:43], v75 offset:128
  s_add_u32 s73, s72, 1
  s_add_u32 s76, s80, 2097152
  s_mul_i32 s91, s31, 240
  s_sub_u32 s91, 2048, s91
  v_lshlrev_b32 v74, 4, v0
  v_add_u32 v32, 3840, v74
  s_nop 1
  v_mov_b32_dpp v74, v32 quad_perm:[0,1,2,3] row_mask:0x2 bank_mask:0xf
  v_writelane_b32 v74, s91, 32
  s_cmp_lt_u32 s16, s17
  s_cbranch_scc0 L_tg_50074
  s_swappc_b64 s[28:29], s[0:1]
L_tb_50075:
  s_waitcnt lgkmcnt(0)
  v_mfma_f32_16x16x32_bf16 v[26:29], v[34:37], v[44:47], 0
  v_mfma_f32_16x16x32_bf16 v[30:33], v[34:37], v[54:57], 0
  v_mfma_f32_16x16x32_bf16 v[26:29], v[38:41], v[48:51], v[26:29]
  v_mfma_f32_16x16x32_bf16 v[30:33], v[38:41], v[58:61], v[30:33]
  v_mfma_f32_16x16x16_bf16 v[26:29], v[42:43], v[52:53], v[26:29]
  v_mfma_f32_16x16x16_bf16 v[30:33], v[42:43], v[62:63], v[30:33]
  v_mfma_f32_16x16x32_bf16 v[48:51], v[34:37], v[34:37], 0
  v_mfma_f32_16x16x32_bf16 v[44:47], v[34:37], v[64:67], 0
  v_mfma_f32_16x16x32_bf16 v[48:51], v[38:41], v[38:41], v[48:51]
  v_mfma_f32_16x16x32_bf16 v[44:47], v[38:41], v[68:71], v[44:47]
  v_mfma_f32_16x16x16_bf16 v[48:51], v[42:43], v[42:43], v[48:51]
  v_mfma_f32_16x16x16_bf16 v[44:47], v[42:43], v[72:73], v[44:47]
  s_nop 0
  v_mov_b32 v29, s73
  v_mov_b32 v27, v30
  s_nop 4
  v_mov_b32 v28, v44
  v_mov_b32_dpp v26, v48 quad_perm:[0,1,2,3] row_mask:0x4 bank_mask:0xf
  v_mov_b32_dpp v27, v48 row_ror:12 row_mask:0x4 bank_mask:0xf
  s_mov_b32 exec_lo, -1
  s_mov_b32 exec_hi, 1
  buffer_store_dwordx4 v[26:29], v74, s[64:67], s76 offen sc1
  s_mov_b64 exec, -1
  s_cmp_lt_u32 s16, s17
  s_cbranch_scc0 L_tg_50076
  s_swappc_b64 s[28:29], s[0:1]
L_tb_50077:
  s_cmp_lt_u32 s16, s17
  s_cbranch_scc0 L_tg_50078
  s_waitcnt vmcnt(10)
  s_swappc_b64 s[28:29], s[0:1]
L_tb_50079:
  s_mov_b32 s77, 0
  s_add_u32 s73, s72, 1
  v_and_b32 v59, 7, v0
  s_add_u32 s91, s27, 2048
  v_lshl_add_u32 v59, v59, 4, s91
  s_add_u32 s97, s81, 2097152
  s_add_u32 s100, s97, 4096
  buffer_load_dwordx4 v[34:37], v59, s[64:67], s97 offen sc1
  buffer_load_dwordx4 v[26:29], v6, s[64:67], s97 offen offset:0 sc1
  buffer_load_dwordx4 v[30:33], v6, s[64:67], s97 offen offset:1024 sc1
  buffer_load_dwordx4 v[38:41], v6, s[64:67], s100 offen offset:0 sc1
  buffer_load_dwordx4 v[42:45], v6, s[64:67], s100 offen offset:1024 sc1
  s_cmp_lt_u32 s16, s17
  s_cbranch_scc0 L_tg_50080
  s_waitcnt vmcnt(15)
  s_swappc_b64 s[28:29], s[0:1]
L_tb_50081:
  s_cmp_lt_u32 s16, s17
  s_cbranch_scc0 L_tg_50082
  s_waitcnt vmcnt(15)
  s_swappc_b64 s[28:29], s[0:1]
L_tb_50083:
  v_and_b32 v58, 15, v0
  v_bfe_u32 v60, v0, 4, 1
  v_lshl_add_u32 v58, v60, 5, v58
  v_lshrrev_b32 v60, 5, v0
  v_lshl_add_u32 v58, v60, 4, v58
  s_mul_i32 s91, s3, 96
  s_add_u32 s91, s91, 160448
  v_lshl_add_u32 v58, v58, 1, s91
  v_lshrrev_b32 v61, 2, v6
  v_add_u32 v61, 162528, v61
  s_cmp_lg_u32 s77, 0
  s_cbranch_scc1 L_wz_50084
  s_waitcnt vmcnt(6)
L_wb_50085:
L_chk_50086:
  v_bitop3_b32 v75, v37, v29, s73 bitop3:0x7e
  v_bitop3_b32 v75, v75, v33, s73 bitop3:0xf6
  v_bitop3_b32 v75, v75, v41, s73 bitop3:0xf6
  v_bitop3_b32 v75, v75, v45, s73 bitop3:0xf6
  v_cmp_ne_u32 vcc, 0, v75
  s_nop 0
  s_cbranch_vccnz L_retry_50087
  v_pk_add_f32 v[26:27], v[26:27], v[30:31]
  v_add_f32 v28, v28, v32
  v_mov_b32 v29, v28
  v_add_f32_dpp v34, v34, v34 quad_perm:[1,0,3,2] row_mask:0xf bank_mask:0xf
  v_add_f32_dpp v35, v35, v35 quad_perm:[1,0,3,2] row_mask:0xf bank_mask:0xf
  v_permlane32_swap_b32 v26, v27
  v_permlane32_swap_b32 v28, v29
  v_add_f32_dpp v34, v34, v34 quad_perm:[2,3,0,1] row_mask:0xf bank_mask:0xf
  v_add_f32_dpp v35, v35, v35 quad_perm:[2,3,0,1] row_mask:0xf bank_mask:0xf
  v_add_f32 v26, v26, v27
  v_add_f32 v28, v28, v29
  v_add_f32_dpp v34, v34, v34 row_half_mirror row_mask:0xf bank_mask:0xf
  v_add_f32_dpp v35, v35, v35 row_half_mirror row_mask:0xf bank_mask:0xf
  v_permlane16_swap_b32 v26, v28
  v_mul_f32 v35, 0x3acccccd, v35
  v_mul_f32 v34, 0x3acccccd, v34
  v_add_f32 v62, v26, v28
  v_fma_f32 v34, -v35, v35, v34
  v_max_f32 v34, 0, v34
  v_add_f32 v34, 0x3727c5ac, v34
  v_rsq_f32 v34, v34
  v_pk_add_f32 v[38:39], v[38:39], v[42:43]
  v_add_f32 v40, v40, v44
  v_mov_b32 v41, v40
  v_permlane32_swap_b32 v38, v39
  s_nop 0
  v_permlane32_swap_b32 v40, v41
  v_add_f32 v38, v38, v39
  v_add_f32 v40, v40, v41
  s_nop 1
  v_permlane16_swap_b32 v38, v40
  v_add_f32 v60, v38, v40
  ds_write_b32 v61, v60
  v_fma_f32 v62, -v35, v60, v62
  s_mov_b32 exec_hi, 0xffff
  v_mul_f32 v62, v62, v34
  v_cvt_pk_bf16_f32 v62, v62, v62
  ds_write_b16 v58, v62
  s_mov_b64 exec, -1
  s_waitcnt lgkmcnt(0)
  s_barrier
  s_mov_b32 s20, 42
  s_cmp_eq_u32 s20, -1
  s_cbranch_scc1 L_ux_50095
L_uw_50094:
  s_cmp_lt_u32 s16, s17
  s_cbranch_scc0 L_ud_50097
  s_waitcnt vmcnt(12)
  s_swappc_b64 s[28:29], s[0:1]
  s_cmp_ge_u32 s16, s20
  s_cbranch_scc0 L_uw_50094
L_uc_50096:
  s_swappc_b64 s[28:29], s[14:15]
  s_cmp_ge_u32 s16, s20
  s_cbranch_scc0 L_ut_50098
  s_swappc_b64 s[28:29], s[14:15]
  s_cmp_ge_u32 s16, s20
  s_cbranch_scc0 L_ut_50098
  s_swappc_b64 s[28:29], s[14:15]
L_ut_50098:
  s_cmp_eq_u32 s20, -1
  s_cbranch_scc0 L_uw_50094
L_ux_50095:
  v_lshrrev_b32 v60, 4, v0
  v_and_b32 v59, 15, v0
  v_lshlrev_b32 v58, 10, v60
  v_lshl_add_u32 v58, v59, 4, v58
  s_lshl_b32 s91, s3, 8
  s_add_u32 s91, s91, 155648
  v_add_u32 v58, s91, v58
  v_add_u32 v59, 155648, v6
  v_mov_b32 v49, s94
  v_permlane32_swap_b32 v8, v9
  v_permlane32_swap_b32 v10, v11
  v_permlane32_swap_b32 v12, v13
  v_permlane32_swap_b32 v14, v15
  v_permlane32_swap_b32 v16, v17
  v_permlane32_swap_b32 v18, v19
  v_add_f32_dpp v46, v9, v8 row_ror:8 row_mask:0xf bank_mask:0x3
  v_add_f32_dpp v47, v13, v12 row_ror:8 row_mask:0xf bank_mask:0x3
  v_add_f32_dpp v48, v17, v16 row_ror:8 row_mask:0xf bank_mask:0x3
  v_add_f32_dpp v46, v10, v11 row_ror:8 row_mask:0xf bank_mask:0xc
  v_add_f32_dpp v47, v14, v15 row_ror:8 row_mask:0xf bank_mask:0xc
  v_add_f32_dpp v48, v18, v19 row_ror:8 row_mask:0xf bank_mask:0xc
  ds_write_b128 v59, v[46:49]
  v_lshlrev_b32 v60, 2, v60
  v_add_u32 v60, 161408, v60
  v_mov_b32 v62, 161408
  s_waitcnt lgkmcnt(0)
  s_barrier
  ds_read_b128 v[54:57], v62
  ds_read_b32 v62, v60
  ds_read_b128 v[50:53], v58
  s_add_u32 s73, s72, 1
  s_mul_i32 s91, s31, 240
  s_sub_u32 s91, 2048, s91
  v_lshlrev_b32 v59, 4, v0
  v_writelane_b32 v59, s91, 16
  v_mov_b32 v49, s73
  s_add_u32 s76, s78, 0
  s_waitcnt lgkmcnt(1)
  v_max3_f32 v54, v54, v55, v56
  v_max_f32 v54, v54, v57
  v_sub_f32 v62, v62, v54
  v_mul_f32 v62, 0x3dd53b95, v62
  v_exp_f32 v62, v62
  s_waitcnt lgkmcnt(0)
  v_pk_mul_f32 v[50:51], v[50:51], v[62:63] op_sel_hi:[1,0]
  v_pk_mul_f32 v[52:53], v[52:53], v[62:63] op_sel_hi:[1,0]
  s_nop 0
  v_permlane32_swap_b32 v50, v51
  v_permlane32_swap_b32 v52, v53
  v_add_f32 v50, v50, v51
  v_add_f32 v52, v52, v53
  s_nop 1
  v_permlane16_swap_b32 v50, v52
  v_add_f32 v46, v50, v52
  v_add_f32 v47, v50, v52
  s_nop 1
  v_permlane32_swap_b32 v46, v47
  v_mov_b32 v48, v46
  s_nop 1
  v_permlane16_swap_b32 v46, v48
  s_nop 1
  v_mov_b32_dpp v46, v54 quad_perm:[0,1,2,3] row_mask:0x2 bank_mask:0xf
  s_mov_b64 exec, 0x1ffff
  buffer_store_dwordx4 v[46:49], v59, s[64:67], s76 offen sc1
  s_mov_b64 exec, -1
  s_add_u32 s73, s72, 1
  v_lshrrev_b32 v45, 4, v0
  v_and_b32 v44, 1, v0
  v_lshl_add_u32 v45, v44, 2, v45
  s_add_u32 s91, s27, 2048
  v_lshl_add_u32 v45, v45, 4, s91
  s_add_u32 s97, s79, 0
  buffer_load_dwordx4 v[34:37], v45, s[64:67], s97 offen sc1
  buffer_load_dwordx4 v[26:29], v6, s[64:67], s97 offen offset:0 sc1
  buffer_load_dwordx4 v[30:33], v6, s[64:67], s97 offen offset:1024 sc1
  v_lshrrev_b32 v46, 2, v0
  v_and_b32 v47, 3, v0
  v_mul_u32_u24 v46, 160, v46
  v_lshl_add_u32 v47, v47, 3, v46
  s_lshl_b32 s91, s3, 5
  s_add_u32 s91, s91, 124928
  v_add_u32 v46, s91, v47
  v_add_u32 v47, 125056, v47
  v_bfe_u32 v49, v0, 4, 1
  v_lshlrev_b32 v49, 8, v49
  v_lshrrev_b32 v48, 5, v0
  v_lshl_add_u32 v49, v48, 7, v49
  v_and_b32 v48, 7, v0
  v_lshl_add_u32 v49, v48, 4, v49
  v_bfe_u32 v48, v0, 3, 1
  v_lshl_add_u32 v49, v48, 2, v49
  s_and_b32 s91, s3, 1
  s_lshl_b32 s91, s91, 3
  s_and_b32 s92, s3, 2
  s_add_u32 s91, s91, s92
  s_add_u32 s91, s91, 159744
  v_add_u32 v49, s91, v49
  v_and_b32 v74, 0x30, v0
  s_lshl_b32 s91, s3, 4
  s_add_u32 s91, s91, 1
  v_writelane_b32 v74, 64, s91
  s_movk_i32 s91, 80
  v_writelane_b32 v74, s91, 2
  s_movk_i32 s91, 96
  v_writelane_b32 v74, s91, 3
  s_movk_i32 s91, 112
  v_writelane_b32 v74, s91, 4
  s_bfe_u32 s68, s73, 0x80000
  s_bfe_u32 s69, s73, 0x80008
  s_bfe_u32 s70, s73, 0x80010
  s_bfe_u32 s90, s73, 0x80018
  ds_read_b64_tr_b16 v[50:51], v46 offset:0
  ds_read_b64_tr_b16 v[52:53], v46 offset:2560
  ds_read_b64_tr_b16 v[54:55], v47 offset:0
  ds_read_b64_tr_b16 v[56:57], v47 offset:2560
  ds_read_b64_tr_b16 v[58:59], v46 offset:5120
  ds_read_b64_tr_b16 v[60:61], v46 offset:7680
  ds_read_b64_tr_b16 v[62:63], v47 offset:5120
  ds_read_b64_tr_b16 v[64:65], v47 offset:7680
  ds_read_b64_tr_b16 v[66:67], v46 offset:10240
  ds_read_b64_tr_b16 v[68:69], v46 offset:12800
  ds_read_b64_tr_b16 v[70:71], v47 offset:10240
  ds_read_b64_tr_b16 v[72:73], v47 offset:12800
  s_waitcnt vmcnt(0)
L_chk_50099:
  v_bitop3_b32 v75, v37, v29, s73 bitop3:0x7e
  v_bitop3_b32 v75, v75, v33, s73 bitop3:0xf6
  v_cmp_ne_u32 vcc, 0, v75
  s_nop 0
  s_cbranch_vccz L_retry_50100
  buffer_load_dwordx4 v[34:37], v45, s[64:67], s97 offen sc1
  buffer_load_dwordx4 v[26:29], v6, s[64:67], s97 offen offset:0 sc1
  buffer_load_dwordx4 v[30:33], v6, s[64:67], s97 offen offset:1024 sc1
  s_sub_u32 s75, s75, 1
  s_cbranch_scc1 L_end
  s_waitcnt vmcnt(0)
  s_branch L_chk_50099
L_retry_50100:
  s_mov_b32 s22, 50528256
  buffer_load_dwordx4 a[144:147], v1, s[32:35], s22 offen offset:0 nt
  buffer_load_dwordx4 a[148:151], v1, s[32:35], s22 offen offset:128 nt
  buffer_load_dwordx4 a[152:155], v1, s[32:35], s22 offen offset:256 nt
  s_mov_b32 s22, 50626560
  buffer_load_dwordx4 a[156:159], v1, s[32:35], s22 offen offset:0 nt
  buffer_load_dwordx4 a[160:163], v1, s[32:35], s22 offen offset:128 nt
  buffer_load_dwordx4 a[164:167], v1, s[32:35], s22 offen offset:256 nt
  v_max_f32_dpp v43, v34, v34 quad_perm:[1,0,3,2] row_mask:0xf bank_mask:0xf
  v_mov_b32 v42, v43
  s_nop 1
  v_permlane32_swap_b32 v43, v42
  v_max_f32 v43, v43, v42
  v_mov_b32 v42, v43
  s_nop 1
  v_permlane16_swap_b32 v43, v42
  v_max_f32 v43, v43, v42
  v_sub_f32 v43, v34, v43
  v_mul_f32 v43, 0x3dd53b95, v43
  v_exp_f32 v43, v43
  s_nop 0
  v_mul_f32 v35, v35, v43
  v_mul_f32_dpp v26, v43, v26 quad_perm:[0,0,2,2] row_mask:0xf bank_mask:0xf
  v_mul_f32_dpp v27, v43, v27 quad_perm:[0,0,2,2] row_mask:0xf bank_mask:0xf
  v_mul_f32_dpp v28, v43, v28 quad_perm:[0,0,2,2] row_mask:0xf bank_mask:0xf
  v_add_f32_dpp v29, v35, v35 quad_perm:[1,0,3,2] row_mask:0xf bank_mask:0xf
  v_fmac_f32_dpp v26, v43, v30 quad_perm:[1,1,3,3] row_mask:0xf bank_mask:0xf
  v_fmac_f32_dpp v27, v43, v31 quad_perm:[1,1,3,3] row_mask:0xf bank_mask:0xf
  v_fmac_f32_dpp v28, v43, v32 quad_perm:[1,1,3,3] row_mask:0xf bank_mask:0xf
  s_nop 0
  v_permlane32_swap_b32 v26, v27
  v_permlane32_swap_b32 v28, v29
  v_add_f32 v26, v26, v27
  v_add_f32 v28, v28, v29
  s_nop 1
  v_permlane16_swap_b32 v26, v28
  v_add_f32 v48, v26, v28
  v_lshrrev_b32 v45, 4, v0
  v_readlane_b32 s92, v48, 48
  v_lshlrev_b32 v45, 3, v45
  v_add_u32 v44, 159744, v45
  v_rcp_f32 v43, s92
  s_mov_b32 exec_hi, 0xffff
  v_mul_f32 v48, v48, v43
  v_cvt_pk_bf16_f32 v48, v48, v48
  ds_write_b16 v49, v48
  s_mov_b64 exec, -1
  s_waitcnt lgkmcnt(0)
  s_barrier
  ds_read2_b64 v[26:29], v44 offset0:0 offset1:4
  ds_read2_b64 v[30:33], v44 offset0:8 offset1:12
  ds_read2_b64 v[34:37], v44 offset0:16 offset1:20
  v_mov_b32 v48, v44
  s_add_u32 s76, s82, 262144
  s_lshl_b32 s91, s3, 4
  s_lshl_b64 vcc, 2, s91
  s_or_b32 s91, vcc_lo, 0x1001d
  s_or_b32 s92, vcc_hi, 0x10001
  v_mov_b32 v49, 0xffffff00
  s_waitcnt lgkmcnt(2)
  v_mfma_f32_16x16x32_bf16 v[38:41], v[50:53], v[26:29], 0
  v_mfma_f32_16x16x32_bf16 v[42:45], v[54:57], v[26:29], 0
  ds_read2_b64 v[26:29], v48 offset0:24 offset1:28
  ds_read_b64_tr_b16 v[50:51], v46 offset:15360
  ds_read_b64_tr_b16 v[52:53], v46 offset:17920
  ds_read_b64_tr_b16 v[54:55], v47 offset:15360
  ds_read_b64_tr_b16 v[56:57], v47 offset:17920
  s_waitcnt lgkmcnt(6)
  v_mfma_f32_16x16x32_bf16 v[38:41], v[58:61], v[30:33], v[38:41]
  v_mfma_f32_16x16x32_bf16 v[42:45], v[62:65], v[30:33], v[42:45]
  ds_read2_b64 v[30:33], v48 offset0:32 offset1:36
  ds_read_b64_tr_b16 v[58:59], v46 offset:20480
  ds_read_b64_tr_b16 v[60:61], v46 offset:23040
  ds_read_b64_tr_b16 v[62:63], v47 offset:20480
  ds_read_b64_tr_b16 v[64:65], v47 offset:23040
  s_waitcnt lgkmcnt(10)
  v_mfma_f32_16x16x32_bf16 v[38:41], v[66:69], v[34:37], v[38:41]
  v_mfma_f32_16x16x32_bf16 v[42:45], v[70:73], v[34:37], v[42:45]
  ds_read2_b64 v[34:37], v48 offset0:40 offset1:44
  ds_read_b64_tr_b16 v[66:67], v46 offset:25600
  ds_read_b64_tr_b16 v[68:69], v46 offset:28160
  ds_read_b64_tr_b16 v[70:71], v47 offset:25600
  ds_read_b64_tr_b16 v[72:73], v47 offset:28160
  s_waitcnt lgkmcnt(10)
  v_mfma_f32_16x16x32_bf16 v[38:41], v[50:53], v[26:29], v[38:41]
  v_mfma_f32_16x16x32_bf16 v[42:45], v[54:57], v[26:29], v[42:45]
  s_waitcnt lgkmcnt(5)
  v_mfma_f32_16x16x32_bf16 v[38:41], v[58:61], v[30:33], v[38:41]
  v_mfma_f32_16x16x32_bf16 v[42:45], v[62:65], v[30:33], v[42:45]
  s_waitcnt lgkmcnt(0)
  v_mfma_f32_16x16x32_bf16 v[38:41], v[66:69], v[34:37], v[38:41]
  v_mfma_f32_16x16x32_bf16 v[42:45], v[70:73], v[34:37], v[42:45]
  s_nop 7
  v_cndmask_b32 v26, v38, v42, vcc
  v_cndmask_b32 v27, v39, v43, vcc
  v_cndmask_b32 v28, v40, v44, vcc
  v_cndmask_b32 v29, v41, v45, vcc
  s_mov_b32 exec_lo, s91
  s_mov_b32 exec_hi, s92
  v_and_or_b32 v26, v26, v49, s68
  v_and_or_b32 v27, v27, v49, s69
  v_and_or_b32 v28, v28, v49, s70
  v_and_or_b32 v29, v29, v49, s90
  buffer_store_dwordx4 v[26:29], v74, s[64:67], s76 offen sc1
  s_mov_b64 exec, -1
  v_bfe_u32 v72, v0, 2, 3
  v_lshrrev_b32 v71, 5, v0
  v_mul_u32_u24 v71, 3072, v71
  v_lshl_add_u32 v71, v72, 7, v71
  v_and_b32 v73, 3, v0
  v_lshl_add_u32 v71, v73, 3, v71
  v_lshrrev_b32 v72, 1, v72
  s_mul_i32 s91, s3, 3
  s_add_u32 s91, s91, 0
  s_and_b32 s92, s91, 3
  s_lshr_b32 s91, s91, 2
  v_xor_b32 v73, s92, v72
  s_lshl_b32 s91, s91, 10
  s_add_u32 s91, s91, 32768
  v_lshl_add_u32 v73, v73, 5, v71
  v_add_u32 v42, s91, v73
  ds_read_b64_tr_b16 v[44:45], v42 offset:0
  ds_read_b64_tr_b16 v[46:47], v42 offset:6144
  ds_read_b64_tr_b16 v[48:49], v42 offset:12288
  ds_read_b64_tr_b16 v[50:51], v42 offset:18432
  ds_read_b64_tr_b16 v[52:53], v42 offset:24576
  s_mul_i32 s91, s3, 3
  s_add_u32 s91, s91, 1
  s_and_b32 s92, s91, 3
  s_lshr_b32 s91, s91, 2
  v_xor_b32 v73, s92, v72
  s_lshl_b32 s91, s91, 10
  s_add_u32 s91, s91, 32768
  v_lshl_add_u32 v73, v73, 5, v71
  v_add_u32 v43, s91, v73
  ds_read_b64_tr_b16 v[54:55], v43 offset:0
  ds_read_b64_tr_b16 v[56:57], v43 offset:6144
  ds_read_b64_tr_b16 v[58:59], v43 offset:12288
  ds_read_b64_tr_b16 v[60:61], v43 offset:18432
  ds_read_b64_tr_b16 v[62:63], v43 offset:24576
  s_mul_i32 s91, s3, 3
  s_add_u32 s91, s91, 2
  s_and_b32 s92, s91, 3
  s_lshr_b32 s91, s91, 2
  v_xor_b32 v73, s92, v72
  s_lshl_b32 s91, s91, 10
  s_add_u32 s91, s91, 32768
  v_lshl_add_u32 v73, v73, 5, v71
  v_add_u32 v42, s91, v73
  ds_read_b64_tr_b16 v[64:65], v42 offset:0
  ds_read_b64_tr_b16 v[66:67], v42 offset:6144
  ds_read_b64_tr_b16 v[68:69], v42 offset:12288
  ds_read_b64_tr_b16 v[70:71], v42 offset:18432
  ds_read_b64_tr_b16 v[72:73], v42 offset:24576
  v_mov_b32 v75, 160288
  v_mov_b32 v32, 161216
  s_mov_b32 vcc_lo, 0x00f000f0
  s_mov_b32 vcc_hi, 0x00f000f0
  v_cndmask_b32 v75, v75, v32, vcc
  v_lshrrev_b32 v32, 4, v0
  v_lshl_add_u32 v75, v32, 3, v75
  ds_read2_b64 v[34:37], v75 offset0:0 offset1:4
  ds_read2_b64 v[38:41], v75 offset0:8 offset1:12
  ds_read_b64 v[42:43], v75 offset:128
  s_add_u32 s73, s72, 0
  s_add_u32 s76, s80, 1048576
  s_mul_i32 s91, s31, 240
  s_sub_u32 s91, 2048, s91
  v_lshlrev_b32 v74, 4, v0
  v_writelane_b32 v74, s91, 32
  s_waitcnt lgkmcnt(0)
  v_mfma_f32_16x16x32_bf16 v[26:29], v[34:37], v[44:47], 0
  v_mfma_f32_16x16x32_bf16 v[30:33], v[34:37], v[54:57], 0
  v_mfma_f32_16x16x32_bf16 v[26:29], v[38:41], v[48:51], v[26:29]
  v_mfma_f32_16x16x32_bf16 v[30:33], v[38:41], v[58:61], v[30:33]
  v_mfma_f32_16x16x16_bf16 v[26:29], v[42:43], v[52:53], v[26:29]
  v_mfma_f32_16x16x16_bf16 v[30:33], v[42:43], v[62:63], v[30:33]
  v_mfma_f32_16x16x32_bf16 v[48:51], v[34:37], v[34:37], 0
  v_mfma_f32_16x16x32_bf16 v[44:47], v[34:37], v[64:67], 0
  v_mfma_f32_16x16x32_bf16 v[48:51], v[38:41], v[38:41], v[48:51]
  v_mfma_f32_16x16x32_bf16 v[44:47], v[38:41], v[68:71], v[44:47]
  v_mfma_f32_16x16x16_bf16 v[48:51], v[42:43], v[42:43], v[48:51]
  v_mfma_f32_16x16x16_bf16 v[44:47], v[42:43], v[72:73], v[44:47]
  s_nop 0
  v_mov_b32 v29, s73
  v_mov_b32 v27, v30
  s_nop 4
  v_mov_b32 v28, v44
  v_mov_b32_dpp v26, v48 quad_perm:[0,1,2,3] row_mask:0x4 bank_mask:0xf
  v_mov_b32_dpp v27, v48 row_ror:12 row_mask:0x4 bank_mask:0xf
  s_mov_b32 exec_lo, 0xffff
  s_mov_b32 exec_hi, 1
  buffer_store_dwordx4 v[26:29], v74, s[64:67], s76 offen sc1
  s_mov_b64 exec, -1
  s_waitcnt vmcnt(0)
  v_bfe_u32 v72, v0, 2, 3
  v_lshrrev_b32 v71, 5, v0
  v_mul_u32_u24 v71, 3072, v71
  v_lshl_add_u32 v71, v72, 7, v71
  v_and_b32 v73, 3, v0
  v_lshl_add_u32 v71, v73, 3, v71
  v_lshrrev_b32 v72, 1, v72
  s_mul_i32 s91, s3, 3
  s_add_u32 s91, s91, 0
  s_and_b32 s92, s91, 3
  s_lshr_b32 s91, s91, 2
  v_xor_b32 v73, s92, v72
  s_lshl_b32 s91, s91, 10
  s_add_u32 s91, s91, 32768
  v_lshl_add_u32 v73, v73, 5, v71
  v_add_u32 v42, s91, v73
  ds_read_b64_tr_b16 v[44:45], v42 offset:0
  ds_read_b64_tr_b16 v[46:47], v42 offset:6144
  ds_read_b64_tr_b16 v[48:49], v42 offset:12288
  ds_read_b64_tr_b16 v[50:51], v42 offset:18432
  ds_read_b64_tr_b16 v[52:53], v42 offset:24576
  s_mul_i32 s91, s3, 3
  s_add_u32 s91, s91, 1
  s_and_b32 s92, s91, 3
  s_lshr_b32 s91, s91, 2
  v_xor_b32 v73, s92, v72
  s_lshl_b32 s91, s91, 10
  s_add_u32 s91, s91, 32768
  v_lshl_add_u32 v73, v73, 5, v71
  v_add_u32 v43, s91, v73
  ds_read_b64_tr_b16 v[54:55], v43 offset:0
  ds_read_b64_tr_b16 v[56:57], v43 offset:6144
  ds_read_b64_tr_b16 v[58:59], v43 offset:12288
  ds_read_b64_tr_b16 v[60:61], v43 offset:18432
  ds_read_b64_tr_b16 v[62:63], v43 offset:24576
  s_mul_i32 s91, s3, 3
  s_add_u32 s91, s91, 2
  s_and_b32 s92, s91, 3
  s_lshr_b32 s91, s91, 2
  v_xor_b32 v73, s92, v72
  s_lshl_b32 s91, s91, 10
  s_add_u32 s91, s91, 32768
  v_lshl_add_u32 v73, v73, 5, v71
  v_add_u32 v42, s91, v73
  ds_read_b64_tr_b16 v[64:65], v42 offset:0
  ds_read_b64_tr_b16 v[66:67], v42 offset:6144
  ds_read_b64_tr_b16 v[68:69], v42 offset:12288
  ds_read_b64_tr_b16 v[70:71], v42 offset:18432
  ds_read_b64_tr_b16 v[72:73], v42 offset:24576
  s_add_u32 s73, s72, 1
  v_lshrrev_b32 v74, 3, v0
  v_and_b32 v75, 7, v0
  v_mul_u32_u24 v74, 128, v74
  v_lshl_add_u32 v74, v75, 4, v74
  s_add_u32 s97, s83, 262144
  s_mov_b32 exec_lo, 0x1f1f1f1f
  s_mov_b32 exec_hi, 0x1f1f1f1f
  buffer_load_dwordx4 v[26:29], v74, s[64:67], s97 offen offset:0 sc1
  buffer_load_dwordx4 v[30:33], v74, s[64:67], s97 offen offset:1024 sc1
  buffer_load_dwordx4 v[34:37], v74, s[64:67], s97 offen offset:2048 sc1
  buffer_load_dwordx4 v[38:41], v74, s[64:67], s97 offen offset:3072 sc1
  s_mov_b64 exec, -1
  s_bfe_u32 s68, s73, 0x80000
  s_bfe_u32 s69, s73, 0x80008
  s_bfe_u32 s70, s73, 0x80010
  s_bfe_u32 s90, s73, 0x80018
  s_waitcnt vmcnt(0)
  s_mov_b32 exec_lo, 0x1f1f1f1f
  s_mov_b32 exec_hi, 0x1f1f1f1f
L_chk_50101:
  v_xor_b32 v26, s68, v26
  v_xor_b32 v30, s68, v30
  v_xor_b32 v34, s68, v34
  v_xor_b32 v38, s68, v38
  v_xor_b32 v27, s69, v27
  v_xor_b32 v31, s69, v31
  v_xor_b32 v35, s69, v35
  v_xor_b32 v39, s69, v39
  v_xor_b32 v28, s70, v28
  v_xor_b32 v32, s70, v32
  v_xor_b32 v36, s70, v36
  v_xor_b32 v40, s70, v40
  v_xor_b32 v29, s90, v29
  v_xor_b32 v33, s90, v33
  v_xor_b32 v37, s90, v37
  v_xor_b32 v41, s90, v41
  v_or3_b32 v75, v26, v30, v34
  v_or3_b32 v75, v75, v38, v27
  v_or3_b32 v75, v75, v31, v35
  v_or3_b32 v75, v75, v39, v28
  v_or3_b32 v75, v75, v32, v36
  v_or3_b32 v75, v75, v40, v29
  v_or3_b32 v75, v75, v33, v37
  v_or3_b32 v75, v75, v41, v41
  v_and_b32 v75, 0xff, v75
  v_cmp_ne_u32 vcc, 0, v75
  s_nop 0
  s_cbranch_vccz L_retry_50102
  buffer_load_dwordx4 v[26:29], v74, s[64:67], s97 offen offset:0 sc1
  buffer_load_dwordx4 v[30:33], v74, s[64:67], s97 offen offset:1024 sc1
  buffer_load_dwordx4 v[34:37], v74, s[64:67], s97 offen offset:2048 sc1
  buffer_load_dwordx4 v[38:41], v74, s[64:67], s97 offen offset:3072 sc1
  s_sub_u32 s75, s75, 1
  s_cbranch_scc1 L_end
  s_waitcnt vmcnt(0)
  s_branch L_chk_50101
L_retry_50102:
  v_pk_add_f32 v[26:27], v[26:27], v[30:31]
  v_pk_add_f32 v[28:29], v[28:29], v[32:33]
  v_pk_add_f32 v[34:35], v[34:35], v[38:39]
  v_pk_add_f32 v[36:37], v[36:37], v[40:41]
  v_pk_add_f32 v[26:27], v[26:27], v[34:35]
  v_pk_add_f32 v[28:29], v[28:29], v[36:37]
  v_add_u32 v33, 160128, v24
  v_add_f32_dpp v30, v26, v26 row_ror:8 row_mask:0xf bank_mask:0x3
  v_add_f32_dpp v31, v28, v28 row_ror:8 row_mask:0xf bank_mask:0x3
  s_nop 0
  v_add_f32_dpp v30, v27, v27 row_ror:8 row_mask:0xf bank_mask:0xc
  v_add_f32_dpp v31, v29, v29 row_ror:8 row_mask:0xf bank_mask:0xc
  s_nop 1
  v_permlane32_swap_b32 v30, v31
  v_add_f32 v30, v30, v31
  v_mov_b32 v31, v30
  s_nop 1
  v_permlane16_swap_b32 v30, v31
  v_add_f32 v30, v30, v31
  v_cvt_pk_bf16_f32 v30, v30, v30
  v_and_b32 v30, 0xffff0000, v30
  v_add_f32 v30, v30, v7
  v_cvt_pk_bf16_f32 v31, v30, v30
  ds_write_b16 v33, v31
  v_and_b32 v7, 0xffff0000, v31
  s_mov_b64 exec, -1
  v_mov_b32 v75, 160128
  v_mov_b32 v32, 161216
  s_mov_b32 vcc_lo, 0x00f000f0
  s_mov_b32 vcc_hi, 0x00f000f0
  v_cndmask_b32 v75, v75, v32, vcc
  v_lshrrev_b32 v32, 4, v0
  v_lshl_add_u32 v75, v32, 3, v75
  s_waitcnt lgkmcnt(0)
  s_barrier
  ds_read2_b64 v[34:37], v75 offset0:0 offset1:4
  ds_read2_b64 v[38:41], v75 offset0:8 offset1:12
  ds_read_b64 v[42:43], v75 offset:128
  s_add_u32 s73, s72, 2
  s_add_u32 s76, s80, 2097152
  s_mul_i32 s91, s31, 240
  s_sub_u32 s91, 2048, s91
  v_lshlrev_b32 v74, 4, v0
  v_writelane_b32 v74, s91, 32
  s_waitcnt lgkmcnt(0)
  v_mfma_f32_16x16x32_bf16 v[26:29], v[34:37], v[44:47], 0
  v_mfma_f32_16x16x32_bf16 v[30:33], v[34:37], v[54:57], 0
  v_mfma_f32_16x16x32_bf16 v[26:29], v[38:41], v[48:51], v[26:29]
  v_mfma_f32_16x16x32_bf16 v[30:33], v[38:41], v[58:61], v[30:33]
  v_mfma_f32_16x16x16_bf16 v[26:29], v[42:43], v[52:53], v[26:29]
  v_mfma_f32_16x16x16_bf16 v[30:33], v[42:43], v[62:63], v[30:33]
  v_mfma_f32_16x16x32_bf16 v[48:51], v[34:37], v[34:37], 0
  v_mfma_f32_16x16x32_bf16 v[44:47], v[34:37], v[64:67], 0
  v_mfma_f32_16x16x32_bf16 v[48:51], v[38:41], v[38:41], v[48:51]
  v_mfma_f32_16x16x32_bf16 v[44:47], v[38:41], v[68:71], v[44:47]
  v_mfma_f32_16x16x16_bf16 v[48:51], v[42:43], v[42:43], v[48:51]
  v_mfma_f32_16x16x16_bf16 v[44:47], v[42:43], v[72:73], v[44:47]
  s_nop 0
  v_mov_b32 v29, s73
  v_mov_b32 v27, v30
  s_nop 4
  v_mov_b32 v28, v44
  v_mov_b32_dpp v26, v48 quad_perm:[0,1,2,3] row_mask:0x4 bank_mask:0xf
  v_mov_b32_dpp v27, v48 row_ror:12 row_mask:0x4 bank_mask:0xf
  s_mov_b32 exec_lo, 0xffff
  s_mov_b32 exec_hi, 1
  buffer_store_dwordx4 v[26:29], v74, s[64:67], s76 offen sc1
  s_mov_b64 exec, -1
  s_add_u32 s73, s72, 2
  v_and_b32 v38, 7, v0
  s_add_u32 s91, s27, 2048
  v_lshl_add_u32 v38, v38, 4, s91
  s_add_u32 s97, s81, 2097152
  buffer_load_dwordx4 v[34:37], v38, s[64:67], s97 offen sc1
  buffer_load_dwordx4 v[26:29], v6, s[64:67], s97 offen offset:0 sc1
  buffer_load_dwordx4 v[30:33], v6, s[64:67], s97 offen offset:1024 sc1
  v_and_b32 v58, 15, v0
  v_bfe_u32 v60, v0, 4, 1
  v_lshl_add_u32 v58, v60, 5, v58
  v_lshrrev_b32 v60, 5, v0
  v_lshl_add_u32 v58, v60, 4, v58
  s_mul_i32 s91, s3, 96
  s_add_u32 s91, s91, 160448
  v_lshl_add_u32 v58, v58, 1, s91
  v_lshrrev_b32 v61, 2, v6
  v_add_u32 v61, 161504, v61
  ds_read_b32 v60, v61
  s_waitcnt vmcnt(0)
L_chk_50103:
  v_bitop3_b32 v75, v37, v29, s73 bitop3:0x7e
  v_bitop3_b32 v75, v75, v33, s73 bitop3:0xf6
  v_cmp_ne_u32 vcc, 0, v75
  s_nop 0
  s_cbranch_vccz L_retry_50104
  buffer_load_dwordx4 v[34:37], v38, s[64:67], s97 offen sc1
  buffer_load_dwordx4 v[26:29], v6, s[64:67], s97 offen offset:0 sc1
  buffer_load_dwordx4 v[30:33], v6, s[64:67], s97 offen offset:1024 sc1
  s_sub_u32 s75, s75, 1
  s_cbranch_scc1 L_end
  s_waitcnt vmcnt(0)
  s_branch L_chk_50103
L_retry_50104:
  s_mov_b32 s22, 50331648
  buffer_load_dwordx4 a[108:111], v1, s[36:39], s22 offen offset:0 nt
  buffer_load_dwordx4 a[112:115], v1, s[36:39], s22 offen offset:128 nt
  buffer_load_dwordx4 a[116:119], v1, s[36:39], s22 offen offset:256 nt
  v_pk_add_f32 v[26:27], v[26:27], v[30:31]
  v_add_f32 v28, v28, v32
  v_mov_b32 v29, v28
  v_add_f32_dpp v34, v34, v34 quad_perm:[1,0,3,2] row_mask:0xf bank_mask:0xf
  v_add_f32_dpp v35, v35, v35 quad_perm:[1,0,3,2] row_mask:0xf bank_mask:0xf
  v_permlane32_swap_b32 v26, v27
  v_permlane32_swap_b32 v28, v29
  v_add_f32_dpp v34, v34, v34 quad_perm:[2,3,0,1] row_mask:0xf bank_mask:0xf
  v_add_f32_dpp v35, v35, v35 quad_perm:[2,3,0,1] row_mask:0xf bank_mask:0xf
  v_add_f32 v26, v26, v27
  v_add_f32 v28, v28, v29
  v_add_f32_dpp v34, v34, v34 row_half_mirror row_mask:0xf bank_mask:0xf
  v_add_f32_dpp v35, v35, v35 row_half_mirror row_mask:0xf bank_mask:0xf
  v_permlane16_swap_b32 v26, v28
  v_mul_f32 v35, 0x3acccccd, v35
  v_mul_f32 v34, 0x3acccccd, v34
  v_add_f32 v62, v26, v28
  v_fma_f32 v34, -v35, v35, v34
  v_max_f32 v34, 0, v34
  v_add_f32 v34, 0x3727c5ac, v34
  v_rsq_f32 v34, v34
  s_waitcnt lgkmcnt(0)
  v_fma_f32 v62, -v35, v60, v62
  s_mov_b32 exec_hi, 0xffff
  v_mul_f32 v62, v62, v34
  v_cvt_pk_bf16_f32 v62, v62, v62
  ds_write_b16 v58, v62
  s_mov_b64 exec, -1
  s_waitcnt lgkmcnt(0)
  s_barrier
  v_and_b32 v66, 7, v0
  v_lshlrev_b32 v66, 4, v66
  v_add_u32 v66, 160448, v66
  ds_read_b128 v[26:29], v66 offset:0
  ds_read_b128 v[30:33], v66 offset:128
  ds_read_b128 v[34:37], v66 offset:256
  s_waitcnt lgkmcnt(0)
.balignl 8, 0xBF800000
  v_mfma_f32_4x4x4_16b_bf16 v[44:47], v[26:27], v[76:77], 0
  v_mfma_f32_4x4x4_16b_bf16 v[48:51], v[26:27], v[88:89], 0
  v_nop_e64
  v_mfma_f32_4x4x4_16b_bf16 v[44:47], v[28:29], v[78:79], v[44:47]
  v_mfma_f32_4x4x4_16b_bf16 v[48:51], v[28:29], v[90:91], v[48:51]
  v_nop_e64
  v_mfma_f32_4x4x4_16b_bf16 v[44:47], v[30:31], v[80:81], v[44:47]
  v_mfma_f32_4x4x4_16b_bf16 v[48:51], v[30:31], v[92:93], v[48:51]
  v_nop_e64
  v_mfma_f32_4x4x4_16b_bf16 v[44:47], v[32:33], v[82:83], v[44:47]
  v_mfma_f32_4x4x4_16b_bf16 v[48:51], v[32:33], v[94:95], v[48:51]
  v_nop_e64
  v_mfma_f32_4x4x4_16b_bf16 v[44:47], v[34:35], v[84:85], v[44:47]
  v_mfma_f32_4x4x4_16b_bf16 v[48:51], v[34:35], v[96:97], v[48:51]
  v_nop_e64
  v_mfma_f32_4x4x4_16b_bf16 v[44:47], v[36:37], v[86:87], v[44:47]
  v_mfma_f32_4x4x4_16b_bf16 v[48:51], v[36:37], v[98:99], v[48:51]
  v_mfma_f32_4x4x4_16b_bf16 v[52:55], v[26:27], v[100:101], 0
  v_mfma_f32_4x4x4_16b_bf16 v[56:59], v[26:27], v[112:113], 0
  v_nop_e64
  v_mfma_f32_4x4x4_16b_bf16 v[52:55], v[28:29], v[102:103], v[52:55]
  v_mov_b32_dpp v60, v44 quad_perm:[0,0,0,0] row_mask:0xf bank_mask:0xf
  v_mfma_f32_4x4x4_16b_bf16 v[56:59], v[28:29], v[114:115], v[56:59]
  v_mov_b32_dpp v61, v48 quad_perm:[0,0,0,0] row_mask:0xf bank_mask:0xf
  v_mfma_f32_4x4x4_16b_bf16 v[52:55], v[30:31], v[104:105], v[52:55]
  v_add_f32_dpp v60, v45, v60 quad_perm:[1,1,1,1] row_mask:0xf bank_mask:0xf
  v_mfma_f32_4x4x4_16b_bf16 v[56:59], v[30:31], v[116:117], v[56:59]
  v_add_f32_dpp v61, v49, v61 quad_perm:[1,1,1,1] row_mask:0xf bank_mask:0xf
  v_mfma_f32_4x4x4_16b_bf16 v[52:55], v[32:33], v[106:107], v[52:55]
  v_add_f32_dpp v60, v46, v60 quad_perm:[2,2,2,2] row_mask:0xf bank_mask:0xf
  v_mfma_f32_4x4x4_16b_bf16 v[56:59], v[32:33], v[118:119], v[56:59]
  v_add_f32_dpp v61, v50, v61 quad_perm:[2,2,2,2] row_mask:0xf bank_mask:0xf
  v_mfma_f32_4x4x4_16b_bf16 v[52:55], v[34:35], v[108:109], v[52:55]
  v_add_f32_dpp v38, v47, v60 quad_perm:[3,3,3,3] row_mask:0xf bank_mask:0xf
  v_mfma_f32_4x4x4_16b_bf16 v[56:59], v[34:35], v[120:121], v[56:59]
  v_add_f32_dpp v61, v51, v61 quad_perm:[3,3,3,3] row_mask:0xf bank_mask:0xf
  v_mfma_f32_4x4x4_16b_bf16 v[52:55], v[36:37], v[110:111], v[52:55]
  v_mfma_f32_4x4x4_16b_bf16 v[56:59], v[36:37], v[122:123], v[56:59]
  v_cndmask_b32 v38, v38, v61, s[84:85]
  s_nop 0
  s_nop 1
  v_mov_b32_dpp v62, v52 quad_perm:[0,0,0,0] row_mask:0xf bank_mask:0xf
  v_mov_b32_dpp v63, v56 quad_perm:[0,0,0,0] row_mask:0xf bank_mask:0xf
  v_nop_e64
  v_add_f32_dpp v62, v53, v62 quad_perm:[1,1,1,1] row_mask:0xf bank_mask:0xf
  v_add_f32_dpp v63, v57, v63 quad_perm:[1,1,1,1] row_mask:0xf bank_mask:0xf
  v_nop_e64
  v_add_f32_dpp v62, v54, v62 quad_perm:[2,2,2,2] row_mask:0xf bank_mask:0xf
  v_add_f32_dpp v63, v58, v63 quad_perm:[2,2,2,2] row_mask:0xf bank_mask:0xf
  v_nop_e64
  v_add_f32_dpp v62, v55, v62 quad_perm:[3,3,3,3] row_mask:0xf bank_mask:0xf
  v_add_f32_dpp v63, v59, v63 quad_perm:[3,3,3,3] row_mask:0xf bank_mask:0xf
  v_cndmask_b32 v38, v38, v62, s[86:87]
  v_cndmask_b32 v38, v38, v63, s[88:89]
  s_nop 0
  s_nop 0
  v_add_f32_dpp v38, v38, v38 row_half_mirror row_mask:0xf bank_mask:0xf
  s_nop 1
  v_max_f32_dpp v66, v38, v38 quad_perm:[1,0,3,2] row_mask:0xf bank_mask:0xf
  s_nop 1
  v_max_f32_dpp v66, v66, v66 quad_perm:[2,3,0,1] row_mask:0xf bank_mask:0xf
  s_nop 1
  v_max_f32_dpp v66, v66, v66 row_ror:8 row_mask:0xf bank_mask:0xf
  s_nop 1
  v_max_f32_dpp v66, v66, v66 row_bcast:15 row_mask:0xa bank_mask:0xf
  s_nop 1
  v_max_f32_dpp v66, v66, v66 row_bcast:31 row_mask:0xc bank_mask:0xf
  s_nop 0
  v_readlane_b32 s95, v66, 63
  v_mov_b32 v67, s21
  s_nop 0
  v_subrev_f32 v38, s95, v38
  v_mov_b32 v66, s95
  v_mul_f32 v38, 0x3dd53b95, v38
  ds_write_b32 v67, v66 offset:64
  v_exp_f32 v38, v38
  s_nop 1
  v_add_f32_dpp v68, v38, v38 quad_perm:[1,0,3,2] row_mask:0xf bank_mask:0xf
  v_cvt_pk_bf16_f32 v38, v38, v38
.balignl 8, 0xBF800000
  s_nop 0
  s_nop 0
  v_and_b32_dpp v46, v38, v2 quad_perm:[0,0,0,0] row_mask:0xf bank_mask:0xf
  v_and_b32_dpp v47, v38, v3 quad_perm:[0,0,0,0] row_mask:0xf bank_mask:0xf
  v_and_b32_dpp v48, v38, v4 quad_perm:[3,3,3,3] row_mask:0xf bank_mask:0xf
  v_and_b32_dpp v49, v38, v5 quad_perm:[3,3,3,3] row_mask:0xf bank_mask:0xf
  s_nop 0
  s_nop 0
  v_mfma_f32_16x16x32_bf16 v[26:29], v[46:49], v[124:127], 0
  v_and_b32_dpp v50, v38, v2 quad_perm:[1,1,1,1] row_mask:0xf bank_mask:0xf
  v_and_b32_dpp v51, v38, v3 quad_perm:[1,1,1,1] row_mask:0xf bank_mask:0xf
  v_mfma_f32_16x16x32_bf16 v[30:33], v[46:49], v[128:131], 0
  v_and_b32_dpp v52, v38, v4 quad_perm:[2,2,2,2] row_mask:0xf bank_mask:0xf
  v_and_b32_dpp v53, v38, v5 quad_perm:[2,2,2,2] row_mask:0xf bank_mask:0xf
  v_mfma_f32_16x16x32_bf16 v[34:37], v[46:49], v[132:135], 0
  v_add_f32_dpp v68, v68, v68 quad_perm:[2,3,0,1] row_mask:0xf bank_mask:0xf
  v_mfma_f32_16x16x32_bf16 v[26:29], v[50:53], v[136:139], v[26:29]
  v_and_b32_dpp v46, v38, v2 quad_perm:[2,2,2,2] row_mask:0xf bank_mask:0xf
  v_and_b32_dpp v47, v38, v3 quad_perm:[2,2,2,2] row_mask:0xf bank_mask:0xf
  v_mfma_f32_16x16x32_bf16 v[30:33], v[50:53], v[140:143], v[30:33]
  v_and_b32_dpp v48, v38, v4 quad_perm:[1,1,1,1] row_mask:0xf bank_mask:0xf
  v_and_b32_dpp v49, v38, v5 quad_perm:[1,1,1,1] row_mask:0xf bank_mask:0xf
  v_mfma_f32_16x16x32_bf16 v[34:37], v[50:53], v[144:147], v[34:37]
  v_add_f32_dpp v68, v68, v68 row_ror:8 row_mask:0xf bank_mask:0xf
  v_mfma_f32_16x16x32_bf16 v[26:29], v[46:49], v[148:151], v[26:29]
  v_and_b32_dpp v50, v38, v2 quad_perm:[3,3,3,3] row_mask:0xf bank_mask:0xf
  v_and_b32_dpp v51, v38, v3 quad_perm:[3,3,3,3] row_mask:0xf bank_mask:0xf
  v_mfma_f32_16x16x32_bf16 v[30:33], v[46:49], v[152:155], v[30:33]
  v_and_b32_dpp v52, v38, v4 quad_perm:[0,0,0,0] row_mask:0xf bank_mask:0xf
  v_and_b32_dpp v53, v38, v5 quad_perm:[0,0,0,0] row_mask:0xf bank_mask:0xf
  v_mfma_f32_16x16x32_bf16 v[34:37], v[46:49], v[156:159], v[34:37]
  v_add_f32_dpp v68, v68, v68 row_bcast:15 row_mask:0xa bank_mask:0xf
  v_mfma_f32_16x16x32_bf16 v[26:29], v[50:53], v[160:163], v[26:29]
  v_mfma_f32_16x16x32_bf16 v[30:33], v[50:53], v[164:167], v[30:33]
  v_mfma_f32_16x16x32_bf16 v[34:37], v[50:53], v[168:171], v[34:37]
  v_add_f32_dpp v68, v68, v68 row_bcast:31 row_mask:0xc bank_mask:0xf
  s_nop 0
  v_readlane_b32 s96, v68, 63
  v_lshrrev_b32 v60, 4, v0
  v_and_b32 v59, 15, v0
  v_lshlrev_b32 v58, 10, v60
  v_lshl_add_u32 v58, v59, 4, v58
  s_lshl_b32 s91, s3, 8
  s_add_u32 s91, s91, 155648
  v_add_u32 v58, s91, v58
  v_add_u32 v59, 155648, v6
  v_mov_b32 v49, s96
  v_permlane32_swap_b32 v26, v27
  v_permlane32_swap_b32 v28, v29
  v_permlane32_swap_b32 v30, v31
  v_permlane32_swap_b32 v32, v33
  v_permlane32_swap_b32 v34, v35
  v_permlane32_swap_b32 v36, v37
  v_add_f32_dpp v46, v27, v26 row_ror:8 row_mask:0xf bank_mask:0x3
  v_add_f32_dpp v47, v31, v30 row_ror:8 row_mask:0xf bank_mask:0x3
  v_add_f32_dpp v48, v35, v34 row_ror:8 row_mask:0xf bank_mask:0x3
  v_add_f32_dpp v46, v28, v29 row_ror:8 row_mask:0xf bank_mask:0xc
  v_add_f32_dpp v47, v32, v33 row_ror:8 row_mask:0xf bank_mask:0xc
  v_add_f32_dpp v48, v36, v37 row_ror:8 row_mask:0xf bank_mask:0xc
  ds_write_b128 v59, v[46:49]
  v_lshlrev_b32 v60, 2, v60
  v_add_u32 v60, 161440, v60
  v_mov_b32 v62, 161440
  s_waitcnt lgkmcnt(0)
  s_barrier
  ds_read_b128 v[54:57], v62
  ds_read_b32 v62, v60
  ds_read_b128 v[50:53], v58
  s_add_u32 s73, s72, 2
  s_mul_i32 s91, s31, 240
  s_sub_u32 s91, 2048, s91
  v_lshlrev_b32 v59, 4, v0
  v_writelane_b32 v59, s91, 16
  v_mov_b32 v49, s73
  s_add_u32 s76, s78, 0
  s_waitcnt lgkmcnt(1)
  v_max3_f32 v54, v54, v55, v56
  v_max_f32 v54, v54, v57
  v_sub_f32 v62, v62, v54
  v_mul_f32 v62, 0x3dd53b95, v62
  v_exp_f32 v62, v62
  s_waitcnt lgkmcnt(0)
  v_pk_mul_f32 v[50:51], v[50:51], v[62:63] op_sel_hi:[1,0]
  v_pk_mul_f32 v[52:53], v[52:53], v[62:63] op_sel_hi:[1,0]
  s_nop 0
  v_permlane32_swap_b32 v50, v51
  v_permlane32_swap_b32 v52, v53
  v_add_f32 v50, v50, v51
  v_add_f32 v52, v52, v53
  s_nop 1
  v_permlane16_swap_b32 v50, v52
  v_add_f32 v46, v50, v52
  v_add_f32 v47, v50, v52
  s_nop 1
  v_permlane32_swap_b32 v46, v47
  v_mov_b32 v48, v46
  s_nop 1
  v_permlane16_swap_b32 v46, v48
  s_nop 1
  v_mov_b32_dpp v46, v54 quad_perm:[0,1,2,3] row_mask:0x2 bank_mask:0xf
  s_mov_b64 exec, 0x1ffff
  buffer_store_dwordx4 v[46:49], v59, s[64:67], s76 offen sc1
  s_mov_b64 exec, -1
  s_add_u32 s73, s72, 2
  v_lshrrev_b32 v45, 4, v0
  v_and_b32 v44, 1, v0
  v_lshl_add_u32 v45, v44, 2, v45
  s_add_u32 s91, s27, 2048
  v_lshl_add_u32 v45, v45, 4, s91
  s_add_u32 s97, s79, 0
  buffer_load_dwordx4 v[34:37], v45, s[64:67], s97 offen sc1
  buffer_load_dwordx4 v[26:29], v6, s[64:67], s97 offen offset:0 sc1
  buffer_load_dwordx4 v[30:33], v6, s[64:67], s97 offen offset:1024 sc1
  v_lshrrev_b32 v46, 2, v0
  v_and_b32 v47, 3, v0
  v_mul_u32_u24 v46, 160, v46
  v_lshl_add_u32 v47, v47, 3, v46
  s_lshl_b32 s91, s3, 5
  s_add_u32 s91, s91, 94208
  v_add_u32 v46, s91, v47
  v_add_u32 v47, 94336, v47
  v_bfe_u32 v49, v0, 4, 1
  v_lshlrev_b32 v49, 8, v49
  v_lshrrev_b32 v48, 5, v0
  v_lshl_add_u32 v49, v48, 7, v49
  v_and_b32 v48, 7, v0
  v_lshl_add_u32 v49, v48, 4, v49
  v_bfe_u32 v48, v0, 3, 1
  v_lshl_add_u32 v49, v48, 2, v49
  s_and_b32 s91, s3, 1
  s_lshl_b32 s91, s91, 3
  s_and_b32 s92, s3, 2
  s_add_u32 s91, s91, s92
  s_add_u32 s91, s91, 159744
  v_add_u32 v49, s91, v49
  v_and_b32 v74, 0x30, v0
  s_lshl_b32 s91, s3, 4
  s_add_u32 s91, s91, 1
  v_writelane_b32 v74, 64, s91
  s_movk_i32 s91, 80
  v_writelane_b32 v74, s91, 2
  s_movk_i32 s91, 96
  v_writelane_b32 v74, s91, 3
  s_movk_i32 s91, 112
  v_writelane_b32 v74, s91, 4
  s_bfe_u32 s68, s73, 0x80000
  s_bfe_u32 s69, s73, 0x80008
  s_bfe_u32 s70, s73, 0x80010
  s_bfe_u32 s90, s73, 0x80018
  ds_read_b64_tr_b16 v[50:51], v46 offset:0
  ds_read_b64_tr_b16 v[52:53], v46 offset:2560
  ds_read_b64_tr_b16 v[54:55], v47 offset:0
  ds_read_b64_tr_b16 v[56:57], v47 offset:2560
  ds_read_b64_tr_b16 v[58:59], v46 offset:5120
  ds_read_b64_tr_b16 v[60:61], v46 offset:7680
  ds_read_b64_tr_b16 v[62:63], v47 offset:5120
  ds_read_b64_tr_b16 v[64:65], v47 offset:7680
  ds_read_b64_tr_b16 v[66:67], v46 offset:10240
  ds_read_b64_tr_b16 v[68:69], v46 offset:12800
  ds_read_b64_tr_b16 v[70:71], v47 offset:10240
  ds_read_b64_tr_b16 v[72:73], v47 offset:12800
  s_waitcnt vmcnt(0)
L_chk_50105:
  v_bitop3_b32 v75, v37, v29, s73 bitop3:0x7e
  v_bitop3_b32 v75, v75, v33, s73 bitop3:0xf6
  v_cmp_ne_u32 vcc, 0, v75
  s_nop 0
  s_cbranch_vccz L_retry_50106
  buffer_load_dwordx4 v[34:37], v45, s[64:67], s97 offen sc1
  buffer_load_dwordx4 v[26:29], v6, s[64:67], s97 offen offset:0 sc1
  buffer_load_dwordx4 v[30:33], v6, s[64:67], s97 offen offset:1024 sc1
  s_sub_u32 s75, s75, 1
  s_cbranch_scc1 L_end
  s_waitcnt vmcnt(0)
  s_branch L_chk_50105
L_retry_50106:
  s_mov_b32 s22, 50429952
  buffer_load_dwordx4 v[76:79], v1, s[36:39], s22 offen offset:0 nt
  buffer_load_dwordx4 v[80:83], v1, s[36:39], s22 offen offset:128 nt
  buffer_load_dwordx4 v[84:87], v1, s[36:39], s22 offen offset:256 nt
  s_mov_b32 s22, 50528256
  buffer_load_dwordx4 v[88:91], v1, s[36:39], s22 offen offset:0 nt
  buffer_load_dwordx4 v[92:95], v1, s[36:39], s22 offen offset:128 nt
  buffer_load_dwordx4 v[96:99], v1, s[36:39], s22 offen offset:256 nt
  v_max_f32_dpp v43, v34, v34 quad_perm:[1,0,3,2] row_mask:0xf bank_mask:0xf
  v_mov_b32 v42, v43
  s_nop 1
  v_permlane32_swap_b32 v43, v42
  v_max_f32 v43, v43, v42
  v_mov_b32 v42, v43
  s_nop 1
  v_permlane16_swap_b32 v43, v42
  v_max_f32 v43, v43, v42
  v_sub_f32 v43, v34, v43
  v_mul_f32 v43, 0x3dd53b95, v43
  v_exp_f32 v43, v43
  s_nop 0
  v_mul_f32 v35, v35, v43
  v_mul_f32_dpp v26, v43, v26 quad_perm:[0,0,2,2] row_mask:0xf bank_mask:0xf
  v_mul_f32_dpp v27, v43, v27 quad_perm:[0,0,2,2] row_mask:0xf bank_mask:0xf
  v_mul_f32_dpp v28, v43, v28 quad_perm:[0,0,2,2] row_mask:0xf bank_mask:0xf
  v_add_f32_dpp v29, v35, v35 quad_perm:[1,0,3,2] row_mask:0xf bank_mask:0xf
  v_fmac_f32_dpp v26, v43, v30 quad_perm:[1,1,3,3] row_mask:0xf bank_mask:0xf
  v_fmac_f32_dpp v27, v43, v31 quad_perm:[1,1,3,3] row_mask:0xf bank_mask:0xf
  v_fmac_f32_dpp v28, v43, v32 quad_perm:[1,1,3,3] row_mask:0xf bank_mask:0xf
  s_nop 0
  v_permlane32_swap_b32 v26, v27
  v_permlane32_swap_b32 v28, v29
  v_add_f32 v26, v26, v27
  v_add_f32 v28, v28, v29
  s_nop 1
  v_permlane16_swap_b32 v26, v28
  v_add_f32 v48, v26, v28
  v_lshrrev_b32 v45, 4, v0
  v_readlane_b32 s92, v48, 48
  v_lshlrev_b32 v45, 3, v45
  v_add_u32 v44, 159744, v45
  v_rcp_f32 v43, s92
  s_mov_b32 exec_hi, 0xffff
  v_mul_f32 v48, v48, v43
  v_cvt_pk_bf16_f32 v48, v48, v48
  ds_write_b16 v49, v48
  s_mov_b64 exec, -1
  s_waitcnt lgkmcnt(0)
  s_barrier
  ds_read2_b64 v[26:29], v44 offset0:0 offset1:4
  ds_read2_b64 v[30:33], v44 offset0:8 offset1:12
  ds_read2_b64 v[34:37], v44 offset0:16 offset1:20
  v_mov_b32 v48, v44
  s_add_u32 s76, s82, 524288
  s_lshl_b32 s91, s3, 4
  s_lshl_b64 vcc, 2, s91
  s_or_b32 s91, vcc_lo, 0x1001d
  s_or_b32 s92, vcc_hi, 0x10001
  v_mov_b32 v49, 0xffffff00
  s_waitcnt lgkmcnt(2)
  v_mfma_f32_16x16x32_bf16 v[38:41], v[50:53], v[26:29], 0
  v_mfma_f32_16x16x32_bf16 v[42:45], v[54:57], v[26:29], 0
  ds_read2_b64 v[26:29], v48 offset0:24 offset1:28
  ds_read_b64_tr_b16 v[50:51], v46 offset:15360
  ds_read_b64_tr_b16 v[52:53], v46 offset:17920
  ds_read_b64_tr_b16 v[54:55], v47 offset:15360
  ds_read_b64_tr_b16 v[56:57], v47 offset:17920
  s_waitcnt lgkmcnt(6)
  v_mfma_f32_16x16x32_bf16 v[38:41], v[58:61], v[30:33], v[38:41]
  v_mfma_f32_16x16x32_bf16 v[42:45], v[62:65], v[30:33], v[42:45]
  ds_read2_b64 v[30:33], v48 offset0:32 offset1:36
  ds_read_b64_tr_b16 v[58:59], v46 offset:20480
  ds_read_b64_tr_b16 v[60:61], v46 offset:23040
  ds_read_b64_tr_b16 v[62:63], v47 offset:20480
  ds_read_b64_tr_b16 v[64:65], v47 offset:23040
  s_waitcnt lgkmcnt(10)
  v_mfma_f32_16x16x32_bf16 v[38:41], v[66:69], v[34:37], v[38:41]
  v_mfma_f32_16x16x32_bf16 v[42:45], v[70:73], v[34:37], v[42:45]
  ds_read2_b64 v[34:37], v48 offset0:40 offset1:44
  ds_read_b64_tr_b16 v[66:67], v46 offset:25600
  ds_read_b64_tr_b16 v[68:69], v46 offset:28160
  ds_read_b64_tr_b16 v[70:71], v47 offset:25600
  ds_read_b64_tr_b16 v[72:73], v47 offset:28160
  s_waitcnt lgkmcnt(10)
  v_mfma_f32_16x16x32_bf16 v[38:41], v[50:53], v[26:29], v[38:41]
  v_mfma_f32_16x16x32_bf16 v[42:45], v[54:57], v[26:29], v[42:45]
  s_waitcnt lgkmcnt(5)
  v_mfma_f32_16x16x32_bf16 v[38:41], v[58:61], v[30:33], v[38:41]
  v_mfma_f32_16x16x32_bf16 v[42:45], v[62:65], v[30:33], v[42:45]
  s_waitcnt lgkmcnt(0)
  v_mfma_f32_16x16x32_bf16 v[38:41], v[66:69], v[34:37], v[38:41]
  v_mfma_f32_16x16x32_bf16 v[42:45], v[70:73], v[34:37], v[42:45]
  s_nop 7
  v_cndmask_b32 v26, v38, v42, vcc
  v_cndmask_b32 v27, v39, v43, vcc
  v_cndmask_b32 v28, v40, v44, vcc
  v_cndmask_b32 v29, v41, v45, vcc
  s_mov_b32 exec_lo, s91
  s_mov_b32 exec_hi, s92
  v_and_or_b32 v26, v26, v49, s68
  v_and_or_b32 v27, v27, v49, s69
  v_and_or_b32 v28, v28, v49, s70
  v_and_or_b32 v29, v29, v49, s90
  buffer_store_dwordx4 v[26:29], v74, s[64:67], s76 offen sc1
  s_mov_b64 exec, -1
  s_waitcnt vmcnt(0)
  v_bfe_u32 v72, v0, 2, 3
  v_lshrrev_b32 v71, 5, v0
  v_mul_u32_u24 v71, 3072, v71
  v_lshl_add_u32 v71, v72, 7, v71
  v_and_b32 v73, 3, v0
  v_lshl_add_u32 v71, v73, 3, v71
  v_lshrrev_b32 v72, 1, v72
  s_mul_i32 s91, s3, 3
  s_add_u32 s91, s91, 0
  s_and_b32 s92, s91, 3
  s_lshr_b32 s91, s91, 2
  v_xor_b32 v73, s92, v72
  s_lshl_b32 s91, s91, 10
  s_add_u32 s91, s91, 63488
  v_lshl_add_u32 v73, v73, 5, v71
  v_add_u32 v42, s91, v73
  ds_read_b64_tr_b16 v[44:45], v42 offset:0
  ds_read_b64_tr_b16 v[46:47], v42 offset:6144
  ds_read_b64_tr_b16 v[48:49], v42 offset:12288
  ds_read_b64_tr_b16 v[50:51], v42 offset:18432
  ds_read_b64_tr_b16 v[52:53], v42 offset:24576
  s_mul_i32 s91, s3, 3
  s_add_u32 s91, s91, 1
  s_and_b32 s92, s91, 3
  s_lshr_b32 s91, s91, 2
  v_xor_b32 v73, s92, v72
  s_lshl_b32 s91, s91, 10
  s_add_u32 s91, s91, 63488
  v_lshl_add_u32 v73, v73, 5, v71
  v_add_u32 v43, s91, v73
  ds_read_b64_tr_b16 v[54:55], v43 offset:0
  ds_read_b64_tr_b16 v[56:57], v43 offset:6144
  ds_read_b64_tr_b16 v[58:59], v43 offset:12288
  ds_read_b64_tr_b16 v[60:61], v43 offset:18432
  ds_read_b64_tr_b16 v[62:63], v43 offset:24576
  s_mul_i32 s91, s3, 3
  s_add_u32 s91, s91, 2
  s_and_b32 s92, s91, 3
  s_lshr_b32 s91, s91, 2
  v_xor_b32 v73, s92, v72
  s_lshl_b32 s91, s91, 10
  s_add_u32 s91, s91, 63488
  v_lshl_add_u32 v73, v73, 5, v71
  v_add_u32 v42, s91, v73
  ds_read_b64_tr_b16 v[64:65], v42 offset:0
  ds_read_b64_tr_b16 v[66:67], v42 offset:6144
  ds_read_b64_tr_b16 v[68:69], v42 offset:12288
  ds_read_b64_tr_b16 v[70:71], v42 offset:18432
  ds_read_b64_tr_b16 v[72:73], v42 offset:24576
  s_add_u32 s73, s72, 2
  v_lshrrev_b32 v74, 3, v0
  v_and_b32 v75, 7, v0
  v_mul_u32_u24 v74, 128, v74
  v_lshl_add_u32 v74, v75, 4, v74
  s_add_u32 s97, s83, 524288
  s_mov_b32 exec_lo, 0x1f1f1f1f
  s_mov_b32 exec_hi, 0x1f1f1f1f
  buffer_load_dwordx4 v[26:29], v74, s[64:67], s97 offen offset:0 sc1
  buffer_load_dwordx4 v[30:33], v74, s[64:67], s97 offen offset:1024 sc1
  buffer_load_dwordx4 v[34:37], v74, s[64:67], s97 offen offset:2048 sc1
  buffer_load_dwordx4 v[38:41], v74, s[64:67], s97 offen offset:3072 sc1
  s_mov_b64 exec, -1
  s_bfe_u32 s68, s73, 0x80000
  s_bfe_u32 s69, s73, 0x80008
  s_bfe_u32 s70, s73, 0x80010
  s_bfe_u32 s90, s73, 0x80018
  s_waitcnt vmcnt(0)
  s_mov_b32 exec_lo, 0x1f1f1f1f
  s_mov_b32 exec_hi, 0x1f1f1f1f
L_chk_50107:
  v_xor_b32 v26, s68, v26
  v_xor_b32 v30, s68, v30
  v_xor_b32 v34, s68, v34
  v_xor_b32 v38, s68, v38
  v_xor_b32 v27, s69, v27
  v_xor_b32 v31, s69, v31
  v_xor_b32 v35, s69, v35
  v_xor_b32 v39, s69, v39
  v_xor_b32 v28, s70, v28
  v_xor_b32 v32, s70, v32
  v_xor_b32 v36, s70, v36
  v_xor_b32 v40, s70, v40
  v_xor_b32 v29, s90, v29
  v_xor_b32 v33, s90, v33
  v_xor_b32 v37, s90, v37
  v_xor_b32 v41, s90, v41
  v_or3_b32 v75, v26, v30, v34
  v_or3_b32 v75, v75, v38, v27
  v_or3_b32 v75, v75, v31, v35
  v_or3_b32 v75, v75, v39, v28
  v_or3_b32 v75, v75, v32, v36
  v_or3_b32 v75, v75, v40, v29
  v_or3_b32 v75, v75, v33, v37
  v_or3_b32 v75, v75, v41, v41
  v_and_b32 v75, 0xff, v75
  v_cmp_ne_u32 vcc, 0, v75
  s_nop 0
  s_cbranch_vccz L_retry_50108
  buffer_load_dwordx4 v[26:29], v74, s[64:67], s97 offen offset:0 sc1
  buffer_load_dwordx4 v[30:33], v74, s[64:67], s97 offen offset:1024 sc1
  buffer_load_dwordx4 v[34:37], v74, s[64:67], s97 offen offset:2048 sc1
  buffer_load_dwordx4 v[38:41], v74, s[64:67], s97 offen offset:3072 sc1
  s_sub_u32 s75, s75, 1
  s_cbranch_scc1 L_end
  s_waitcnt vmcnt(0)
  s_branch L_chk_50107
L_retry_50108:
  s_mov_b64 exec, -1
  s_mov_b32 s22, 50626560
  buffer_load_dwordx4 v[100:103], v1, s[36:39], s22 offen offset:0 nt
  buffer_load_dwordx4 v[104:107], v1, s[36:39], s22 offen offset:128 nt
  buffer_load_dwordx4 v[108:111], v1, s[36:39], s22 offen offset:256 nt
  s_mov_b32 exec_lo, 0x1f1f1f1f
  s_mov_b32 exec_hi, 0x1f1f1f1f
  v_pk_add_f32 v[26:27], v[26:27], v[30:31]
  v_pk_add_f32 v[28:29], v[28:29], v[32:33]
  v_pk_add_f32 v[34:35], v[34:35], v[38:39]
  v_pk_add_f32 v[36:37], v[36:37], v[40:41]
  v_pk_add_f32 v[26:27], v[26:27], v[34:35]
  v_pk_add_f32 v[28:29], v[28:29], v[36:37]
  v_add_u32 v33, 160128, v24
  v_add_f32_dpp v30, v26, v26 row_ror:8 row_mask:0xf bank_mask:0x3
  v_add_f32_dpp v31, v28, v28 row_ror:8 row_mask:0xf bank_mask:0x3
  s_nop 0
  v_add_f32_dpp v30, v27, v27 row_ror:8 row_mask:0xf bank_mask:0xc
  v_add_f32_dpp v31, v29, v29 row_ror:8 row_mask:0xf bank_mask:0xc
  s_nop 1
  v_permlane32_swap_b32 v30, v31
  v_add_f32 v30, v30, v31
  v_mov_b32 v31, v30
  s_nop 1
  v_permlane16_swap_b32 v30, v31
  v_add_f32 v30, v30, v31
  v_cvt_pk_bf16_f32 v30, v30, v30
  v_and_b32 v30, 0xffff0000, v30
  v_add_f32 v30, v30, v7
  v_cvt_pk_bf16_f32 v31, v30, v30
  ds_write_b16 v33, v31
  v_and_b32 v7, 0xffff0000, v31
  s_mov_b64 exec, -1
  v_mov_b32 v75, 160128
  v_mov_b32 v32, 161216
  s_mov_b32 vcc_lo, 0x00f000f0
  s_mov_b32 vcc_hi, 0x00f000f0
  v_cndmask_b32 v75, v75, v32, vcc
  v_lshrrev_b32 v32, 4, v0
  v_lshl_add_u32 v75, v32, 3, v75
  s_waitcnt lgkmcnt(0)
  s_barrier
  ds_read2_b64 v[34:37], v75 offset0:0 offset1:4
  ds_read2_b64 v[38:41], v75 offset0:8 offset1:12
  ds_read_b64 v[42:43], v75 offset:128
  s_add_u32 s73, s72, 3
  s_add_u32 s76, s80, 2097152
  s_mul_i32 s91, s31, 240
  s_sub_u32 s91, 2048, s91
  v_lshlrev_b32 v74, 4, v0
  v_writelane_b32 v74, s91, 32
  s_waitcnt lgkmcnt(0)
  v_mfma_f32_16x16x32_bf16 v[26:29], v[34:37], v[44:47], 0
  v_mfma_f32_16x16x32_bf16 v[30:33], v[34:37], v[54:57], 0
  v_mfma_f32_16x16x32_bf16 v[26:29], v[38:41], v[48:51], v[26:29]
  v_mfma_f32_16x16x32_bf16 v[30:33], v[38:41], v[58:61], v[30:33]
  v_mfma_f32_16x16x16_bf16 v[26:29], v[42:43], v[52:53], v[26:29]
  v_mfma_f32_16x16x16_bf16 v[30:33], v[42:43], v[62:63], v[30:33]
  v_mfma_f32_16x16x32_bf16 v[48:51], v[34:37], v[34:37], 0
  v_mfma_f32_16x16x32_bf16 v[44:47], v[34:37], v[64:67], 0
  v_mfma_f32_16x16x32_bf16 v[48:51], v[38:41], v[38:41], v[48:51]
  v_mfma_f32_16x16x32_bf16 v[44:47], v[38:41], v[68:71], v[44:47]
  v_mfma_f32_16x16x16_bf16 v[48:51], v[42:43], v[42:43], v[48:51]
  v_mfma_f32_16x16x16_bf16 v[44:47], v[42:43], v[72:73], v[44:47]
  s_nop 0
  v_mov_b32 v29, s73
  v_mov_b32 v27, v30
  s_nop 4
  v_mov_b32 v28, v44
  v_mov_b32_dpp v26, v48 quad_perm:[0,1,2,3] row_mask:0x4 bank_mask:0xf
  v_mov_b32_dpp v27, v48 row_ror:12 row_mask:0x4 bank_mask:0xf
  s_mov_b32 exec_lo, 0xffff
  s_mov_b32 exec_hi, 1
  buffer_store_dwordx4 v[26:29], v74, s[64:67], s76 offen sc1
  s_mov_b64 exec, -1
  s_getpc_b64 s[0:1]
L_pc_50109:
  s_sub_u32 s0, s0, L_pc_50109-L_S144
  s_subb_u32 s1, s1, 0
  s_mov_b32 s16, 144
  s_mov_b32 s19, 159
  s_min_u32 s17, s18, s19
  s_cmp_lt_u32 s16, s17
  s_cbranch_scc0 L_tg_50110
  s_swappc_b64 s[28:29], s[0:1]
L_tb_50111:
  s_mov_b32 s77, 0
  s_add_u32 s73, s72, 3
  v_and_b32 v38, 7, v0
  s_add_u32 s91, s27, 2048
  v_lshl_add_u32 v38, v38, 4, s91
  s_add_u32 s97, s81, 2097152
  buffer_load_dwordx4 v[34:37], v38, s[64:67], s97 offen sc1
  buffer_load_dwordx4 v[26:29], v6, s[64:67], s97 offen offset:0 sc1
  buffer_load_dwordx4 v[30:33], v6, s[64:67], s97 offen offset:1024 sc1
  s_cmp_lt_u32 s16, s17
  s_cbranch_scc0 L_tg_50112
  s_waitcnt vmcnt(7)
  s_swappc_b64 s[28:29], s[0:1]
L_tb_50113:
  v_and_b32 v58, 15, v0
  v_bfe_u32 v60, v0, 4, 1
  v_lshl_add_u32 v58, v60, 5, v58
  v_lshrrev_b32 v60, 5, v0
  v_lshl_add_u32 v58, v60, 4, v58
  s_mul_i32 s91, s3, 96
  s_add_u32 s91, s91, 160448
  v_lshl_add_u32 v58, v58, 1, s91
  v_lshrrev_b32 v61, 2, v6
  v_add_u32 v61, 162528, v61
  ds_read_b32 v60, v61
  s_cmp_lg_u32 s77, 0
  s_cbranch_scc1 L_wz_50114
  s_waitcnt vmcnt(3)
L_wb_50115:
L_chk_50116:
  v_bitop3_b32 v75, v37, v29, s73 bitop3:0x7e
  v_bitop3_b32 v75, v75, v33, s73 bitop3:0xf6
  v_cmp_ne_u32 vcc, 0, v75
  s_nop 0
  s_cbranch_vccnz L_retry_50117
  v_pk_add_f32 v[26:27], v[26:27], v[30:31]
  v_add_f32 v28, v28, v32
  v_mov_b32 v29, v28
  v_add_f32_dpp v34, v34, v34 quad_perm:[1,0,3,2] row_mask:0xf bank_mask:0xf
  v_add_f32_dpp v35, v35, v35 quad_perm:[1,0,3,2] row_mask:0xf bank_mask:0xf
  v_permlane32_swap_b32 v26, v27
  v_permlane32_swap_b32 v28, v29
  v_add_f32_dpp v34, v34, v34 quad_perm:[2,3,0,1] row_mask:0xf bank_mask:0xf
  v_add_f32_dpp v35, v35, v35 quad_perm:[2,3,0,1] row_mask:0xf bank_mask:0xf
  v_add_f32 v26, v26, v27
  v_add_f32 v28, v28, v29
  v_add_f32_dpp v34, v34, v34 row_half_mirror row_mask:0xf bank_mask:0xf
  v_add_f32_dpp v35, v35, v35 row_half_mirror row_mask:0xf bank_mask:0xf
  v_permlane16_swap_b32 v26, v28
  v_mul_f32 v35, 0x3acccccd, v35
  v_mul_f32 v34, 0x3acccccd, v34
  v_add_f32 v62, v26, v28
  v_fma_f32 v34, -v35, v35, v34
  v_max_f32 v34, 0, v34
  v_add_f32 v34, 0x3727c5ac, v34
  v_rsq_f32 v34, v34
  s_waitcnt lgkmcnt(0)
  v_fma_f32 v62, -v35, v60, v62
  s_mov_b32 exec_hi, 0xffff
  v_mul_f32 v62, v62, v34
  v_cvt_pk_bf16_f32 v62, v62, v62
  ds_write_b16 v58, v62
  s_mov_b64 exec, -1
  s_waitcnt lgkmcnt(0)
  s_barrier
  s_add_u32 s73, s72, 0
  v_and_b32 v38, 7, v0
  s_add_u32 s91, s27, 2048
  v_lshl_add_u32 v38, v38, 4, s91
  s_add_u32 s97, s81, 1048576
  buffer_load_dwordx4 v[34:37], v38, s[64:67], s97 offen sc1
  buffer_load_dwordx4 v[26:29], v6, s[64:67], s97 offen offset:0 sc1
  buffer_load_dwordx4 v[30:33], v6, s[64:67], s97 offen offset:1024 sc1
  s_mov_b32 s77, 0
  s_cmp_lt_u32 s16, s17
  s_cbranch_scc0 L_tg_50122
  s_swappc_b64 s[28:29], s[0:1]
L_tb_50123:
  s_cmp_lt_u32 s16, s17
  s_cbranch_scc0 L_tg_50124
  s_swappc_b64 s[28:29], s[0:1]
L_tb_50125:
  v_and_b32 v66, 7, v0
  v_lshlrev_b32 v66, 4, v66
  v_add_u32 v66, 160448, v66
  ds_read_b128 v[8:11], v66 offset:0
  ds_read_b128 v[12:15], v66 offset:128
  ds_read_b128 v[16:19], v66 offset:256
  s_waitcnt lgkmcnt(0)
.balignl 8, 0xBF800000
  v_mfma_f32_4x4x4_16b_bf16 v[44:47], v[8:9], v[172:173], 0
  v_mfma_f32_4x4x4_16b_bf16 v[48:51], v[8:9], v[184:185], 0
  v_nop_e64
  v_mfma_f32_4x4x4_16b_bf16 v[44:47], v[10:11], v[174:175], v[44:47]
  v_mfma_f32_4x4x4_16b_bf16 v[48:51], v[10:11], v[186:187], v[48:51]
  v_nop_e64
  v_mfma_f32_4x4x4_16b_bf16 v[44:47], v[12:13], v[176:177], v[44:47]
  v_mfma_f32_4x4x4_16b_bf16 v[48:51], v[12:13], v[188:189], v[48:51]
  v_nop_e64
  v_mfma_f32_4x4x4_16b_bf16 v[44:47], v[14:15], v[178:179], v[44:47]
  v_mfma_f32_4x4x4_16b_bf16 v[48:51], v[14:15], v[190:191], v[48:51]
  v_nop_e64
  v_mfma_f32_4x4x4_16b_bf16 v[44:47], v[16:17], v[180:181], v[44:47]
  v_mfma_f32_4x4x4_16b_bf16 v[48:51], v[16:17], v[192:193], v[48:51]
  v_nop_e64
  v_mfma_f32_4x4x4_16b_bf16 v[44:47], v[18:19], v[182:183], v[44:47]
  v_mfma_f32_4x4x4_16b_bf16 v[48:51], v[18:19], v[194:195], v[48:51]
  v_mfma_f32_4x4x4_16b_bf16 v[52:55], v[8:9], v[196:197], 0
  v_mfma_f32_4x4x4_16b_bf16 v[56:59], v[8:9], v[208:209], 0
  v_nop_e64
  v_mfma_f32_4x4x4_16b_bf16 v[52:55], v[10:11], v[198:199], v[52:55]
  v_mov_b32_dpp v60, v44 quad_perm:[0,0,0,0] row_mask:0xf bank_mask:0xf
  v_mfma_f32_4x4x4_16b_bf16 v[56:59], v[10:11], v[210:211], v[56:59]
  v_mov_b32_dpp v61, v48 quad_perm:[0,0,0,0] row_mask:0xf bank_mask:0xf
  v_mfma_f32_4x4x4_16b_bf16 v[52:55], v[12:13], v[200:201], v[52:55]
  v_add_f32_dpp v60, v45, v60 quad_perm:[1,1,1,1] row_mask:0xf bank_mask:0xf
  v_mfma_f32_4x4x4_16b_bf16 v[56:59], v[12:13], v[212:213], v[56:59]
  v_add_f32_dpp v61, v49, v61 quad_perm:[1,1,1,1] row_mask:0xf bank_mask:0xf
  v_mfma_f32_4x4x4_16b_bf16 v[52:55], v[14:15], v[202:203], v[52:55]
  v_add_f32_dpp v60, v46, v60 quad_perm:[2,2,2,2] row_mask:0xf bank_mask:0xf
  v_mfma_f32_4x4x4_16b_bf16 v[56:59], v[14:15], v[214:215], v[56:59]
  v_add_f32_dpp v61, v50, v61 quad_perm:[2,2,2,2] row_mask:0xf bank_mask:0xf
  v_mfma_f32_4x4x4_16b_bf16 v[52:55], v[16:17], v[204:205], v[52:55]
  v_add_f32_dpp v20, v47, v60 quad_perm:[3,3,3,3] row_mask:0xf bank_mask:0xf
  v_mfma_f32_4x4x4_16b_bf16 v[56:59], v[16:17], v[216:217], v[56:59]
  v_add_f32_dpp v61, v51, v61 quad_perm:[3,3,3,3] row_mask:0xf bank_mask:0xf
  v_mfma_f32_4x4x4_16b_bf16 v[52:55], v[18:19], v[206:207], v[52:55]
  v_mfma_f32_4x4x4_16b_bf16 v[56:59], v[18:19], v[218:219], v[56:59]
  v_mfma_f32_4x4x4_16b_bf16 v[44:47], v[8:9], v[220:221], 0
  v_cndmask_b32 v20, v20, v61, s[84:85]
  v_mfma_f32_4x4x4_16b_bf16 v[48:51], v[8:9], v[232:233], 0
  v_mfma_f32_4x4x4_16b_bf16 v[44:47], v[10:11], v[222:223], v[44:47]
  v_mov_b32_dpp v62, v52 quad_perm:[0,0,0,0] row_mask:0xf bank_mask:0xf
  v_mfma_f32_4x4x4_16b_bf16 v[48:51], v[10:11], v[234:235], v[48:51]
  v_mov_b32_dpp v63, v56 quad_perm:[0,0,0,0] row_mask:0xf bank_mask:0xf
  v_mfma_f32_4x4x4_16b_bf16 v[44:47], v[12:13], v[224:225], v[44:47]
  v_add_f32_dpp v62, v53, v62 quad_perm:[1,1,1,1] row_mask:0xf bank_mask:0xf
  v_mfma_f32_4x4x4_16b_bf16 v[48:51], v[12:13], v[236:237], v[48:51]
  v_add_f32_dpp v63, v57, v63 quad_perm:[1,1,1,1] row_mask:0xf bank_mask:0xf
  v_mfma_f32_4x4x4_16b_bf16 v[44:47], v[14:15], v[226:227], v[44:47]
  v_add_f32_dpp v62, v54, v62 quad_perm:[2,2,2,2] row_mask:0xf bank_mask:0xf
  v_mfma_f32_4x4x4_16b_bf16 v[48:51], v[14:15], v[238:239], v[48:51]
  v_add_f32_dpp v63, v58, v63 quad_perm:[2,2,2,2] row_mask:0xf bank_mask:0xf
  v_mfma_f32_4x4x4_16b_bf16 v[44:47], v[16:17], v[228:229], v[44:47]
  v_add_f32_dpp v62, v55, v62 quad_perm:[3,3,3,3] row_mask:0xf bank_mask:0xf
  v_mfma_f32_4x4x4_16b_bf16 v[48:51], v[16:17], v[240:241], v[48:51]
  v_add_f32_dpp v63, v59, v63 quad_perm:[3,3,3,3] row_mask:0xf bank_mask:0xf
  v_mfma_f32_4x4x4_16b_bf16 v[44:47], v[18:19], v[230:231], v[44:47]
  v_mfma_f32_4x4x4_16b_bf16 v[48:51], v[18:19], v[242:243], v[48:51]
  v_mfma_f32_4x4x4_16b_bf16 v[52:55], v[8:9], v[244:245], 0
  v_cndmask_b32 v20, v20, v62, s[86:87]
  v_mfma_f32_4x4x4_16b_bf16 v[56:59], v[8:9], a[0:1], 0
  v_cndmask_b32 v20, v20, v63, s[88:89]
  v_mfma_f32_4x4x4_16b_bf16 v[52:55], v[10:11], v[246:247], v[52:55]
  v_mov_b32_dpp v60, v44 quad_perm:[0,0,0,0] row_mask:0xf bank_mask:0xf
  v_mfma_f32_4x4x4_16b_bf16 v[56:59], v[10:11], a[2:3], v[56:59]
  v_mov_b32_dpp v61, v48 quad_perm:[0,0,0,0] row_mask:0xf bank_mask:0xf
  v_mfma_f32_4x4x4_16b_bf16 v[52:55], v[12:13], v[248:249], v[52:55]
  v_add_f32_dpp v20, v20, v20 row_half_mirror row_mask:0xf bank_mask:0xf
  v_mfma_f32_4x4x4_16b_bf16 v[56:59], v[12:13], a[4:5], v[56:59]
  v_add_f32_dpp v60, v45, v60 quad_perm:[1,1,1,1] row_mask:0xf bank_mask:0xf
  v_mfma_f32_4x4x4_16b_bf16 v[52:55], v[14:15], v[250:251], v[52:55]
  v_add_f32_dpp v61, v49, v61 quad_perm:[1,1,1,1] row_mask:0xf bank_mask:0xf
  v_mfma_f32_4x4x4_16b_bf16 v[56:59], v[14:15], a[6:7], v[56:59]
  v_add_f32_dpp v60, v46, v60 quad_perm:[2,2,2,2] row_mask:0xf bank_mask:0xf
  v_mfma_f32_4x4x4_16b_bf16 v[52:55], v[16:17], v[252:253], v[52:55]
  v_add_f32_dpp v61, v50, v61 quad_perm:[2,2,2,2] row_mask:0xf bank_mask:0xf
  v_mfma_f32_4x4x4_16b_bf16 v[56:59], v[16:17], a[8:9], v[56:59]
  v_add_f32_dpp v21, v47, v60 quad_perm:[3,3,3,3] row_mask:0xf bank_mask:0xf
  v_mfma_f32_4x4x4_16b_bf16 v[52:55], v[18:19], v[254:255], v[52:55]
  v_add_f32_dpp v61, v51, v61 quad_perm:[3,3,3,3] row_mask:0xf bank_mask:0xf
  v_mfma_f32_4x4x4_16b_bf16 v[56:59], v[18:19], a[10:11], v[56:59]
  v_mfma_f32_4x4x4_16b_bf16 v[44:47], v[8:9], a[12:13], 0
  v_cndmask_b32 v21, v21, v61, s[84:85]
  v_mfma_f32_4x4x4_16b_bf16 v[48:51], v[8:9], a[24:25], 0
  v_mfma_f32_4x4x4_16b_bf16 v[44:47], v[10:11], a[14:15], v[44:47]
  v_mov_b32_dpp v62, v52 quad_perm:[0,0,0,0] row_mask:0xf bank_mask:0xf
  v_mfma_f32_4x4x4_16b_bf16 v[48:51], v[10:11], a[26:27], v[48:51]
  v_mov_b32_dpp v63, v56 quad_perm:[0,0,0,0] row_mask:0xf bank_mask:0xf
  v_mfma_f32_4x4x4_16b_bf16 v[44:47], v[12:13], a[16:17], v[44:47]
  v_add_f32_dpp v62, v53, v62 quad_perm:[1,1,1,1] row_mask:0xf bank_mask:0xf
  v_mfma_f32_4x4x4_16b_bf16 v[48:51], v[12:13], a[28:29], v[48:51]
  v_add_f32_dpp v63, v57, v63 quad_perm:[1,1,1,1] row_mask:0xf bank_mask:0xf
  v_mfma_f32_4x4x4_16b_bf16 v[44:47], v[14:15], a[18:19], v[44:47]
  v_add_f32_dpp v62, v54, v62 quad_perm:[2,2,2,2] row_mask:0xf bank_mask:0xf
  v_mfma_f32_4x4x4_16b_bf16 v[48:51], v[14:15], a[30:31], v[48:51]
  v_add_f32_dpp v63, v58, v63 quad_perm:[2,2,2,2] row_mask:0xf bank_mask:0xf
  v_mfma_f32_4x4x4_16b_bf16 v[44:47], v[16:17], a[20:21], v[44:47]
  v_add_f32_dpp v62, v55, v62 quad_perm:[3,3,3,3] row_mask:0xf bank_mask:0xf
  v_mfma_f32_4x4x4_16b_bf16 v[48:51], v[16:17], a[32:33], v[48:51]
  v_add_f32_dpp v63, v59, v63 quad_perm:[3,3,3,3] row_mask:0xf bank_mask:0xf
  v_mfma_f32_4x4x4_16b_bf16 v[44:47], v[18:19], a[22:23], v[44:47]
  v_mfma_f32_4x4x4_16b_bf16 v[48:51], v[18:19], a[34:35], v[48:51]
  v_mfma_f32_4x4x4_16b_bf16 v[52:55], v[8:9], a[36:37], 0
  v_cndmask_b32 v21, v21, v62, s[86:87]
  v_mfma_f32_4x4x4_16b_bf16 v[56:59], v[8:9], a[48:49], 0
  v_cndmask_b32 v21, v21, v63, s[88:89]
  v_mfma_f32_4x4x4_16b_bf16 v[52:55], v[10:11], a[38:39], v[52:55]
  v_mov_b32_dpp v60, v44 quad_perm:[0,0,0,0] row_mask:0xf bank_mask:0xf
  v_mfma_f32_4x4x4_16b_bf16 v[56:59], v[10:11], a[50:51], v[56:59]
  v_mov_b32_dpp v61, v48 quad_perm:[0,0,0,0] row_mask:0xf bank_mask:0xf
  v_mfma_f32_4x4x4_16b_bf16 v[52:55], v[12:13], a[40:41], v[52:55]
  v_add_f32_dpp v21, v21, v21 row_half_mirror row_mask:0xf bank_mask:0xf
  v_mfma_f32_4x4x4_16b_bf16 v[56:59], v[12:13], a[52:53], v[56:59]
  v_add_f32_dpp v60, v45, v60 quad_perm:[1,1,1,1] row_mask:0xf bank_mask:0xf
  v_mfma_f32_4x4x4_16b_bf16 v[52:55], v[14:15], a[42:43], v[52:55]
  v_add_f32_dpp v61, v49, v61 quad_perm:[1,1,1,1] row_mask:0xf bank_mask:0xf
  v_mfma_f32_4x4x4_16b_bf16 v[56:59], v[14:15], a[54:55], v[56:59]
  v_add_f32_dpp v60, v46, v60 quad_perm:[2,2,2,2] row_mask:0xf bank_mask:0xf
  v_mfma_f32_4x4x4_16b_bf16 v[52:55], v[16:17], a[44:45], v[52:55]
  v_add_f32_dpp v61, v50, v61 quad_perm:[2,2,2,2] row_mask:0xf bank_mask:0xf
  v_mfma_f32_4x4x4_16b_bf16 v[56:59], v[16:17], a[56:57], v[56:59]
  v_add_f32_dpp v22, v47, v60 quad_perm:[3,3,3,3] row_mask:0xf bank_mask:0xf
  v_mfma_f32_4x4x4_16b_bf16 v[52:55], v[18:19], a[46:47], v[52:55]
  v_add_f32_dpp v61, v51, v61 quad_perm:[3,3,3,3] row_mask:0xf bank_mask:0xf
  v_mfma_f32_4x4x4_16b_bf16 v[56:59], v[18:19], a[58:59], v[56:59]
  v_mfma_f32_4x4x4_16b_bf16 v[44:47], v[8:9], a[60:61], 0
  v_cndmask_b32 v22, v22, v61, s[84:85]
  v_mfma_f32_4x4x4_16b_bf16 v[48:51], v[8:9], a[72:73], 0
  v_mfma_f32_4x4x4_16b_bf16 v[44:47], v[10:11], a[62:63], v[44:47]
  v_mov_b32_dpp v62, v52 quad_perm:[0,0,0,0] row_mask:0xf bank_mask:0xf
  v_mfma_f32_4x4x4_16b_bf16 v[48:51], v[10:11], a[74:75], v[48:51]
  v_mov_b32_dpp v63, v56 quad_perm:[0,0,0,0] row_mask:0xf bank_mask:0xf
  v_mfma_f32_4x4x4_16b_bf16 v[44:47], v[12:13], a[64:65], v[44:47]
  v_add_f32_dpp v62, v53, v62 quad_perm:[1,1,1,1] row_mask:0xf bank_mask:0xf
  v_mfma_f32_4x4x4_16b_bf16 v[48:51], v[12:13], a[76:77], v[48:51]
  v_add_f32_dpp v63, v57, v63 quad_perm:[1,1,1,1] row_mask:0xf bank_mask:0xf
  v_mfma_f32_4x4x4_16b_bf16 v[44:47], v[14:15], a[66:67], v[44:47]
  v_add_f32_dpp v62, v54, v62 quad_perm:[2,2,2,2] row_mask:0xf bank_mask:0xf
  v_mfma_f32_4x4x4_16b_bf16 v[48:51], v[14:15], a[78:79], v[48:51]
  v_add_f32_dpp v63, v58, v63 quad_perm:[2,2,2,2] row_mask:0xf bank_mask:0xf
  v_mfma_f32_4x4x4_16b_bf16 v[44:47], v[16:17], a[68:69], v[44:47]
  v_add_f32_dpp v62, v55, v62 quad_perm:[3,3,3,3] row_mask:0xf bank_mask:0xf
  v_mfma_f32_4x4x4_16b_bf16 v[48:51], v[16:17], a[80:81], v[48:51]
  v_add_f32_dpp v63, v59, v63 quad_perm:[3,3,3,3] row_mask:0xf bank_mask:0xf
  v_mfma_f32_4x4x4_16b_bf16 v[44:47], v[18:19], a[70:71], v[44:47]
  v_mfma_f32_4x4x4_16b_bf16 v[48:51], v[18:19], a[82:83], v[48:51]
  v_mfma_f32_4x4x4_16b_bf16 v[52:55], v[8:9], a[84:85], 0
  v_cndmask_b32 v22, v22, v62, s[86:87]
  v_mfma_f32_4x4x4_16b_bf16 v[56:59], v[8:9], a[96:97], 0
  v_cndmask_b32 v22, v22, v63, s[88:89]
  v_mfma_f32_4x4x4_16b_bf16 v[52:55], v[10:11], a[86:87], v[52:55]
  v_mov_b32_dpp v60, v44 quad_perm:[0,0,0,0] row_mask:0xf bank_mask:0xf
  v_mfma_f32_4x4x4_16b_bf16 v[56:59], v[10:11], a[98:99], v[56:59]
  v_mov_b32_dpp v61, v48 quad_perm:[0,0,0,0] row_mask:0xf bank_mask:0xf
  v_mfma_f32_4x4x4_16b_bf16 v[52:55], v[12:13], a[88:89], v[52:55]
  v_add_f32_dpp v22, v22, v22 row_half_mirror row_mask:0xf bank_mask:0xf
  v_mfma_f32_4x4x4_16b_bf16 v[56:59], v[12:13], a[100:101], v[56:59]
  v_add_f32_dpp v60, v45, v60 quad_perm:[1,1,1,1] row_mask:0xf bank_mask:0xf
  v_mfma_f32_4x4x4_16b_bf16 v[52:55], v[14:15], a[90:91], v[52:55]
  v_add_f32_dpp v61, v49, v61 quad_perm:[1,1,1,1] row_mask:0xf bank_mask:0xf
  v_mfma_f32_4x4x4_16b_bf16 v[56:59], v[14:15], a[102:103], v[56:59]
  v_add_f32_dpp v60, v46, v60 quad_perm:[2,2,2,2] row_mask:0xf bank_mask:0xf
  v_mfma_f32_4x4x4_16b_bf16 v[52:55], v[16:17], a[92:93], v[52:55]
  v_add_f32_dpp v61, v50, v61 quad_perm:[2,2,2,2] row_mask:0xf bank_mask:0xf
  v_mfma_f32_4x4x4_16b_bf16 v[56:59], v[16:17], a[104:105], v[56:59]
  v_add_f32_dpp v23, v47, v60 quad_perm:[3,3,3,3] row_mask:0xf bank_mask:0xf
  v_mfma_f32_4x4x4_16b_bf16 v[52:55], v[18:19], a[94:95], v[52:55]
  v_add_f32_dpp v61, v51, v61 quad_perm:[3,3,3,3] row_mask:0xf bank_mask:0xf
  v_mfma_f32_4x4x4_16b_bf16 v[56:59], v[18:19], a[106:107], v[56:59]
  v_cndmask_b32 v23, v23, v61, s[84:85]
  s_nop 0
  s_nop 0
  v_mov_b32_dpp v62, v52 quad_perm:[0,0,0,0] row_mask:0xf bank_mask:0xf
  v_nop_e64
  v_mov_b32_dpp v63, v56 quad_perm:[0,0,0,0] row_mask:0xf bank_mask:0xf
  v_add_f32_dpp v62, v53, v62 quad_perm:[1,1,1,1] row_mask:0xf bank_mask:0xf
  v_nop_e64
  v_add_f32_dpp v63, v57, v63 quad_perm:[1,1,1,1] row_mask:0xf bank_mask:0xf
  v_add_f32_dpp v62, v54, v62 quad_perm:[2,2,2,2] row_mask:0xf bank_mask:0xf
  v_nop_e64
  v_add_f32_dpp v63, v58, v63 quad_perm:[2,2,2,2] row_mask:0xf bank_mask:0xf
  v_add_f32_dpp v62, v55, v62 quad_perm:[3,3,3,3] row_mask:0xf bank_mask:0xf
  v_nop_e64
  v_add_f32_dpp v63, v59, v63 quad_perm:[3,3,3,3] row_mask:0xf bank_mask:0xf
  v_cndmask_b32 v23, v23, v62, s[86:87]
  v_cndmask_b32 v23, v23, v63, s[88:89]
  s_nop 0
  s_nop 0
  v_add_f32_dpp v23, v23, v23 row_half_mirror row_mask:0xf bank_mask:0xf
  s_mov_b32 s22, 0
  buffer_load_dwordx4 v[172:175], v1, s[44:47], s22 offen offset:0 nt
  buffer_load_dwordx4 v[176:179], v1, s[44:47], s22 offen offset:128 nt
  buffer_load_dwordx4 v[180:183], v1, s[44:47], s22 offen offset:256 nt
  s_mov_b32 s22, 98304
  buffer_load_dwordx4 v[184:187], v1, s[44:47], s22 offen offset:0 nt
  buffer_load_dwordx4 v[188:191], v1, s[44:47], s22 offen offset:128 nt
  buffer_load_dwordx4 v[192:195], v1, s[44:47], s22 offen offset:256 nt
  s_mov_b32 s22, 196608
  buffer_load_dwordx4 v[196:199], v1, s[44:47], s22 offen offset:0 nt
  buffer_load_dwordx4 v[200:203], v1, s[44:47], s22 offen offset:128 nt
  buffer_load_dwordx4 v[204:207], v1, s[44:47], s22 offen offset:256 nt
  s_mov_b32 s22, 294912
  buffer_load_dwordx4 v[208:211], v1, s[44:47], s22 offen offset:0 nt
  buffer_load_dwordx4 v[212:215], v1, s[44:47], s22 offen offset:128 nt
  buffer_load_dwordx4 v[216:219], v1, s[44:47], s22 offen offset:256 nt
  s_mov_b32 s22, 393216
  buffer_load_dwordx4 v[220:223], v1, s[44:47], s22 offen offset:0 nt
  buffer_load_dwordx4 v[224:227], v1, s[44:47], s22 offen offset:128 nt
  buffer_load_dwordx4 v[228:231], v1, s[44:47], s22 offen offset:256 nt
  s_mov_b32 s22, 491520
  buffer_load_dwordx4 v[232:235], v1, s[44:47], s22 offen offset:0 nt
  buffer_load_dwordx4 v[236:239], v1, s[44:47], s22 offen offset:128 nt
  buffer_load_dwordx4 v[240:243], v1, s[44:47], s22 offen offset:256 nt
  s_mov_b32 s19, 189
  s_min_u32 s17, s18, s19
  s_cmp_lt_u32 s16, s17
  s_cbranch_scc0 L_tg_50126
  s_waitcnt vmcnt(9)
  s_swappc_b64 s[28:29], s[0:1]
L_tb_50127:
  s_cmp_lt_u32 s16, s17
  s_cbranch_scc0 L_tg_50128
  s_waitcnt vmcnt(9)
  s_swappc_b64 s[28:29], s[0:1]
L_tb_50129:
  v_and_b32 v58, 15, v0
  v_bfe_u32 v60, v0, 4, 1
  v_lshl_add_u32 v58, v60, 5, v58
  v_lshrrev_b32 v60, 5, v0
  v_lshl_add_u32 v58, v60, 4, v58
  s_mul_i32 s91, s3, 96
  s_add_u32 s91, s91, 160832
  v_lshl_add_u32 v58, v58, 1, s91
  v_lshrrev_b32 v61, 2, v6
  v_add_u32 v61, 161504, v61
  ds_read_b32 v60, v61
  s_cmp_lg_u32 s77, 0
  s_cbranch_scc1 L_wz_50130
  s_waitcnt vmcnt(24)
L_wb_50131:
L_chk_50132:
  v_bitop3_b32 v75, v37, v29, s73 bitop3:0x7e
  v_bitop3_b32 v75, v75, v33, s73 bitop3:0xf6
  v_cmp_ne_u32 vcc, 0, v75
  s_nop 0
  s_cbranch_vccnz L_retry_50133
  v_pk_add_f32 v[26:27], v[26:27], v[30:31]
  v_add_f32 v28, v28, v32
  v_mov_b32 v29, v28
  v_add_f32_dpp v34, v34, v34 quad_perm:[1,0,3,2] row_mask:0xf bank_mask:0xf
  v_add_f32_dpp v35, v35, v35 quad_perm:[1,0,3,2] row_mask:0xf bank_mask:0xf
  v_permlane32_swap_b32 v26, v27
  v_permlane32_swap_b32 v28, v29
  v_add_f32_dpp v34, v34, v34 quad_perm:[2,3,0,1] row_mask:0xf bank_mask:0xf
  v_add_f32_dpp v35, v35, v35 quad_perm:[2,3,0,1] row_mask:0xf bank_mask:0xf
  v_add_f32 v26, v26, v27
  v_add_f32 v28, v28, v29
  v_add_f32_dpp v34, v34, v34 row_half_mirror row_mask:0xf bank_mask:0xf
  v_add_f32_dpp v35, v35, v35 row_half_mirror row_mask:0xf bank_mask:0xf
  v_permlane16_swap_b32 v26, v28
  v_mul_f32 v35, 0x3acccccd, v35
  v_mul_f32 v34, 0x3acccccd, v34
  v_add_f32 v62, v26, v28
  v_fma_f32 v34, -v35, v35, v34
  v_max_f32 v34, 0, v34
  v_add_f32 v34, 0x3727c5ac, v34
  v_rsq_f32 v34, v34
  s_waitcnt lgkmcnt(0)
  v_fma_f32 v62, -v35, v60, v62
  s_mov_b32 exec_hi, 0xffff
  v_mul_f32 v62, v62, v34
  v_cvt_pk_bf16_f32 v62, v62, v62
  ds_write_b16 v58, v62
  s_mov_b64 exec, -1
  s_waitcnt lgkmcnt(0)
  s_barrier
L_nw_50140:
  s_cmp_ge_u32 s16, 150
  s_cbranch_scc1 L_nx_50141
  s_cmp_lt_u32 s16, s17
  s_cbranch_scc0 L_nd_50142
  s_waitcnt vmcnt(9)
  s_swappc_b64 s[28:29], s[0:1]
  s_branch L_nw_50140
L_nx_50141:
  s_waitcnt vmcnt(6)
L_nq_50143:
  v_and_b32 v66, 7, v0
  v_lshlrev_b32 v66, 4, v66
  v_add_u32 v66, 160832, v66
  ds_read_b128 v[26:29], v66 offset:0
  ds_read_b128 v[30:33], v66 offset:128
  ds_read_b128 v[34:37], v66 offset:256
  s_waitcnt lgkmcnt(0)
.balignl 8, 0xBF800000
  v_mfma_f32_4x4x4_16b_bf16 v[44:47], v[26:27], a[120:121], 0
  v_mfma_f32_4x4x4_16b_bf16 v[48:51], v[26:27], a[132:133], 0
  v_nop_e64
  v_mfma_f32_4x4x4_16b_bf16 v[44:47], v[28:29], a[122:123], v[44:47]
  v_mfma_f32_4x4x4_16b_bf16 v[48:51], v[28:29], a[134:135], v[48:51]
  v_nop_e64
  v_mfma_f32_4x4x4_16b_bf16 v[44:47], v[30:31], a[124:125], v[44:47]
  v_mfma_f32_4x4x4_16b_bf16 v[48:51], v[30:31], a[136:137], v[48:51]
  v_nop_e64
  v_mfma_f32_4x4x4_16b_bf16 v[44:47], v[32:33], a[126:127], v[44:47]
  v_mfma_f32_4x4x4_16b_bf16 v[48:51], v[32:33], a[138:139], v[48:51]
  v_nop_e64
  v_mfma_f32_4x4x4_16b_bf16 v[44:47], v[34:35], a[128:129], v[44:47]
  v_mfma_f32_4x4x4_16b_bf16 v[48:51], v[34:35], a[140:141], v[48:51]
  v_nop_e64
  v_mfma_f32_4x4x4_16b_bf16 v[44:47], v[36:37], a[130:131], v[44:47]
  v_mfma_f32_4x4x4_16b_bf16 v[48:51], v[36:37], a[142:143], v[48:51]
  v_mfma_f32_4x4x4_16b_bf16 v[52:55], v[26:27], a[144:145], 0
  v_mfma_f32_4x4x4_16b_bf16 v[56:59], v[26:27], a[156:157], 0
  v_nop_e64
  v_mfma_f32_4x4x4_16b_bf16 v[52:55], v[28:29], a[146:147], v[52:55]
  v_mov_b32_dpp v60, v44 quad_perm:[0,0,0,0] row_mask:0xf bank_mask:0xf
  v_mfma_f32_4x4x4_16b_bf16 v[56:59], v[28:29], a[158:159], v[56:59]
  v_mov_b32_dpp v61, v48 quad_perm:[0,0,0,0] row_mask:0xf bank_mask:0xf
  v_mfma_f32_4x4x4_16b_bf16 v[52:55], v[30:31], a[148:149], v[52:55]
  v_add_f32_dpp v60, v45, v60 quad_perm:[1,1,1,1] row_mask:0xf bank_mask:0xf
  v_mfma_f32_4x4x4_16b_bf16 v[56:59], v[30:31], a[160:161], v[56:59]
  v_add_f32_dpp v61, v49, v61 quad_perm:[1,1,1,1] row_mask:0xf bank_mask:0xf
  v_mfma_f32_4x4x4_16b_bf16 v[52:55], v[32:33], a[150:151], v[52:55]
  v_add_f32_dpp v60, v46, v60 quad_perm:[2,2,2,2] row_mask:0xf bank_mask:0xf
  v_mfma_f32_4x4x4_16b_bf16 v[56:59], v[32:33], a[162:163], v[56:59]
  v_add_f32_dpp v61, v50, v61 quad_perm:[2,2,2,2] row_mask:0xf bank_mask:0xf
  v_mfma_f32_4x4x4_16b_bf16 v[52:55], v[34:35], a[152:153], v[52:55]
  v_add_f32_dpp v38, v47, v60 quad_perm:[3,3,3,3] row_mask:0xf bank_mask:0xf
  v_mfma_f32_4x4x4_16b_bf16 v[56:59], v[34:35], a[164:165], v[56:59]
  v_add_f32_dpp v61, v51, v61 quad_perm:[3,3,3,3] row_mask:0xf bank_mask:0xf
  v_mfma_f32_4x4x4_16b_bf16 v[52:55], v[36:37], a[154:155], v[52:55]
  v_mfma_f32_4x4x4_16b_bf16 v[56:59], v[36:37], a[166:167], v[56:59]
  v_cndmask_b32 v38, v38, v61, s[84:85]
  s_nop 0
  s_nop 1
  v_mov_b32_dpp v62, v52 quad_perm:[0,0,0,0] row_mask:0xf bank_mask:0xf
  v_mov_b32_dpp v63, v56 quad_perm:[0,0,0,0] row_mask:0xf bank_mask:0xf
  v_nop_e64
  v_add_f32_dpp v62, v53, v62 quad_perm:[1,1,1,1] row_mask:0xf bank_mask:0xf
  v_add_f32_dpp v63, v57, v63 quad_perm:[1,1,1,1] row_mask:0xf bank_mask:0xf
  v_nop_e64
  v_add_f32_dpp v62, v54, v62 quad_perm:[2,2,2,2] row_mask:0xf bank_mask:0xf
  v_add_f32_dpp v63, v58, v63 quad_perm:[2,2,2,2] row_mask:0xf bank_mask:0xf
  v_nop_e64
  v_add_f32_dpp v62, v55, v62 quad_perm:[3,3,3,3] row_mask:0xf bank_mask:0xf
  v_add_f32_dpp v63, v59, v63 quad_perm:[3,3,3,3] row_mask:0xf bank_mask:0xf
  v_cndmask_b32 v38, v38, v62, s[86:87]
  v_cndmask_b32 v38, v38, v63, s[88:89]
  s_nop 0
  s_nop 0
  v_add_f32_dpp v38, v38, v38 row_half_mirror row_mask:0xf bank_mask:0xf
  s_nop 1
  v_max_f32_dpp v66, v38, v38 quad_perm:[1,0,3,2] row_mask:0xf bank_mask:0xf
  s_nop 1
  v_max_f32_dpp v66, v66, v66 quad_perm:[2,3,0,1] row_mask:0xf bank_mask:0xf
  s_nop 1
  v_max_f32_dpp v66, v66, v66 row_ror:8 row_mask:0xf bank_mask:0xf
  s_nop 1
  v_max_f32_dpp v66, v66, v66 row_bcast:15 row_mask:0xa bank_mask:0xf
  s_nop 1
  v_max_f32_dpp v66, v66, v66 row_bcast:31 row_mask:0xc bank_mask:0xf
  s_nop 0
  v_readlane_b32 s95, v66, 63
  v_mov_b32 v67, s21
  s_nop 0
  v_subrev_f32 v38, s95, v38
  v_mov_b32 v66, s95
  v_mul_f32 v38, 0x3dd53b95, v38
  ds_write_b32 v67, v66 offset:16
  v_exp_f32 v38, v38
  s_nop 1
  v_add_f32_dpp v68, v38, v38 quad_perm:[1,0,3,2] row_mask:0xf bank_mask:0xf
  v_cvt_pk_bf16_f32 v38, v38, v38
.balignl 8, 0xBF800000
  s_nop 0
  s_nop 0
  v_and_b32_dpp v46, v38, v2 quad_perm:[0,0,0,0] row_mask:0xf bank_mask:0xf
  v_and_b32_dpp v47, v38, v3 quad_perm:[0,0,0,0] row_mask:0xf bank_mask:0xf
  v_and_b32_dpp v48, v38, v4 quad_perm:[3,3,3,3] row_mask:0xf bank_mask:0xf
  v_and_b32_dpp v49, v38, v5 quad_perm:[3,3,3,3] row_mask:0xf bank_mask:0xf
  s_nop 0
  s_nop 0
  v_mfma_f32_16x16x32_bf16 v[26:29], v[46:49], a[108:111], 0
  v_and_b32_dpp v50, v38, v2 quad_perm:[1,1,1,1] row_mask:0xf bank_mask:0xf
  v_and_b32_dpp v51, v38, v3 quad_perm:[1,1,1,1] row_mask:0xf bank_mask:0xf
  v_mfma_f32_16x16x32_bf16 v[30:33], v[46:49], a[112:115], 0
  v_and_b32_dpp v52, v38, v4 quad_perm:[2,2,2,2] row_mask:0xf bank_mask:0xf
  v_and_b32_dpp v53, v38, v5 quad_perm:[2,2,2,2] row_mask:0xf bank_mask:0xf
  v_mfma_f32_16x16x32_bf16 v[34:37], v[46:49], a[116:119], 0
  v_add_f32_dpp v68, v68, v68 quad_perm:[2,3,0,1] row_mask:0xf bank_mask:0xf
  s_cmp_lt_u32 s16, s17
  s_cbranch_scc0 L_tg_50144
  s_waitcnt vmcnt(9)
  s_swappc_b64 s[28:29], s[0:1]
L_tb_50145:
.balignl 8, 0xBF800000
  v_mfma_f32_16x16x32_bf16 v[26:29], v[50:53], v[76:79], v[26:29]
  v_and_b32_dpp v46, v38, v2 quad_perm:[2,2,2,2] row_mask:0xf bank_mask:0xf
  v_and_b32_dpp v47, v38, v3 quad_perm:[2,2,2,2] row_mask:0xf bank_mask:0xf
  v_mfma_f32_16x16x32_bf16 v[30:33], v[50:53], v[80:83], v[30:33]
  v_and_b32_dpp v48, v38, v4 quad_perm:[1,1,1,1] row_mask:0xf bank_mask:0xf
  v_and_b32_dpp v49, v38, v5 quad_perm:[1,1,1,1] row_mask:0xf bank_mask:0xf
  v_mfma_f32_16x16x32_bf16 v[34:37], v[50:53], v[84:87], v[34:37]
  v_add_f32_dpp v68, v68, v68 row_ror:8 row_mask:0xf bank_mask:0xf
  v_mfma_f32_16x16x32_bf16 v[26:29], v[46:49], v[88:91], v[26:29]
  v_and_b32_dpp v50, v38, v2 quad_perm:[3,3,3,3] row_mask:0xf bank_mask:0xf
  v_and_b32_dpp v51, v38, v3 quad_perm:[3,3,3,3] row_mask:0xf bank_mask:0xf
  v_mfma_f32_16x16x32_bf16 v[30:33], v[46:49], v[92:95], v[30:33]
  v_and_b32_dpp v52, v38, v4 quad_perm:[0,0,0,0] row_mask:0xf bank_mask:0xf
  v_and_b32_dpp v53, v38, v5 quad_perm:[0,0,0,0] row_mask:0xf bank_mask:0xf
  v_mfma_f32_16x16x32_bf16 v[34:37], v[46:49], v[96:99], v[34:37]
  v_add_f32_dpp v68, v68, v68 row_bcast:15 row_mask:0xa bank_mask:0xf
  v_mfma_f32_16x16x32_bf16 v[26:29], v[50:53], v[100:103], v[26:29]
  v_mfma_f32_16x16x32_bf16 v[30:33], v[50:53], v[104:107], v[30:33]
  v_mfma_f32_16x16x32_bf16 v[34:37], v[50:53], v[108:111], v[34:37]
  v_add_f32_dpp v68, v68, v68 row_bcast:31 row_mask:0xc bank_mask:0xf
  s_nop 0
  v_readlane_b32 s96, v68, 63
  v_lshrrev_b32 v60, 4, v0
  v_and_b32 v59, 15, v0
  v_lshlrev_b32 v58, 10, v60
  v_lshl_add_u32 v58, v59, 4, v58
  s_lshl_b32 s91, s3, 8
  s_add_u32 s91, s91, 155648
  v_add_u32 v58, s91, v58
  v_add_u32 v59, 155648, v6
  v_mov_b32 v49, s96
  v_permlane32_swap_b32 v26, v27
  v_permlane32_swap_b32 v28, v29
  v_permlane32_swap_b32 v30, v31
  v_permlane32_swap_b32 v32, v33
  v_permlane32_swap_b32 v34, v35
  v_permlane32_swap_b32 v36, v37
  v_add_f32_dpp v46, v27, v26 row_ror:8 row_mask:0xf bank_mask:0x3
  v_add_f32_dpp v47, v31, v30 row_ror:8 row_mask:0xf bank_mask:0x3
  v_add_f32_dpp v48, v35, v34 row_ror:8 row_mask:0xf bank_mask:0x3
  v_add_f32_dpp v46, v28, v29 row_ror:8 row_mask:0xf bank_mask:0xc
  v_add_f32_dpp v47, v32, v33 row_ror:8 row_mask:0xf bank_mask:0xc
  v_add_f32_dpp v48, v36, v37 row_ror:8 row_mask:0xf bank_mask:0xc
  ds_write_b128 v59, v[46:49]
  v_lshlrev_b32 v60, 2, v60
  v_add_u32 v60, 161392, v60
  v_mov_b32 v62, 161392
  s_waitcnt lgkmcnt(0)
  s_barrier
  ds_read_b128 v[54:57], v62
  ds_read_b32 v62, v60
  ds_read_b128 v[50:53], v58
  s_add_u32 s73, s72, 0
  s_mul_i32 s91, s31, 240
  s_sub_u32 s91, 2048, s91
  v_lshlrev_b32 v59, 4, v0
  v_writelane_b32 v59, s91, 16
  v_mov_b32 v49, s73
  s_add_u32 s76, s78, 524288
  s_waitcnt lgkmcnt(1)
  v_max3_f32 v54, v54, v55, v56
  v_max_f32 v54, v54, v57
  v_sub_f32 v62, v62, v54
  v_mul_f32 v62, 0x3dd53b95, v62
  v_exp_f32 v62, v62
  s_waitcnt lgkmcnt(0)
  v_pk_mul_f32 v[50:51], v[50:51], v[62:63] op_sel_hi:[1,0]
  v_pk_mul_f32 v[52:53], v[52:53], v[62:63] op_sel_hi:[1,0]
  s_nop 0
  v_permlane32_swap_b32 v50, v51
  v_permlane32_swap_b32 v52, v53
  v_add_f32 v50, v50, v51
  v_add_f32 v52, v52, v53
  s_nop 1
  v_permlane16_swap_b32 v50, v52
  v_add_f32 v46, v50, v52
  v_add_f32 v47, v50, v52
  s_nop 1
  v_permlane32_swap_b32 v46, v47
  v_mov_b32 v48, v46
  s_nop 1
  v_permlane16_swap_b32 v46, v48
  s_nop 1
  v_mov_b32_dpp v46, v54 quad_perm:[0,1,2,3] row_mask:0x2 bank_mask:0xf
  s_mov_b64 exec, 0x1ffff
  buffer_store_dwordx4 v[46:49], v59, s[64:67], s76 offen sc1
  s_mov_b64 exec, -1
  v_max3_f32 v66, v20, v21, v22
  v_max_f32 v66, v66, v23
  s_nop 1
  v_max_f32_dpp v66, v66, v66 quad_perm:[1,0,3,2] row_mask:0xf bank_mask:0xf
  s_nop 1
  v_max_f32_dpp v66, v66, v66 quad_perm:[2,3,0,1] row_mask:0xf bank_mask:0xf
  s_nop 1
  v_max_f32_dpp v66, v66, v66 row_ror:8 row_mask:0xf bank_mask:0xf
  s_nop 1
  v_max_f32_dpp v66, v66, v66 row_bcast:15 row_mask:0xa bank_mask:0xf
  s_nop 1
  v_max_f32_dpp v66, v66, v66 row_bcast:31 row_mask:0xc bank_mask:0xf
  s_nop 0
  v_readlane_b32 s93, v66, 63
  s_cmp_lt_u32 s16, s17
  s_cbranch_scc0 L_tg_50146
  s_waitcnt vmcnt(10)
  s_swappc_b64 s[28:29], s[0:1]
L_tb_50147:
  v_mov_b32 v67, s21
  v_subrev_f32 v20, s93, v20
  v_subrev_f32 v21, s93, v21
  v_subrev_f32 v22, s93, v22
  v_subrev_f32 v23, s93, v23
  v_mov_b32 v66, s93
  v_mul_f32 v20, 0x3dd53b95, v20
  v_mul_f32 v21, 0x3dd53b95, v21
  v_mul_f32 v22, 0x3dd53b95, v22
  v_mul_f32 v23, 0x3dd53b95, v23
  ds_write_b32 v67, v66 offset:96
  v_exp_f32 v20, v20
  v_exp_f32 v21, v21
  v_exp_f32 v22, v22
  v_exp_f32 v23, v23
  v_add_f32 v66, v20, v21
  v_add_f32 v68, v22, v23
  v_add_f32 v68, v68, v66
  v_cvt_pk_bf16_f32 v20, v20, v20
  v_cvt_pk_bf16_f32 v21, v21, v21
  v_cvt_pk_bf16_f32 v22, v22, v22
  v_cvt_pk_bf16_f32 v23, v23, v23
.balignl 8, 0xBF800000
  v_and_b32_dpp v46, v21, v2 quad_perm:[2,2,2,2] row_mask:0xf bank_mask:0xf
  v_and_b32_dpp v47, v21, v3 quad_perm:[2,2,2,2] row_mask:0xf bank_mask:0xf
  v_and_b32_dpp v48, v21, v4 quad_perm:[1,1,1,1] row_mask:0xf bank_mask:0xf
  v_and_b32_dpp v49, v21, v5 quad_perm:[1,1,1,1] row_mask:0xf bank_mask:0xf
  s_nop 0
  s_nop 0
  v_mfma_f32_16x16x32_bf16 v[8:11], v[46:49], a[168:171], 0
  v_and_b32_dpp v50, v21, v2 quad_perm:[3,3,3,3] row_mask:0xf bank_mask:0xf
  v_and_b32_dpp v51, v21, v3 quad_perm:[3,3,3,3] row_mask:0xf bank_mask:0xf
  v_mfma_f32_16x16x32_bf16 v[12:15], v[46:49], a[172:175], 0
  v_and_b32_dpp v52, v21, v4 quad_perm:[0,0,0,0] row_mask:0xf bank_mask:0xf
  v_and_b32_dpp v53, v21, v5 quad_perm:[0,0,0,0] row_mask:0xf bank_mask:0xf
  v_mfma_f32_16x16x32_bf16 v[16:19], v[46:49], a[176:179], 0
  v_add_f32_dpp v68, v68, v68 quad_perm:[1,0,3,2] row_mask:0xf bank_mask:0xf
  v_mfma_f32_16x16x32_bf16 v[8:11], v[50:53], a[180:183], v[8:11]
  v_and_b32_dpp v46, v22, v2 quad_perm:[0,0,0,0] row_mask:0xf bank_mask:0xf
  v_and_b32_dpp v47, v22, v3 quad_perm:[0,0,0,0] row_mask:0xf bank_mask:0xf
  v_mfma_f32_16x16x32_bf16 v[12:15], v[50:53], a[184:187], v[12:15]
  v_and_b32_dpp v48, v22, v4 quad_perm:[3,3,3,3] row_mask:0xf bank_mask:0xf
  v_and_b32_dpp v49, v22, v5 quad_perm:[3,3,3,3] row_mask:0xf bank_mask:0xf
  v_mfma_f32_16x16x32_bf16 v[16:19], v[50:53], a[188:191], v[16:19]
  v_add_f32_dpp v68, v68, v68 quad_perm:[2,3,0,1] row_mask:0xf bank_mask:0xf
  v_mfma_f32_16x16x32_bf16 v[8:11], v[46:49], a[192:195], v[8:11]
  v_and_b32_dpp v50, v22, v2 quad_perm:[1,1,1,1] row_mask:0xf bank_mask:0xf
  v_and_b32_dpp v51, v22, v3 quad_perm:[1,1,1,1] row_mask:0xf bank_mask:0xf
  v_mfma_f32_16x16x32_bf16 v[12:15], v[46:49], a[196:199], v[12:15]
  v_and_b32_dpp v52, v22, v4 quad_perm:[2,2,2,2] row_mask:0xf bank_mask:0xf
  v_and_b32_dpp v53, v22, v5 quad_perm:[2,2,2,2] row_mask:0xf bank_mask:0xf
  v_mfma_f32_16x16x32_bf16 v[16:19], v[46:49], a[200:203], v[16:19]
  v_add_f32_dpp v68, v68, v68 row_ror:8 row_mask:0xf bank_mask:0xf
  v_mfma_f32_16x16x32_bf16 v[8:11], v[50:53], a[204:207], v[8:11]
  v_mfma_f32_16x16x32_bf16 v[12:15], v[50:53], a[208:211], v[12:15]
  v_mfma_f32_16x16x32_bf16 v[16:19], v[50:53], a[212:215], v[16:19]
  v_add_f32_dpp v68, v68, v68 row_bcast:15 row_mask:0xa bank_mask:0xf
  s_nop 1
  v_add_f32_dpp v68, v68, v68 row_bcast:31 row_mask:0xc bank_mask:0xf
  s_nop 0
  v_readlane_b32 s94, v68, 63
  s_cmp_lt_u32 s16, s17
  s_cbranch_scc0 L_tg_50148
  s_waitcnt vmcnt(10)
  s_swappc_b64 s[28:29], s[0:1]
L_tb_50149:
  s_mov_b32 s77, 0
  s_add_u32 s73, s72, 0
  v_lshrrev_b32 v45, 4, v0
  v_and_b32 v44, 1, v0
  v_lshl_add_u32 v45, v44, 2, v45
  s_add_u32 s91, s27, 2048
  v_lshl_add_u32 v45, v45, 4, s91
  s_add_u32 s97, s79, 524288
  buffer_load_dwordx4 v[34:37], v45, s[64:67], s97 offen sc1
  buffer_load_dwordx4 v[26:29], v6, s[64:67], s97 offen offset:0 sc1
  buffer_load_dwordx4 v[30:33], v6, s[64:67], s97 offen offset:1024 sc1
  s_cmp_lt_u32 s16, s17
  s_cbranch_scc0 L_tg_50150
  s_waitcnt vmcnt(13)
  s_swappc_b64 s[28:29], s[0:1]
L_tb_50151:
  s_cmp_lt_u32 s16, s17
  s_cbranch_scc0 L_tg_50152
  s_waitcnt vmcnt(13)
  s_swappc_b64 s[28:29], s[0:1]
L_tb_50153:
  v_lshrrev_b32 v46, 2, v0
  v_and_b32 v47, 3, v0
  v_mul_u32_u24 v46, 160, v46
  v_lshl_add_u32 v47, v47, 3, v46
  s_lshl_b32 s91, s3, 5
  s_add_u32 s91, s91, 94208
  v_add_u32 v46, s91, v47
  v_add_u32 v47, 94336, v47
  v_bfe_u32 v49, v0, 4, 1
  v_lshlrev_b32 v49, 8, v49
  v_lshrrev_b32 v48, 5, v0
  v_lshl_add_u32 v49, v48, 7, v49
  v_and_b32 v48, 7, v0
  v_lshl_add_u32 v49, v48, 4, v49
  v_bfe_u32 v48, v0, 3, 1
  v_lshl_add_u32 v49, v48, 2, v49
  s_and_b32 s91, s3, 1
  s_lshl_b32 s91, s91, 3
  s_and_b32 s92, s3, 2
  s_add_u32 s91, s91, s92
  s_add_u32 s91, s91, 159744
  v_add_u32 v49, s91, v49
  v_and_b32 v74, 0x30, v0
  s_lshl_b32 s91, s3, 4
  s_add_u32 s91, s91, 1
  v_writelane_b32 v74, 64, s91
  s_movk_i32 s91, 80
  v_writelane_b32 v74, s91, 2
  s_movk_i32 s91, 96
  v_writelane_b32 v74, s91, 3
  s_movk_i32 s91, 112
  v_writelane_b32 v74, s91, 4
  s_bfe_u32 s68, s73, 0x80000
  s_bfe_u32 s69, s73, 0x80008
  s_bfe_u32 s70, s73, 0x80010
  s_bfe_u32 s90, s73, 0x80018
  s_cmp_lg_u32 s77, 0
  s_cbranch_scc1 L_wz_50154
  s_waitcnt vmcnt(6)
L_wb_50155:
L_chk_50156:
  v_bitop3_b32 v75, v37, v29, s73 bitop3:0x7e
  v_bitop3_b32 v75, v75, v33, s73 bitop3:0xf6
  v_cmp_ne_u32 vcc, 0, v75
  s_nop 0
  s_cbranch_vccnz L_retry_50157
  v_max_f32_dpp v43, v34, v34 quad_perm:[1,0,3,2] row_mask:0xf bank_mask:0xf
  v_mov_b32 v42, v43
  ds_read_b64_tr_b16 v[50:51], v46 offset:0
  ds_read_b64_tr_b16 v[52:53], v46 offset:2560
  ds_read_b64_tr_b16 v[54:55], v47 offset:0
  ds_read_b64_tr_b16 v[56:57], v47 offset:2560
  v_permlane32_swap_b32 v43, v42
  v_max_f32 v43, v43, v42
  v_mov_b32 v42, v43
  ds_read_b64_tr_b16 v[58:59], v46 offset:5120
  ds_read_b64_tr_b16 v[60:61], v46 offset:7680
  ds_read_b64_tr_b16 v[62:63], v47 offset:5120
  ds_read_b64_tr_b16 v[64:65], v47 offset:7680
  v_permlane16_swap_b32 v43, v42
  v_max_f32 v43, v43, v42
  v_sub_f32 v43, v34, v43
  v_mul_f32 v43, 0x3dd53b95, v43
  v_exp_f32 v43, v43
  ds_read_b64_tr_b16 v[66:67], v46 offset:10240
  ds_read_b64_tr_b16 v[68:69], v46 offset:12800
  ds_read_b64_tr_b16 v[70:71], v47 offset:10240
  ds_read_b64_tr_b16 v[72:73], v47 offset:12800
  v_mul_f32 v35, v35, v43
  v_mul_f32_dpp v26, v43, v26 quad_perm:[0,0,2,2] row_mask:0xf bank_mask:0xf
  v_mul_f32_dpp v27, v43, v27 quad_perm:[0,0,2,2] row_mask:0xf bank_mask:0xf
  v_mul_f32_dpp v28, v43, v28 quad_perm:[0,0,2,2] row_mask:0xf bank_mask:0xf
  v_add_f32_dpp v29, v35, v35 quad_perm:[1,0,3,2] row_mask:0xf bank_mask:0xf
  v_fmac_f32_dpp v26, v43, v30 quad_perm:[1,1,3,3] row_mask:0xf bank_mask:0xf
  v_fmac_f32_dpp v27, v43, v31 quad_perm:[1,1,3,3] row_mask:0xf bank_mask:0xf
  v_fmac_f32_dpp v28, v43, v32 quad_perm:[1,1,3,3] row_mask:0xf bank_mask:0xf
  s_nop 0
  v_permlane32_swap_b32 v26, v27
  v_permlane32_swap_b32 v28, v29
  v_add_f32 v26, v26, v27
  v_add_f32 v28, v28, v29
  s_nop 1
  v_permlane16_swap_b32 v26, v28
  v_add_f32 v48, v26, v28
  v_lshrrev_b32 v45, 4, v0
  v_readlane_b32 s92, v48, 48
  v_lshlrev_b32 v45, 3, v45
  v_add_u32 v44, 159744, v45
  v_rcp_f32 v43, s92
  s_mov_b32 exec_hi, 0xffff
  v_mul_f32 v48, v48, v43
  v_cvt_pk_bf16_f32 v48, v48, v48
  ds_write_b16 v49, v48
  s_mov_b64 exec, -1
  s_waitcnt lgkmcnt(0)
  s_barrier
  ds_read2_b64 v[26:29], v44 offset0:0 offset1:4
  ds_read2_b64 v[30:33], v44 offset0:8 offset1:12
  ds_read2_b64 v[34:37], v44 offset0:16 offset1:20
  v_mov_b32 v48, v44
  s_add_u32 s76, s82, 131072
  s_lshl_b32 s91, s3, 4
  s_lshl_b64 vcc, 2, s91
  s_or_b32 s91, vcc_lo, 0x1001d
  s_or_b32 s92, vcc_hi, 0x10001
  v_mov_b32 v49, 0xffffff00
  s_waitcnt lgkmcnt(2)
  v_mfma_f32_16x16x32_bf16 v[38:41], v[50:53], v[26:29], 0
  v_mfma_f32_16x16x32_bf16 v[42:45], v[54:57], v[26:29], 0
  ds_read2_b64 v[26:29], v48 offset0:24 offset1:28
  ds_read_b64_tr_b16 v[50:51], v46 offset:15360
  ds_read_b64_tr_b16 v[52:53], v46 offset:17920
  ds_read_b64_tr_b16 v[54:55], v47 offset:15360
  ds_read_b64_tr_b16 v[56:57], v47 offset:17920
  s_waitcnt lgkmcnt(6)
  v_mfma_f32_16x16x32_bf16 v[38:41], v[58:61], v[30:33], v[38:41]
  v_mfma_f32_16x16x32_bf16 v[42:45], v[62:65], v[30:33], v[42:45]
  ds_read2_b64 v[30:33], v48 offset0:32 offset1:36
  ds_read_b64_tr_b16 v[58:59], v46 offset:20480
  ds_read_b64_tr_b16 v[60:61], v46 offset:23040
  ds_read_b64_tr_b16 v[62:63], v47 offset:20480
  ds_read_b64_tr_b16 v[64:65], v47 offset:23040
  s_waitcnt lgkmcnt(10)
  v_mfma_f32_16x16x32_bf16 v[38:41], v[66:69], v[34:37], v[38:41]
  v_mfma_f32_16x16x32_bf16 v[42:45], v[70:73], v[34:37], v[42:45]
  ds_read2_b64 v[34:37], v48 offset0:40 offset1:44
  ds_read_b64_tr_b16 v[66:67], v46 offset:25600
  ds_read_b64_tr_b16 v[68:69], v46 offset:28160
  ds_read_b64_tr_b16 v[70:71], v47 offset:25600
  ds_read_b64_tr_b16 v[72:73], v47 offset:28160
  s_cmp_lt_u32 s16, s17
  s_cbranch_scc0 L_tg_50164
  s_swappc_b64 s[28:29], s[0:1]
L_tb_50165:
  s_waitcnt lgkmcnt(10)
  v_mfma_f32_16x16x32_bf16 v[38:41], v[50:53], v[26:29], v[38:41]
  v_mfma_f32_16x16x32_bf16 v[42:45], v[54:57], v[26:29], v[42:45]
  s_waitcnt lgkmcnt(5)
  v_mfma_f32_16x16x32_bf16 v[38:41], v[58:61], v[30:33], v[38:41]
  v_mfma_f32_16x16x32_bf16 v[42:45], v[62:65], v[30:33], v[42:45]
  s_waitcnt lgkmcnt(0)
  v_mfma_f32_16x16x32_bf16 v[38:41], v[66:69], v[34:37], v[38:41]
  v_mfma_f32_16x16x32_bf16 v[42:45], v[70:73], v[34:37], v[42:45]
  s_nop 7
  v_cndmask_b32 v26, v38, v42, vcc
  v_cndmask_b32 v27, v39, v43, vcc
  v_cndmask_b32 v28, v40, v44, vcc
  v_cndmask_b32 v29, v41, v45, vcc
  s_mov_b32 exec_lo, s91
  s_mov_b32 exec_hi, s92
  v_and_or_b32 v26, v26, v49, s68
  v_and_or_b32 v27, v27, v49, s69
  v_and_or_b32 v28, v28, v49, s70
  v_and_or_b32 v29, v29, v49, s90
  buffer_store_dwordx4 v[26:29], v74, s[64:67], s76 offen sc1
  s_mov_b64 exec, -1
.balignl 8, 0xBF800000
  v_and_b32_dpp v46, v22, v2 quad_perm:[2,2,2,2] row_mask:0xf bank_mask:0xf
  v_and_b32_dpp v47, v22, v3 quad_perm:[2,2,2,2] row_mask:0xf bank_mask:0xf
  v_and_b32_dpp v48, v22, v4 quad_perm:[1,1,1,1] row_mask:0xf bank_mask:0xf
  v_and_b32_dpp v49, v22, v5 quad_perm:[1,1,1,1] row_mask:0xf bank_mask:0xf
  s_cmp_lt_u32 s16, s17
  s_cbranch_scc0 L_tg_50166
  s_swappc_b64 s[28:29], s[0:1]
L_tb_50167:
.balignl 8, 0xBF800000
  v_mfma_f32_16x16x32_bf16 v[8:11], v[46:49], a[216:219], v[8:11]
  v_and_b32_dpp v50, v22, v2 quad_perm:[3,3,3,3] row_mask:0xf bank_mask:0xf
  v_and_b32_dpp v51, v22, v3 quad_perm:[3,3,3,3] row_mask:0xf bank_mask:0xf
  v_mfma_f32_16x16x32_bf16 v[12:15], v[46:49], a[220:223], v[12:15]
  v_and_b32_dpp v52, v22, v4 quad_perm:[0,0,0,0] row_mask:0xf bank_mask:0xf
  v_and_b32_dpp v53, v22, v5 quad_perm:[0,0,0,0] row_mask:0xf bank_mask:0xf
  v_mfma_f32_16x16x32_bf16 v[16:19], v[46:49], a[224:227], v[16:19]
  v_nop_e64
  v_mfma_f32_16x16x32_bf16 v[8:11], v[50:53], a[228:231], v[8:11]
  v_and_b32_dpp v46, v23, v2 quad_perm:[0,0,0,0] row_mask:0xf bank_mask:0xf
  v_and_b32_dpp v47, v23, v3 quad_perm:[0,0,0,0] row_mask:0xf bank_mask:0xf
  v_mfma_f32_16x16x32_bf16 v[12:15], v[50:53], a[232:235], v[12:15]
  v_and_b32_dpp v48, v23, v4 quad_perm:[3,3,3,3] row_mask:0xf bank_mask:0xf
  v_and_b32_dpp v49, v23, v5 quad_perm:[3,3,3,3] row_mask:0xf bank_mask:0xf
  v_mfma_f32_16x16x32_bf16 v[16:19], v[50:53], a[236:239], v[16:19]
  v_nop_e64
  v_mfma_f32_16x16x32_bf16 v[8:11], v[46:49], a[240:243], v[8:11]
  v_and_b32_dpp v50, v23, v2 quad_perm:[1,1,1,1] row_mask:0xf bank_mask:0xf
  v_and_b32_dpp v51, v23, v3 quad_perm:[1,1,1,1] row_mask:0xf bank_mask:0xf
  v_mfma_f32_16x16x32_bf16 v[12:15], v[46:49], a[244:247], v[12:15]
  v_and_b32_dpp v52, v23, v4 quad_perm:[2,2,2,2] row_mask:0xf bank_mask:0xf
  v_and_b32_dpp v53, v23, v5 quad_perm:[2,2,2,2] row_mask:0xf bank_mask:0xf
  v_mfma_f32_16x16x32_bf16 v[16:19], v[46:49], a[248:251], v[16:19]
  ds_read_b128 v[56:59], v6 offset:0
  ds_read_b128 v[60:63], v6 offset:4096
  s_waitcnt lgkmcnt(0)
  v_mfma_f32_16x16x32_bf16 v[8:11], v[50:53], a[252:255], v[8:11]
  v_and_b32_dpp v46, v23, v2 quad_perm:[2,2,2,2] row_mask:0xf bank_mask:0xf
  v_and_b32_dpp v47, v23, v3 quad_perm:[2,2,2,2] row_mask:0xf bank_mask:0xf
  v_mfma_f32_16x16x32_bf16 v[12:15], v[50:53], v[56:59], v[12:15]
  v_and_b32_dpp v48, v23, v4 quad_perm:[1,1,1,1] row_mask:0xf bank_mask:0xf
  v_and_b32_dpp v49, v23, v5 quad_perm:[1,1,1,1] row_mask:0xf bank_mask:0xf
  v_mfma_f32_16x16x32_bf16 v[16:19], v[50:53], v[60:63], v[16:19]
  ds_read_b128 v[56:59], v6 offset:8192
  ds_read_b128 v[60:63], v6 offset:12288
  ds_read_b128 v[64:67], v6 offset:16384
  s_waitcnt lgkmcnt(0)
  v_mfma_f32_16x16x32_bf16 v[8:11], v[46:49], v[56:59], v[8:11]
  v_and_b32_dpp v50, v23, v2 quad_perm:[3,3,3,3] row_mask:0xf bank_mask:0xf
  v_and_b32_dpp v51, v23, v3 quad_perm:[3,3,3,3] row_mask:0xf bank_mask:0xf
  v_mfma_f32_16x16x32_bf16 v[12:15], v[46:49], v[60:63], v[12:15]
  v_and_b32_dpp v52, v23, v4 quad_perm:[0,0,0,0] row_mask:0xf bank_mask:0xf
  v_and_b32_dpp v53, v23, v5 quad_perm:[0,0,0,0] row_mask:0xf bank_mask:0xf
  v_mfma_f32_16x16x32_bf16 v[16:19], v[46:49], v[64:67], v[16:19]
  ds_read_b128 v[56:59], v6 offset:20480
  ds_read_b128 v[60:63], v6 offset:24576
  ds_read_b128 v[64:67], v6 offset:28672
  s_waitcnt lgkmcnt(0)
  v_mfma_f32_16x16x32_bf16 v[8:11], v[50:53], v[56:59], v[8:11]
  v_and_b32_dpp v46, v20, v2 quad_perm:[0,0,0,0] row_mask:0xf bank_mask:0xf
  v_and_b32_dpp v47, v20, v3 quad_perm:[0,0,0,0] row_mask:0xf bank_mask:0xf
  v_mfma_f32_16x16x32_bf16 v[12:15], v[50:53], v[60:63], v[12:15]
  v_and_b32_dpp v48, v20, v4 quad_perm:[3,3,3,3] row_mask:0xf bank_mask:0xf
  v_and_b32_dpp v49, v20, v5 quad_perm:[3,3,3,3] row_mask:0xf bank_mask:0xf
  v_mfma_f32_16x16x32_bf16 v[16:19], v[50:53], v[64:67], v[16:19]
  s_cmp_lt_u32 s16, s17
  s_cbranch_scc0 L_tg_50168
  s_waitcnt vmcnt(10)
  s_swappc_b64 s[28:29], s[0:1]
L_tb_50169:
.balignl 8, 0xBF800000
  v_mfma_f32_16x16x32_bf16 v[8:11], v[46:49], v[172:175], v[8:11]
  v_and_b32_dpp v50, v20, v2 quad_perm:[1,1,1,1] row_mask:0xf bank_mask:0xf
  v_and_b32_dpp v51, v20, v3 quad_perm:[1,1,1,1] row_mask:0xf bank_mask:0xf
  v_mfma_f32_16x16x32_bf16 v[12:15], v[46:49], v[176:179], v[12:15]
  v_and_b32_dpp v52, v20, v4 quad_perm:[2,2,2,2] row_mask:0xf bank_mask:0xf
  v_and_b32_dpp v53, v20, v5 quad_perm:[2,2,2,2] row_mask:0xf bank_mask:0xf
  v_mfma_f32_16x16x32_bf16 v[16:19], v[46:49], v[180:183], v[16:19]
  v_nop_e64
  v_mfma_f32_16x16x32_bf16 v[8:11], v[50:53], v[184:187], v[8:11]
  v_and_b32_dpp v46, v20, v2 quad_perm:[2,2,2,2] row_mask:0xf bank_mask:0xf
  v_and_b32_dpp v47, v20, v3 quad_perm:[2,2,2,2] row_mask:0xf bank_mask:0xf
  v_mfma_f32_16x16x32_bf16 v[12:15], v[50:53], v[188:191], v[12:15]
  v_and_b32_dpp v48, v20, v4 quad_perm:[1,1,1,1] row_mask:0xf bank_mask:0xf
  v_and_b32_dpp v49, v20, v5 quad_perm:[1,1,1,1] row_mask:0xf bank_mask:0xf
  v_mfma_f32_16x16x32_bf16 v[16:19], v[50:53], v[192:195], v[16:19]
  v_nop_e64
  v_mfma_f32_16x16x32_bf16 v[8:11], v[46:49], v[196:199], v[8:11]
  v_and_b32_dpp v50, v20, v2 quad_perm:[3,3,3,3] row_mask:0xf bank_mask:0xf
  v_and_b32_dpp v51, v20, v3 quad_perm:[3,3,3,3] row_mask:0xf bank_mask:0xf
  v_mfma_f32_16x16x32_bf16 v[12:15], v[46:49], v[200:203], v[12:15]
  v_and_b32_dpp v52, v20, v4 quad_perm:[0,0,0,0] row_mask:0xf bank_mask:0xf
  v_and_b32_dpp v53, v20, v5 quad_perm:[0,0,0,0] row_mask:0xf bank_mask:0xf
  v_mfma_f32_16x16x32_bf16 v[16:19], v[46:49], v[204:207], v[16:19]
  v_nop_e64
  v_mfma_f32_16x16x32_bf16 v[8:11], v[50:53], v[208:211], v[8:11]
  v_and_b32_dpp v46, v21, v2 quad_perm:[0,0,0,0] row_mask:0xf bank_mask:0xf
  v_and_b32_dpp v47, v21, v3 quad_perm:[0,0,0,0] row_mask:0xf bank_mask:0xf
  v_mfma_f32_16x16x32_bf16 v[12:15], v[50:53], v[212:215], v[12:15]
  v_and_b32_dpp v48, v21, v4 quad_perm:[3,3,3,3] row_mask:0xf bank_mask:0xf
  v_and_b32_dpp v49, v21, v5 quad_perm:[3,3,3,3] row_mask:0xf bank_mask:0xf
  v_mfma_f32_16x16x32_bf16 v[16:19], v[50:53], v[216:219], v[16:19]
  v_nop_e64
  v_mfma_f32_16x16x32_bf16 v[8:11], v[46:49], v[220:223], v[8:11]
  v_and_b32_dpp v50, v21, v2 quad_perm:[1,1,1,1] row_mask:0xf bank_mask:0xf
  v_and_b32_dpp v51, v21, v3 quad_perm:[1,1,1,1] row_mask:0xf bank_mask:0xf
  v_mfma_f32_16x16x32_bf16 v[12:15], v[46:49], v[224:227], v[12:15]
  v_and_b32_dpp v52, v21, v4 quad_perm:[2,2,2,2] row_mask:0xf bank_mask:0xf
  v_and_b32_dpp v53, v21, v5 quad_perm:[2,2,2,2] row_mask:0xf bank_mask:0xf
  v_mfma_f32_16x16x32_bf16 v[16:19], v[46:49], v[228:231], v[16:19]
  v_nop_e64
  v_mfma_f32_16x16x32_bf16 v[8:11], v[50:53], v[232:235], v[8:11]
  v_mfma_f32_16x16x32_bf16 v[12:15], v[50:53], v[236:239], v[12:15]
  v_mfma_f32_16x16x32_bf16 v[16:19], v[50:53], v[240:243], v[16:19]
  s_mov_b32 s19, 237
  s_min_u32 s17, s18, s19
  v_lshrrev_b32 v60, 4, v0
  v_and_b32 v59, 15, v0
  v_lshlrev_b32 v58, 10, v60
  v_lshl_add_u32 v58, v59, 4, v58
  s_lshl_b32 s91, s3, 8
  s_add_u32 s91, s91, 155648
  v_add_u32 v58, s91, v58
  v_add_u32 v59, 155648, v6
  v_mov_b32 v49, s94
  v_permlane32_swap_b32 v8, v9
  v_permlane32_swap_b32 v10, v11
  v_permlane32_swap_b32 v12, v13
  v_permlane32_swap_b32 v14, v15
  v_permlane32_swap_b32 v16, v17
  v_permlane32_swap_b32 v18, v19
  v_add_f32_dpp v46, v9, v8 row_ror:8 row_mask:0xf bank_mask:0x3
  v_add_f32_dpp v47, v13, v12 row_ror:8 row_mask:0xf bank_mask:0x3
  v_add_f32_dpp v48, v17, v16 row_ror:8 row_mask:0xf bank_mask:0x3
  v_add_f32_dpp v46, v10, v11 row_ror:8 row_mask:0xf bank_mask:0xc
  v_add_f32_dpp v47, v14, v15 row_ror:8 row_mask:0xf bank_mask:0xc
  v_add_f32_dpp v48, v18, v19 row_ror:8 row_mask:0xf bank_mask:0xc
  ds_write_b128 v59, v[46:49]
  v_lshlrev_b32 v60, 2, v60
  v_add_u32 v60, 161472, v60
  v_mov_b32 v62, 161472
  s_waitcnt lgkmcnt(0)
  s_barrier
  ds_read_b128 v[54:57], v62
  ds_read_b32 v62, v60
  ds_read_b128 v[50:53], v58
  s_add_u32 s73, s72, 3
  s_mul_i32 s91, s31, 240
  s_sub_u32 s91, 2048, s91
  v_lshlrev_b32 v59, 4, v0
  v_writelane_b32 v59, s91, 16
  v_mov_b32 v49, s73
  s_add_u32 s76, s78, 0
  s_cmp_lt_u32 s16, s17
  s_cbranch_scc0 L_tg_50170
  s_waitcnt vmcnt(10)
  s_swappc_b64 s[28:29], s[0:1]
L_tb_50171:
  s_waitcnt lgkmcnt(1)
  v_max3_f32 v54, v54, v55, v56
  v_max_f32 v54, v54, v57
  v_sub_f32 v62, v62, v54
  v_mul_f32 v62, 0x3dd53b95, v62
  v_exp_f32 v62, v62
  s_waitcnt lgkmcnt(0)
  v_pk_mul_f32 v[50:51], v[50:51], v[62:63] op_sel_hi:[1,0]
  v_pk_mul_f32 v[52:53], v[52:53], v[62:63] op_sel_hi:[1,0]
  s_nop 0
  v_permlane32_swap_b32 v50, v51
  v_permlane32_swap_b32 v52, v53
  v_add_f32 v50, v50, v51
  v_add_f32 v52, v52, v53
  s_nop 1
  v_permlane16_swap_b32 v50, v52
  v_add_f32 v46, v50, v52
  v_add_f32 v47, v50, v52
  s_nop 1
  v_permlane32_swap_b32 v46, v47
  v_mov_b32 v48, v46
  s_nop 1
  v_permlane16_swap_b32 v46, v48
  s_nop 1
  v_mov_b32_dpp v46, v54 quad_perm:[0,1,2,3] row_mask:0x2 bank_mask:0xf
  s_mov_b64 exec, 0x1ffff
  buffer_store_dwordx4 v[46:49], v59, s[64:67], s76 offen sc1
  s_mov_b64 exec, -1
  s_cmp_lt_u32 s16, s17
  s_cbranch_scc0 L_tg_50172
  s_waitcnt vmcnt(11)
  s_swappc_b64 s[28:29], s[0:1]
L_tb_50173:
  s_mov_b32 s77, 0
  s_add_u32 s73, s72, 3
  v_lshrrev_b32 v45, 4, v0
  v_and_b32 v44, 1, v0
  v_lshl_add_u32 v45, v44, 2, v45
  s_add_u32 s91, s27, 2048
  v_lshl_add_u32 v45, v45, 4, s91
  s_add_u32 s97, s79, 0
  buffer_load_dwordx4 v[34:37], v45, s[64:67], s97 offen sc1
  buffer_load_dwordx4 v[26:29], v6, s[64:67], s97 offen offset:0 sc1
  buffer_load_dwordx4 v[30:33], v6, s[64:67], s97 offen offset:1024 sc1
  s_cmp_lt_u32 s16, s17
  s_cbranch_scc0 L_tg_50174
  s_waitcnt vmcnt(13)
  s_swappc_b64 s[28:29], s[0:1]
L_tb_50175:
  s_cmp_lt_u32 s16, s17
  s_cbranch_scc0 L_tg_50176
  s_waitcnt vmcnt(13)
  s_swappc_b64 s[28:29], s[0:1]
L_tb_50177:
  v_lshrrev_b32 v46, 2, v0
  v_and_b32 v47, 3, v0
  v_mul_u32_u24 v46, 160, v46
  v_lshl_add_u32 v47, v47, 3, v46
  s_lshl_b32 s91, s3, 5
  s_add_u32 s91, s91, 124928
  v_add_u32 v46, s91, v47
  v_add_u32 v47, 125056, v47
  v_bfe_u32 v49, v0, 4, 1
  v_lshlrev_b32 v49, 8, v49
  v_lshrrev_b32 v48, 5, v0
  v_lshl_add_u32 v49, v48, 7, v49
  v_and_b32 v48, 7, v0
  v_lshl_add_u32 v49, v48, 4, v49
  v_bfe_u32 v48, v0, 3, 1
  v_lshl_add_u32 v49, v48, 2, v49
  s_and_b32 s91, s3, 1
  s_lshl_b32 s91, s91, 3
  s_and_b32 s92, s3, 2
  s_add_u32 s91, s91, s92
  s_add_u32 s91, s91, 159744
  v_add_u32 v49, s91, v49
  v_and_b32 v74, 0x30, v0
  s_lshl_b32 s91, s3, 4
  s_add_u32 s91, s91, 1
  v_writelane_b32 v74, 64, s91
  s_movk_i32 s91, 80
  v_writelane_b32 v74, s91, 2
  s_movk_i32 s91, 96
  v_writelane_b32 v74, s91, 3
  s_movk_i32 s91, 112
  v_writelane_b32 v74, s91, 4
  s_bfe_u32 s68, s73, 0x80000
  s_bfe_u32 s69, s73, 0x80008
  s_bfe_u32 s70, s73, 0x80010
  s_bfe_u32 s90, s73, 0x80018
  s_cmp_lg_u32 s77, 0
  s_cbranch_scc1 L_wz_50178
  s_waitcnt vmcnt(6)
L_wb_50179:
L_chk_50180:
  v_bitop3_b32 v75, v37, v29, s73 bitop3:0x7e
  v_bitop3_b32 v75, v75, v33, s73 bitop3:0xf6
  v_cmp_ne_u32 vcc, 0, v75
  s_nop 0
  s_cbranch_vccnz L_retry_50181
  v_max_f32_dpp v43, v34, v34 quad_perm:[1,0,3,2] row_mask:0xf bank_mask:0xf
  v_mov_b32 v42, v43
  ds_read_b64_tr_b16 v[50:51], v46 offset:0
  ds_read_b64_tr_b16 v[52:53], v46 offset:2560
  ds_read_b64_tr_b16 v[54:55], v47 offset:0
  ds_read_b64_tr_b16 v[56:57], v47 offset:2560
  v_permlane32_swap_b32 v43, v42
  v_max_f32 v43, v43, v42
  v_mov_b32 v42, v43
  ds_read_b64_tr_b16 v[58:59], v46 offset:5120
  ds_read_b64_tr_b16 v[60:61], v46 offset:7680
  ds_read_b64_tr_b16 v[62:63], v47 offset:5120
  ds_read_b64_tr_b16 v[64:65], v47 offset:7680
  v_permlane16_swap_b32 v43, v42
  v_max_f32 v43, v43, v42
  v_sub_f32 v43, v34, v43
  v_mul_f32 v43, 0x3dd53b95, v43
  v_exp_f32 v43, v43
  ds_read_b64_tr_b16 v[66:67], v46 offset:10240
  ds_read_b64_tr_b16 v[68:69], v46 offset:12800
  ds_read_b64_tr_b16 v[70:71], v47 offset:10240
  ds_read_b64_tr_b16 v[72:73], v47 offset:12800
  v_mul_f32 v35, v35, v43
  v_mul_f32_dpp v26, v43, v26 quad_perm:[0,0,2,2] row_mask:0xf bank_mask:0xf
  v_mul_f32_dpp v27, v43, v27 quad_perm:[0,0,2,2] row_mask:0xf bank_mask:0xf
  v_mul_f32_dpp v28, v43, v28 quad_perm:[0,0,2,2] row_mask:0xf bank_mask:0xf
  v_add_f32_dpp v29, v35, v35 quad_perm:[1,0,3,2] row_mask:0xf bank_mask:0xf
  v_fmac_f32_dpp v26, v43, v30 quad_perm:[1,1,3,3] row_mask:0xf bank_mask:0xf
  v_fmac_f32_dpp v27, v43, v31 quad_perm:[1,1,3,3] row_mask:0xf bank_mask:0xf
  v_fmac_f32_dpp v28, v43, v32 quad_perm:[1,1,3,3] row_mask:0xf bank_mask:0xf
  s_nop 0
  v_permlane32_swap_b32 v26, v27
  v_permlane32_swap_b32 v28, v29
  v_add_f32 v26, v26, v27
  v_add_f32 v28, v28, v29
  s_nop 1
  v_permlane16_swap_b32 v26, v28
  v_add_f32 v48, v26, v28
  v_lshrrev_b32 v45, 4, v0
  v_readlane_b32 s92, v48, 48
  v_lshlrev_b32 v45, 3, v45
  v_add_u32 v44, 159744, v45
  v_rcp_f32 v43, s92
  s_mov_b32 exec_hi, 0xffff
  v_mul_f32 v48, v48, v43
  v_cvt_pk_bf16_f32 v48, v48, v48
  ds_write_b16 v49, v48
  s_mov_b64 exec, -1
  s_waitcnt lgkmcnt(0)
  s_barrier
  ds_read2_b64 v[26:29], v44 offset0:0 offset1:4
  ds_read2_b64 v[30:33], v44 offset0:8 offset1:12
  ds_read2_b64 v[34:37], v44 offset0:16 offset1:20
  v_mov_b32 v48, v44
  s_add_u32 s76, s82, 786432
  s_lshl_b32 s91, s3, 4
  s_lshl_b64 vcc, 2, s91
  s_or_b32 s91, vcc_lo, 0x1001d
  s_or_b32 s92, vcc_hi, 0x10001
  v_mov_b32 v49, 0xffffff00
  s_waitcnt lgkmcnt(2)
  v_mfma_f32_16x16x32_bf16 v[38:41], v[50:53], v[26:29], 0
  v_mfma_f32_16x16x32_bf16 v[42:45], v[54:57], v[26:29], 0
  ds_read2_b64 v[26:29], v48 offset0:24 offset1:28
  ds_read_b64_tr_b16 v[50:51], v46 offset:15360
  ds_read_b64_tr_b16 v[52:53], v46 offset:17920
  ds_read_b64_tr_b16 v[54:55], v47 offset:15360
  ds_read_b64_tr_b16 v[56:57], v47 offset:17920
  s_waitcnt lgkmcnt(6)
  v_mfma_f32_16x16x32_bf16 v[38:41], v[58:61], v[30:33], v[38:41]
  v_mfma_f32_16x16x32_bf16 v[42:45], v[62:65], v[30:33], v[42:45]
  ds_read2_b64 v[30:33], v48 offset0:32 offset1:36
  ds_read_b64_tr_b16 v[58:59], v46 offset:20480
  ds_read_b64_tr_b16 v[60:61], v46 offset:23040
  ds_read_b64_tr_b16 v[62:63], v47 offset:20480
  ds_read_b64_tr_b16 v[64:65], v47 offset:23040
  s_waitcnt lgkmcnt(10)
  v_mfma_f32_16x16x32_bf16 v[38:41], v[66:69], v[34:37], v[38:41]
  v_mfma_f32_16x16x32_bf16 v[42:45], v[70:73], v[34:37], v[42:45]
  ds_read2_b64 v[34:37], v48 offset0:40 offset1:44
  ds_read_b64_tr_b16 v[66:67], v46 offset:25600
  ds_read_b64_tr_b16 v[68:69], v46 offset:28160
  ds_read_b64_tr_b16 v[70:71], v47 offset:25600
  ds_read_b64_tr_b16 v[72:73], v47 offset:28160
  s_cmp_lt_u32 s16, s17
  s_cbranch_scc0 L_tg_50188
  s_swappc_b64 s[28:29], s[0:1]
L_tb_50189:
  s_waitcnt lgkmcnt(10)
  v_mfma_f32_16x16x32_bf16 v[38:41], v[50:53], v[26:29], v[38:41]
  v_mfma_f32_16x16x32_bf16 v[42:45], v[54:57], v[26:29], v[42:45]
  s_waitcnt lgkmcnt(5)
  v_mfma_f32_16x16x32_bf16 v[38:41], v[58:61], v[30:33], v[38:41]
  v_mfma_f32_16x16x32_bf16 v[42:45], v[62:65], v[30:33], v[42:45]
  s_waitcnt lgkmcnt(0)
  v_mfma_f32_16x16x32_bf16 v[38:41], v[66:69], v[34:37], v[38:41]
  v_mfma_f32_16x16x32_bf16 v[42:45], v[70:73], v[34:37], v[42:45]
  s_nop 7
  v_cndmask_b32 v26, v38, v42, vcc
  v_cndmask_b32 v27, v39, v43, vcc
  v_cndmask_b32 v28, v40, v44, vcc
  v_cndmask_b32 v29, v41, v45, vcc
  s_mov_b32 exec_lo, s91
  s_mov_b32 exec_hi, s92
  v_and_or_b32 v26, v26, v49, s68
  v_and_or_b32 v27, v27, v49, s69
  v_and_or_b32 v28, v28, v49, s70
  v_and_or_b32 v29, v29, v49, s90
  buffer_store_dwordx4 v[26:29], v74, s[64:67], s76 offen sc1
  s_mov_b64 exec, -1
  s_mov_b32 s77, 0
  s_add_u32 s73, s72, 0
  v_lshrrev_b32 v74, 3, v0
  v_and_b32 v75, 7, v0
  v_mul_u32_u24 v74, 128, v74
  v_lshl_add_u32 v74, v75, 4, v74
  s_add_u32 s97, s83, 131072
  s_mov_b32 exec_lo, 0x1f1f1f1f
  s_mov_b32 exec_hi, 0x1f1f1f1f
  buffer_load_dwordx4 v[26:29], v74, s[64:67], s97 offen offset:0 sc1
  buffer_load_dwordx4 v[30:33], v74, s[64:67], s97 offen offset:1024 sc1
  buffer_load_dwordx4 v[34:37], v74, s[64:67], s97 offen offset:2048 sc1
  buffer_load_dwordx4 v[38:41], v74, s[64:67], s97 offen offset:3072 sc1
  s_mov_b64 exec, -1
  s_bfe_u32 s68, s73, 0x80000
  s_bfe_u32 s69, s73, 0x80008
  s_bfe_u32 s70, s73, 0x80010
  s_bfe_u32 s90, s73, 0x80018
  s_cmp_lt_u32 s16, s17
  s_cbranch_scc0 L_tg_50190
  s_swappc_b64 s[28:29], s[0:1]
L_tb_50191:
  s_cmp_lt_u32 s16, s17
  s_cbranch_scc0 L_tg_50192
  s_waitcnt vmcnt(14)
  s_swappc_b64 s[28:29], s[0:1]
L_tb_50193:
  s_cmp_lg_u32 s77, 0
  s_cbranch_scc1 L_wz_50194
  s_waitcnt vmcnt(6)
L_wb_50195:
  s_mov_b32 exec_lo, 0x1f1f1f1f
  s_mov_b32 exec_hi, 0x1f1f1f1f
L_chk_50196:
  v_xor_b32 v26, s68, v26
  v_xor_b32 v30, s68, v30
  v_xor_b32 v34, s68, v34
  v_xor_b32 v38, s68, v38
  v_xor_b32 v27, s69, v27
  v_xor_b32 v31, s69, v31
  v_xor_b32 v35, s69, v35
  v_xor_b32 v39, s69, v39
  v_xor_b32 v28, s70, v28
  v_xor_b32 v32, s70, v32
  v_xor_b32 v36, s70, v36
  v_xor_b32 v40, s70, v40
  v_xor_b32 v29, s90, v29
  v_xor_b32 v33, s90, v33
  v_xor_b32 v37, s90, v37
  v_xor_b32 v41, s90, v41
  v_or3_b32 v75, v26, v30, v34
  v_or3_b32 v75, v75, v38, v27
  v_or3_b32 v75, v75, v31, v35
  v_or3_b32 v75, v75, v39, v28
  v_or3_b32 v75, v75, v32, v36
  v_or3_b32 v75, v75, v40, v29
  v_or3_b32 v75, v75, v33, v37
  v_or3_b32 v75, v75, v41, v41
  v_and_b32 v75, 0xff, v75
  v_cmp_ne_u32 vcc, 0, v75
  s_nop 0
  s_cbranch_vccnz L_retry_50197
  v_pk_add_f32 v[26:27], v[26:27], v[30:31]
  v_pk_add_f32 v[28:29], v[28:29], v[32:33]
  v_pk_add_f32 v[34:35], v[34:35], v[38:39]
  v_pk_add_f32 v[36:37], v[36:37], v[40:41]
  v_pk_add_f32 v[26:27], v[26:27], v[34:35]
  v_pk_add_f32 v[28:29], v[28:29], v[36:37]
  v_add_u32 v33, 160288, v24
  v_add_f32_dpp v30, v26, v26 row_ror:8 row_mask:0xf bank_mask:0x3
  v_add_f32_dpp v31, v28, v28 row_ror:8 row_mask:0xf bank_mask:0x3
  s_nop 0
  v_add_f32_dpp v30, v27, v27 row_ror:8 row_mask:0xf bank_mask:0xc
  v_add_f32_dpp v31, v29, v29 row_ror:8 row_mask:0xf bank_mask:0xc
  s_nop 1
  v_permlane32_swap_b32 v30, v31
  v_add_f32 v30, v30, v31
  v_mov_b32 v31, v30
  s_nop 1
  v_permlane16_swap_b32 v30, v31
  v_add_f32 v30, v30, v31
  v_cvt_pk_bf16_f32 v30, v30, v30
  v_and_b32 v30, 0xffff0000, v30
  v_add_f32 v30, v30, v25
  v_cvt_pk_bf16_f32 v31, v30, v30
  ds_write_b16 v33, v31
  v_and_b32 v25, 0xffff0000, v31
  s_mov_b64 exec, -1
  v_bfe_u32 v72, v0, 2, 3
  v_lshrrev_b32 v71, 5, v0
  v_mul_u32_u24 v71, 3072, v71
  v_lshl_add_u32 v71, v72, 7, v71
  v_and_b32 v73, 3, v0
  v_lshl_add_u32 v71, v73, 3, v71
  v_lshrrev_b32 v72, 1, v72
  s_mul_i32 s91, s3, 3
  s_add_u32 s91, s91, 0
  s_and_b32 s92, s91, 3
  s_lshr_b32 s91, s91, 2
  v_xor_b32 v73, s92, v72
  s_lshl_b32 s91, s91, 10
  s_add_u32 s91, s91, 63488
  v_lshl_add_u32 v73, v73, 5, v71
  v_add_u32 v42, s91, v73
  ds_read_b64_tr_b16 v[44:45], v42 offset:0
  ds_read_b64_tr_b16 v[46:47], v42 offset:6144
  ds_read_b64_tr_b16 v[48:49], v42 offset:12288
  ds_read_b64_tr_b16 v[50:51], v42 offset:18432
  ds_read_b64_tr_b16 v[52:53], v42 offset:24576
  s_mul_i32 s91, s3, 3
  s_add_u32 s91, s91, 1
  s_and_b32 s92, s91, 3
  s_lshr_b32 s91, s91, 2
  v_xor_b32 v73, s92, v72
  s_lshl_b32 s91, s91, 10
  s_add_u32 s91, s91, 63488
  v_lshl_add_u32 v73, v73, 5, v71
  v_add_u32 v43, s91, v73
  ds_read_b64_tr_b16 v[54:55], v43 offset:0
  ds_read_b64_tr_b16 v[56:57], v43 offset:6144
  ds_read_b64_tr_b16 v[58:59], v43 offset:12288
  ds_read_b64_tr_b16 v[60:61], v43 offset:18432
  ds_read_b64_tr_b16 v[62:63], v43 offset:24576
  s_mul_i32 s91, s3, 3
  s_add_u32 s91, s91, 2
  s_and_b32 s92, s91, 3
  s_lshr_b32 s91, s91, 2
  v_xor_b32 v73, s92, v72
  s_lshl_b32 s91, s91, 10
  s_add_u32 s91, s91, 63488
  v_lshl_add_u32 v73, v73, 5, v71
  v_add_u32 v42, s91, v73
  ds_read_b64_tr_b16 v[64:65], v42 offset:0
  ds_read_b64_tr_b16 v[66:67], v42 offset:6144
  ds_read_b64_tr_b16 v[68:69], v42 offset:12288
  ds_read_b64_tr_b16 v[70:71], v42 offset:18432
  ds_read_b64_tr_b16 v[72:73], v42 offset:24576
  v_mov_b32 v75, 160288
  v_mov_b32 v32, 161216
  s_mov_b32 vcc_lo, 0x00f000f0
  s_mov_b32 vcc_hi, 0x00f000f0
  v_cndmask_b32 v75, v75, v32, vcc
  v_lshrrev_b32 v32, 4, v0
  v_lshl_add_u32 v75, v32, 3, v75
  s_waitcnt lgkmcnt(0)
  s_barrier
  ds_read2_b64 v[34:37], v75 offset0:0 offset1:4
  ds_read2_b64 v[38:41], v75 offset0:8 offset1:12
  ds_read_b64 v[42:43], v75 offset:128
  s_add_u32 s73, s72, 1
  s_add_u32 s76, s80, 3145728
  s_mul_i32 s91, s31, 240
  s_sub_u32 s91, 2048, s91
  v_lshlrev_b32 v74, 4, v0
  v_writelane_b32 v74, s91, 32
  s_cmp_lt_u32 s16, s17
  s_cbranch_scc0 L_tg_50204
  s_swappc_b64 s[28:29], s[0:1]
L_tb_50205:
  s_waitcnt lgkmcnt(0)
  v_mfma_f32_16x16x32_bf16 v[26:29], v[34:37], v[44:47], 0
  v_mfma_f32_16x16x32_bf16 v[30:33], v[34:37], v[54:57], 0
  v_mfma_f32_16x16x32_bf16 v[26:29], v[38:41], v[48:51], v[26:29]
  v_mfma_f32_16x16x32_bf16 v[30:33], v[38:41], v[58:61], v[30:33]
  v_mfma_f32_16x16x16_bf16 v[26:29], v[42:43], v[52:53], v[26:29]
  v_mfma_f32_16x16x16_bf16 v[30:33], v[42:43], v[62:63], v[30:33]
  v_mfma_f32_16x16x32_bf16 v[48:51], v[34:37], v[34:37], 0
  v_mfma_f32_16x16x32_bf16 v[44:47], v[34:37], v[64:67], 0
  v_mfma_f32_16x16x32_bf16 v[48:51], v[38:41], v[38:41], v[48:51]
  v_mfma_f32_16x16x32_bf16 v[44:47], v[38:41], v[68:71], v[44:47]
  v_mfma_f32_16x16x16_bf16 v[48:51], v[42:43], v[42:43], v[48:51]
  v_mfma_f32_16x16x16_bf16 v[44:47], v[42:43], v[72:73], v[44:47]
  s_nop 0
  v_mov_b32 v29, s73
  v_mov_b32 v27, v30
  s_nop 4
  v_mov_b32 v28, v44
  v_mov_b32_dpp v26, v48 quad_perm:[0,1,2,3] row_mask:0x4 bank_mask:0xf
  v_mov_b32_dpp v27, v48 row_ror:12 row_mask:0x4 bank_mask:0xf
  s_mov_b32 exec_lo, 0xffff
  s_mov_b32 exec_hi, 1
  buffer_store_dwordx4 v[26:29], v74, s[64:67], s76 offen sc1
  s_mov_b64 exec, -1
  s_mov_b32 s77, 0
  s_add_u32 s73, s72, 1
  v_and_b32 v38, 7, v0
  s_add_u32 s91, s27, 2048
  v_lshl_add_u32 v38, v38, 4, s91
  s_add_u32 s97, s81, 3145728
  buffer_load_dwordx4 v[34:37], v38, s[64:67], s97 offen sc1
  buffer_load_dwordx4 v[26:29], v6, s[64:67], s97 offen offset:0 sc1
  buffer_load_dwordx4 v[30:33], v6, s[64:67], s97 offen offset:1024 sc1
  s_cmp_lt_u32 s16, s17
  s_cbranch_scc0 L_tg_50206
  s_swappc_b64 s[28:29], s[0:1]
L_tb_50207:
  s_cmp_lt_u32 s16, s17
  s_cbranch_scc0 L_tg_50208
  s_waitcnt vmcnt(13)
  s_swappc_b64 s[28:29], s[0:1]
L_tb_50209:
  v_and_b32 v58, 15, v0
  v_bfe_u32 v60, v0, 4, 1
  v_lshl_add_u32 v58, v60, 5, v58
  v_lshrrev_b32 v60, 5, v0
  v_lshl_add_u32 v58, v60, 4, v58
  s_mul_i32 s91, s3, 96
  s_add_u32 s91, s91, 160832
  v_lshl_add_u32 v58, v58, 1, s91
  v_lshrrev_b32 v61, 2, v6
  v_add_u32 v61, 162528, v61
  ds_read_b32 v60, v61
  s_cmp_lg_u32 s77, 0
  s_cbranch_scc1 L_wz_50210
  s_waitcnt vmcnt(6)
L_wb_50211:
L_chk_50212:
  v_bitop3_b32 v75, v37, v29, s73 bitop3:0x7e
  v_bitop3_b32 v75, v75, v33, s73 bitop3:0xf6
  v_cmp_ne_u32 vcc, 0, v75
  s_nop 0
  s_cbranch_vccnz L_retry_50213
  v_pk_add_f32 v[26:27], v[26:27], v[30:31]
  v_add_f32 v28, v28, v32
  v_mov_b32 v29, v28
  v_add_f32_dpp v34, v34, v34 quad_perm:[1,0,3,2] row_mask:0xf bank_mask:0xf
  v_add_f32_dpp v35, v35, v35 quad_perm:[1,0,3,2] row_mask:0xf bank_mask:0xf
  v_permlane32_swap_b32 v26, v27
  v_permlane32_swap_b32 v28, v29
  v_add_f32_dpp v34, v34, v34 quad_perm:[2,3,0,1] row_mask:0xf bank_mask:0xf
  v_add_f32_dpp v35, v35, v35 quad_perm:[2,3,0,1] row_mask:0xf bank_mask:0xf
  v_add_f32 v26, v26, v27
  v_add_f32 v28, v28, v29
  v_add_f32_dpp v34, v34, v34 row_half_mirror row_mask:0xf bank_mask:0xf
  v_add_f32_dpp v35, v35, v35 row_half_mirror row_mask:0xf bank_mask:0xf
  v_permlane16_swap_b32 v26, v28
  v_mul_f32 v35, 0x3acccccd, v35
  v_mul_f32 v34, 0x3acccccd, v34
  v_add_f32 v62, v26, v28
  v_fma_f32 v34, -v35, v35, v34
  v_max_f32 v34, 0, v34
  v_add_f32 v34, 0x3727c5ac, v34
  v_rsq_f32 v34, v34
  s_waitcnt lgkmcnt(0)
  v_fma_f32 v62, -v35, v60, v62
  s_mov_b32 exec_hi, 0xffff
  v_mul_f32 v62, v62, v34
  v_cvt_pk_bf16_f32 v62, v62, v62
  ds_write_b16 v58, v62
  s_mov_b64 exec, -1
  s_waitcnt lgkmcnt(0)
  s_barrier
L_nw_50220:
  s_cmp_ge_u32 s16, 198
  s_cbranch_scc1 L_nx_50221
  s_cmp_lt_u32 s16, s17
  s_cbranch_scc0 L_nd_50222
  s_waitcnt vmcnt(9)
  s_swappc_b64 s[28:29], s[0:1]
  s_branch L_nw_50220
L_nx_50221:
  s_waitcnt vmcnt(6)
L_nq_50223:
  v_and_b32 v66, 7, v0
  v_lshlrev_b32 v66, 4, v66
  v_add_u32 v66, 160832, v66
  ds_read_b128 v[8:11], v66 offset:0
  ds_read_b128 v[12:15], v66 offset:128
  ds_read_b128 v[16:19], v66 offset:256
  s_waitcnt lgkmcnt(0)
.balignl 8, 0xBF800000
  v_mfma_f32_4x4x4_16b_bf16 v[44:47], v[8:9], v[112:113], 0
  v_mfma_f32_4x4x4_16b_bf16 v[48:51], v[8:9], v[124:125], 0
  v_nop_e64
  v_mfma_f32_4x4x4_16b_bf16 v[44:47], v[10:11], v[114:115], v[44:47]
  v_mfma_f32_4x4x4_16b_bf16 v[48:51], v[10:11], v[126:127], v[48:51]
  v_nop_e64
  v_mfma_f32_4x4x4_16b_bf16 v[44:47], v[12:13], v[116:117], v[44:47]
  v_mfma_f32_4x4x4_16b_bf16 v[48:51], v[12:13], v[128:129], v[48:51]
  v_nop_e64
  v_mfma_f32_4x4x4_16b_bf16 v[44:47], v[14:15], v[118:119], v[44:47]
  v_mfma_f32_4x4x4_16b_bf16 v[48:51], v[14:15], v[130:131], v[48:51]
  v_nop_e64
  v_mfma_f32_4x4x4_16b_bf16 v[44:47], v[16:17], v[120:121], v[44:47]
  v_mfma_f32_4x4x4_16b_bf16 v[48:51], v[16:17], v[132:133], v[48:51]
  v_nop_e64
  v_mfma_f32_4x4x4_16b_bf16 v[44:47], v[18:19], v[122:123], v[44:47]
  v_mfma_f32_4x4x4_16b_bf16 v[48:51], v[18:19], v[134:135], v[48:51]
  v_mfma_f32_4x4x4_16b_bf16 v[52:55], v[8:9], v[136:137], 0
  v_mfma_f32_4x4x4_16b_bf16 v[56:59], v[8:9], v[148:149], 0
  v_nop_e64
  v_mfma_f32_4x4x4_16b_bf16 v[52:55], v[10:11], v[138:139], v[52:55]
  v_mov_b32_dpp v60, v44 quad_perm:[0,0,0,0] row_mask:0xf bank_mask:0xf
  v_mfma_f32_4x4x4_16b_bf16 v[56:59], v[10:11], v[150:151], v[56:59]
  v_mov_b32_dpp v61, v48 quad_perm:[0,0,0,0] row_mask:0xf bank_mask:0xf
  v_mfma_f32_4x4x4_16b_bf16 v[52:55], v[12:13], v[140:141], v[52:55]
  v_add_f32_dpp v60, v45, v60 quad_perm:[1,1,1,1] row_mask:0xf bank_mask:0xf
  v_mfma_f32_4x4x4_16b_bf16 v[56:59], v[12:13], v[152:153], v[56:59]
  v_add_f32_dpp v61, v49, v61 quad_perm:[1,1,1,1] row_mask:0xf bank_mask:0xf
  v_mfma_f32_4x4x4_16b_bf16 v[52:55], v[14:15], v[142:143], v[52:55]
  v_add_f32_dpp v60, v46, v60 quad_perm:[2,2,2,2] row_mask:0xf bank_mask:0xf
  v_mfma_f32_4x4x4_16b_bf16 v[56:59], v[14:15], v[154:155], v[56:59]
  v_add_f32_dpp v61, v50, v61 quad_perm:[2,2,2,2] row_mask:0xf bank_mask:0xf
  v_mfma_f32_4x4x4_16b_bf16 v[52:55], v[16:17], v[144:145], v[52:55]
  v_add_f32_dpp v20, v47, v60 quad_perm:[3,3,3,3] row_mask:0xf bank_mask:0xf
  v_mfma_f32_4x4x4_16b_bf16 v[56:59], v[16:17], v[156:157], v[56:59]
  v_add_f32_dpp v61, v51, v61 quad_perm:[3,3,3,3] row_mask:0xf bank_mask:0xf
  v_mfma_f32_4x4x4_16b_bf16 v[52:55], v[18:19], v[146:147], v[52:55]
  v_mfma_f32_4x4x4_16b_bf16 v[56:59], v[18:19], v[158:159], v[56:59]
  v_mfma_f32_4x4x4_16b_bf16 v[44:47], v[8:9], v[160:161], 0
  v_cndmask_b32 v20, v20, v61, s[84:85]
  v_mfma_f32_4x4x4_16b_bf16 v[48:51], v[8:9], v[244:245], 0
  v_mfma_f32_4x4x4_16b_bf16 v[44:47], v[10:11], v[162:163], v[44:47]
  v_mov_b32_dpp v62, v52 quad_perm:[0,0,0,0] row_mask:0xf bank_mask:0xf
  v_mfma_f32_4x4x4_16b_bf16 v[48:51], v[10:11], v[246:247], v[48:51]
  v_mov_b32_dpp v63, v56 quad_perm:[0,0,0,0] row_mask:0xf bank_mask:0xf
  v_mfma_f32_4x4x4_16b_bf16 v[44:47], v[12:13], v[164:165], v[44:47]
  v_add_f32_dpp v62, v53, v62 quad_perm:[1,1,1,1] row_mask:0xf bank_mask:0xf
  v_mfma_f32_4x4x4_16b_bf16 v[48:51], v[12:13], v[248:249], v[48:51]
  v_add_f32_dpp v63, v57, v63 quad_perm:[1,1,1,1] row_mask:0xf bank_mask:0xf
  v_mfma_f32_4x4x4_16b_bf16 v[44:47], v[14:15], v[166:167], v[44:47]
  v_add_f32_dpp v62, v54, v62 quad_perm:[2,2,2,2] row_mask:0xf bank_mask:0xf
  v_mfma_f32_4x4x4_16b_bf16 v[48:51], v[14:15], v[250:251], v[48:51]
  v_add_f32_dpp v63, v58, v63 quad_perm:[2,2,2,2] row_mask:0xf bank_mask:0xf
  v_mfma_f32_4x4x4_16b_bf16 v[44:47], v[16:17], v[168:169], v[44:47]
  v_add_f32_dpp v62, v55, v62 quad_perm:[3,3,3,3] row_mask:0xf bank_mask:0xf
  v_mfma_f32_4x4x4_16b_bf16 v[48:51], v[16:17], v[252:253], v[48:51]
  v_add_f32_dpp v63, v59, v63 quad_perm:[3,3,3,3] row_mask:0xf bank_mask:0xf
  v_mfma_f32_4x4x4_16b_bf16 v[44:47], v[18:19], v[170:171], v[44:47]
  v_mfma_f32_4x4x4_16b_bf16 v[48:51], v[18:19], v[254:255], v[48:51]
  v_mfma_f32_4x4x4_16b_bf16 v[52:55], v[8:9], a[0:1], 0
  v_cndmask_b32 v20, v20, v62, s[86:87]
  v_mfma_f32_4x4x4_16b_bf16 v[56:59], v[8:9], a[12:13], 0
  v_cndmask_b32 v20, v20, v63, s[88:89]
  v_mfma_f32_4x4x4_16b_bf16 v[52:55], v[10:11], a[2:3], v[52:55]
  v_mov_b32_dpp v60, v44 quad_perm:[0,0,0,0] row_mask:0xf bank_mask:0xf
  v_mfma_f32_4x4x4_16b_bf16 v[56:59], v[10:11], a[14:15], v[56:59]
  v_mov_b32_dpp v61, v48 quad_perm:[0,0,0,0] row_mask:0xf bank_mask:0xf
  v_mfma_f32_4x4x4_16b_bf16 v[52:55], v[12:13], a[4:5], v[52:55]
  v_add_f32_dpp v20, v20, v20 row_half_mirror row_mask:0xf bank_mask:0xf
  v_mfma_f32_4x4x4_16b_bf16 v[56:59], v[12:13], a[16:17], v[56:59]
  v_add_f32_dpp v60, v45, v60 quad_perm:[1,1,1,1] row_mask:0xf bank_mask:0xf
  v_mfma_f32_4x4x4_16b_bf16 v[52:55], v[14:15], a[6:7], v[52:55]
  v_add_f32_dpp v61, v49, v61 quad_perm:[1,1,1,1] row_mask:0xf bank_mask:0xf
  v_mfma_f32_4x4x4_16b_bf16 v[56:59], v[14:15], a[18:19], v[56:59]
  v_add_f32_dpp v60, v46, v60 quad_perm:[2,2,2,2] row_mask:0xf bank_mask:0xf
  v_mfma_f32_4x4x4_16b_bf16 v[52:55], v[16:17], a[8:9], v[52:55]
  v_add_f32_dpp v61, v50, v61 quad_perm:[2,2,2,2] row_mask:0xf bank_mask:0xf
  v_mfma_f32_4x4x4_16b_bf16 v[56:59], v[16:17], a[20:21], v[56:59]
  v_add_f32_dpp v21, v47, v60 quad_perm:[3,3,3,3] row_mask:0xf bank_mask:0xf
  v_mfma_f32_4x4x4_16b_bf16 v[52:55], v[18:19], a[10:11], v[52:55]
  v_add_f32_dpp v61, v51, v61 quad_perm:[3,3,3,3] row_mask:0xf bank_mask:0xf
  v_mfma_f32_4x4x4_16b_bf16 v[56:59], v[18:19], a[22:23], v[56:59]
  s_cmp_lt_u32 s16, s17
  s_cbranch_scc0 L_tg_50224
  s_waitcnt vmcnt(9)
  s_swappc_b64 s[28:29], s[0:1]
L_tb_50225:
.balignl 8, 0xBF800000
  v_mfma_f32_4x4x4_16b_bf16 v[44:47], v[8:9], a[24:25], 0
  v_cndmask_b32 v21, v21, v61, s[84:85]
  v_mfma_f32_4x4x4_16b_bf16 v[48:51], v[8:9], a[36:37], 0
  v_mfma_f32_4x4x4_16b_bf16 v[44:47], v[10:11], a[26:27], v[44:47]
  v_mov_b32_dpp v62, v52 quad_perm:[0,0,0,0] row_mask:0xf bank_mask:0xf
  v_mfma_f32_4x4x4_16b_bf16 v[48:51], v[10:11], a[38:39], v[48:51]
  v_mov_b32_dpp v63, v56 quad_perm:[0,0,0,0] row_mask:0xf bank_mask:0xf
  v_mfma_f32_4x4x4_16b_bf16 v[44:47], v[12:13], a[28:29], v[44:47]
  v_add_f32_dpp v62, v53, v62 quad_perm:[1,1,1,1] row_mask:0xf bank_mask:0xf
  v_mfma_f32_4x4x4_16b_bf16 v[48:51], v[12:13], a[40:41], v[48:51]
  v_add_f32_dpp v63, v57, v63 quad_perm:[1,1,1,1] row_mask:0xf bank_mask:0xf
  v_mfma_f32_4x4x4_16b_bf16 v[44:47], v[14:15], a[30:31], v[44:47]
  v_add_f32_dpp v62, v54, v62 quad_perm:[2,2,2,2] row_mask:0xf bank_mask:0xf
  v_mfma_f32_4x4x4_16b_bf16 v[48:51], v[14:15], a[42:43], v[48:51]
  v_add_f32_dpp v63, v58, v63 quad_perm:[2,2,2,2] row_mask:0xf bank_mask:0xf
  v_mfma_f32_4x4x4_16b_bf16 v[44:47], v[16:17], a[32:33], v[44:47]
  v_add_f32_dpp v62, v55, v62 quad_perm:[3,3,3,3] row_mask:0xf bank_mask:0xf
  v_mfma_f32_4x4x4_16b_bf16 v[48:51], v[16:17], a[44:45], v[48:51]
  v_add_f32_dpp v63, v59, v63 quad_perm:[3,3,3,3] row_mask:0xf bank_mask:0xf
  v_mfma_f32_4x4x4_16b_bf16 v[44:47], v[18:19], a[34:35], v[44:47]
  v_mfma_f32_4x4x4_16b_bf16 v[48:51], v[18:19], a[46:47], v[48:51]
  v_mfma_f32_4x4x4_16b_bf16 v[52:55], v[8:9], a[48:49], 0
  v_cndmask_b32 v21, v21, v62, s[86:87]
  v_mfma_f32_4x4x4_16b_bf16 v[56:59], v[8:9], a[60:61], 0
  v_cndmask_b32 v21, v21, v63, s[88:89]
  v_mfma_f32_4x4x4_16b_bf16 v[52:55], v[10:11], a[50:51], v[52:55]
  v_mov_b32_dpp v60, v44 quad_perm:[0,0,0,0] row_mask:0xf bank_mask:0xf
  v_mfma_f32_4x4x4_16b_bf16 v[56:59], v[10:11], a[62:63], v[56:59]
  v_mov_b32_dpp v61, v48 quad_perm:[0,0,0,0] row_mask:0xf bank_mask:0xf
  v_mfma_f32_4x4x4_16b_bf16 v[52:55], v[12:13], a[52:53], v[52:55]
  v_add_f32_dpp v21, v21, v21 row_half_mirror row_mask:0xf bank_mask:0xf
  v_mfma_f32_4x4x4_16b_bf16 v[56:59], v[12:13], a[64:65], v[56:59]
  v_add_f32_dpp v60, v45, v60 quad_perm:[1,1,1,1] row_mask:0xf bank_mask:0xf
  v_mfma_f32_4x4x4_16b_bf16 v[52:55], v[14:15], a[54:55], v[52:55]
  v_add_f32_dpp v61, v49, v61 quad_perm:[1,1,1,1] row_mask:0xf bank_mask:0xf
  v_mfma_f32_4x4x4_16b_bf16 v[56:59], v[14:15], a[66:67], v[56:59]
  v_add_f32_dpp v60, v46, v60 quad_perm:[2,2,2,2] row_mask:0xf bank_mask:0xf
  v_mfma_f32_4x4x4_16b_bf16 v[52:55], v[16:17], a[56:57], v[52:55]
  v_add_f32_dpp v61, v50, v61 quad_perm:[2,2,2,2] row_mask:0xf bank_mask:0xf
  v_mfma_f32_4x4x4_16b_bf16 v[56:59], v[16:17], a[68:69], v[56:59]
  v_add_f32_dpp v22, v47, v60 quad_perm:[3,3,3,3] row_mask:0xf bank_mask:0xf
  v_mfma_f32_4x4x4_16b_bf16 v[52:55], v[18:19], a[58:59], v[52:55]
  v_add_f32_dpp v61, v51, v61 quad_perm:[3,3,3,3] row_mask:0xf bank_mask:0xf
  v_mfma_f32_4x4x4_16b_bf16 v[56:59], v[18:19], a[70:71], v[56:59]
  v_mfma_f32_4x4x4_16b_bf16 v[44:47], v[8:9], a[72:73], 0
  v_cndmask_b32 v22, v22, v61, s[84:85]
  v_mfma_f32_4x4x4_16b_bf16 v[48:51], v[8:9], a[84:85], 0
  v_mfma_f32_4x4x4_16b_bf16 v[44:47], v[10:11], a[74:75], v[44:47]
  v_mov_b32_dpp v62, v52 quad_perm:[0,0,0,0] row_mask:0xf bank_mask:0xf
  v_mfma_f32_4x4x4_16b_bf16 v[48:51], v[10:11], a[86:87], v[48:51]
  v_mov_b32_dpp v63, v56 quad_perm:[0,0,0,0] row_mask:0xf bank_mask:0xf
  v_mfma_f32_4x4x4_16b_bf16 v[44:47], v[12:13], a[76:77], v[44:47]
  v_add_f32_dpp v62, v53, v62 quad_perm:[1,1,1,1] row_mask:0xf bank_mask:0xf
  v_mfma_f32_4x4x4_16b_bf16 v[48:51], v[12:13], a[88:89], v[48:51]
  v_add_f32_dpp v63, v57, v63 quad_perm:[1,1,1,1] row_mask:0xf bank_mask:0xf
  v_mfma_f32_4x4x4_16b_bf16 v[44:47], v[14:15], a[78:79], v[44:47]
  v_add_f32_dpp v62, v54, v62 quad_perm:[2,2,2,2] row_mask:0xf bank_mask:0xf
  v_mfma_f32_4x4x4_16b_bf16 v[48:51], v[14:15], a[90:91], v[48:51]
  v_add_f32_dpp v63, v58, v63 quad_perm:[2,2,2,2] row_mask:0xf bank_mask:0xf
  v_mfma_f32_4x4x4_16b_bf16 v[44:47], v[16:17], a[80:81], v[44:47]
  v_add_f32_dpp v62, v55, v62 quad_perm:[3,3,3,3] row_mask:0xf bank_mask:0xf
  v_mfma_f32_4x4x4_16b_bf16 v[48:51], v[16:17], a[92:93], v[48:51]
  v_add_f32_dpp v63, v59, v63 quad_perm:[3,3,3,3] row_mask:0xf bank_mask:0xf
  v_mfma_f32_4x4x4_16b_bf16 v[44:47], v[18:19], a[82:83], v[44:47]
  v_mfma_f32_4x4x4_16b_bf16 v[48:51], v[18:19], a[94:95], v[48:51]
  v_mfma_f32_4x4x4_16b_bf16 v[52:55], v[8:9], a[96:97], 0
  v_cndmask_b32 v22, v22, v62, s[86:87]
  v_mfma_f32_4x4x4_16b_bf16 v[56:59], v[8:9], a[168:169], 0
  v_cndmask_b32 v22, v22, v63, s[88:89]
  v_mfma_f32_4x4x4_16b_bf16 v[52:55], v[10:11], a[98:99], v[52:55]
  v_mov_b32_dpp v60, v44 quad_perm:[0,0,0,0] row_mask:0xf bank_mask:0xf
  v_mfma_f32_4x4x4_16b_bf16 v[56:59], v[10:11], a[170:171], v[56:59]
  v_mov_b32_dpp v61, v48 quad_perm:[0,0,0,0] row_mask:0xf bank_mask:0xf
  v_mfma_f32_4x4x4_16b_bf16 v[52:55], v[12:13], a[100:101], v[52:55]
  v_add_f32_dpp v22, v22, v22 row_half_mirror row_mask:0xf bank_mask:0xf
  v_mfma_f32_4x4x4_16b_bf16 v[56:59], v[12:13], a[172:173], v[56:59]
  v_add_f32_dpp v60, v45, v60 quad_perm:[1,1,1,1] row_mask:0xf bank_mask:0xf
  v_mfma_f32_4x4x4_16b_bf16 v[52:55], v[14:15], a[102:103], v[52:55]
  v_add_f32_dpp v61, v49, v61 quad_perm:[1,1,1,1] row_mask:0xf bank_mask:0xf
  v_mfma_f32_4x4x4_16b_bf16 v[56:59], v[14:15], a[174:175], v[56:59]
  v_add_f32_dpp v60, v46, v60 quad_perm:[2,2,2,2] row_mask:0xf bank_mask:0xf
  v_mfma_f32_4x4x4_16b_bf16 v[52:55], v[16:17], a[104:105], v[52:55]
  v_add_f32_dpp v61, v50, v61 quad_perm:[2,2,2,2] row_mask:0xf bank_mask:0xf
  v_mfma_f32_4x4x4_16b_bf16 v[56:59], v[16:17], a[176:177], v[56:59]
  v_add_f32_dpp v23, v47, v60 quad_perm:[3,3,3,3] row_mask:0xf bank_mask:0xf
  v_mfma_f32_4x4x4_16b_bf16 v[52:55], v[18:19], a[106:107], v[52:55]
  v_add_f32_dpp v61, v51, v61 quad_perm:[3,3,3,3] row_mask:0xf bank_mask:0xf
  v_mfma_f32_4x4x4_16b_bf16 v[56:59], v[18:19], a[178:179], v[56:59]
  v_cndmask_b32 v23, v23, v61, s[84:85]
  s_nop 0
  s_nop 0
  v_mov_b32_dpp v62, v52 quad_perm:[0,0,0,0] row_mask:0xf bank_mask:0xf
  v_nop_e64
  v_mov_b32_dpp v63, v56 quad_perm:[0,0,0,0] row_mask:0xf bank_mask:0xf
  v_add_f32_dpp v62, v53, v62 quad_perm:[1,1,1,1] row_mask:0xf bank_mask:0xf
  v_nop_e64
  v_add_f32_dpp v63, v57, v63 quad_perm:[1,1,1,1] row_mask:0xf bank_mask:0xf
  v_add_f32_dpp v62, v54, v62 quad_perm:[2,2,2,2] row_mask:0xf bank_mask:0xf
  v_nop_e64
  v_add_f32_dpp v63, v58, v63 quad_perm:[2,2,2,2] row_mask:0xf bank_mask:0xf
  v_add_f32_dpp v62, v55, v62 quad_perm:[3,3,3,3] row_mask:0xf bank_mask:0xf
  v_nop_e64
  v_add_f32_dpp v63, v59, v63 quad_perm:[3,3,3,3] row_mask:0xf bank_mask:0xf
  v_cndmask_b32 v23, v23, v62, s[86:87]
  v_cndmask_b32 v23, v23, v63, s[88:89]
  s_nop 0
  s_nop 0
  v_add_f32_dpp v23, v23, v23 row_half_mirror row_mask:0xf bank_mask:0xf
  s_mov_b32 s19, 240
  s_min_u32 s17, s18, s19
  v_max3_f32 v66, v20, v21, v22
  v_max_f32 v66, v66, v23
  s_nop 1
  v_max_f32_dpp v66, v66, v66 quad_perm:[1,0,3,2] row_mask:0xf bank_mask:0xf
  s_nop 1
  v_max_f32_dpp v66, v66, v66 quad_perm:[2,3,0,1] row_mask:0xf bank_mask:0xf
  s_nop 1
  v_max_f32_dpp v66, v66, v66 row_ror:8 row_mask:0xf bank_mask:0xf
  s_nop 1
  v_max_f32_dpp v66, v66, v66 row_bcast:15 row_mask:0xa bank_mask:0xf
  s_nop 1
  v_max_f32_dpp v66, v66, v66 row_bcast:31 row_mask:0xc bank_mask:0xf
  s_nop 0
  v_readlane_b32 s93, v66, 63
  s_cmp_lt_u32 s16, s17
  s_cbranch_scc0 L_tg_50226
  s_waitcnt vmcnt(9)
  s_swappc_b64 s[28:29], s[0:1]
L_tb_50227:
  v_mov_b32 v67, s21
  v_subrev_f32 v20, s93, v20
  v_subrev_f32 v21, s93, v21
  v_subrev_f32 v22, s93, v22
  v_subrev_f32 v23, s93, v23
  v_mov_b32 v66, s93
  v_mul_f32 v20, 0x3dd53b95, v20
  v_mul_f32 v21, 0x3dd53b95, v21
  v_mul_f32 v22, 0x3dd53b95, v22
  v_mul_f32 v23, 0x3dd53b95, v23
  ds_write_b32 v67, v66 offset:48
  v_exp_f32 v20, v20
  v_exp_f32 v21, v21
  v_exp_f32 v22, v22
  v_exp_f32 v23, v23
  v_add_f32 v66, v20, v21
  v_add_f32 v68, v22, v23
  v_add_f32 v68, v68, v66
  v_cvt_pk_bf16_f32 v20, v20, v20
  v_cvt_pk_bf16_f32 v21, v21, v21
  v_cvt_pk_bf16_f32 v22, v22, v22
  v_cvt_pk_bf16_f32 v23, v23, v23
  v_add_f32_dpp v68, v68, v68 quad_perm:[1,0,3,2] row_mask:0xf bank_mask:0xf
  s_nop 1
  v_add_f32_dpp v68, v68, v68 quad_perm:[2,3,0,1] row_mask:0xf bank_mask:0xf
  s_nop 1
  v_add_f32_dpp v68, v68, v68 row_ror:8 row_mask:0xf bank_mask:0xf
  s_nop 1
  v_add_f32_dpp v68, v68, v68 row_bcast:15 row_mask:0xa bank_mask:0xf
  s_nop 1
  v_add_f32_dpp v68, v68, v68 row_bcast:31 row_mask:0xc bank_mask:0xf
  s_nop 0
  v_readlane_b32 s94, v68, 63
L_nw_50228:
  s_cmp_ge_u32 s16, 222
  s_cbranch_scc1 L_nx_50229
  s_cmp_lt_u32 s16, s17
  s_cbranch_scc0 L_nd_50230
  s_waitcnt vmcnt(9)
  s_swappc_b64 s[28:29], s[0:1]
  s_branch L_nw_50228
L_nx_50229:
  s_waitcnt vmcnt(6)
L_nq_50231:
.balignl 8, 0xBF800000
  v_and_b32_dpp v46, v20, v2 quad_perm:[0,0,0,0] row_mask:0xf bank_mask:0xf
  v_and_b32_dpp v47, v20, v3 quad_perm:[0,0,0,0] row_mask:0xf bank_mask:0xf
  v_and_b32_dpp v48, v20, v4 quad_perm:[3,3,3,3] row_mask:0xf bank_mask:0xf
  v_and_b32_dpp v49, v20, v5 quad_perm:[3,3,3,3] row_mask:0xf bank_mask:0xf
  s_nop 0
  s_nop 0
  v_mfma_f32_16x16x32_bf16 v[8:11], v[46:49], a[180:183], 0
  v_and_b32_dpp v50, v20, v2 quad_perm:[1,1,1,1] row_mask:0xf bank_mask:0xf
  v_and_b32_dpp v51, v20, v3 quad_perm:[1,1,1,1] row_mask:0xf bank_mask:0xf
  v_mfma_f32_16x16x32_bf16 v[12:15], v[46:49], a[184:187], 0
  v_and_b32_dpp v52, v20, v4 quad_perm:[2,2,2,2] row_mask:0xf bank_mask:0xf
  v_and_b32_dpp v53, v20, v5 quad_perm:[2,2,2,2] row_mask:0xf bank_mask:0xf
  v_mfma_f32_16x16x32_bf16 v[16:19], v[46:49], a[188:191], 0
  v_nop_e64
  v_mfma_f32_16x16x32_bf16 v[8:11], v[50:53], a[192:195], v[8:11]
  v_and_b32_dpp v46, v20, v2 quad_perm:[2,2,2,2] row_mask:0xf bank_mask:0xf
  v_and_b32_dpp v47, v20, v3 quad_perm:[2,2,2,2] row_mask:0xf bank_mask:0xf
  v_mfma_f32_16x16x32_bf16 v[12:15], v[50:53], a[196:199], v[12:15]
  v_and_b32_dpp v48, v20, v4 quad_perm:[1,1,1,1] row_mask:0xf bank_mask:0xf
  v_and_b32_dpp v49, v20, v5 quad_perm:[1,1,1,1] row_mask:0xf bank_mask:0xf
  v_mfma_f32_16x16x32_bf16 v[16:19], v[50:53], a[200:203], v[16:19]
  v_nop_e64
  v_mfma_f32_16x16x32_bf16 v[8:11], v[46:49], a[204:207], v[8:11]
  v_and_b32_dpp v50, v20, v2 quad_perm:[3,3,3,3] row_mask:0xf bank_mask:0xf
  v_and_b32_dpp v51, v20, v3 quad_perm:[3,3,3,3] row_mask:0xf bank_mask:0xf
  v_mfma_f32_16x16x32_bf16 v[12:15], v[46:49], a[208:211], v[12:15]
  v_and_b32_dpp v52, v20, v4 quad_perm:[0,0,0,0] row_mask:0xf bank_mask:0xf
  v_and_b32_dpp v53, v20, v5 quad_perm:[0,0,0,0] row_mask:0xf bank_mask:0xf
  v_mfma_f32_16x16x32_bf16 v[16:19], v[46:49], a[212:215], v[16:19]
  v_nop_e64
  v_mfma_f32_16x16x32_bf16 v[8:11], v[50:53], a[216:219], v[8:11]
  v_and_b32_dpp v46, v21, v2 quad_perm:[0,0,0,0] row_mask:0xf bank_mask:0xf
  v_and_b32_dpp v47, v21, v3 quad_perm:[0,0,0,0] row_mask:0xf bank_mask:0xf
  v_mfma_f32_16x16x32_bf16 v[12:15], v[50:53], a[220:223], v[12:15]
  v_and_b32_dpp v48, v21, v4 quad_perm:[3,3,3,3] row_mask:0xf bank_mask:0xf
  v_and_b32_dpp v49, v21, v5 quad_perm:[3,3,3,3] row_mask:0xf bank_mask:0xf
  v_mfma_f32_16x16x32_bf16 v[16:19], v[50:53], a[224:227], v[16:19]
  v_nop_e64
  v_mfma_f32_16x16x32_bf16 v[8:11], v[46:49], a[228:231], v[8:11]
  v_and_b32_dpp v50, v21, v2 quad_perm:[1,1,1,1] row_mask:0xf bank_mask:0xf
  v_and_b32_dpp v51, v21, v3 quad_perm:[1,1,1,1] row_mask:0xf bank_mask:0xf
  v_mfma_f32_16x16x32_bf16 v[12:15], v[46:49], a[232:235], v[12:15]
  v_and_b32_dpp v52, v21, v4 quad_perm:[2,2,2,2] row_mask:0xf bank_mask:0xf
  v_and_b32_dpp v53, v21, v5 quad_perm:[2,2,2,2] row_mask:0xf bank_mask:0xf
  v_mfma_f32_16x16x32_bf16 v[16:19], v[46:49], a[236:239], v[16:19]
  v_nop_e64
  v_mfma_f32_16x16x32_bf16 v[8:11], v[50:53], a[240:243], v[8:11]
  v_and_b32_dpp v46, v21, v2 quad_perm:[2,2,2,2] row_mask:0xf bank_mask:0xf
  v_and_b32_dpp v47, v21, v3 quad_perm:[2,2,2,2] row_mask:0xf bank_mask:0xf
  v_mfma_f32_16x16x32_bf16 v[12:15], v[50:53], a[244:247], v[12:15]
  v_and_b32_dpp v48, v21, v4 quad_perm:[1,1,1,1] row_mask:0xf bank_mask:0xf
  v_and_b32_dpp v49, v21, v5 quad_perm:[1,1,1,1] row_mask:0xf bank_mask:0xf
  v_mfma_f32_16x16x32_bf16 v[16:19], v[50:53], a[248:251], v[16:19]
  v_nop_e64
  v_mfma_f32_16x16x32_bf16 v[8:11], v[46:49], v[172:175], v[8:11]
  v_and_b32_dpp v50, v21, v2 quad_perm:[3,3,3,3] row_mask:0xf bank_mask:0xf
  v_and_b32_dpp v51, v21, v3 quad_perm:[3,3,3,3] row_mask:0xf bank_mask:0xf
  v_mfma_f32_16x16x32_bf16 v[12:15], v[46:49], v[176:179], v[12:15]
  v_and_b32_dpp v52, v21, v4 quad_perm:[0,0,0,0] row_mask:0xf bank_mask:0xf
  v_and_b32_dpp v53, v21, v5 quad_perm:[0,0,0,0] row_mask:0xf bank_mask:0xf
  v_mfma_f32_16x16x32_bf16 v[16:19], v[46:49], v[180:183], v[16:19]
  v_nop_e64
  v_mfma_f32_16x16x32_bf16 v[8:11], v[50:53], v[184:187], v[8:11]
  v_mfma_f32_16x16x32_bf16 v[12:15], v[50:53], v[188:191], v[12:15]
  v_mfma_f32_16x16x32_bf16 v[16:19], v[50:53], v[192:195], v[16:19]
  s_mov_b32 s20, 234
  s_cmp_eq_u32 s20, -1
  s_cbranch_scc1 L_ux_50233
L_uw_50232:
  s_cmp_lt_u32 s16, s17
  s_cbranch_scc0 L_ud_50235
  s_waitcnt vmcnt(12)
  s_swappc_b64 s[28:29], s[0:1]
  s_cmp_ge_u32 s16, s20
  s_cbranch_scc0 L_uw_50232
L_uc_50234:
  s_swappc_b64 s[28:29], s[14:15]
  s_cmp_ge_u32 s16, s20
  s_cbranch_scc0 L_ut_50236
  s_swappc_b64 s[28:29], s[14:15]
  s_cmp_ge_u32 s16, s20
  s_cbranch_scc0 L_ut_50236
  s_swappc_b64 s[28:29], s[14:15]
L_ut_50236:
  s_cmp_eq_u32 s20, -1
  s_cbranch_scc0 L_uw_50232
L_ux_50233:
  v_lshrrev_b32 v60, 4, v0
  v_and_b32 v59, 15, v0
  v_lshlrev_b32 v58, 10, v60
  v_lshl_add_u32 v58, v59, 4, v58
  s_lshl_b32 s91, s3, 8
  s_add_u32 s91, s91, 155648
  v_add_u32 v58, s91, v58
  v_add_u32 v59, 155648, v6
  v_mov_b32 v49, s94
  v_permlane32_swap_b32 v8, v9
  v_permlane32_swap_b32 v10, v11
  v_permlane32_swap_b32 v12, v13
  v_permlane32_swap_b32 v14, v15
  v_permlane32_swap_b32 v16, v17
  v_permlane32_swap_b32 v18, v19
  v_add_f32_dpp v46, v9, v8 row_ror:8 row_mask:0xf bank_mask:0x3
  v_add_f32_dpp v47, v13, v12 row_ror:8 row_mask:0xf bank_mask:0x3
  v_add_f32_dpp v48, v17, v16 row_ror:8 row_mask:0xf bank_mask:0x3
  v_add_f32_dpp v46, v10, v11 row_ror:8 row_mask:0xf bank_mask:0xc
  v_add_f32_dpp v47, v14, v15 row_ror:8 row_mask:0xf bank_mask:0xc
  v_add_f32_dpp v48, v18, v19 row_ror:8 row_mask:0xf bank_mask:0xc
  ds_write_b128 v59, v[46:49]
  v_lshlrev_b32 v60, 2, v60
  v_add_u32 v60, 161424, v60
  v_mov_b32 v62, 161424
  s_waitcnt lgkmcnt(0)
  s_barrier
  ds_read_b128 v[54:57], v62
  ds_read_b32 v62, v60
  ds_read_b128 v[50:53], v58
  s_add_u32 s73, s72, 1
  s_mul_i32 s91, s31, 240
  s_sub_u32 s91, 2048, s91
  v_lshlrev_b32 v59, 4, v0
  v_writelane_b32 v59, s91, 16
  v_mov_b32 v49, s73
  s_add_u32 s76, s78, 524288
  s_waitcnt lgkmcnt(1)
  v_max3_f32 v54, v54, v55, v56
  v_max_f32 v54, v54, v57
  v_sub_f32 v62, v62, v54
  v_mul_f32 v62, 0x3dd53b95, v62
  v_exp_f32 v62, v62
  s_waitcnt lgkmcnt(0)
  v_pk_mul_f32 v[50:51], v[50:51], v[62:63] op_sel_hi:[1,0]
  v_pk_mul_f32 v[52:53], v[52:53], v[62:63] op_sel_hi:[1,0]
  s_nop 0
  v_permlane32_swap_b32 v50, v51
  v_permlane32_swap_b32 v52, v53
  v_add_f32 v50, v50, v51
  v_add_f32 v52, v52, v53
  s_nop 1
  v_permlane16_swap_b32 v50, v52
  v_add_f32 v46, v50, v52
  v_add_f32 v47, v50, v52
  s_nop 1
  v_permlane32_swap_b32 v46, v47
  v_mov_b32 v48, v46
  s_nop 1
  v_permlane16_swap_b32 v46, v48
  s_nop 1
  v_mov_b32_dpp v46, v54 quad_perm:[0,1,2,3] row_mask:0x2 bank_mask:0xf
  s_mov_b64 exec, 0x1ffff
  buffer_store_dwordx4 v[46:49], v59, s[64:67], s76 offen sc1
  s_mov_b64 exec, -1
  s_add_u32 s73, s72, 1
  v_lshrrev_b32 v45, 4, v0
  v_and_b32 v44, 1, v0
  v_lshl_add_u32 v45, v44, 2, v45
  s_add_u32 s91, s27, 2048
  v_lshl_add_u32 v45, v45, 4, s91
  s_add_u32 s97, s79, 524288
  buffer_load_dwordx4 v[34:37], v45, s[64:67], s97 offen sc1
  buffer_load_dwordx4 v[26:29], v6, s[64:67], s97 offen offset:0 sc1
  buffer_load_dwordx4 v[30:33], v6, s[64:67], s97 offen offset:1024 sc1
  v_lshrrev_b32 v46, 2, v0
  v_and_b32 v47, 3, v0
  v_mul_u32_u24 v46, 160, v46
  v_lshl_add_u32 v47, v47, 3, v46
  s_lshl_b32 s91, s3, 5
  s_add_u32 s91, s91, 124928
  v_add_u32 v46, s91, v47
  v_add_u32 v47, 125056, v47
  v_bfe_u32 v49, v0, 4, 1
  v_lshlrev_b32 v49, 8, v49
  v_lshrrev_b32 v48, 5, v0
  v_lshl_add_u32 v49, v48, 7, v49
  v_and_b32 v48, 7, v0
  v_lshl_add_u32 v49, v48, 4, v49
  v_bfe_u32 v48, v0, 3, 1
  v_lshl_add_u32 v49, v48, 2, v49
  s_and_b32 s91, s3, 1
  s_lshl_b32 s91, s91, 3
  s_and_b32 s92, s3, 2
  s_add_u32 s91, s91, s92
  s_add_u32 s91, s91, 159744
  v_add_u32 v49, s91, v49
  v_and_b32 v74, 0x30, v0
  s_lshl_b32 s91, s3, 4
  s_add_u32 s91, s91, 1
  v_writelane_b32 v74, 64, s91
  s_movk_i32 s91, 80
  v_writelane_b32 v74, s91, 2
  s_movk_i32 s91, 96
  v_writelane_b32 v74, s91, 3
  s_movk_i32 s91, 112
  v_writelane_b32 v74, s91, 4
  s_bfe_u32 s68, s73, 0x80000
  s_bfe_u32 s69, s73, 0x80008
  s_bfe_u32 s70, s73, 0x80010
  s_bfe_u32 s90, s73, 0x80018
  ds_read_b64_tr_b16 v[50:51], v46 offset:0
  ds_read_b64_tr_b16 v[52:53], v46 offset:2560
  ds_read_b64_tr_b16 v[54:55], v47 offset:0
  ds_read_b64_tr_b16 v[56:57], v47 offset:2560
  ds_read_b64_tr_b16 v[58:59], v46 offset:5120
  ds_read_b64_tr_b16 v[60:61], v46 offset:7680
  ds_read_b64_tr_b16 v[62:63], v47 offset:5120
  ds_read_b64_tr_b16 v[64:65], v47 offset:7680
  ds_read_b64_tr_b16 v[66:67], v46 offset:10240
  ds_read_b64_tr_b16 v[68:69], v46 offset:12800
  ds_read_b64_tr_b16 v[70:71], v47 offset:10240
  ds_read_b64_tr_b16 v[72:73], v47 offset:12800
  s_waitcnt vmcnt(0)
L_chk_50237:
  v_bitop3_b32 v75, v37, v29, s73 bitop3:0x7e
  v_bitop3_b32 v75, v75, v33, s73 bitop3:0xf6
  v_cmp_ne_u32 vcc, 0, v75
  s_nop 0
  s_cbranch_vccz L_retry_50238
  buffer_load_dwordx4 v[34:37], v45, s[64:67], s97 offen sc1
  buffer_load_dwordx4 v[26:29], v6, s[64:67], s97 offen offset:0 sc1
  buffer_load_dwordx4 v[30:33], v6, s[64:67], s97 offen offset:1024 sc1
  s_sub_u32 s75, s75, 1
  s_cbranch_scc1 L_end
  s_waitcnt vmcnt(0)
  s_branch L_chk_50237
L_retry_50238:
  v_max_f32_dpp v43, v34, v34 quad_perm:[1,0,3,2] row_mask:0xf bank_mask:0xf
  v_mov_b32 v42, v43
  s_nop 1
  v_permlane32_swap_b32 v43, v42
  v_max_f32 v43, v43, v42
  v_mov_b32 v42, v43
  s_nop 1
  v_permlane16_swap_b32 v43, v42
  v_max_f32 v43, v43, v42
  v_sub_f32 v43, v34, v43
  v_mul_f32 v43, 0x3dd53b95, v43
  v_exp_f32 v43, v43
  s_nop 0
  v_mul_f32 v35, v35, v43
  v_mul_f32_dpp v26, v43, v26 quad_perm:[0,0,2,2] row_mask:0xf bank_mask:0xf
  v_mul_f32_dpp v27, v43, v27 quad_perm:[0,0,2,2] row_mask:0xf bank_mask:0xf
  v_mul_f32_dpp v28, v43, v28 quad_perm:[0,0,2,2] row_mask:0xf bank_mask:0xf
  v_add_f32_dpp v29, v35, v35 quad_perm:[1,0,3,2] row_mask:0xf bank_mask:0xf
  v_fmac_f32_dpp v26, v43, v30 quad_perm:[1,1,3,3] row_mask:0xf bank_mask:0xf
  v_fmac_f32_dpp v27, v43, v31 quad_perm:[1,1,3,3] row_mask:0xf bank_mask:0xf
  v_fmac_f32_dpp v28, v43, v32 quad_perm:[1,1,3,3] row_mask:0xf bank_mask:0xf
  s_nop 0
  v_permlane32_swap_b32 v26, v27
  v_permlane32_swap_b32 v28, v29
  v_add_f32 v26, v26, v27
  v_add_f32 v28, v28, v29
  s_nop 1
  v_permlane16_swap_b32 v26, v28
  v_add_f32 v48, v26, v28
  v_lshrrev_b32 v45, 4, v0
  v_readlane_b32 s92, v48, 48
  v_lshlrev_b32 v45, 3, v45
  v_add_u32 v44, 159744, v45
  v_rcp_f32 v43, s92
  s_mov_b32 exec_hi, 0xffff
  v_mul_f32 v48, v48, v43
  v_cvt_pk_bf16_f32 v48, v48, v48
  ds_write_b16 v49, v48
  s_mov_b64 exec, -1
  s_waitcnt lgkmcnt(0)
  s_barrier
  ds_read2_b64 v[26:29], v44 offset0:0 offset1:4
  ds_read2_b64 v[30:33], v44 offset0:8 offset1:12
  ds_read2_b64 v[34:37], v44 offset0:16 offset1:20
  v_mov_b32 v48, v44
  s_add_u32 s76, s82, 393216
  s_lshl_b32 s91, s3, 4
  s_lshl_b64 vcc, 2, s91
  s_or_b32 s91, vcc_lo, 0x1001d
  s_or_b32 s92, vcc_hi, 0x10001
  v_mov_b32 v49, 0xffffff00
  s_waitcnt lgkmcnt(2)
  v_mfma_f32_16x16x32_bf16 v[38:41], v[50:53], v[26:29], 0
  v_mfma_f32_16x16x32_bf16 v[42:45], v[54:57], v[26:29], 0
  ds_read2_b64 v[26:29], v48 offset0:24 offset1:28
  ds_read_b64_tr_b16 v[50:51], v46 offset:15360
  ds_read_b64_tr_b16 v[52:53], v46 offset:17920
  ds_read_b64_tr_b16 v[54:55], v47 offset:15360
  ds_read_b64_tr_b16 v[56:57], v47 offset:17920
  s_waitcnt lgkmcnt(6)
  v_mfma_f32_16x16x32_bf16 v[38:41], v[58:61], v[30:33], v[38:41]
  v_mfma_f32_16x16x32_bf16 v[42:45], v[62:65], v[30:33], v[42:45]
  ds_read2_b64 v[30:33], v48 offset0:32 offset1:36
  ds_read_b64_tr_b16 v[58:59], v46 offset:20480
  ds_read_b64_tr_b16 v[60:61], v46 offset:23040
  ds_read_b64_tr_b16 v[62:63], v47 offset:20480
  ds_read_b64_tr_b16 v[64:65], v47 offset:23040
  s_waitcnt lgkmcnt(10)
  v_mfma_f32_16x16x32_bf16 v[38:41], v[66:69], v[34:37], v[38:41]
  v_mfma_f32_16x16x32_bf16 v[42:45], v[70:73], v[34:37], v[42:45]
  ds_read2_b64 v[34:37], v48 offset0:40 offset1:44
  ds_read_b64_tr_b16 v[66:67], v46 offset:25600
  ds_read_b64_tr_b16 v[68:69], v46 offset:28160
  ds_read_b64_tr_b16 v[70:71], v47 offset:25600
  ds_read_b64_tr_b16 v[72:73], v47 offset:28160
  s_waitcnt lgkmcnt(10)
  v_mfma_f32_16x16x32_bf16 v[38:41], v[50:53], v[26:29], v[38:41]
  v_mfma_f32_16x16x32_bf16 v[42:45], v[54:57], v[26:29], v[42:45]
  s_waitcnt lgkmcnt(5)
  v_mfma_f32_16x16x32_bf16 v[38:41], v[58:61], v[30:33], v[38:41]
  v_mfma_f32_16x16x32_bf16 v[42:45], v[62:65], v[30:33], v[42:45]
  s_waitcnt lgkmcnt(0)
  v_mfma_f32_16x16x32_bf16 v[38:41], v[66:69], v[34:37], v[38:41]
  v_mfma_f32_16x16x32_bf16 v[42:45], v[70:73], v[34:37], v[42:45]
  s_nop 7
  v_cndmask_b32 v26, v38, v42, vcc
  v_cndmask_b32 v27, v39, v43, vcc
  v_cndmask_b32 v28, v40, v44, vcc
  v_cndmask_b32 v29, v41, v45, vcc
  s_mov_b32 exec_lo, s91
  s_mov_b32 exec_hi, s92
  v_and_or_b32 v26, v26, v49, s68
  v_and_or_b32 v27, v27, v49, s69
  v_and_or_b32 v28, v28, v49, s70
  v_and_or_b32 v29, v29, v49, s90
  buffer_store_dwordx4 v[26:29], v74, s[64:67], s76 offen sc1
  s_mov_b64 exec, -1
  s_waitcnt vmcnt(0)
  v_bfe_u32 v72, v0, 2, 3
  v_lshrrev_b32 v71, 5, v0
  v_mul_u32_u24 v71, 3072, v71
  v_lshl_add_u32 v71, v72, 7, v71
  v_and_b32 v73, 3, v0
  v_lshl_add_u32 v71, v73, 3, v71
  v_lshrrev_b32 v72, 1, v72
  s_mul_i32 s91, s3, 3
  s_add_u32 s91, s91, 0
  s_and_b32 s92, s91, 3
  s_lshr_b32 s91, s91, 2
  v_xor_b32 v73, s92, v72
  s_lshl_b32 s91, s91, 10
  s_add_u32 s91, s91, 32768
  v_lshl_add_u32 v73, v73, 5, v71
  v_add_u32 v42, s91, v73
  ds_read_b64_tr_b16 v[44:45], v42 offset:0
  ds_read_b64_tr_b16 v[46:47], v42 offset:6144
  ds_read_b64_tr_b16 v[48:49], v42 offset:12288
  ds_read_b64_tr_b16 v[50:51], v42 offset:18432
  ds_read_b64_tr_b16 v[52:53], v42 offset:24576
  s_mul_i32 s91, s3, 3
  s_add_u32 s91, s91, 1
  s_and_b32 s92, s91, 3
  s_lshr_b32 s91, s91, 2
  v_xor_b32 v73, s92, v72
  s_lshl_b32 s91, s91, 10
  s_add_u32 s91, s91, 32768
  v_lshl_add_u32 v73, v73, 5, v71
  v_add_u32 v43, s91, v73
  ds_read_b64_tr_b16 v[54:55], v43 offset:0
  ds_read_b64_tr_b16 v[56:57], v43 offset:6144
  ds_read_b64_tr_b16 v[58:59], v43 offset:12288
  ds_read_b64_tr_b16 v[60:61], v43 offset:18432
  ds_read_b64_tr_b16 v[62:63], v43 offset:24576
  s_mul_i32 s91, s3, 3
  s_add_u32 s91, s91, 2
  s_and_b32 s92, s91, 3
  s_lshr_b32 s91, s91, 2
  v_xor_b32 v73, s92, v72
  s_lshl_b32 s91, s91, 10
  s_add_u32 s91, s91, 32768
  v_lshl_add_u32 v73, v73, 5, v71
  v_add_u32 v42, s91, v73
  ds_read_b64_tr_b16 v[64:65], v42 offset:0
  ds_read_b64_tr_b16 v[66:67], v42 offset:6144
  ds_read_b64_tr_b16 v[68:69], v42 offset:12288
  ds_read_b64_tr_b16 v[70:71], v42 offset:18432
  ds_read_b64_tr_b16 v[72:73], v42 offset:24576
  s_add_u32 s73, s72, 1
  v_lshrrev_b32 v74, 3, v0
  v_and_b32 v75, 7, v0
  v_mul_u32_u24 v74, 128, v74
  v_lshl_add_u32 v74, v75, 4, v74
  s_add_u32 s97, s83, 393216
  s_mov_b32 exec_lo, 0x1f1f1f1f
  s_mov_b32 exec_hi, 0x1f1f1f1f
  buffer_load_dwordx4 v[26:29], v74, s[64:67], s97 offen offset:0 sc1
  buffer_load_dwordx4 v[30:33], v74, s[64:67], s97 offen offset:1024 sc1
  buffer_load_dwordx4 v[34:37], v74, s[64:67], s97 offen offset:2048 sc1
  buffer_load_dwordx4 v[38:41], v74, s[64:67], s97 offen offset:3072 sc1
  s_mov_b64 exec, -1
  s_bfe_u32 s68, s73, 0x80000
  s_bfe_u32 s69, s73, 0x80008
  s_bfe_u32 s70, s73, 0x80010
  s_bfe_u32 s90, s73, 0x80018
  s_waitcnt vmcnt(0)
  s_mov_b32 exec_lo, 0x1f1f1f1f
  s_mov_b32 exec_hi, 0x1f1f1f1f
L_chk_50239:
  v_xor_b32 v26, s68, v26
  v_xor_b32 v30, s68, v30
  v_xor_b32 v34, s68, v34
  v_xor_b32 v38, s68, v38
  v_xor_b32 v27, s69, v27
  v_xor_b32 v31, s69, v31
  v_xor_b32 v35, s69, v35
  v_xor_b32 v39, s69, v39
  v_xor_b32 v28, s70, v28
  v_xor_b32 v32, s70, v32
  v_xor_b32 v36, s70, v36
  v_xor_b32 v40, s70, v40
  v_xor_b32 v29, s90, v29
  v_xor_b32 v33, s90, v33
  v_xor_b32 v37, s90, v37
  v_xor_b32 v41, s90, v41
  v_or3_b32 v75, v26, v30, v34
  v_or3_b32 v75, v75, v38, v27
  v_or3_b32 v75, v75, v31, v35
  v_or3_b32 v75, v75, v39, v28
  v_or3_b32 v75, v75, v32, v36
  v_or3_b32 v75, v75, v40, v29
  v_or3_b32 v75, v75, v33, v37
  v_or3_b32 v75, v75, v41, v41
  v_and_b32 v75, 0xff, v75
  v_cmp_ne_u32 vcc, 0, v75
  s_nop 0
  s_cbranch_vccz L_retry_50240
  buffer_load_dwordx4 v[26:29], v74, s[64:67], s97 offen offset:0 sc1
  buffer_load_dwordx4 v[30:33], v74, s[64:67], s97 offen offset:1024 sc1
  buffer_load_dwordx4 v[34:37], v74, s[64:67], s97 offen offset:2048 sc1
  buffer_load_dwordx4 v[38:41], v74, s[64:67], s97 offen offset:3072 sc1
  s_sub_u32 s75, s75, 1
  s_cbranch_scc1 L_end
  s_waitcnt vmcnt(0)
  s_branch L_chk_50239
L_retry_50240:
  v_pk_add_f32 v[26:27], v[26:27], v[30:31]
  v_pk_add_f32 v[28:29], v[28:29], v[32:33]
  v_pk_add_f32 v[34:35], v[34:35], v[38:39]
  v_pk_add_f32 v[36:37], v[36:37], v[40:41]
  v_pk_add_f32 v[26:27], v[26:27], v[34:35]
  v_pk_add_f32 v[28:29], v[28:29], v[36:37]
  v_add_u32 v33, 160288, v24
  v_add_f32_dpp v30, v26, v26 row_ror:8 row_mask:0xf bank_mask:0x3
  v_add_f32_dpp v31, v28, v28 row_ror:8 row_mask:0xf bank_mask:0x3
  s_nop 0
  v_add_f32_dpp v30, v27, v27 row_ror:8 row_mask:0xf bank_mask:0xc
  v_add_f32_dpp v31, v29, v29 row_ror:8 row_mask:0xf bank_mask:0xc
  s_nop 1
  v_permlane32_swap_b32 v30, v31
  v_add_f32 v30, v30, v31
  v_mov_b32 v31, v30
  s_nop 1
  v_permlane16_swap_b32 v30, v31
  v_add_f32 v30, v30, v31
  v_cvt_pk_bf16_f32 v30, v30, v30
  v_and_b32 v30, 0xffff0000, v30
  v_add_f32 v30, v30, v25
  v_cvt_pk_bf16_f32 v31, v30, v30
  ds_write_b16 v33, v31
  v_and_b32 v25, 0xffff0000, v31
  s_mov_b64 exec, -1
  v_mov_b32 v75, 160288
  v_mov_b32 v32, 161216
  s_mov_b32 vcc_lo, 0x00f000f0
  s_mov_b32 vcc_hi, 0x00f000f0
  v_cndmask_b32 v75, v75, v32, vcc
  v_lshrrev_b32 v32, 4, v0
  v_lshl_add_u32 v75, v32, 3, v75
  s_waitcnt lgkmcnt(0)
  s_barrier
  ds_read2_b64 v[34:37], v75 offset0:0 offset1:4
  ds_read2_b64 v[38:41], v75 offset0:8 offset1:12
  ds_read_b64 v[42:43], v75 offset:128
  s_add_u32 s73, s72, 2
  s_add_u32 s76, s80, 3145728
  s_mul_i32 s91, s31, 240
  s_sub_u32 s91, 2048, s91
  v_lshlrev_b32 v74, 4, v0
  v_writelane_b32 v74, s91, 32
  s_waitcnt lgkmcnt(0)
  v_mfma_f32_16x16x32_bf16 v[26:29], v[34:37], v[44:47], 0
  v_mfma_f32_16x16x32_bf16 v[30:33], v[34:37], v[54:57], 0
  v_mfma_f32_16x16x32_bf16 v[26:29], v[38:41], v[48:51], v[26:29]
  v_mfma_f32_16x16x32_bf16 v[30:33], v[38:41], v[58:61], v[30:33]
  v_mfma_f32_16x16x16_bf16 v[26:29], v[42:43], v[52:53], v[26:29]
  v_mfma_f32_16x16x16_bf16 v[30:33], v[42:43], v[62:63], v[30:33]
  v_mfma_f32_16x16x32_bf16 v[48:51], v[34:37], v[34:37], 0
  v_mfma_f32_16x16x32_bf16 v[44:47], v[34:37], v[64:67], 0
  v_mfma_f32_16x16x32_bf16 v[48:51], v[38:41], v[38:41], v[48:51]
  v_mfma_f32_16x16x32_bf16 v[44:47], v[38:41], v[68:71], v[44:47]
  v_mfma_f32_16x16x16_bf16 v[48:51], v[42:43], v[42:43], v[48:51]
  v_mfma_f32_16x16x16_bf16 v[44:47], v[42:43], v[72:73], v[44:47]
  s_nop 0
  v_mov_b32 v29, s73
  v_mov_b32 v27, v30
  s_nop 4
  v_mov_b32 v28, v44
  v_mov_b32_dpp v26, v48 quad_perm:[0,1,2,3] row_mask:0x4 bank_mask:0xf
  v_mov_b32_dpp v27, v48 row_ror:12 row_mask:0x4 bank_mask:0xf
  s_mov_b32 exec_lo, 0xffff
  s_mov_b32 exec_hi, 1
  buffer_store_dwordx4 v[26:29], v74, s[64:67], s76 offen sc1
  s_mov_b64 exec, -1
  s_add_u32 s73, s72, 2
  v_and_b32 v38, 7, v0
  s_add_u32 s91, s27, 2048
  v_lshl_add_u32 v38, v38, 4, s91
  s_add_u32 s97, s81, 3145728
  buffer_load_dwordx4 v[34:37], v38, s[64:67], s97 offen sc1
  buffer_load_dwordx4 v[26:29], v6, s[64:67], s97 offen offset:0 sc1
  buffer_load_dwordx4 v[30:33], v6, s[64:67], s97 offen offset:1024 sc1
  v_and_b32 v58, 15, v0
  v_bfe_u32 v60, v0, 4, 1
  v_lshl_add_u32 v58, v60, 5, v58
  v_lshrrev_b32 v60, 5, v0
  v_lshl_add_u32 v58, v60, 4, v58
  s_mul_i32 s91, s3, 96
  s_add_u32 s91, s91, 160832
  v_lshl_add_u32 v58, v58, 1, s91
  v_lshrrev_b32 v61, 2, v6
  v_add_u32 v61, 161504, v61
  ds_read_b32 v60, v61
  s_waitcnt vmcnt(0)
L_chk_50241:
  v_bitop3_b32 v75, v37, v29, s73 bitop3:0x7e
  v_bitop3_b32 v75, v75, v33, s73 bitop3:0xf6
  v_cmp_ne_u32 vcc, 0, v75
  s_nop 0
  s_cbranch_vccz L_retry_50242
  buffer_load_dwordx4 v[34:37], v38, s[64:67], s97 offen sc1
  buffer_load_dwordx4 v[26:29], v6, s[64:67], s97 offen offset:0 sc1
  buffer_load_dwordx4 v[30:33], v6, s[64:67], s97 offen offset:1024 sc1
  s_sub_u32 s75, s75, 1
  s_cbranch_scc1 L_end
  s_waitcnt vmcnt(0)
  s_branch L_chk_50241
L_retry_50242:
  v_pk_add_f32 v[26:27], v[26:27], v[30:31]
  v_add_f32 v28, v28, v32
  v_mov_b32 v29, v28
  v_add_f32_dpp v34, v34, v34 quad_perm:[1,0,3,2] row_mask:0xf bank_mask:0xf
  v_add_f32_dpp v35, v35, v35 quad_perm:[1,0,3,2] row_mask:0xf bank_mask:0xf
  v_permlane32_swap_b32 v26, v27
  v_permlane32_swap_b32 v28, v29
  v_add_f32_dpp v34, v34, v34 quad_perm:[2,3,0,1] row_mask:0xf bank_mask:0xf
  v_add_f32_dpp v35, v35, v35 quad_perm:[2,3,0,1] row_mask:0xf bank_mask:0xf
  v_add_f32 v26, v26, v27
  v_add_f32 v28, v28, v29
  v_add_f32_dpp v34, v34, v34 row_half_mirror row_mask:0xf bank_mask:0xf
  v_add_f32_dpp v35, v35, v35 row_half_mirror row_mask:0xf bank_mask:0xf
  v_permlane16_swap_b32 v26, v28
  v_mul_f32 v35, 0x3acccccd, v35
  v_mul_f32 v34, 0x3acccccd, v34
  v_add_f32 v62, v26, v28
  v_fma_f32 v34, -v35, v35, v34
  v_max_f32 v34, 0, v34
  v_add_f32 v34, 0x3727c5ac, v34
  v_rsq_f32 v34, v34
  s_waitcnt lgkmcnt(0)
  v_fma_f32 v62, -v35, v60, v62
  s_mov_b32 exec_hi, 0xffff
  v_mul_f32 v62, v62, v34
  v_cvt_pk_bf16_f32 v62, v62, v62
  ds_write_b16 v58, v62
  s_mov_b64 exec, -1
  s_waitcnt lgkmcnt(0)
  s_barrier
  v_and_b32 v66, 7, v0
  v_lshlrev_b32 v66, 4, v66
  v_add_u32 v66, 160832, v66
  ds_read_b128 v[26:29], v66 offset:0
  ds_read_b128 v[30:33], v66 offset:128
  ds_read_b128 v[34:37], v66 offset:256
  s_waitcnt lgkmcnt(0)
.balignl 8, 0xBF800000
  v_mfma_f32_4x4x4_16b_bf16 v[44:47], v[26:27], a[120:121], 0
  v_mfma_f32_4x4x4_16b_bf16 v[48:51], v[26:27], a[132:133], 0
  v_nop_e64
  v_mfma_f32_4x4x4_16b_bf16 v[44:47], v[28:29], a[122:123], v[44:47]
  v_mfma_f32_4x4x4_16b_bf16 v[48:51], v[28:29], a[134:135], v[48:51]
  v_nop_e64
  v_mfma_f32_4x4x4_16b_bf16 v[44:47], v[30:31], a[124:125], v[44:47]
  v_mfma_f32_4x4x4_16b_bf16 v[48:51], v[30:31], a[136:137], v[48:51]
  v_nop_e64
  v_mfma_f32_4x4x4_16b_bf16 v[44:47], v[32:33], a[126:127], v[44:47]
  v_mfma_f32_4x4x4_16b_bf16 v[48:51], v[32:33], a[138:139], v[48:51]
  v_nop_e64
  v_mfma_f32_4x4x4_16b_bf16 v[44:47], v[34:35], a[128:129], v[44:47]
  v_mfma_f32_4x4x4_16b_bf16 v[48:51], v[34:35], a[140:141], v[48:51]
  v_nop_e64
  v_mfma_f32_4x4x4_16b_bf16 v[44:47], v[36:37], a[130:131], v[44:47]
  v_mfma_f32_4x4x4_16b_bf16 v[48:51], v[36:37], a[142:143], v[48:51]
  v_mfma_f32_4x4x4_16b_bf16 v[52:55], v[26:27], a[144:145], 0
  v_mfma_f32_4x4x4_16b_bf16 v[56:59], v[26:27], a[156:157], 0
  v_nop_e64
  v_mfma_f32_4x4x4_16b_bf16 v[52:55], v[28:29], a[146:147], v[52:55]
  v_mov_b32_dpp v60, v44 quad_perm:[0,0,0,0] row_mask:0xf bank_mask:0xf
  v_mfma_f32_4x4x4_16b_bf16 v[56:59], v[28:29], a[158:159], v[56:59]
  v_mov_b32_dpp v61, v48 quad_perm:[0,0,0,0] row_mask:0xf bank_mask:0xf
  v_mfma_f32_4x4x4_16b_bf16 v[52:55], v[30:31], a[148:149], v[52:55]
  v_add_f32_dpp v60, v45, v60 quad_perm:[1,1,1,1] row_mask:0xf bank_mask:0xf
  v_mfma_f32_4x4x4_16b_bf16 v[56:59], v[30:31], a[160:161], v[56:59]
  v_add_f32_dpp v61, v49, v61 quad_perm:[1,1,1,1] row_mask:0xf bank_mask:0xf
  v_mfma_f32_4x4x4_16b_bf16 v[52:55], v[32:33], a[150:151], v[52:55]
  v_add_f32_dpp v60, v46, v60 quad_perm:[2,2,2,2] row_mask:0xf bank_mask:0xf
  v_mfma_f32_4x4x4_16b_bf16 v[56:59], v[32:33], a[162:163], v[56:59]
  v_add_f32_dpp v61, v50, v61 quad_perm:[2,2,2,2] row_mask:0xf bank_mask:0xf
  v_mfma_f32_4x4x4_16b_bf16 v[52:55], v[34:35], a[152:153], v[52:55]
  v_add_f32_dpp v38, v47, v60 quad_perm:[3,3,3,3] row_mask:0xf bank_mask:0xf
  v_mfma_f32_4x4x4_16b_bf16 v[56:59], v[34:35], a[164:165], v[56:59]
  v_add_f32_dpp v61, v51, v61 quad_perm:[3,3,3,3] row_mask:0xf bank_mask:0xf
  v_mfma_f32_4x4x4_16b_bf16 v[52:55], v[36:37], a[154:155], v[52:55]
  v_mfma_f32_4x4x4_16b_bf16 v[56:59], v[36:37], a[166:167], v[56:59]
  v_cndmask_b32 v38, v38, v61, s[84:85]
  s_nop 0
  s_nop 1
  v_mov_b32_dpp v62, v52 quad_perm:[0,0,0,0] row_mask:0xf bank_mask:0xf
  v_mov_b32_dpp v63, v56 quad_perm:[0,0,0,0] row_mask:0xf bank_mask:0xf
  v_nop_e64
  v_add_f32_dpp v62, v53, v62 quad_perm:[1,1,1,1] row_mask:0xf bank_mask:0xf
  v_add_f32_dpp v63, v57, v63 quad_perm:[1,1,1,1] row_mask:0xf bank_mask:0xf
  v_nop_e64
  v_add_f32_dpp v62, v54, v62 quad_perm:[2,2,2,2] row_mask:0xf bank_mask:0xf
  v_add_f32_dpp v63, v58, v63 quad_perm:[2,2,2,2] row_mask:0xf bank_mask:0xf
  v_nop_e64
  v_add_f32_dpp v62, v55, v62 quad_perm:[3,3,3,3] row_mask:0xf bank_mask:0xf
  v_add_f32_dpp v63, v59, v63 quad_perm:[3,3,3,3] row_mask:0xf bank_mask:0xf
  v_cndmask_b32 v38, v38, v62, s[86:87]
  v_cndmask_b32 v38, v38, v63, s[88:89]
  s_nop 0
  s_nop 0
  v_add_f32_dpp v38, v38, v38 row_half_mirror row_mask:0xf bank_mask:0xf
  s_mov_b32 s22, 50331648
  buffer_load_dwordx4 a[156:159], v1, s[40:43], s22 offen offset:0 nt
  buffer_load_dwordx4 a[160:163], v1, s[40:43], s22 offen offset:128 nt
  buffer_load_dwordx4 a[164:167], v1, s[40:43], s22 offen offset:256 nt
  v_max_f32_dpp v66, v38, v38 quad_perm:[1,0,3,2] row_mask:0xf bank_mask:0xf
  s_nop 1
  v_max_f32_dpp v66, v66, v66 quad_perm:[2,3,0,1] row_mask:0xf bank_mask:0xf
  s_nop 1
  v_max_f32_dpp v66, v66, v66 row_ror:8 row_mask:0xf bank_mask:0xf
  s_nop 1
  v_max_f32_dpp v66, v66, v66 row_bcast:15 row_mask:0xa bank_mask:0xf
  s_nop 1
  v_max_f32_dpp v66, v66, v66 row_bcast:31 row_mask:0xc bank_mask:0xf
  s_nop 0
  v_readlane_b32 s95, v66, 63
  v_mov_b32 v67, s21
  s_nop 0
  v_subrev_f32 v38, s95, v38
  v_mov_b32 v66, s95
  v_mul_f32 v38, 0x3dd53b95, v38
  ds_write_b32 v67, v66 offset:80
  v_exp_f32 v38, v38
  s_nop 1
  v_add_f32_dpp v68, v38, v38 quad_perm:[1,0,3,2] row_mask:0xf bank_mask:0xf
  v_cvt_pk_bf16_f32 v38, v38, v38
.balignl 8, 0xBF800000
  s_nop 0
  s_nop 0
  v_and_b32_dpp v46, v38, v2 quad_perm:[0,0,0,0] row_mask:0xf bank_mask:0xf
  v_and_b32_dpp v47, v38, v3 quad_perm:[0,0,0,0] row_mask:0xf bank_mask:0xf
  v_and_b32_dpp v48, v38, v4 quad_perm:[3,3,3,3] row_mask:0xf bank_mask:0xf
  v_and_b32_dpp v49, v38, v5 quad_perm:[3,3,3,3] row_mask:0xf bank_mask:0xf
  s_nop 0
  s_nop 0
  v_mfma_f32_16x16x32_bf16 v[26:29], v[46:49], a[108:111], 0
  v_and_b32_dpp v50, v38, v2 quad_perm:[1,1,1,1] row_mask:0xf bank_mask:0xf
  v_and_b32_dpp v51, v38, v3 quad_perm:[1,1,1,1] row_mask:0xf bank_mask:0xf
  v_mfma_f32_16x16x32_bf16 v[30:33], v[46:49], a[112:115], 0
  v_and_b32_dpp v52, v38, v4 quad_perm:[2,2,2,2] row_mask:0xf bank_mask:0xf
  v_and_b32_dpp v53, v38, v5 quad_perm:[2,2,2,2] row_mask:0xf bank_mask:0xf
  v_mfma_f32_16x16x32_bf16 v[34:37], v[46:49], a[116:119], 0
  v_add_f32_dpp v68, v68, v68 quad_perm:[2,3,0,1] row_mask:0xf bank_mask:0xf
  v_mfma_f32_16x16x32_bf16 v[26:29], v[50:53], v[76:79], v[26:29]
  v_and_b32_dpp v46, v38, v2 quad_perm:[2,2,2,2] row_mask:0xf bank_mask:0xf
  v_and_b32_dpp v47, v38, v3 quad_perm:[2,2,2,2] row_mask:0xf bank_mask:0xf
  v_mfma_f32_16x16x32_bf16 v[30:33], v[50:53], v[80:83], v[30:33]
  v_and_b32_dpp v48, v38, v4 quad_perm:[1,1,1,1] row_mask:0xf bank_mask:0xf
  v_and_b32_dpp v49, v38, v5 quad_perm:[1,1,1,1] row_mask:0xf bank_mask:0xf
  v_mfma_f32_16x16x32_bf16 v[34:37], v[50:53], v[84:87], v[34:37]
  v_add_f32_dpp v68, v68, v68 row_ror:8 row_mask:0xf bank_mask:0xf
  v_mfma_f32_16x16x32_bf16 v[26:29], v[46:49], v[88:91], v[26:29]
  v_and_b32_dpp v50, v38, v2 quad_perm:[3,3,3,3] row_mask:0xf bank_mask:0xf
  v_and_b32_dpp v51, v38, v3 quad_perm:[3,3,3,3] row_mask:0xf bank_mask:0xf
  v_mfma_f32_16x16x32_bf16 v[30:33], v[46:49], v[92:95], v[30:33]
  v_and_b32_dpp v52, v38, v4 quad_perm:[0,0,0,0] row_mask:0xf bank_mask:0xf
  v_and_b32_dpp v53, v38, v5 quad_perm:[0,0,0,0] row_mask:0xf bank_mask:0xf
  v_mfma_f32_16x16x32_bf16 v[34:37], v[46:49], v[96:99], v[34:37]
  v_add_f32_dpp v68, v68, v68 row_bcast:15 row_mask:0xa bank_mask:0xf
  v_mfma_f32_16x16x32_bf16 v[26:29], v[50:53], v[100:103], v[26:29]
  v_mfma_f32_16x16x32_bf16 v[30:33], v[50:53], v[104:107], v[30:33]
  v_mfma_f32_16x16x32_bf16 v[34:37], v[50:53], v[108:111], v[34:37]
  v_add_f32_dpp v68, v68, v68 row_bcast:31 row_mask:0xc bank_mask:0xf
  s_nop 0
  v_readlane_b32 s96, v68, 63
  v_lshrrev_b32 v60, 4, v0
  v_and_b32 v59, 15, v0
  v_lshlrev_b32 v58, 10, v60
  v_lshl_add_u32 v58, v59, 4, v58
  s_lshl_b32 s91, s3, 8
  s_add_u32 s91, s91, 155648
  v_add_u32 v58, s91, v58
  v_add_u32 v59, 155648, v6
  v_mov_b32 v49, s96
  v_permlane32_swap_b32 v26, v27
  v_permlane32_swap_b32 v28, v29
  v_permlane32_swap_b32 v30, v31
  v_permlane32_swap_b32 v32, v33
  v_permlane32_swap_b32 v34, v35
  v_permlane32_swap_b32 v36, v37
  v_add_f32_dpp v46, v27, v26 row_ror:8 row_mask:0xf bank_mask:0x3
  v_add_f32_dpp v47, v31, v30 row_ror:8 row_mask:0xf bank_mask:0x3
  v_add_f32_dpp v48, v35, v34 row_ror:8 row_mask:0xf bank_mask:0x3
  v_add_f32_dpp v46, v28, v29 row_ror:8 row_mask:0xf bank_mask:0xc
  v_add_f32_dpp v47, v32, v33 row_ror:8 row_mask:0xf bank_mask:0xc
  v_add_f32_dpp v48, v36, v37 row_ror:8 row_mask:0xf bank_mask:0xc
  ds_write_b128 v59, v[46:49]
  v_lshlrev_b32 v60, 2, v60
  v_add_u32 v60, 161456, v60
  v_mov_b32 v62, 161456
  s_waitcnt lgkmcnt(0)
  s_barrier
  ds_read_b128 v[54:57], v62
  ds_read_b32 v62, v60
  ds_read_b128 v[50:53], v58
  s_add_u32 s73, s72, 2
  s_mul_i32 s91, s31, 240
  s_sub_u32 s91, 2048, s91
  v_lshlrev_b32 v59, 4, v0
  v_writelane_b32 v59, s91, 16
  v_mov_b32 v49, s73
  s_add_u32 s76, s78, 524288
  s_waitcnt lgkmcnt(1)
  v_max3_f32 v54, v54, v55, v56
  v_max_f32 v54, v54, v57
  v_sub_f32 v62, v62, v54
  v_mul_f32 v62, 0x3dd53b95, v62
  v_exp_f32 v62, v62
  s_waitcnt lgkmcnt(0)
  v_pk_mul_f32 v[50:51], v[50:51], v[62:63] op_sel_hi:[1,0]
  v_pk_mul_f32 v[52:53], v[52:53], v[62:63] op_sel_hi:[1,0]
  s_nop 0
  v_permlane32_swap_b32 v50, v51
  v_permlane32_swap_b32 v52, v53
  v_add_f32 v50, v50, v51
  v_add_f32 v52, v52, v53
  s_nop 1
  v_permlane16_swap_b32 v50, v52
  v_add_f32 v46, v50, v52
  v_add_f32 v47, v50, v52
  s_nop 1
  v_permlane32_swap_b32 v46, v47
  v_mov_b32 v48, v46
  s_nop 1
  v_permlane16_swap_b32 v46, v48
  s_nop 1
  v_mov_b32_dpp v46, v54 quad_perm:[0,1,2,3] row_mask:0x2 bank_mask:0xf
  s_mov_b64 exec, 0x1ffff
  buffer_store_dwordx4 v[46:49], v59, s[64:67], s76 offen sc1
  s_mov_b64 exec, -1
  s_add_u32 s73, s72, 2
  v_lshrrev_b32 v45, 4, v0
  v_and_b32 v44, 1, v0
  v_lshl_add_u32 v45, v44, 2, v45
  s_add_u32 s91, s27, 2048
  v_lshl_add_u32 v45, v45, 4, s91
  s_add_u32 s97, s79, 524288
  buffer_load_dwordx4 v[34:37], v45, s[64:67], s97 offen sc1
  buffer_load_dwordx4 v[26:29], v6, s[64:67], s97 offen offset:0 sc1
  buffer_load_dwordx4 v[30:33], v6, s[64:67], s97 offen offset:1024 sc1
  v_lshrrev_b32 v46, 2, v0
  v_and_b32 v47, 3, v0
  v_mul_u32_u24 v46, 160, v46
  v_lshl_add_u32 v47, v47, 3, v46
  s_lshl_b32 s91, s3, 5
  s_add_u32 s91, s91, 94208
  v_add_u32 v46, s91, v47
  v_add_u32 v47, 94336, v47
  v_bfe_u32 v49, v0, 4, 1
  v_lshlrev_b32 v49, 8, v49
  v_lshrrev_b32 v48, 5, v0
  v_lshl_add_u32 v49, v48, 7, v49
  v_and_b32 v48, 7, v0
  v_lshl_add_u32 v49, v48, 4, v49
  v_bfe_u32 v48, v0, 3, 1
  v_lshl_add_u32 v49, v48, 2, v49
  s_and_b32 s91, s3, 1
  s_lshl_b32 s91, s91, 3
  s_and_b32 s92, s3, 2
  s_add_u32 s91, s91, s92
  s_add_u32 s91, s91, 159744
  v_add_u32 v49, s91, v49
  v_and_b32 v74, 0x30, v0
  s_lshl_b32 s91, s3, 4
  s_add_u32 s91, s91, 1
  v_writelane_b32 v74, 64, s91
  s_movk_i32 s91, 80
  v_writelane_b32 v74, s91, 2
  s_movk_i32 s91, 96
  v_writelane_b32 v74, s91, 3
  s_movk_i32 s91, 112
  v_writelane_b32 v74, s91, 4
  s_bfe_u32 s68, s73, 0x80000
  s_bfe_u32 s69, s73, 0x80008
  s_bfe_u32 s70, s73, 0x80010
  s_bfe_u32 s90, s73, 0x80018
  ds_read_b64_tr_b16 v[50:51], v46 offset:0
  ds_read_b64_tr_b16 v[52:53], v46 offset:2560
  ds_read_b64_tr_b16 v[54:55], v47 offset:0
  ds_read_b64_tr_b16 v[56:57], v47 offset:2560
  ds_read_b64_tr_b16 v[58:59], v46 offset:5120
  ds_read_b64_tr_b16 v[60:61], v46 offset:7680
  ds_read_b64_tr_b16 v[62:63], v47 offset:5120
  ds_read_b64_tr_b16 v[64:65], v47 offset:7680
  ds_read_b64_tr_b16 v[66:67], v46 offset:10240
  ds_read_b64_tr_b16 v[68:69], v46 offset:12800
  ds_read_b64_tr_b16 v[70:71], v47 offset:10240
  ds_read_b64_tr_b16 v[72:73], v47 offset:12800
  s_waitcnt vmcnt(0)
L_chk_50243:
  v_bitop3_b32 v75, v37, v29, s73 bitop3:0x7e
  v_bitop3_b32 v75, v75, v33, s73 bitop3:0xf6
  v_cmp_ne_u32 vcc, 0, v75
  s_nop 0
  s_cbranch_vccz L_retry_50244
  buffer_load_dwordx4 v[34:37], v45, s[64:67], s97 offen sc1
  buffer_load_dwordx4 v[26:29], v6, s[64:67], s97 offen offset:0 sc1
  buffer_load_dwordx4 v[30:33], v6, s[64:67], s97 offen offset:1024 sc1
  s_sub_u32 s75, s75, 1
  s_cbranch_scc1 L_end
  s_waitcnt vmcnt(0)
  s_branch L_chk_50243
L_retry_50244:
  v_max_f32_dpp v43, v34, v34 quad_perm:[1,0,3,2] row_mask:0xf bank_mask:0xf
  v_mov_b32 v42, v43
  s_nop 1
  v_permlane32_swap_b32 v43, v42
  v_max_f32 v43, v43, v42
  v_mov_b32 v42, v43
  s_nop 1
  v_permlane16_swap_b32 v43, v42
  v_max_f32 v43, v43, v42
  v_sub_f32 v43, v34, v43
  v_mul_f32 v43, 0x3dd53b95, v43
  v_exp_f32 v43, v43
  s_nop 0
  v_mul_f32 v35, v35, v43
  v_mul_f32_dpp v26, v43, v26 quad_perm:[0,0,2,2] row_mask:0xf bank_mask:0xf
  v_mul_f32_dpp v27, v43, v27 quad_perm:[0,0,2,2] row_mask:0xf bank_mask:0xf
  v_mul_f32_dpp v28, v43, v28 quad_perm:[0,0,2,2] row_mask:0xf bank_mask:0xf
  v_add_f32_dpp v29, v35, v35 quad_perm:[1,0,3,2] row_mask:0xf bank_mask:0xf
  v_fmac_f32_dpp v26, v43, v30 quad_perm:[1,1,3,3] row_mask:0xf bank_mask:0xf
  v_fmac_f32_dpp v27, v43, v31 quad_perm:[1,1,3,3] row_mask:0xf bank_mask:0xf
  v_fmac_f32_dpp v28, v43, v32 quad_perm:[1,1,3,3] row_mask:0xf bank_mask:0xf
  s_nop 0
  v_permlane32_swap_b32 v26, v27
  v_permlane32_swap_b32 v28, v29
  v_add_f32 v26, v26, v27
  v_add_f32 v28, v28, v29
  s_nop 1
  v_permlane16_swap_b32 v26, v28
  v_add_f32 v48, v26, v28
  v_lshrrev_b32 v45, 4, v0
  v_readlane_b32 s92, v48, 48
  v_lshlrev_b32 v45, 3, v45
  v_add_u32 v44, 159744, v45
  v_rcp_f32 v43, s92
  s_mov_b32 exec_hi, 0xffff
  v_mul_f32 v48, v48, v43
  v_cvt_pk_bf16_f32 v48, v48, v48
  ds_write_b16 v49, v48
  s_mov_b64 exec, -1
  s_waitcnt lgkmcnt(0)
  s_barrier
  ds_read2_b64 v[26:29], v44 offset0:0 offset1:4
  ds_read2_b64 v[30:33], v44 offset0:8 offset1:12
  ds_read2_b64 v[34:37], v44 offset0:16 offset1:20
  v_mov_b32 v48, v44
  s_add_u32 s76, s82, 655360
  s_lshl_b32 s91, s3, 4
  s_lshl_b64 vcc, 2, s91
  s_or_b32 s91, vcc_lo, 0x1001d
  s_or_b32 s92, vcc_hi, 0x10001
  v_mov_b32 v49, 0xffffff00
  s_waitcnt lgkmcnt(2)
  v_mfma_f32_16x16x32_bf16 v[38:41], v[50:53], v[26:29], 0
  v_mfma_f32_16x16x32_bf16 v[42:45], v[54:57], v[26:29], 0
  ds_read2_b64 v[26:29], v48 offset0:24 offset1:28
  ds_read_b64_tr_b16 v[50:51], v46 offset:15360
  ds_read_b64_tr_b16 v[52:53], v46 offset:17920
  ds_read_b64_tr_b16 v[54:55], v47 offset:15360
  ds_read_b64_tr_b16 v[56:57], v47 offset:17920
  s_waitcnt lgkmcnt(6)
  v_mfma_f32_16x16x32_bf16 v[38:41], v[58:61], v[30:33], v[38:41]
  v_mfma_f32_16x16x32_bf16 v[42:45], v[62:65], v[30:33], v[42:45]
  ds_read2_b64 v[30:33], v48 offset0:32 offset1:36
  ds_read_b64_tr_b16 v[58:59], v46 offset:20480
  ds_read_b64_tr_b16 v[60:61], v46 offset:23040
  ds_read_b64_tr_b16 v[62:63], v47 offset:20480
  ds_read_b64_tr_b16 v[64:65], v47 offset:23040
  s_waitcnt lgkmcnt(10)
  v_mfma_f32_16x16x32_bf16 v[38:41], v[66:69], v[34:37], v[38:41]
  v_mfma_f32_16x16x32_bf16 v[42:45], v[70:73], v[34:37], v[42:45]
  ds_read2_b64 v[34:37], v48 offset0:40 offset1:44
  ds_read_b64_tr_b16 v[66:67], v46 offset:25600
  ds_read_b64_tr_b16 v[68:69], v46 offset:28160
  ds_read_b64_tr_b16 v[70:71], v47 offset:25600
  ds_read_b64_tr_b16 v[72:73], v47 offset:28160
  s_waitcnt lgkmcnt(10)
  v_mfma_f32_16x16x32_bf16 v[38:41], v[50:53], v[26:29], v[38:41]
  v_mfma_f32_16x16x32_bf16 v[42:45], v[54:57], v[26:29], v[42:45]
  s_waitcnt lgkmcnt(5)
  v_mfma_f32_16x16x32_bf16 v[38:41], v[58:61], v[30:33], v[38:41]
  v_mfma_f32_16x16x32_bf16 v[42:45], v[62:65], v[30:33], v[42:45]
  s_waitcnt lgkmcnt(0)
  v_mfma_f32_16x16x32_bf16 v[38:41], v[66:69], v[34:37], v[38:41]
  v_mfma_f32_16x16x32_bf16 v[42:45], v[70:73], v[34:37], v[42:45]
  s_nop 7
  v_cndmask_b32 v26, v38, v42, vcc
  v_cndmask_b32 v27, v39, v43, vcc
  v_cndmask_b32 v28, v40, v44, vcc
  v_cndmask_b32 v29, v41, v45, vcc
  s_mov_b32 exec_lo, s91
  s_mov_b32 exec_hi, s92
  v_and_or_b32 v26, v26, v49, s68
  v_and_or_b32 v27, v27, v49, s69
  v_and_or_b32 v28, v28, v49, s70
  v_and_or_b32 v29, v29, v49, s90
  buffer_store_dwordx4 v[26:29], v74, s[64:67], s76 offen sc1
  s_mov_b64 exec, -1
  s_waitcnt vmcnt(0)
  v_bfe_u32 v72, v0, 2, 3
  v_lshrrev_b32 v71, 5, v0
  v_mul_u32_u24 v71, 3072, v71
  v_lshl_add_u32 v71, v72, 7, v71
  v_and_b32 v73, 3, v0
  v_lshl_add_u32 v71, v73, 3, v71
  v_lshrrev_b32 v72, 1, v72
  s_mul_i32 s91, s3, 3
  s_add_u32 s91, s91, 0
  s_and_b32 s92, s91, 3
  s_lshr_b32 s91, s91, 2
  v_xor_b32 v73, s92, v72
  s_lshl_b32 s91, s91, 10
  s_add_u32 s91, s91, 63488
  v_lshl_add_u32 v73, v73, 5, v71
  v_add_u32 v42, s91, v73
  ds_read_b64_tr_b16 v[44:45], v42 offset:0
  ds_read_b64_tr_b16 v[46:47], v42 offset:6144
  ds_read_b64_tr_b16 v[48:49], v42 offset:12288
  ds_read_b64_tr_b16 v[50:51], v42 offset:18432
  ds_read_b64_tr_b16 v[52:53], v42 offset:24576
  s_mul_i32 s91, s3, 3
  s_add_u32 s91, s91, 1
  s_and_b32 s92, s91, 3
  s_lshr_b32 s91, s91, 2
  v_xor_b32 v73, s92, v72
  s_lshl_b32 s91, s91, 10
  s_add_u32 s91, s91, 63488
  v_lshl_add_u32 v73, v73, 5, v71
  v_add_u32 v43, s91, v73
  ds_read_b64_tr_b16 v[54:55], v43 offset:0
  ds_read_b64_tr_b16 v[56:57], v43 offset:6144
  ds_read_b64_tr_b16 v[58:59], v43 offset:12288
  ds_read_b64_tr_b16 v[60:61], v43 offset:18432
  ds_read_b64_tr_b16 v[62:63], v43 offset:24576
  s_mul_i32 s91, s3, 3
  s_add_u32 s91, s91, 2
  s_and_b32 s92, s91, 3
  s_lshr_b32 s91, s91, 2
  v_xor_b32 v73, s92, v72
  s_lshl_b32 s91, s91, 10
  s_add_u32 s91, s91, 63488
  v_lshl_add_u32 v73, v73, 5, v71
  v_add_u32 v42, s91, v73
  ds_read_b64_tr_b16 v[64:65], v42 offset:0
  ds_read_b64_tr_b16 v[66:67], v42 offset:6144
  ds_read_b64_tr_b16 v[68:69], v42 offset:12288
  ds_read_b64_tr_b16 v[70:71], v42 offset:18432
  ds_read_b64_tr_b16 v[72:73], v42 offset:24576
  s_add_u32 s73, s72, 2
  v_lshrrev_b32 v74, 3, v0
  v_and_b32 v75, 7, v0
  v_mul_u32_u24 v74, 128, v74
  v_lshl_add_u32 v74, v75, 4, v74
  s_add_u32 s97, s83, 655360
  s_mov_b32 exec_lo, 0x1f1f1f1f
  s_mov_b32 exec_hi, 0x1f1f1f1f
  buffer_load_dwordx4 v[26:29], v74, s[64:67], s97 offen offset:0 sc1
  buffer_load_dwordx4 v[30:33], v74, s[64:67], s97 offen offset:1024 sc1
  buffer_load_dwordx4 v[34:37], v74, s[64:67], s97 offen offset:2048 sc1
  buffer_load_dwordx4 v[38:41], v74, s[64:67], s97 offen offset:3072 sc1
  s_mov_b64 exec, -1
  s_bfe_u32 s68, s73, 0x80000
  s_bfe_u32 s69, s73, 0x80008
  s_bfe_u32 s70, s73, 0x80010
  s_bfe_u32 s90, s73, 0x80018
  s_waitcnt vmcnt(0)
  s_mov_b32 exec_lo, 0x1f1f1f1f
  s_mov_b32 exec_hi, 0x1f1f1f1f
L_chk_50245:
  v_xor_b32 v26, s68, v26
  v_xor_b32 v30, s68, v30
  v_xor_b32 v34, s68, v34
  v_xor_b32 v38, s68, v38
  v_xor_b32 v27, s69, v27
  v_xor_b32 v31, s69, v31
  v_xor_b32 v35, s69, v35
  v_xor_b32 v39, s69, v39
  v_xor_b32 v28, s70, v28
  v_xor_b32 v32, s70, v32
  v_xor_b32 v36, s70, v36
  v_xor_b32 v40, s70, v40
  v_xor_b32 v29, s90, v29
  v_xor_b32 v33, s90, v33
  v_xor_b32 v37, s90, v37
  v_xor_b32 v41, s90, v41
  v_or3_b32 v75, v26, v30, v34
  v_or3_b32 v75, v75, v38, v27
  v_or3_b32 v75, v75, v31, v35
  v_or3_b32 v75, v75, v39, v28
  v_or3_b32 v75, v75, v32, v36
  v_or3_b32 v75, v75, v40, v29
  v_or3_b32 v75, v75, v33, v37
  v_or3_b32 v75, v75, v41, v41
  v_and_b32 v75, 0xff, v75
  v_cmp_ne_u32 vcc, 0, v75
  s_nop 0
  s_cbranch_vccz L_retry_50246
  buffer_load_dwordx4 v[26:29], v74, s[64:67], s97 offen offset:0 sc1
  buffer_load_dwordx4 v[30:33], v74, s[64:67], s97 offen offset:1024 sc1
  buffer_load_dwordx4 v[34:37], v74, s[64:67], s97 offen offset:2048 sc1
  buffer_load_dwordx4 v[38:41], v74, s[64:67], s97 offen offset:3072 sc1
  s_sub_u32 s75, s75, 1
  s_cbranch_scc1 L_end
  s_waitcnt vmcnt(0)
  s_branch L_chk_50245
L_retry_50246:
  v_pk_add_f32 v[26:27], v[26:27], v[30:31]
  v_pk_add_f32 v[28:29], v[28:29], v[32:33]
  v_pk_add_f32 v[34:35], v[34:35], v[38:39]
  v_pk_add_f32 v[36:37], v[36:37], v[40:41]
  v_pk_add_f32 v[26:27], v[26:27], v[34:35]
  v_pk_add_f32 v[28:29], v[28:29], v[36:37]
  v_add_u32 v33, 160288, v24
  v_add_f32_dpp v30, v26, v26 row_ror:8 row_mask:0xf bank_mask:0x3
  v_add_f32_dpp v31, v28, v28 row_ror:8 row_mask:0xf bank_mask:0x3
  s_nop 0
  v_add_f32_dpp v30, v27, v27 row_ror:8 row_mask:0xf bank_mask:0xc
  v_add_f32_dpp v31, v29, v29 row_ror:8 row_mask:0xf bank_mask:0xc
  s_nop 1
  v_permlane32_swap_b32 v30, v31
  v_add_f32 v30, v30, v31
  v_mov_b32 v31, v30
  s_nop 1
  v_permlane16_swap_b32 v30, v31
  v_add_f32 v30, v30, v31
  v_cvt_pk_bf16_f32 v30, v30, v30
  v_and_b32 v30, 0xffff0000, v30
  v_add_f32 v30, v30, v25
  v_cvt_pk_bf16_f32 v31, v30, v30
  ds_write_b16 v33, v31
  v_and_b32 v25, 0xffff0000, v31
  s_mov_b64 exec, -1
  v_mov_b32 v75, 160288
  v_mov_b32 v32, 161216
  s_mov_b32 vcc_lo, 0x00f000f0
  s_mov_b32 vcc_hi, 0x00f000f0
  v_cndmask_b32 v75, v75, v32, vcc
  v_lshrrev_b32 v32, 4, v0
  v_lshl_add_u32 v75, v32, 3, v75
  s_waitcnt lgkmcnt(0)
  s_barrier
  ds_read2_b64 v[34:37], v75 offset0:0 offset1:4
  ds_read2_b64 v[38:41], v75 offset0:8 offset1:12
  ds_read_b64 v[42:43], v75 offset:128
  s_add_u32 s73, s72, 3
  s_add_u32 s76, s80, 3145728
  s_mul_i32 s91, s31, 240
  s_sub_u32 s91, 2048, s91
  v_lshlrev_b32 v74, 4, v0
  v_writelane_b32 v74, s91, 32
  s_waitcnt lgkmcnt(0)
  v_mfma_f32_16x16x32_bf16 v[26:29], v[34:37], v[44:47], 0
  v_mfma_f32_16x16x32_bf16 v[30:33], v[34:37], v[54:57], 0
  v_mfma_f32_16x16x32_bf16 v[26:29], v[38:41], v[48:51], v[26:29]
  v_mfma_f32_16x16x32_bf16 v[30:33], v[38:41], v[58:61], v[30:33]
  v_mfma_f32_16x16x16_bf16 v[26:29], v[42:43], v[52:53], v[26:29]
  v_mfma_f32_16x16x16_bf16 v[30:33], v[42:43], v[62:63], v[30:33]
  v_mfma_f32_16x16x32_bf16 v[48:51], v[34:37], v[34:37], 0
  v_mfma_f32_16x16x32_bf16 v[44:47], v[34:37], v[64:67], 0
  v_mfma_f32_16x16x32_bf16 v[48:51], v[38:41], v[38:41], v[48:51]
  v_mfma_f32_16x16x32_bf16 v[44:47], v[38:41], v[68:71], v[44:47]
  v_mfma_f32_16x16x16_bf16 v[48:51], v[42:43], v[42:43], v[48:51]
  v_mfma_f32_16x16x16_bf16 v[44:47], v[42:43], v[72:73], v[44:47]
  s_nop 0
  v_mov_b32 v29, s73
  v_mov_b32 v27, v30
  s_nop 4
  v_mov_b32 v28, v44
  v_mov_b32_dpp v26, v48 quad_perm:[0,1,2,3] row_mask:0x4 bank_mask:0xf
  v_mov_b32_dpp v27, v48 row_ror:12 row_mask:0x4 bank_mask:0xf
  s_mov_b32 exec_lo, 0xffff
  s_mov_b32 exec_hi, 1
  buffer_store_dwordx4 v[26:29], v74, s[64:67], s76 offen sc1
  s_mov_b64 exec, -1
  s_add_u32 s73, s72, 3
  v_and_b32 v38, 7, v0
  s_add_u32 s91, s27, 2048
  v_lshl_add_u32 v38, v38, 4, s91
  s_add_u32 s97, s81, 3145728
  buffer_load_dwordx4 v[34:37], v38, s[64:67], s97 offen sc1
  buffer_load_dwordx4 v[26:29], v6, s[64:67], s97 offen offset:0 sc1
  buffer_load_dwordx4 v[30:33], v6, s[64:67], s97 offen offset:1024 sc1
  v_and_b32 v58, 15, v0
  v_bfe_u32 v60, v0, 4, 1
  v_lshl_add_u32 v58, v60, 5, v58
  v_lshrrev_b32 v60, 5, v0
  v_lshl_add_u32 v58, v60, 4, v58
  s_mul_i32 s91, s3, 96
  s_add_u32 s91, s91, 160832
  v_lshl_add_u32 v58, v58, 1, s91
  v_lshrrev_b32 v61, 2, v6
  v_add_u32 v61, 162528, v61
  ds_read_b32 v60, v61
  s_waitcnt vmcnt(0)
L_chk_50247:
  v_bitop3_b32 v75, v37, v29, s73 bitop3:0x7e
  v_bitop3_b32 v75, v75, v33, s73 bitop3:0xf6
  v_cmp_ne_u32 vcc, 0, v75
  s_nop 0
  s_cbranch_vccz L_retry_50248
  buffer_load_dwordx4 v[34:37], v38, s[64:67], s97 offen sc1
  buffer_load_dwordx4 v[26:29], v6, s[64:67], s97 offen offset:0 sc1
  buffer_load_dwordx4 v[30:33], v6, s[64:67], s97 offen offset:1024 sc1
  s_sub_u32 s75, s75, 1
  s_cbranch_scc1 L_end
  s_waitcnt vmcnt(0)
  s_branch L_chk_50247
L_retry_50248:
  v_pk_add_f32 v[26:27], v[26:27], v[30:31]
  v_add_f32 v28, v28, v32
  v_mov_b32 v29, v28
  v_add_f32_dpp v34, v34, v34 quad_perm:[1,0,3,2] row_mask:0xf bank_mask:0xf
  v_add_f32_dpp v35, v35, v35 quad_perm:[1,0,3,2] row_mask:0xf bank_mask:0xf
  v_permlane32_swap_b32 v26, v27
  v_permlane32_swap_b32 v28, v29
  v_add_f32_dpp v34, v34, v34 quad_perm:[2,3,0,1] row_mask:0xf bank_mask:0xf
  v_add_f32_dpp v35, v35, v35 quad_perm:[2,3,0,1] row_mask:0xf bank_mask:0xf
  v_add_f32 v26, v26, v27
  v_add_f32 v28, v28, v29
  v_add_f32_dpp v34, v34, v34 row_half_mirror row_mask:0xf bank_mask:0xf
  v_add_f32_dpp v35, v35, v35 row_half_mirror row_mask:0xf bank_mask:0xf
  v_permlane16_swap_b32 v26, v28
  v_mul_f32 v35, 0x3acccccd, v35
  v_mul_f32 v34, 0x3acccccd, v34
  v_add_f32 v62, v26, v28
  v_fma_f32 v34, -v35, v35, v34
  v_max_f32 v34, 0, v34
  v_add_f32 v34, 0x3727c5ac, v34
  v_rsq_f32 v34, v34
  s_waitcnt lgkmcnt(0)
  v_fma_f32 v62, -v35, v60, v62
  s_mov_b32 exec_hi, 0xffff
  v_mul_f32 v62, v62, v34
  v_cvt_pk_bf16_f32 v62, v62, v62
  ds_write_b16 v58, v62
  s_mov_b64 exec, -1
  s_waitcnt lgkmcnt(0)
  s_barrier
  v_and_b32 v66, 7, v0
  v_lshlrev_b32 v66, 4, v66
  v_add_u32 v66, 160832, v66
  ds_read_b128 v[26:29], v66 offset:0
  ds_read_b128 v[30:33], v66 offset:128
  ds_read_b128 v[34:37], v66 offset:256
  s_waitcnt lgkmcnt(0)
.balignl 8, 0xBF800000
  v_mfma_f32_4x4x4_16b_bf16 v[44:47], v[26:27], a[156:157], 0
  v_mfma_f32_4x4x4_16b_bf16 v[48:51], v[26:27], v[124:125], 0
  v_nop_e64
  v_mfma_f32_4x4x4_16b_bf16 v[44:47], v[28:29], a[158:159], v[44:47]
  v_mfma_f32_4x4x4_16b_bf16 v[48:51], v[28:29], v[126:127], v[48:51]
  v_nop_e64
  v_mfma_f32_4x4x4_16b_bf16 v[44:47], v[30:31], a[160:161], v[44:47]
  v_mfma_f32_4x4x4_16b_bf16 v[48:51], v[30:31], v[128:129], v[48:51]
  v_nop_e64
  v_mfma_f32_4x4x4_16b_bf16 v[44:47], v[32:33], a[162:163], v[44:47]
  v_mfma_f32_4x4x4_16b_bf16 v[48:51], v[32:33], v[130:131], v[48:51]
  v_nop_e64
  v_mfma_f32_4x4x4_16b_bf16 v[44:47], v[34:35], a[164:165], v[44:47]
  v_mfma_f32_4x4x4_16b_bf16 v[48:51], v[34:35], v[132:133], v[48:51]
  v_nop_e64
  v_mfma_f32_4x4x4_16b_bf16 v[44:47], v[36:37], a[166:167], v[44:47]
  v_mfma_f32_4x4x4_16b_bf16 v[48:51], v[36:37], v[134:135], v[48:51]
  v_mfma_f32_4x4x4_16b_bf16 v[52:55], v[26:27], v[136:137], 0
  v_mfma_f32_4x4x4_16b_bf16 v[56:59], v[26:27], v[148:149], 0
  v_nop_e64
  v_mfma_f32_4x4x4_16b_bf16 v[52:55], v[28:29], v[138:139], v[52:55]
  v_mov_b32_dpp v60, v44 quad_perm:[0,0,0,0] row_mask:0xf bank_mask:0xf
  v_mfma_f32_4x4x4_16b_bf16 v[56:59], v[28:29], v[150:151], v[56:59]
  v_mov_b32_dpp v61, v48 quad_perm:[0,0,0,0] row_mask:0xf bank_mask:0xf
  v_mfma_f32_4x4x4_16b_bf16 v[52:55], v[30:31], v[140:141], v[52:55]
  v_add_f32_dpp v60, v45, v60 quad_perm:[1,1,1,1] row_mask:0xf bank_mask:0xf
  v_mfma_f32_4x4x4_16b_bf16 v[56:59], v[30:31], v[152:153], v[56:59]
  v_add_f32_dpp v61, v49, v61 quad_perm:[1,1,1,1] row_mask:0xf bank_mask:0xf
  v_mfma_f32_4x4x4_16b_bf16 v[52:55], v[32:33], v[142:143], v[52:55]
  v_add_f32_dpp v60, v46, v60 quad_perm:[2,2,2,2] row_mask:0xf bank_mask:0xf
  v_mfma_f32_4x4x4_16b_bf16 v[56:59], v[32:33], v[154:155], v[56:59]
  v_add_f32_dpp v61, v50, v61 quad_perm:[2,2,2,2] row_mask:0xf bank_mask:0xf
  v_mfma_f32_4x4x4_16b_bf16 v[52:55], v[34:35], v[144:145], v[52:55]
  v_add_f32_dpp v38, v47, v60 quad_perm:[3,3,3,3] row_mask:0xf bank_mask:0xf
  v_mfma_f32_4x4x4_16b_bf16 v[56:59], v[34:35], v[156:157], v[56:59]
  v_add_f32_dpp v61, v51, v61 quad_perm:[3,3,3,3] row_mask:0xf bank_mask:0xf
  v_mfma_f32_4x4x4_16b_bf16 v[52:55], v[36:37], v[146:147], v[52:55]
  v_mfma_f32_4x4x4_16b_bf16 v[56:59], v[36:37], v[158:159], v[56:59]
  v_mfma_f32_4x4x4_16b_bf16 v[44:47], v[26:27], v[160:161], 0
  v_cndmask_b32 v38, v38, v61, s[84:85]
  v_mfma_f32_4x4x4_16b_bf16 v[48:51], v[26:27], v[244:245], 0
  v_mfma_f32_4x4x4_16b_bf16 v[44:47], v[28:29], v[162:163], v[44:47]
  v_mov_b32_dpp v62, v52 quad_perm:[0,0,0,0] row_mask:0xf bank_mask:0xf
  v_mfma_f32_4x4x4_16b_bf16 v[48:51], v[28:29], v[246:247], v[48:51]
  v_mov_b32_dpp v63, v56 quad_perm:[0,0,0,0] row_mask:0xf bank_mask:0xf
  v_mfma_f32_4x4x4_16b_bf16 v[44:47], v[30:31], v[164:165], v[44:47]
  v_add_f32_dpp v62, v53, v62 quad_perm:[1,1,1,1] row_mask:0xf bank_mask:0xf
  v_mfma_f32_4x4x4_16b_bf16 v[48:51], v[30:31], v[248:249], v[48:51]
  v_add_f32_dpp v63, v57, v63 quad_perm:[1,1,1,1] row_mask:0xf bank_mask:0xf
  v_mfma_f32_4x4x4_16b_bf16 v[44:47], v[32:33], v[166:167], v[44:47]
  v_add_f32_dpp v62, v54, v62 quad_perm:[2,2,2,2] row_mask:0xf bank_mask:0xf
  v_mfma_f32_4x4x4_16b_bf16 v[48:51], v[32:33], v[250:251], v[48:51]
  v_add_f32_dpp v63, v58, v63 quad_perm:[2,2,2,2] row_mask:0xf bank_mask:0xf
  v_mfma_f32_4x4x4_16b_bf16 v[44:47], v[34:35], v[168:169], v[44:47]
  v_add_f32_dpp v62, v55, v62 quad_perm:[3,3,3,3] row_mask:0xf bank_mask:0xf
  v_mfma_f32_4x4x4_16b_bf16 v[48:51], v[34:35], v[252:253], v[48:51]
  v_add_f32_dpp v63, v59, v63 quad_perm:[3,3,3,3] row_mask:0xf bank_mask:0xf
  v_mfma_f32_4x4x4_16b_bf16 v[44:47], v[36:37], v[170:171], v[44:47]
  v_mfma_f32_4x4x4_16b_bf16 v[48:51], v[36:37], v[254:255], v[48:51]
  v_mfma_f32_4x4x4_16b_bf16 v[52:55], v[26:27], a[0:1], 0
  v_cndmask_b32 v38, v38, v62, s[86:87]
  v_mfma_f32_4x4x4_16b_bf16 v[56:59], v[26:27], a[12:13], 0
  v_cndmask_b32 v38, v38, v63, s[88:89]
  v_mfma_f32_4x4x4_16b_bf16 v[52:55], v[28:29], a[2:3], v[52:55]
  v_mov_b32_dpp v60, v44 quad_perm:[0,0,0,0] row_mask:0xf bank_mask:0xf
  v_mfma_f32_4x4x4_16b_bf16 v[56:59], v[28:29], a[14:15], v[56:59]
  v_mov_b32_dpp v61, v48 quad_perm:[0,0,0,0] row_mask:0xf bank_mask:0xf
  v_mfma_f32_4x4x4_16b_bf16 v[52:55], v[30:31], a[4:5], v[52:55]
  v_add_f32_dpp v38, v38, v38 row_half_mirror row_mask:0xf bank_mask:0xf
  v_mfma_f32_4x4x4_16b_bf16 v[56:59], v[30:31], a[16:17], v[56:59]
  v_add_f32_dpp v60, v45, v60 quad_perm:[1,1,1,1] row_mask:0xf bank_mask:0xf
  v_mfma_f32_4x4x4_16b_bf16 v[52:55], v[32:33], a[6:7], v[52:55]
  v_add_f32_dpp v61, v49, v61 quad_perm:[1,1,1,1] row_mask:0xf bank_mask:0xf
  v_mfma_f32_4x4x4_16b_bf16 v[56:59], v[32:33], a[18:19], v[56:59]
  v_add_f32_dpp v60, v46, v60 quad_perm:[2,2,2,2] row_mask:0xf bank_mask:0xf
  v_mfma_f32_4x4x4_16b_bf16 v[52:55], v[34:35], a[8:9], v[52:55]
  v_add_f32_dpp v61, v50, v61 quad_perm:[2,2,2,2] row_mask:0xf bank_mask:0xf
  v_mfma_f32_4x4x4_16b_bf16 v[56:59], v[34:35], a[20:21], v[56:59]
  v_add_f32_dpp v39, v47, v60 quad_perm:[3,3,3,3] row_mask:0xf bank_mask:0xf
  v_mfma_f32_4x4x4_16b_bf16 v[52:55], v[36:37], a[10:11], v[52:55]
  v_add_f32_dpp v61, v51, v61 quad_perm:[3,3,3,3] row_mask:0xf bank_mask:0xf
  v_mfma_f32_4x4x4_16b_bf16 v[56:59], v[36:37], a[22:23], v[56:59]
  v_mfma_f32_4x4x4_16b_bf16 v[44:47], v[26:27], a[24:25], 0
  v_cndmask_b32 v39, v39, v61, s[84:85]
  v_mfma_f32_4x4x4_16b_bf16 v[48:51], v[26:27], a[36:37], 0
  v_mfma_f32_4x4x4_16b_bf16 v[44:47], v[28:29], a[26:27], v[44:47]
  v_mov_b32_dpp v62, v52 quad_perm:[0,0,0,0] row_mask:0xf bank_mask:0xf
  v_mfma_f32_4x4x4_16b_bf16 v[48:51], v[28:29], a[38:39], v[48:51]
  v_mov_b32_dpp v63, v56 quad_perm:[0,0,0,0] row_mask:0xf bank_mask:0xf
  v_mfma_f32_4x4x4_16b_bf16 v[44:47], v[30:31], a[28:29], v[44:47]
  v_add_f32_dpp v62, v53, v62 quad_perm:[1,1,1,1] row_mask:0xf bank_mask:0xf
  v_mfma_f32_4x4x4_16b_bf16 v[48:51], v[30:31], a[40:41], v[48:51]
  v_add_f32_dpp v63, v57, v63 quad_perm:[1,1,1,1] row_mask:0xf bank_mask:0xf
  v_mfma_f32_4x4x4_16b_bf16 v[44:47], v[32:33], a[30:31], v[44:47]
  v_add_f32_dpp v62, v54, v62 quad_perm:[2,2,2,2] row_mask:0xf bank_mask:0xf
  v_mfma_f32_4x4x4_16b_bf16 v[48:51], v[32:33], a[42:43], v[48:51]
  v_add_f32_dpp v63, v58, v63 quad_perm:[2,2,2,2] row_mask:0xf bank_mask:0xf
  v_mfma_f32_4x4x4_16b_bf16 v[44:47], v[34:35], a[32:33], v[44:47]
  v_add_f32_dpp v62, v55, v62 quad_perm:[3,3,3,3] row_mask:0xf bank_mask:0xf
  v_mfma_f32_4x4x4_16b_bf16 v[48:51], v[34:35], a[44:45], v[48:51]
  v_add_f32_dpp v63, v59, v63 quad_perm:[3,3,3,3] row_mask:0xf bank_mask:0xf
  v_mfma_f32_4x4x4_16b_bf16 v[44:47], v[36:37], a[34:35], v[44:47]
  v_mfma_f32_4x4x4_16b_bf16 v[48:51], v[36:37], a[46:47], v[48:51]
  v_mfma_f32_4x4x4_16b_bf16 v[52:55], v[26:27], a[48:49], 0
  v_cndmask_b32 v39, v39, v62, s[86:87]
  v_mfma_f32_4x4x4_16b_bf16 v[56:59], v[26:27], a[60:61], 0
  v_cndmask_b32 v39, v39, v63, s[88:89]
  v_mfma_f32_4x4x4_16b_bf16 v[52:55], v[28:29], a[50:51], v[52:55]
  v_mov_b32_dpp v60, v44 quad_perm:[0,0,0,0] row_mask:0xf bank_mask:0xf
  v_mfma_f32_4x4x4_16b_bf16 v[56:59], v[28:29], a[62:63], v[56:59]
  v_mov_b32_dpp v61, v48 quad_perm:[0,0,0,0] row_mask:0xf bank_mask:0xf
  v_mfma_f32_4x4x4_16b_bf16 v[52:55], v[30:31], a[52:53], v[52:55]
  v_add_f32_dpp v39, v39, v39 row_half_mirror row_mask:0xf bank_mask:0xf
  v_mfma_f32_4x4x4_16b_bf16 v[56:59], v[30:31], a[64:65], v[56:59]
  v_add_f32_dpp v60, v45, v60 quad_perm:[1,1,1,1] row_mask:0xf bank_mask:0xf
  v_mfma_f32_4x4x4_16b_bf16 v[52:55], v[32:33], a[54:55], v[52:55]
  v_add_f32_dpp v61, v49, v61 quad_perm:[1,1,1,1] row_mask:0xf bank_mask:0xf
  v_mfma_f32_4x4x4_16b_bf16 v[56:59], v[32:33], a[66:67], v[56:59]
  v_add_f32_dpp v60, v46, v60 quad_perm:[2,2,2,2] row_mask:0xf bank_mask:0xf
  v_mfma_f32_4x4x4_16b_bf16 v[52:55], v[34:35], a[56:57], v[52:55]
  v_add_f32_dpp v61, v50, v61 quad_perm:[2,2,2,2] row_mask:0xf bank_mask:0xf
  v_mfma_f32_4x4x4_16b_bf16 v[56:59], v[34:35], a[68:69], v[56:59]
  v_add_f32_dpp v40, v47, v60 quad_perm:[3,3,3,3] row_mask:0xf bank_mask:0xf
  v_mfma_f32_4x4x4_16b_bf16 v[52:55], v[36:37], a[58:59], v[52:55]
  v_add_f32_dpp v61, v51, v61 quad_perm:[3,3,3,3] row_mask:0xf bank_mask:0xf
  v_mfma_f32_4x4x4_16b_bf16 v[56:59], v[36:37], a[70:71], v[56:59]
  v_mfma_f32_4x4x4_16b_bf16 v[44:47], v[26:27], a[72:73], 0
  v_cndmask_b32 v40, v40, v61, s[84:85]
  v_mfma_f32_4x4x4_16b_bf16 v[48:51], v[26:27], a[84:85], 0
  v_mfma_f32_4x4x4_16b_bf16 v[44:47], v[28:29], a[74:75], v[44:47]
  v_mov_b32_dpp v62, v52 quad_perm:[0,0,0,0] row_mask:0xf bank_mask:0xf
  v_mfma_f32_4x4x4_16b_bf16 v[48:51], v[28:29], a[86:87], v[48:51]
  v_mov_b32_dpp v63, v56 quad_perm:[0,0,0,0] row_mask:0xf bank_mask:0xf
  v_mfma_f32_4x4x4_16b_bf16 v[44:47], v[30:31], a[76:77], v[44:47]
  v_add_f32_dpp v62, v53, v62 quad_perm:[1,1,1,1] row_mask:0xf bank_mask:0xf
  v_mfma_f32_4x4x4_16b_bf16 v[48:51], v[30:31], a[88:89], v[48:51]
  v_add_f32_dpp v63, v57, v63 quad_perm:[1,1,1,1] row_mask:0xf bank_mask:0xf
  v_mfma_f32_4x4x4_16b_bf16 v[44:47], v[32:33], a[78:79], v[44:47]
  v_add_f32_dpp v62, v54, v62 quad_perm:[2,2,2,2] row_mask:0xf bank_mask:0xf
  v_mfma_f32_4x4x4_16b_bf16 v[48:51], v[32:33], a[90:91], v[48:51]
  v_add_f32_dpp v63, v58, v63 quad_perm:[2,2,2,2] row_mask:0xf bank_mask:0xf
  v_mfma_f32_4x4x4_16b_bf16 v[44:47], v[34:35], a[80:81], v[44:47]
  v_add_f32_dpp v62, v55, v62 quad_perm:[3,3,3,3] row_mask:0xf bank_mask:0xf
  v_mfma_f32_4x4x4_16b_bf16 v[48:51], v[34:35], a[92:93], v[48:51]
  v_add_f32_dpp v63, v59, v63 quad_perm:[3,3,3,3] row_mask:0xf bank_mask:0xf
  v_mfma_f32_4x4x4_16b_bf16 v[44:47], v[36:37], a[82:83], v[44:47]
  v_mfma_f32_4x4x4_16b_bf16 v[48:51], v[36:37], a[94:95], v[48:51]
  v_mfma_f32_4x4x4_16b_bf16 v[52:55], v[26:27], a[96:97], 0
  v_cndmask_b32 v40, v40, v62, s[86:87]
  v_mfma_f32_4x4x4_16b_bf16 v[56:59], v[26:27], a[168:169], 0
  v_cndmask_b32 v40, v40, v63, s[88:89]
  v_mfma_f32_4x4x4_16b_bf16 v[52:55], v[28:29], a[98:99], v[52:55]
  v_mov_b32_dpp v60, v44 quad_perm:[0,0,0,0] row_mask:0xf bank_mask:0xf
  v_mfma_f32_4x4x4_16b_bf16 v[56:59], v[28:29], a[170:171], v[56:59]
  v_mov_b32_dpp v61, v48 quad_perm:[0,0,0,0] row_mask:0xf bank_mask:0xf
  v_mfma_f32_4x4x4_16b_bf16 v[52:55], v[30:31], a[100:101], v[52:55]
  v_add_f32_dpp v40, v40, v40 row_half_mirror row_mask:0xf bank_mask:0xf
  v_mfma_f32_4x4x4_16b_bf16 v[56:59], v[30:31], a[172:173], v[56:59]
  v_add_f32_dpp v60, v45, v60 quad_perm:[1,1,1,1] row_mask:0xf bank_mask:0xf
  v_mfma_f32_4x4x4_16b_bf16 v[52:55], v[32:33], a[102:103], v[52:55]
  v_add_f32_dpp v61, v49, v61 quad_perm:[1,1,1,1] row_mask:0xf bank_mask:0xf
  v_mfma_f32_4x4x4_16b_bf16 v[56:59], v[32:33], a[174:175], v[56:59]
  v_add_f32_dpp v60, v46, v60 quad_perm:[2,2,2,2] row_mask:0xf bank_mask:0xf
  v_mfma_f32_4x4x4_16b_bf16 v[52:55], v[34:35], a[104:105], v[52:55]
  v_add_f32_dpp v61, v50, v61 quad_perm:[2,2,2,2] row_mask:0xf bank_mask:0xf
  v_mfma_f32_4x4x4_16b_bf16 v[56:59], v[34:35], a[176:177], v[56:59]
  v_add_f32_dpp v41, v47, v60 quad_perm:[3,3,3,3] row_mask:0xf bank_mask:0xf
  v_mfma_f32_4x4x4_16b_bf16 v[52:55], v[36:37], a[106:107], v[52:55]
  v_add_f32_dpp v61, v51, v61 quad_perm:[3,3,3,3] row_mask:0xf bank_mask:0xf
  v_mfma_f32_4x4x4_16b_bf16 v[56:59], v[36:37], a[178:179], v[56:59]
  v_cndmask_b32 v41, v41, v61, s[84:85]
  s_nop 0
  s_nop 0
  v_mov_b32_dpp v62, v52 quad_perm:[0,0,0,0] row_mask:0xf bank_mask:0xf
  v_nop_e64
  v_mov_b32_dpp v63, v56 quad_perm:[0,0,0,0] row_mask:0xf bank_mask:0xf
  v_add_f32_dpp v62, v53, v62 quad_perm:[1,1,1,1] row_mask:0xf bank_mask:0xf
  v_nop_e64
  v_add_f32_dpp v63, v57, v63 quad_perm:[1,1,1,1] row_mask:0xf bank_mask:0xf
  v_add_f32_dpp v62, v54, v62 quad_perm:[2,2,2,2] row_mask:0xf bank_mask:0xf
  v_nop_e64
  v_add_f32_dpp v63, v58, v63 quad_perm:[2,2,2,2] row_mask:0xf bank_mask:0xf
  v_add_f32_dpp v62, v55, v62 quad_perm:[3,3,3,3] row_mask:0xf bank_mask:0xf
  v_nop_e64
  v_add_f32_dpp v63, v59, v63 quad_perm:[3,3,3,3] row_mask:0xf bank_mask:0xf
  v_cndmask_b32 v41, v41, v62, s[86:87]
  v_cndmask_b32 v41, v41, v63, s[88:89]
  s_nop 0
  s_nop 0
  v_add_f32_dpp v41, v41, v41 row_half_mirror row_mask:0xf bank_mask:0xf
  ds_read_b128 a[156:159], v6 offset:0
  ds_read_b128 a[160:163], v6 offset:4096
  ds_read_b128 a[164:167], v6 offset:8192
  ds_read_b128 v[124:127], v6 offset:12288
  ds_read_b128 v[128:131], v6 offset:16384
  ds_read_b128 v[132:135], v6 offset:20480
  ds_read_b128 v[136:139], v6 offset:24576
  ds_read_b128 v[140:143], v6 offset:28672
  v_max3_f32 v66, v38, v39, v40
  v_max_f32 v66, v66, v41
  s_nop 1
  v_max_f32_dpp v66, v66, v66 quad_perm:[1,0,3,2] row_mask:0xf bank_mask:0xf
  s_nop 1
  v_max_f32_dpp v66, v66, v66 quad_perm:[2,3,0,1] row_mask:0xf bank_mask:0xf
  s_nop 1
  v_max_f32_dpp v66, v66, v66 row_ror:8 row_mask:0xf bank_mask:0xf
  s_nop 1
  v_max_f32_dpp v66, v66, v66 row_bcast:15 row_mask:0xa bank_mask:0xf
  s_nop 1
  v_max_f32_dpp v66, v66, v66 row_bcast:31 row_mask:0xc bank_mask:0xf
  s_nop 0
  v_readlane_b32 s95, v66, 63
  v_mov_b32 v67, s21
  s_nop 0
  v_subrev_f32 v38, s95, v38
  v_subrev_f32 v39, s95, v39
  v_subrev_f32 v40, s95, v40
  v_subrev_f32 v41, s95, v41
  v_mov_b32 v66, s95
  v_mul_f32 v38, 0x3dd53b95, v38
  v_mul_f32 v39, 0x3dd53b95, v39
  v_mul_f32 v40, 0x3dd53b95, v40
  v_mul_f32 v41, 0x3dd53b95, v41
  ds_write_b32 v67, v66 offset:112
  v_exp_f32 v38, v38
  v_exp_f32 v39, v39
  v_exp_f32 v40, v40
  v_exp_f32 v41, v41
  v_add_f32 v66, v38, v39
  v_add_f32 v68, v40, v41
  v_add_f32 v68, v68, v66
  v_cvt_pk_bf16_f32 v38, v38, v38
  v_cvt_pk_bf16_f32 v39, v39, v39
  v_cvt_pk_bf16_f32 v40, v40, v40
  v_cvt_pk_bf16_f32 v41, v41, v41
  s_waitcnt lgkmcnt(0)
.balignl 8, 0xBF800000
  v_and_b32_dpp v46, v38, v2 quad_perm:[0,0,0,0] row_mask:0xf bank_mask:0xf
  v_and_b32_dpp v47, v38, v3 quad_perm:[0,0,0,0] row_mask:0xf bank_mask:0xf
  v_and_b32_dpp v48, v38, v4 quad_perm:[3,3,3,3] row_mask:0xf bank_mask:0xf
  v_and_b32_dpp v49, v38, v5 quad_perm:[3,3,3,3] row_mask:0xf bank_mask:0xf
  s_nop 0
  s_nop 0
  v_mfma_f32_16x16x32_bf16 v[26:29], v[46:49], a[180:183], 0
  v_and_b32_dpp v50, v38, v2 quad_perm:[1,1,1,1] row_mask:0xf bank_mask:0xf
  v_and_b32_dpp v51, v38, v3 quad_perm:[1,1,1,1] row_mask:0xf bank_mask:0xf
  v_mfma_f32_16x16x32_bf16 v[30:33], v[46:49], a[184:187], 0
  v_and_b32_dpp v52, v38, v4 quad_perm:[2,2,2,2] row_mask:0xf bank_mask:0xf
  v_and_b32_dpp v53, v38, v5 quad_perm:[2,2,2,2] row_mask:0xf bank_mask:0xf
  v_mfma_f32_16x16x32_bf16 v[34:37], v[46:49], a[188:191], 0
  v_add_f32_dpp v68, v68, v68 quad_perm:[1,0,3,2] row_mask:0xf bank_mask:0xf
  v_mfma_f32_16x16x32_bf16 v[26:29], v[50:53], a[192:195], v[26:29]
  v_and_b32_dpp v46, v38, v2 quad_perm:[2,2,2,2] row_mask:0xf bank_mask:0xf
  v_and_b32_dpp v47, v38, v3 quad_perm:[2,2,2,2] row_mask:0xf bank_mask:0xf
  v_mfma_f32_16x16x32_bf16 v[30:33], v[50:53], a[196:199], v[30:33]
  v_and_b32_dpp v48, v38, v4 quad_perm:[1,1,1,1] row_mask:0xf bank_mask:0xf
  v_and_b32_dpp v49, v38, v5 quad_perm:[1,1,1,1] row_mask:0xf bank_mask:0xf
  v_mfma_f32_16x16x32_bf16 v[34:37], v[50:53], a[200:203], v[34:37]
  v_add_f32_dpp v68, v68, v68 quad_perm:[2,3,0,1] row_mask:0xf bank_mask:0xf
  v_mfma_f32_16x16x32_bf16 v[26:29], v[46:49], a[204:207], v[26:29]
  v_and_b32_dpp v50, v38, v2 quad_perm:[3,3,3,3] row_mask:0xf bank_mask:0xf
  v_and_b32_dpp v51, v38, v3 quad_perm:[3,3,3,3] row_mask:0xf bank_mask:0xf
  v_mfma_f32_16x16x32_bf16 v[30:33], v[46:49], a[208:211], v[30:33]
  v_and_b32_dpp v52, v38, v4 quad_perm:[0,0,0,0] row_mask:0xf bank_mask:0xf
  v_and_b32_dpp v53, v38, v5 quad_perm:[0,0,0,0] row_mask:0xf bank_mask:0xf
  v_mfma_f32_16x16x32_bf16 v[34:37], v[46:49], a[212:215], v[34:37]
  v_add_f32_dpp v68, v68, v68 row_ror:8 row_mask:0xf bank_mask:0xf
  v_mfma_f32_16x16x32_bf16 v[26:29], v[50:53], a[216:219], v[26:29]
  v_and_b32_dpp v46, v39, v2 quad_perm:[0,0,0,0] row_mask:0xf bank_mask:0xf
  v_and_b32_dpp v47, v39, v3 quad_perm:[0,0,0,0] row_mask:0xf bank_mask:0xf
  v_mfma_f32_16x16x32_bf16 v[30:33], v[50:53], a[220:223], v[30:33]
  v_and_b32_dpp v48, v39, v4 quad_perm:[3,3,3,3] row_mask:0xf bank_mask:0xf
  v_and_b32_dpp v49, v39, v5 quad_perm:[3,3,3,3] row_mask:0xf bank_mask:0xf
  v_mfma_f32_16x16x32_bf16 v[34:37], v[50:53], a[224:227], v[34:37]
  v_add_f32_dpp v68, v68, v68 row_bcast:15 row_mask:0xa bank_mask:0xf
  v_mfma_f32_16x16x32_bf16 v[26:29], v[46:49], a[228:231], v[26:29]
  v_and_b32_dpp v50, v39, v2 quad_perm:[1,1,1,1] row_mask:0xf bank_mask:0xf
  v_and_b32_dpp v51, v39, v3 quad_perm:[1,1,1,1] row_mask:0xf bank_mask:0xf
  v_mfma_f32_16x16x32_bf16 v[30:33], v[46:49], a[232:235], v[30:33]
  v_and_b32_dpp v52, v39, v4 quad_perm:[2,2,2,2] row_mask:0xf bank_mask:0xf
  v_and_b32_dpp v53, v39, v5 quad_perm:[2,2,2,2] row_mask:0xf bank_mask:0xf
  v_mfma_f32_16x16x32_bf16 v[34:37], v[46:49], a[236:239], v[34:37]
  v_add_f32_dpp v68, v68, v68 row_bcast:31 row_mask:0xc bank_mask:0xf
  v_mfma_f32_16x16x32_bf16 v[26:29], v[50:53], a[240:243], v[26:29]
  v_and_b32_dpp v46, v39, v2 quad_perm:[2,2,2,2] row_mask:0xf bank_mask:0xf
  v_and_b32_dpp v47, v39, v3 quad_perm:[2,2,2,2] row_mask:0xf bank_mask:0xf
  v_mfma_f32_16x16x32_bf16 v[30:33], v[50:53], a[244:247], v[30:33]
  v_and_b32_dpp v48, v39, v4 quad_perm:[1,1,1,1] row_mask:0xf bank_mask:0xf
  v_and_b32_dpp v49, v39, v5 quad_perm:[1,1,1,1] row_mask:0xf bank_mask:0xf
  v_mfma_f32_16x16x32_bf16 v[34:37], v[50:53], a[248:251], v[34:37]
  v_readlane_b32 s96, v68, 63
  v_mfma_f32_16x16x32_bf16 v[26:29], v[46:49], v[172:175], v[26:29]
  v_and_b32_dpp v50, v39, v2 quad_perm:[3,3,3,3] row_mask:0xf bank_mask:0xf
  v_and_b32_dpp v51, v39, v3 quad_perm:[3,3,3,3] row_mask:0xf bank_mask:0xf
  v_mfma_f32_16x16x32_bf16 v[30:33], v[46:49], v[176:179], v[30:33]
  v_and_b32_dpp v52, v39, v4 quad_perm:[0,0,0,0] row_mask:0xf bank_mask:0xf
  v_and_b32_dpp v53, v39, v5 quad_perm:[0,0,0,0] row_mask:0xf bank_mask:0xf
  v_mfma_f32_16x16x32_bf16 v[34:37], v[46:49], v[180:183], v[34:37]
  v_nop_e64
  v_mfma_f32_16x16x32_bf16 v[26:29], v[50:53], v[184:187], v[26:29]
  v_and_b32_dpp v46, v40, v2 quad_perm:[0,0,0,0] row_mask:0xf bank_mask:0xf
  v_and_b32_dpp v47, v40, v3 quad_perm:[0,0,0,0] row_mask:0xf bank_mask:0xf
  v_mfma_f32_16x16x32_bf16 v[30:33], v[50:53], v[188:191], v[30:33]
  v_and_b32_dpp v48, v40, v4 quad_perm:[3,3,3,3] row_mask:0xf bank_mask:0xf
  v_and_b32_dpp v49, v40, v5 quad_perm:[3,3,3,3] row_mask:0xf bank_mask:0xf
  v_mfma_f32_16x16x32_bf16 v[34:37], v[50:53], v[192:195], v[34:37]
  v_nop_e64
  v_mfma_f32_16x16x32_bf16 v[26:29], v[46:49], v[196:199], v[26:29]
  v_and_b32_dpp v50, v40, v2 quad_perm:[1,1,1,1] row_mask:0xf bank_mask:0xf
  v_and_b32_dpp v51, v40, v3 quad_perm:[1,1,1,1] row_mask:0xf bank_mask:0xf
  v_mfma_f32_16x16x32_bf16 v[30:33], v[46:49], v[200:203], v[30:33]
  v_and_b32_dpp v52, v40, v4 quad_perm:[2,2,2,2] row_mask:0xf bank_mask:0xf
  v_and_b32_dpp v53, v40, v5 quad_perm:[2,2,2,2] row_mask:0xf bank_mask:0xf
  v_mfma_f32_16x16x32_bf16 v[34:37], v[46:49], v[204:207], v[34:37]
  v_nop_e64
  v_mfma_f32_16x16x32_bf16 v[26:29], v[50:53], v[208:211], v[26:29]
  v_and_b32_dpp v46, v40, v2 quad_perm:[2,2,2,2] row_mask:0xf bank_mask:0xf
  v_and_b32_dpp v47, v40, v3 quad_perm:[2,2,2,2] row_mask:0xf bank_mask:0xf
  v_mfma_f32_16x16x32_bf16 v[30:33], v[50:53], v[212:215], v[30:33]
  v_and_b32_dpp v48, v40, v4 quad_perm:[1,1,1,1] row_mask:0xf bank_mask:0xf
  v_and_b32_dpp v49, v40, v5 quad_perm:[1,1,1,1] row_mask:0xf bank_mask:0xf
  v_mfma_f32_16x16x32_bf16 v[34:37], v[50:53], v[216:219], v[34:37]
  v_nop_e64
  v_mfma_f32_16x16x32_bf16 v[26:29], v[46:49], v[220:223], v[26:29]
  v_and_b32_dpp v50, v40, v2 quad_perm:[3,3,3,3] row_mask:0xf bank_mask:0xf
  v_and_b32_dpp v51, v40, v3 quad_perm:[3,3,3,3] row_mask:0xf bank_mask:0xf
  v_mfma_f32_16x16x32_bf16 v[30:33], v[46:49], v[224:227], v[30:33]
  v_and_b32_dpp v52, v40, v4 quad_perm:[0,0,0,0] row_mask:0xf bank_mask:0xf
  v_and_b32_dpp v53, v40, v5 quad_perm:[0,0,0,0] row_mask:0xf bank_mask:0xf
  v_mfma_f32_16x16x32_bf16 v[34:37], v[46:49], v[228:231], v[34:37]
  v_nop_e64
  v_mfma_f32_16x16x32_bf16 v[26:29], v[50:53], v[232:235], v[26:29]
  v_and_b32_dpp v46, v41, v2 quad_perm:[0,0,0,0] row_mask:0xf bank_mask:0xf
  v_and_b32_dpp v47, v41, v3 quad_perm:[0,0,0,0] row_mask:0xf bank_mask:0xf
  v_mfma_f32_16x16x32_bf16 v[30:33], v[50:53], v[236:239], v[30:33]
  v_and_b32_dpp v48, v41, v4 quad_perm:[3,3,3,3] row_mask:0xf bank_mask:0xf
  v_and_b32_dpp v49, v41, v5 quad_perm:[3,3,3,3] row_mask:0xf bank_mask:0xf
  v_mfma_f32_16x16x32_bf16 v[34:37], v[50:53], v[240:243], v[34:37]
  v_nop_e64
  v_mfma_f32_16x16x32_bf16 v[26:29], v[46:49], a[252:255], v[26:29]
  v_and_b32_dpp v50, v41, v2 quad_perm:[1,1,1,1] row_mask:0xf bank_mask:0xf
  v_and_b32_dpp v51, v41, v3 quad_perm:[1,1,1,1] row_mask:0xf bank_mask:0xf
  v_mfma_f32_16x16x32_bf16 v[30:33], v[46:49], a[156:159], v[30:33]
  v_and_b32_dpp v52, v41, v4 quad_perm:[2,2,2,2] row_mask:0xf bank_mask:0xf
  v_and_b32_dpp v53, v41, v5 quad_perm:[2,2,2,2] row_mask:0xf bank_mask:0xf
  v_mfma_f32_16x16x32_bf16 v[34:37], v[46:49], a[160:163], v[34:37]
  v_nop_e64
  v_mfma_f32_16x16x32_bf16 v[26:29], v[50:53], a[164:167], v[26:29]
  v_and_b32_dpp v46, v41, v2 quad_perm:[2,2,2,2] row_mask:0xf bank_mask:0xf
  v_and_b32_dpp v47, v41, v3 quad_perm:[2,2,2,2] row_mask:0xf bank_mask:0xf
  v_mfma_f32_16x16x32_bf16 v[30:33], v[50:53], v[124:127], v[30:33]
  v_and_b32_dpp v48, v41, v4 quad_perm:[1,1,1,1] row_mask:0xf bank_mask:0xf
  v_and_b32_dpp v49, v41, v5 quad_perm:[1,1,1,1] row_mask:0xf bank_mask:0xf
  v_mfma_f32_16x16x32_bf16 v[34:37], v[50:53], v[128:131], v[34:37]
  v_nop_e64
  v_mfma_f32_16x16x32_bf16 v[26:29], v[46:49], v[132:135], v[26:29]
  v_and_b32_dpp v50, v41, v2 quad_perm:[3,3,3,3] row_mask:0xf bank_mask:0xf
  v_and_b32_dpp v51, v41, v3 quad_perm:[3,3,3,3] row_mask:0xf bank_mask:0xf
  v_mfma_f32_16x16x32_bf16 v[30:33], v[46:49], v[136:139], v[30:33]
  v_and_b32_dpp v52, v41, v4 quad_perm:[0,0,0,0] row_mask:0xf bank_mask:0xf
  v_and_b32_dpp v53, v41, v5 quad_perm:[0,0,0,0] row_mask:0xf bank_mask:0xf
  v_mfma_f32_16x16x32_bf16 v[34:37], v[46:49], v[140:143], v[34:37]
  v_nop_e64
  v_mfma_f32_16x16x32_bf16 v[26:29], v[50:53], v[112:115], v[26:29]
  v_mfma_f32_16x16x32_bf16 v[30:33], v[50:53], v[116:119], v[30:33]
  v_mfma_f32_16x16x32_bf16 v[34:37], v[50:53], v[120:123], v[34:37]
  v_lshrrev_b32 v60, 4, v0
  v_and_b32 v59, 15, v0
  v_lshlrev_b32 v58, 10, v60
  v_lshl_add_u32 v58, v59, 4, v58
  s_lshl_b32 s91, s3, 8
  s_add_u32 s91, s91, 155648
  v_add_u32 v58, s91, v58
  v_add_u32 v59, 155648, v6
  v_mov_b32 v49, s96
  v_permlane32_swap_b32 v26, v27
  v_permlane32_swap_b32 v28, v29
  v_permlane32_swap_b32 v30, v31
  v_permlane32_swap_b32 v32, v33
  v_permlane32_swap_b32 v34, v35
  v_permlane32_swap_b32 v36, v37
  v_add_f32_dpp v46, v27, v26 row_ror:8 row_mask:0xf bank_mask:0x3
  v_add_f32_dpp v47, v31, v30 row_ror:8 row_mask:0xf bank_mask:0x3
  v_add_f32_dpp v48, v35, v34 row_ror:8 row_mask:0xf bank_mask:0x3
  v_add_f32_dpp v46, v28, v29 row_ror:8 row_mask:0xf bank_mask:0xc
  v_add_f32_dpp v47, v32, v33 row_ror:8 row_mask:0xf bank_mask:0xc
  v_add_f32_dpp v48, v36, v37 row_ror:8 row_mask:0xf bank_mask:0xc
  ds_write_b128 v59, v[46:49]
  v_lshlrev_b32 v60, 2, v60
  v_add_u32 v60, 161488, v60
  v_mov_b32 v62, 161488
  s_waitcnt lgkmcnt(0)
  s_barrier
  ds_read_b128 v[54:57], v62
  ds_read_b32 v62, v60
  ds_read_b128 v[50:53], v58
  s_add_u32 s73, s72, 3
  s_mul_i32 s91, s31, 240
  s_sub_u32 s91, 2048, s91
  v_lshlrev_b32 v59, 4, v0
  v_writelane_b32 v59, s91, 16
  v_mov_b32 v49, s73
  s_add_u32 s76, s78, 524288
  s_waitcnt lgkmcnt(1)
  v_max3_f32 v54, v54, v55, v56
  v_max_f32 v54, v54, v57
  v_sub_f32 v62, v62, v54
  v_mul_f32 v62, 0x3dd53b95, v62
  v_exp_f32 v62, v62
  s_waitcnt lgkmcnt(0)
  v_pk_mul_f32 v[50:51], v[50:51], v[62:63] op_sel_hi:[1,0]
  v_pk_mul_f32 v[52:53], v[52:53], v[62:63] op_sel_hi:[1,0]
  s_nop 0
  v_permlane32_swap_b32 v50, v51
  v_permlane32_swap_b32 v52, v53
  v_add_f32 v50, v50, v51
  v_add_f32 v52, v52, v53
  s_nop 1
  v_permlane16_swap_b32 v50, v52
  v_add_f32 v46, v50, v52
  v_add_f32 v47, v50, v52
  s_nop 1
  v_permlane32_swap_b32 v46, v47
  v_mov_b32 v48, v46
  s_nop 1
  v_permlane16_swap_b32 v46, v48
  s_nop 1
  v_mov_b32_dpp v46, v54 quad_perm:[0,1,2,3] row_mask:0x2 bank_mask:0xf
  s_mov_b64 exec, 0x1ffff
  buffer_store_dwordx4 v[46:49], v59, s[64:67], s76 offen sc1
  s_mov_b64 exec, -1
  s_add_u32 s73, s72, 3
  v_lshrrev_b32 v45, 4, v0
  v_and_b32 v44, 1, v0
  v_lshl_add_u32 v45, v44, 2, v45
  s_add_u32 s91, s27, 2048
  v_lshl_add_u32 v45, v45, 4, s91
  s_add_u32 s97, s79, 524288
  buffer_load_dwordx4 v[34:37], v45, s[64:67], s97 offen sc1
  buffer_load_dwordx4 v[26:29], v6, s[64:67], s97 offen offset:0 sc1
  buffer_load_dwordx4 v[30:33], v6, s[64:67], s97 offen offset:1024 sc1
  v_lshrrev_b32 v46, 2, v0
  v_and_b32 v47, 3, v0
  v_mul_u32_u24 v46, 160, v46
  v_lshl_add_u32 v47, v47, 3, v46
  s_lshl_b32 s91, s3, 5
  s_add_u32 s91, s91, 124928
  v_add_u32 v46, s91, v47
  v_add_u32 v47, 125056, v47
  v_bfe_u32 v49, v0, 4, 1
  v_lshlrev_b32 v49, 8, v49
  v_lshrrev_b32 v48, 5, v0
  v_lshl_add_u32 v49, v48, 7, v49
  v_and_b32 v48, 7, v0
  v_lshl_add_u32 v49, v48, 4, v49
  v_bfe_u32 v48, v0, 3, 1
  v_lshl_add_u32 v49, v48, 2, v49
  s_and_b32 s91, s3, 1
  s_lshl_b32 s91, s91, 3
  s_and_b32 s92, s3, 2
  s_add_u32 s91, s91, s92
  s_add_u32 s91, s91, 159744
  v_add_u32 v49, s91, v49
  v_and_b32 v74, 0x30, v0
  s_lshl_b32 s91, s3, 4
  s_add_u32 s91, s91, 1
  v_writelane_b32 v74, 64, s91
  s_movk_i32 s91, 80
  v_writelane_b32 v74, s91, 2
  s_movk_i32 s91, 96
  v_writelane_b32 v74, s91, 3
  s_movk_i32 s91, 112
  v_writelane_b32 v74, s91, 4
  s_bfe_u32 s68, s73, 0x80000
  s_bfe_u32 s69, s73, 0x80008
  s_bfe_u32 s70, s73, 0x80010
  s_bfe_u32 s90, s73, 0x80018
  ds_read_b64_tr_b16 v[50:51], v46 offset:0
  ds_read_b64_tr_b16 v[52:53], v46 offset:2560
  ds_read_b64_tr_b16 v[54:55], v47 offset:0
  ds_read_b64_tr_b16 v[56:57], v47 offset:2560
  ds_read_b64_tr_b16 v[58:59], v46 offset:5120
  ds_read_b64_tr_b16 v[60:61], v46 offset:7680
  ds_read_b64_tr_b16 v[62:63], v47 offset:5120
  ds_read_b64_tr_b16 v[64:65], v47 offset:7680
  ds_read_b64_tr_b16 v[66:67], v46 offset:10240
  ds_read_b64_tr_b16 v[68:69], v46 offset:12800
  ds_read_b64_tr_b16 v[70:71], v47 offset:10240
  ds_read_b64_tr_b16 v[72:73], v47 offset:12800
  s_waitcnt vmcnt(0)
L_chk_50249:
  v_bitop3_b32 v75, v37, v29, s73 bitop3:0x7e
  v_bitop3_b32 v75, v75, v33, s73 bitop3:0xf6
  v_cmp_ne_u32 vcc, 0, v75
  s_nop 0
  s_cbranch_vccz L_retry_50250
  buffer_load_dwordx4 v[34:37], v45, s[64:67], s97 offen sc1
  buffer_load_dwordx4 v[26:29], v6, s[64:67], s97 offen offset:0 sc1
  buffer_load_dwordx4 v[30:33], v6, s[64:67], s97 offen offset:1024 sc1
  s_sub_u32 s75, s75, 1
  s_cbranch_scc1 L_end
  s_waitcnt vmcnt(0)
  s_branch L_chk_50249
L_retry_50250:
  v_max_f32_dpp v43, v34, v34 quad_perm:[1,0,3,2] row_mask:0xf bank_mask:0xf
  v_mov_b32 v42, v43
  s_nop 1
  v_permlane32_swap_b32 v43, v42
  v_max_f32 v43, v43, v42
  v_mov_b32 v42, v43
  s_nop 1
  v_permlane16_swap_b32 v43, v42
  v_max_f32 v43, v43, v42
  v_sub_f32 v43, v34, v43
  v_mul_f32 v43, 0x3dd53b95, v43
  v_exp_f32 v43, v43
  s_nop 0
  v_mul_f32 v35, v35, v43
  v_mul_f32_dpp v26, v43, v26 quad_perm:[0,0,2,2] row_mask:0xf bank_mask:0xf
  v_mul_f32_dpp v27, v43, v27 quad_perm:[0,0,2,2] row_mask:0xf bank_mask:0xf
  v_mul_f32_dpp v28, v43, v28 quad_perm:[0,0,2,2] row_mask:0xf bank_mask:0xf
  v_add_f32_dpp v29, v35, v35 quad_perm:[1,0,3,2] row_mask:0xf bank_mask:0xf
  v_fmac_f32_dpp v26, v43, v30 quad_perm:[1,1,3,3] row_mask:0xf bank_mask:0xf
  v_fmac_f32_dpp v27, v43, v31 quad_perm:[1,1,3,3] row_mask:0xf bank_mask:0xf
  v_fmac_f32_dpp v28, v43, v32 quad_perm:[1,1,3,3] row_mask:0xf bank_mask:0xf
  s_nop 0
  v_permlane32_swap_b32 v26, v27
  v_permlane32_swap_b32 v28, v29
  v_add_f32 v26, v26, v27
  v_add_f32 v28, v28, v29
  s_nop 1
  v_permlane16_swap_b32 v26, v28
  v_add_f32 v48, v26, v28
  v_lshrrev_b32 v45, 4, v0
  v_readlane_b32 s92, v48, 48
  v_lshlrev_b32 v45, 3, v45
  v_add_u32 v44, 159744, v45
  v_rcp_f32 v43, s92
  s_mov_b32 exec_hi, 0xffff
  v_mul_f32 v48, v48, v43
  v_cvt_pk_bf16_f32 v48, v48, v48
  ds_write_b16 v49, v48
  s_mov_b64 exec, -1
  s_waitcnt lgkmcnt(0)
  s_barrier
  ds_read2_b64 v[26:29], v44 offset0:0 offset1:4
  ds_read2_b64 v[30:33], v44 offset0:8 offset1:12
  ds_read2_b64 v[34:37], v44 offset0:16 offset1:20
  v_mov_b32 v48, v44
  s_add_u32 s76, s82, 917504
  s_lshl_b32 s91, s3, 4
  s_lshl_b64 vcc, 2, s91
  s_or_b32 s91, vcc_lo, 0x1001d
  s_or_b32 s92, vcc_hi, 0x10001
  v_mov_b32 v49, 0xffffff00
  s_waitcnt lgkmcnt(2)
  v_mfma_f32_16x16x32_bf16 v[38:41], v[50:53], v[26:29], 0
  v_mfma_f32_16x16x32_bf16 v[42:45], v[54:57], v[26:29], 0
  ds_read2_b64 v[26:29], v48 offset0:24 offset1:28
  ds_read_b64_tr_b16 v[50:51], v46 offset:15360
  ds_read_b64_tr_b16 v[52:53], v46 offset:17920
  ds_read_b64_tr_b16 v[54:55], v47 offset:15360
  ds_read_b64_tr_b16 v[56:57], v47 offset:17920
  s_waitcnt lgkmcnt(6)
  v_mfma_f32_16x16x32_bf16 v[38:41], v[58:61], v[30:33], v[38:41]
  v_mfma_f32_16x16x32_bf16 v[42:45], v[62:65], v[30:33], v[42:45]
  ds_read2_b64 v[30:33], v48 offset0:32 offset1:36
  ds_read_b64_tr_b16 v[58:59], v46 offset:20480
  ds_read_b64_tr_b16 v[60:61], v46 offset:23040
  ds_read_b64_tr_b16 v[62:63], v47 offset:20480
  ds_read_b64_tr_b16 v[64:65], v47 offset:23040
  s_waitcnt lgkmcnt(10)
  v_mfma_f32_16x16x32_bf16 v[38:41], v[66:69], v[34:37], v[38:41]
  v_mfma_f32_16x16x32_bf16 v[42:45], v[70:73], v[34:37], v[42:45]
  ds_read2_b64 v[34:37], v48 offset0:40 offset1:44
  ds_read_b64_tr_b16 v[66:67], v46 offset:25600
  ds_read_b64_tr_b16 v[68:69], v46 offset:28160
  ds_read_b64_tr_b16 v[70:71], v47 offset:25600
  ds_read_b64_tr_b16 v[72:73], v47 offset:28160
  s_waitcnt lgkmcnt(10)
  v_mfma_f32_16x16x32_bf16 v[38:41], v[50:53], v[26:29], v[38:41]
  v_mfma_f32_16x16x32_bf16 v[42:45], v[54:57], v[26:29], v[42:45]
  s_waitcnt lgkmcnt(5)
  v_mfma_f32_16x16x32_bf16 v[38:41], v[58:61], v[30:33], v[38:41]
  v_mfma_f32_16x16x32_bf16 v[42:45], v[62:65], v[30:33], v[42:45]
  s_waitcnt lgkmcnt(0)
  v_mfma_f32_16x16x32_bf16 v[38:41], v[66:69], v[34:37], v[38:41]
  v_mfma_f32_16x16x32_bf16 v[42:45], v[70:73], v[34:37], v[42:45]
  s_nop 7
  v_cndmask_b32 v26, v38, v42, vcc
  v_cndmask_b32 v27, v39, v43, vcc
  v_cndmask_b32 v28, v40, v44, vcc
  v_cndmask_b32 v29, v41, v45, vcc
  s_mov_b32 exec_lo, s91
  s_mov_b32 exec_hi, s92
  v_and_or_b32 v26, v26, v49, s68
  v_and_or_b32 v27, v27, v49, s69
  v_and_or_b32 v28, v28, v49, s70
  v_and_or_b32 v29, v29, v49, s90
  buffer_store_dwordx4 v[26:29], v74, s[64:67], s76 offen sc1
  s_mov_b64 exec, -1
  s_waitcnt vmcnt(0)
  s_cmp_ge_u32 s30, 2
  s_cbranch_scc1 L_done2
  s_cmp_eq_u32 s30, 0
  s_cselect_b64 vcc, -1, 0
  v_cndmask_b32 v74, v7, v25, vcc
  s_cselect_b32 s101, 917504, 0
  s_max_u32 s101, s101, 786432
  s_add_u32 s73, s72, 3
  v_lshrrev_b32 v58, 3, v0
  v_and_b32 v75, 7, v0
  v_mul_u32_u24 v58, 128, v58
  v_lshl_add_u32 v58, v75, 4, v58
  s_add_u32 s97, s83, s101
  s_mov_b32 exec_lo, 0x1f1f1f1f
  s_mov_b32 exec_hi, 0x1f1f1f1f
  buffer_load_dwordx4 v[26:29], v58, s[64:67], s97 offen offset:0 sc1
  buffer_load_dwordx4 v[30:33], v58, s[64:67], s97 offen offset:1024 sc1
  buffer_load_dwordx4 v[34:37], v58, s[64:67], s97 offen offset:2048 sc1
  buffer_load_dwordx4 v[38:41], v58, s[64:67], s97 offen offset:3072 sc1
  s_mov_b64 exec, -1
  s_bfe_u32 s68, s73, 0x80000
  s_bfe_u32 s69, s73, 0x80008
  s_bfe_u32 s70, s73, 0x80010
  s_bfe_u32 s90, s73, 0x80018
  s_xor_b32 s91, s30, 1
  s_mul_i32 s91, s91, 1280
  s_mul_i32 s92, s31, 160
  s_add_u32 s101, s91, s92
  s_mov_b32 s48, s24
  s_mov_b32 s49, s25
  s_mov_b32 s50, 2560
  s_waitcnt vmcnt(0)
  s_mov_b32 exec_lo, 0x1f1f1f1f
  s_mov_b32 exec_hi, 0x1f1f1f1f
L_chk_50251:
  v_xor_b32 v26, s68, v26
  v_xor_b32 v30, s68, v30
  v_xor_b32 v34, s68, v34
  v_xor_b32 v38, s68, v38
  v_xor_b32 v27, s69, v27
  v_xor_b32 v31, s69, v31
  v_xor_b32 v35, s69, v35
  v_xor_b32 v39, s69, v39
  v_xor_b32 v28, s70, v28
  v_xor_b32 v32, s70, v32
  v_xor_b32 v36, s70, v36
  v_xor_b32 v40, s70, v40
  v_xor_b32 v29, s90, v29
  v_xor_b32 v33, s90, v33
  v_xor_b32 v37, s90, v37
  v_xor_b32 v41, s90, v41
  v_or3_b32 v75, v26, v30, v34
  v_or3_b32 v75, v75, v38, v27
  v_or3_b32 v75, v75, v31, v35
  v_or3_b32 v75, v75, v39, v28
  v_or3_b32 v75, v75, v32, v36
  v_or3_b32 v75, v75, v40, v29
  v_or3_b32 v75, v75, v33, v37
  v_or3_b32 v75, v75, v41, v41
  v_and_b32 v75, 0xff, v75
  v_cmp_ne_u32 vcc, 0, v75
  s_nop 0
  s_cbranch_vccz L_retry_50252
  buffer_load_dwordx4 v[26:29], v58, s[64:67], s97 offen offset:0 sc1
  buffer_load_dwordx4 v[30:33], v58, s[64:67], s97 offen offset:1024 sc1
  buffer_load_dwordx4 v[34:37], v58, s[64:67], s97 offen offset:2048 sc1
  buffer_load_dwordx4 v[38:41], v58, s[64:67], s97 offen offset:3072 sc1
  s_sub_u32 s75, s75, 1
  s_cbranch_scc1 L_end
  s_waitcnt vmcnt(0)
  s_branch L_chk_50251
L_retry_50252:
  v_pk_add_f32 v[26:27], v[26:27], v[30:31]
  v_pk_add_f32 v[28:29], v[28:29], v[32:33]
  v_pk_add_f32 v[34:35], v[34:35], v[38:39]
  v_pk_add_f32 v[36:37], v[36:37], v[40:41]
  v_pk_add_f32 v[26:27], v[26:27], v[34:35]
  v_pk_add_f32 v[28:29], v[28:29], v[36:37]
  v_add_u32 v33, 160128, v24
  v_add_f32_dpp v30, v26, v26 row_ror:8 row_mask:0xf bank_mask:0x3
  v_add_f32_dpp v31, v28, v28 row_ror:8 row_mask:0xf bank_mask:0x3
  s_nop 0
  v_add_f32_dpp v30, v27, v27 row_ror:8 row_mask:0xf bank_mask:0xc
  v_add_f32_dpp v31, v29, v29 row_ror:8 row_mask:0xf bank_mask:0xc
  s_nop 1
  v_permlane32_swap_b32 v30, v31
  v_add_f32 v30, v30, v31
  v_mov_b32 v31, v30
  s_nop 1
  v_permlane16_swap_b32 v30, v31
  v_add_f32 v30, v30, v31
  v_cvt_pk_bf16_f32 v30, v30, v30
  v_and_b32 v30, 0xffff0000, v30
  v_add_f32 v30, v30, v74
  v_cvt_pk_bf16_f32 v31, v30, v30
  s_mov_b32 exec_lo, 0x1f1f
  s_mov_b32 exec_hi, 0x1f1f
  buffer_store_short v31, v24, s[48:51], s101 offen
  s_or_b32 s91, s2, s3
  s_cmp_lg_u32 s91, 0
  s_cbranch_scc1 L_done2
  s_mov_b32 exec_lo, -1
  s_mov_b32 exec_hi, 0
  v_mov_b32 v27, s72
  v_lshlrev_b32 v28, 2, v0
  buffer_store_dword v27, v28, s[64:67], 0 offen
L_done2:
  s_mov_b64 exec, -1
  s_endpgm
L_tg_50001:
  s_mov_b32 s77, 1
  s_branch L_tb_50002
L_tg_50003:
  s_mov_b32 s77, 1
  s_branch L_tb_50004
L_tg_50005:
  s_mov_b32 s77, 1
  s_branch L_tb_50006
L_tg_50007:
  s_mov_b32 s77, 1
  s_branch L_tb_50008
L_wz_50009:
  s_waitcnt vmcnt(0)
  s_branch L_wb_50010
L_tg_50015:
  s_mov_b32 s77, 1
  s_branch L_tb_50016
L_tg_50017:
  s_mov_b32 s77, 1
  s_branch L_tb_50018
L_retry_50012:
s_sub_u32 s75, s75, 1
s_cbranch_scc1 L_end
buffer_load_dwordx4 v[34:37], v59, s[64:67], s97 offen sc1
buffer_load_dwordx4 v[26:29], v6, s[64:67], s97 offen offset:0 sc1
buffer_load_dwordx4 v[30:33], v6, s[64:67], s97 offen offset:1024 sc1
buffer_load_dwordx4 v[38:41], v6, s[64:67], s100 offen offset:0 sc1
buffer_load_dwordx4 v[42:45], v6, s[64:67], s100 offen offset:1024 sc1
s_mov_b64 exec, -1
s_mov_b32 s77, 0
s_cmp_lt_u32 s16, s17
s_cbranch_scc0 L_tg_50015
s_waitcnt vmcnt(14)
s_swappc_b64 s[28:29], s[0:1]
L_tb_50016:
s_cmp_lt_u32 s16, s17
s_cbranch_scc0 L_tg_50017
s_waitcnt vmcnt(14)
s_swappc_b64 s[28:29], s[0:1]
L_tb_50018:
s_cmp_lg_u32 s77, 0
s_cbranch_scc1 L_rz_50013
s_waitcnt vmcnt(6)
s_branch L_chk_50011
L_rz_50013:
s_waitcnt vmcnt(0)
s_branch L_chk_50011
L_nd_50021:
  s_waitcnt vmcnt(0)
  s_cmp_ge_u32 s16, 24
  s_cbranch_scc1 L_nq_50022
  s_branch L_end
L_tg_50023:
  s_mov_b32 s77, 1
  s_branch L_tb_50024
L_tg_50025:
  s_mov_b32 s77, 1
  s_branch L_tb_50026
L_tg_50028:
  s_mov_b32 s77, 1
  s_branch L_tb_50029
L_tg_50030:
  s_mov_b32 s77, 1
  s_branch L_tb_50031
L_tg_50032:
  s_mov_b32 s77, 1
  s_branch L_tb_50033
L_wz_50034:
  s_waitcnt vmcnt(0)
  s_branch L_wb_50035
L_tg_50040:
  s_mov_b32 s77, 1
  s_branch L_tb_50041
L_tg_50042:
  s_mov_b32 s77, 1
  s_branch L_tb_50043
L_retry_50037:
s_sub_u32 s75, s75, 1
s_cbranch_scc1 L_end
buffer_load_dwordx4 v[34:37], v45, s[64:67], s97 offen sc1
buffer_load_dwordx4 v[26:29], v6, s[64:67], s97 offen offset:0 sc1
buffer_load_dwordx4 v[30:33], v6, s[64:67], s97 offen offset:1024 sc1
s_mov_b64 exec, -1
s_mov_b32 s77, 0
s_cmp_lt_u32 s16, s17
s_cbranch_scc0 L_tg_50040
s_waitcnt vmcnt(12)
s_swappc_b64 s[28:29], s[0:1]
L_tb_50041:
s_cmp_lt_u32 s16, s17
s_cbranch_scc0 L_tg_50042
s_waitcnt vmcnt(12)
s_swappc_b64 s[28:29], s[0:1]
L_tb_50043:
s_cmp_lg_u32 s77, 0
s_cbranch_scc1 L_rz_50038
s_waitcnt vmcnt(6)
s_branch L_chk_50036
L_rz_50038:
s_waitcnt vmcnt(0)
s_branch L_chk_50036
L_tg_50044:
  s_mov_b32 s77, 1
  s_branch L_tb_50045
L_tg_50046:
  s_mov_b32 s77, 1
  s_branch L_tb_50047
L_tg_50048:
  s_mov_b32 s77, 1
  s_branch L_tb_50049
L_tg_50050:
  s_mov_b32 s77, 1
  s_branch L_tb_50051
L_tg_50052:
  s_mov_b32 s77, 1
  s_branch L_tb_50053
L_tg_50054:
  s_mov_b32 s77, 1
  s_branch L_tb_50055
L_tg_50056:
  s_mov_b32 s77, 1
  s_branch L_tb_50057
L_tg_50058:
  s_mov_b32 s77, 1
  s_branch L_tb_50059
L_tg_50060:
  s_mov_b32 s77, 1
  s_branch L_tb_50061
L_tg_50062:
  s_mov_b32 s77, 1
  s_branch L_tb_50063
L_wz_50064:
  s_waitcnt vmcnt(0)
  s_branch L_wb_50065
L_tg_50070:
  s_mov_b32 s77, 1
  s_branch L_tb_50071
L_tg_50072:
  s_mov_b32 s77, 1
  s_branch L_tb_50073
L_retry_50067:
s_sub_u32 s75, s75, 1
s_cbranch_scc1 L_end
buffer_load_dwordx4 v[26:29], v74, s[64:67], s97 offen offset:0 sc1
buffer_load_dwordx4 v[30:33], v74, s[64:67], s97 offen offset:1024 sc1
buffer_load_dwordx4 v[34:37], v74, s[64:67], s97 offen offset:2048 sc1
buffer_load_dwordx4 v[38:41], v74, s[64:67], s97 offen offset:3072 sc1
s_mov_b64 exec, -1
s_mov_b32 s77, 0
s_cmp_lt_u32 s16, s17
s_cbranch_scc0 L_tg_50070
s_waitcnt vmcnt(13)
s_swappc_b64 s[28:29], s[0:1]
L_tb_50071:
s_cmp_lt_u32 s16, s17
s_cbranch_scc0 L_tg_50072
s_waitcnt vmcnt(13)
s_swappc_b64 s[28:29], s[0:1]
L_tb_50073:
  s_mov_b32 exec_lo, 0x1f1f1f1f
  s_mov_b32 exec_hi, 0x1f1f1f1f
s_cmp_lg_u32 s77, 0
s_cbranch_scc1 L_rz_50068
s_waitcnt vmcnt(6)
s_branch L_chk_50066
L_rz_50068:
s_waitcnt vmcnt(0)
s_branch L_chk_50066
L_tg_50074:
  s_mov_b32 s77, 1
  s_branch L_tb_50075
L_tg_50076:
  s_mov_b32 s77, 1
  s_branch L_tb_50077
L_tg_50078:
  s_mov_b32 s77, 1
  s_branch L_tb_50079
L_tg_50080:
  s_mov_b32 s77, 1
  s_branch L_tb_50081
L_tg_50082:
  s_mov_b32 s77, 1
  s_branch L_tb_50083
L_wz_50084:
  s_waitcnt vmcnt(0)
  s_branch L_wb_50085
L_tg_50090:
  s_mov_b32 s77, 1
  s_branch L_tb_50091
L_tg_50092:
  s_mov_b32 s77, 1
  s_branch L_tb_50093
L_retry_50087:
s_sub_u32 s75, s75, 1
s_cbranch_scc1 L_end
buffer_load_dwordx4 v[34:37], v59, s[64:67], s97 offen sc1
buffer_load_dwordx4 v[26:29], v6, s[64:67], s97 offen offset:0 sc1
buffer_load_dwordx4 v[30:33], v6, s[64:67], s97 offen offset:1024 sc1
buffer_load_dwordx4 v[38:41], v6, s[64:67], s100 offen offset:0 sc1
buffer_load_dwordx4 v[42:45], v6, s[64:67], s100 offen offset:1024 sc1
s_mov_b64 exec, -1
s_mov_b32 s77, 0
s_cmp_lt_u32 s16, s17
s_cbranch_scc0 L_tg_50090
s_waitcnt vmcnt(14)
s_swappc_b64 s[28:29], s[0:1]
L_tb_50091:
s_cmp_lt_u32 s16, s17
s_cbranch_scc0 L_tg_50092
s_waitcnt vmcnt(14)
s_swappc_b64 s[28:29], s[0:1]
L_tb_50093:
s_cmp_lg_u32 s77, 0
s_cbranch_scc1 L_rz_50088
s_waitcnt vmcnt(6)
s_branch L_chk_50086
L_rz_50088:
s_waitcnt vmcnt(0)
s_branch L_chk_50086
L_ud_50097:
  s_cmp_ge_u32 s16, s20
  s_cbranch_scc1 L_uc_50096
  s_waitcnt vmcnt(0)
  s_branch L_uc_50096
L_tg_50110:
  s_mov_b32 s77, 1
  s_branch L_tb_50111
L_tg_50112:
  s_mov_b32 s77, 1
  s_branch L_tb_50113
L_wz_50114:
  s_waitcnt vmcnt(0)
  s_branch L_wb_50115
L_tg_50120:
  s_mov_b32 s77, 1
  s_branch L_tb_50121
L_retry_50117:
s_sub_u32 s75, s75, 1
s_cbranch_scc1 L_end
buffer_load_dwordx4 v[34:37], v38, s[64:67], s97 offen sc1
buffer_load_dwordx4 v[26:29], v6, s[64:67], s97 offen offset:0 sc1
buffer_load_dwordx4 v[30:33], v6, s[64:67], s97 offen offset:1024 sc1
s_mov_b64 exec, -1
s_mov_b32 s77, 0
s_cmp_lt_u32 s16, s17
s_cbranch_scc0 L_tg_50120
s_waitcnt vmcnt(6)
s_swappc_b64 s[28:29], s[0:1]
L_tb_50121:
s_cmp_lg_u32 s77, 0
s_cbranch_scc1 L_rz_50118
s_waitcnt vmcnt(3)
s_branch L_chk_50116
L_rz_50118:
s_waitcnt vmcnt(0)
s_branch L_chk_50116
L_tg_50122:
  s_mov_b32 s77, 1
  s_branch L_tb_50123
L_tg_50124:
  s_mov_b32 s77, 1
  s_branch L_tb_50125
L_tg_50126:
  s_mov_b32 s77, 1
  s_branch L_tb_50127
L_tg_50128:
  s_mov_b32 s77, 1
  s_branch L_tb_50129
L_wz_50130:
  s_waitcnt vmcnt(18)
  s_branch L_wb_50131
L_tg_50136:
  s_mov_b32 s77, 1
  s_branch L_tb_50137
L_tg_50138:
  s_mov_b32 s77, 1
  s_branch L_tb_50139
L_retry_50133:
s_sub_u32 s75, s75, 1
s_cbranch_scc1 L_end
buffer_load_dwordx4 v[34:37], v38, s[64:67], s97 offen sc1
buffer_load_dwordx4 v[26:29], v6, s[64:67], s97 offen offset:0 sc1
buffer_load_dwordx4 v[30:33], v6, s[64:67], s97 offen offset:1024 sc1
s_mov_b64 exec, -1
s_mov_b32 s77, 0
s_cmp_lt_u32 s16, s17
s_cbranch_scc0 L_tg_50136
s_waitcnt vmcnt(12)
s_swappc_b64 s[28:29], s[0:1]
L_tb_50137:
s_cmp_lt_u32 s16, s17
s_cbranch_scc0 L_tg_50138
s_waitcnt vmcnt(12)
s_swappc_b64 s[28:29], s[0:1]
L_tb_50139:
s_cmp_lg_u32 s77, 0
s_cbranch_scc1 L_rz_50134
s_waitcnt vmcnt(6)
s_branch L_chk_50132
L_rz_50134:
s_waitcnt vmcnt(0)
s_branch L_chk_50132
L_nd_50142:
  s_waitcnt vmcnt(0)
  s_cmp_ge_u32 s16, 144
  s_cbranch_scc1 L_nq_50143
  s_branch L_end
L_tg_50144:
  s_mov_b32 s77, 1
  s_branch L_tb_50145
L_tg_50146:
  s_mov_b32 s77, 1
  s_branch L_tb_50147
L_tg_50148:
  s_mov_b32 s77, 1
  s_branch L_tb_50149
L_tg_50150:
  s_mov_b32 s77, 1
  s_branch L_tb_50151
L_tg_50152:
  s_mov_b32 s77, 1
  s_branch L_tb_50153
L_wz_50154:
  s_waitcnt vmcnt(0)
  s_branch L_wb_50155
L_tg_50160:
  s_mov_b32 s77, 1
  s_branch L_tb_50161
L_tg_50162:
  s_mov_b32 s77, 1
  s_branch L_tb_50163
L_retry_50157:
s_sub_u32 s75, s75, 1
s_cbranch_scc1 L_end
buffer_load_dwordx4 v[34:37], v45, s[64:67], s97 offen sc1
buffer_load_dwordx4 v[26:29], v6, s[64:67], s97 offen offset:0 sc1
buffer_load_dwordx4 v[30:33], v6, s[64:67], s97 offen offset:1024 sc1
s_mov_b64 exec, -1
s_mov_b32 s77, 0
s_cmp_lt_u32 s16, s17
s_cbranch_scc0 L_tg_50160
s_waitcnt vmcnt(12)
s_swappc_b64 s[28:29], s[0:1]
L_tb_50161:
s_cmp_lt_u32 s16, s17
s_cbranch_scc0 L_tg_50162
s_waitcnt vmcnt(12)
s_swappc_b64 s[28:29], s[0:1]
L_tb_50163:
s_cmp_lg_u32 s77, 0
s_cbranch_scc1 L_rz_50158
s_waitcnt vmcnt(6)
s_branch L_chk_50156
L_rz_50158:
s_waitcnt vmcnt(0)
s_branch L_chk_50156
L_tg_50164:
  s_mov_b32 s77, 1
  s_branch L_tb_50165
L_tg_50166:
  s_mov_b32 s77, 1
  s_branch L_tb_50167
L_tg_50168:
  s_mov_b32 s77, 1
  s_branch L_tb_50169
L_tg_50170:
  s_mov_b32 s77, 1
  s_branch L_tb_50171
L_tg_50172:
  s_mov_b32 s77, 1
  s_branch L_tb_50173
L_tg_50174:
  s_mov_b32 s77, 1
  s_branch L_tb_50175
L_tg_50176:
  s_mov_b32 s77, 1
  s_branch L_tb_50177
L_wz_50178:
  s_waitcnt vmcnt(0)
  s_branch L_wb_50179
L_tg_50184:
  s_mov_b32 s77, 1
  s_branch L_tb_50185
L_tg_50186:
  s_mov_b32 s77, 1
  s_branch L_tb_50187
L_retry_50181:
s_sub_u32 s75, s75, 1
s_cbranch_scc1 L_end
buffer_load_dwordx4 v[34:37], v45, s[64:67], s97 offen sc1
buffer_load_dwordx4 v[26:29], v6, s[64:67], s97 offen offset:0 sc1
buffer_load_dwordx4 v[30:33], v6, s[64:67], s97 offen offset:1024 sc1
s_mov_b64 exec, -1
s_mov_b32 s77, 0
s_cmp_lt_u32 s16, s17
s_cbranch_scc0 L_tg_50184
s_waitcnt vmcnt(12)
s_swappc_b64 s[28:29], s[0:1]
L_tb_50185:
s_cmp_lt_u32 s16, s17
s_cbranch_scc0 L_tg_50186
s_waitcnt vmcnt(12)
s_swappc_b64 s[28:29], s[0:1]
L_tb_50187:
s_cmp_lg_u32 s77, 0
s_cbranch_scc1 L_rz_50182
s_waitcnt vmcnt(6)
s_branch L_chk_50180
L_rz_50182:
s_waitcnt vmcnt(0)
s_branch L_chk_50180
L_tg_50188:
  s_mov_b32 s77, 1
  s_branch L_tb_50189
L_tg_50190:
  s_mov_b32 s77, 1
  s_branch L_tb_50191
L_tg_50192:
  s_mov_b32 s77, 1
  s_branch L_tb_50193
L_wz_50194:
  s_waitcnt vmcnt(0)
  s_branch L_wb_50195
L_tg_50200:
  s_mov_b32 s77, 1
  s_branch L_tb_50201
L_tg_50202:
  s_mov_b32 s77, 1
  s_branch L_tb_50203
L_retry_50197:
s_sub_u32 s75, s75, 1
s_cbranch_scc1 L_end
buffer_load_dwordx4 v[26:29], v74, s[64:67], s97 offen offset:0 sc1
buffer_load_dwordx4 v[30:33], v74, s[64:67], s97 offen offset:1024 sc1
buffer_load_dwordx4 v[34:37], v74, s[64:67], s97 offen offset:2048 sc1
buffer_load_dwordx4 v[38:41], v74, s[64:67], s97 offen offset:3072 sc1
s_mov_b64 exec, -1
s_mov_b32 s77, 0
s_cmp_lt_u32 s16, s17
s_cbranch_scc0 L_tg_50200
s_waitcnt vmcnt(13)
s_swappc_b64 s[28:29], s[0:1]
L_tb_50201:
s_cmp_lt_u32 s16, s17
s_cbranch_scc0 L_tg_50202
s_waitcnt vmcnt(13)
s_swappc_b64 s[28:29], s[0:1]
L_tb_50203:
  s_mov_b32 exec_lo, 0x1f1f1f1f
  s_mov_b32 exec_hi, 0x1f1f1f1f
s_cmp_lg_u32 s77, 0
s_cbranch_scc1 L_rz_50198
s_waitcnt vmcnt(6)
s_branch L_chk_50196
L_rz_50198:
s_waitcnt vmcnt(0)
s_branch L_chk_50196
L_tg_50204:
  s_mov_b32 s77, 1
  s_branch L_tb_50205
L_tg_50206:
  s_mov_b32 s77, 1
  s_branch L_tb_50207
L_tg_50208:
  s_mov_b32 s77, 1
  s_branch L_tb_50209
L_wz_50210:
  s_waitcnt vmcnt(0)
  s_branch L_wb_50211
L_tg_50216:
  s_mov_b32 s77, 1
  s_branch L_tb_50217
L_tg_50218:
  s_mov_b32 s77, 1
  s_branch L_tb_50219
L_retry_50213:
s_sub_u32 s75, s75, 1
s_cbranch_scc1 L_end
buffer_load_dwordx4 v[34:37], v38, s[64:67], s97 offen sc1
buffer_load_dwordx4 v[26:29], v6, s[64:67], s97 offen offset:0 sc1
buffer_load_dwordx4 v[30:33], v6, s[64:67], s97 offen offset:1024 sc1
s_mov_b64 exec, -1
s_mov_b32 s77, 0
s_cmp_lt_u32 s16, s17
s_cbranch_scc0 L_tg_50216
s_waitcnt vmcnt(12)
s_swappc_b64 s[28:29], s[0:1]
L_tb_50217:
s_cmp_lt_u32 s16, s17
s_cbranch_scc0 L_tg_50218
s_waitcnt vmcnt(12)
s_swappc_b64 s[28:29], s[0:1]
L_tb_50219:
s_cmp_lg_u32 s77, 0
s_cbranch_scc1 L_rz_50214
s_waitcnt vmcnt(6)
s_branch L_chk_50212
L_rz_50214:
s_waitcnt vmcnt(0)
s_branch L_chk_50212
L_nd_50222:
  s_waitcnt vmcnt(0)
  s_cmp_ge_u32 s16, 192
  s_cbranch_scc1 L_nq_50223
  s_branch L_end
L_tg_50224:
  s_mov_b32 s77, 1
  s_branch L_tb_50225
L_tg_50226:
  s_mov_b32 s77, 1
  s_branch L_tb_50227
L_nd_50230:
  s_waitcnt vmcnt(0)
  s_cmp_ge_u32 s16, 216
  s_cbranch_scc1 L_nq_50231
  s_branch L_end
L_ud_50235:
  s_cmp_ge_u32 s16, s20
  s_cbranch_scc1 L_uc_50234
  s_waitcnt vmcnt(0)
  s_branch L_uc_50234
L_end:
  s_endpgm
L_code_end:
.section .rodata,"a"
.p2align 6
.amdhsa_kernel interleave_layers__sliding_block_cached__gqa_block_cached__decode_kernel
  .amdhsa_next_free_vgpr 512
  .amdhsa_next_free_sgpr 102
  .amdhsa_accum_offset 256
  .amdhsa_group_segment_fixed_size 0
  .amdhsa_kernarg_size 104
  .amdhsa_user_sgpr_count 2
  .amdhsa_user_sgpr_kernarg_segment_ptr 1
  .amdhsa_system_sgpr_workgroup_id_x 1
  .amdhsa_float_denorm_mode_32 3
.end_amdhsa_kernel
```
